```python
import torch

def _softmax(x, axis=-1):
    return torch.softmax(x, dim=axis)
def _gelu(x):
    return torch.nn.functional.gelu(x, approximate="tanh")
def _silu(x):
    return torch.nn.functional.silu(x)
def _sigmoid(x):
    return torch.sigmoid(x)
def _layernorm(x, axis=-1, eps=1e-5):
    m = x.mean(dim=axis, keepdim=True)
    v = x.var(dim=axis, keepdim=True, unbiased=False)
    return (x - m) / torch.sqrt(v + eps)
def _scatter_add(tgt, idx, src, axis=0):
    return tgt.clone().index_add_(axis, idx, src)
def _segment_sum(src, seg, n):
    out = torch.zeros((n,) + src.shape[1:], dtype=src.dtype)
    return out.index_add_(0, seg, src)
def _pad(x, pw):
    flat = tuple(v for pair in reversed(pw) for v in pair)
    return torch.nn.functional.pad(x, flat)

kernel_name = 'recurrent_scan__linear_attn_block__geglu_ffn__prompt'

def setup_inputs():

    _w = (lambda a: (lambda t: t.to(torch.bfloat16) if t.is_floating_point() else t)(torch.as_tensor(a)))
    def _A_setup():
        B, S, D = 1, 2048, 1024
        return {
            "x": _w((lambda *s: torch.randn(*s, dtype=torch.bfloat16) * 0.05)(B, S, D)),
            "wqkv": _w((lambda *s: torch.randn(*s, dtype=torch.bfloat16) * 0.05)(D, 3 * D)),
            "wo": _w((lambda *s: torch.randn(*s, dtype=torch.bfloat16) * 0.05)(D, D)),
        }
    _A_in = _A_setup()

    def _B_setup():
        B, S, D, F = 1, 2048, 1024, 3584
        return {
            "x": _w((lambda *s: torch.randn(*s, dtype=torch.bfloat16) * 0.05)(B, S, D)),
            "w_gate": _w((lambda *s: torch.randn(*s, dtype=torch.bfloat16) * 0.05)(D, F)),
            "w_up": _w((lambda *s: torch.randn(*s, dtype=torch.bfloat16) * 0.05)(D, F)),
            "w_down": _w((lambda *s: torch.randn(*s, dtype=torch.bfloat16) * 0.05)(F, D)),
        }
    _B_in = _B_setup()

    return {
        "A_x": _A_in["x"],
        "A_wqkv": _A_in["wqkv"],
        "A_wo": _A_in["wo"],
        "B_x": _B_in["x"],
        "B_w_gate": _B_in["w_gate"],
        "B_w_up": _B_in["w_up"],
        "B_w_down": _B_in["w_down"],
    }

def reference(A_x, A_wqkv, A_wo, B_x, B_w_gate, B_w_up, B_w_down):
    def _A_ref(x, wqkv, wo):
        B, S, D = x.shape
        H = 32; Dh = D // H
        qkv = (lambda x, *d: x.permute(*d))((x @ wqkv).reshape(B, S, 3, H, Dh), 2, 0, 3, 1, 4)
        q, k, v = qkv[0], qkv[1], qkv[2]
        phi = lambda t: torch.where(t > 0, t + 1, torch.exp(t)) + 1e-6
        pq, pk = phi(q), phi(k)
        kv = torch.einsum("bhsd,bhse->bhde", pk, v)
        z = torch.einsum("bhsd->bhd", pk)
        num = torch.einsum("bhqd,bhde->bhqe", pq, kv)
        den = torch.einsum("bhqd,bhd->bhq", pq, z)[..., None] + 1e-6
        o = num / den
        return (lambda x, *d: x.permute(*d))(o, 0, 2, 1, 3).reshape(B, S, D) @ wo

    def _B_ref(x, w_gate, w_up, w_down):
        return (_gelu(x @ w_gate) * (x @ w_up)) @ w_down

    x = A_x
    xn = _layernorm(x, axis=-1)
    s = _A_ref(xn, A_wqkv, A_wo)
    g = _silu(_B_ref(xn, B_w_gate, B_w_up, B_w_down))
    return x + s * g
```

```asm
; @launch grid=(256,1,1) block=(256,1,1) lds=163840
.amdgcn_target "amdgcn-amd-amdhsa--gfx950"
.text
.macro mf d,a,b
v_mfma_f32_16x16x32_bf16 \d,\a,\b,\d
.endm
.macro dt d,a,o
ds_read_b64_tr_b16 \d,\a offset:\o
.endm
.macro dq d,a,o
ds_read_b128 \d,\a offset:\o
.endm
.p2align 12
.globl recurrent_scan__linear_attn_block__geglu_ffn__prompt_kernel
.p2align 8
.type recurrent_scan__linear_attn_block__geglu_ffn__prompt_kernel,@function
recurrent_scan__linear_attn_block__geglu_ffn__prompt_kernel:
s_cmp_ge_u32 s2, 256
s_cbranch_scc0 L_go
s_endpgm
L_go:
s_load_dwordx16 s[4:19], s[0:1], 0
s_load_dwordx4 s[92:95], s[0:1], 64
s_memrealtime s[80:81]
s_getpc_b64 s[90:91]
L_base:
s_lshr_b32 s82, s2, 3
s_lshl_b32 s83, s82, 12
v_lshrrev_b32 v14, 3, v0
v_lshl_add_u32 v14, v14, 7, s83
v_min_u32 v14, L_pcref-L_base, v14
global_load_dword v5, v14, s[90:91]
v_and_b32 v2, 63, v0
v_lshrrev_b32 v6, 6, v0
v_lshlrev_b32 v3, 4, v2
v_readfirstlane_b32 s20, v6
s_and_b32 s3, s2, 7
s_and_b32 s83, s82, 3
s_lshl_b32 s23, s3, 2
s_add_u32 s23, s23, s83
s_lshr_b32 s24, s82, 2
s_add_u32 s72, s83, s24
s_lshr_b32 s25, s23, 1
s_and_b32 s26, s23, 1
s_and_b32 s3, s25, 1
s_lshr_b32 s21, s20, 1
s_and_b32 s22, s20, 1
s_lshl_b32 s27, s25, 1
s_add_u32 s27, s27, s22
s_mul_i32 s82, s25, 448
s_cmp_eq_u32 s3, 1
s_cselect_b32 s76, 320, 0
s_cselect_b32 s77, 0xc0, 0
s_cselect_b32 s83, 64, 0x100
s_cselect_b32 s69, 0, 0x180
s_cselect_b32 s70, 0, 0x80
s_add_u32 s77, s77, s70
s_cmp_eq_u32 s26, 1
s_cselect_b32 s76, s76, s83
s_cselect_b32 s77, s77, s69
s_add_u32 s76, s76, s82
s_add_u32 s77, s77, s82
v_mov_b32 v4, 0
v_lshrrev_b32 v100, 1, v2
v_subrev_u32 v101, s72, v100
v_add_u32 v101, 1, v101
v_and_b32 v101, 3, v101
v_cmp_ge_u32 vcc, 1, v101
v_mov_b32 v103, -1
v_mov_b32 v104, 1
v_cndmask_b32 v102, 0, v103, vcc
v_cmp_eq_u32 vcc, 0, v101
v_sub_u32 v101, v100, v101
v_mov_b32 v103, 0
v_cndmask_b32 v102, v102, v104, vcc
v_subrev_u32 v104, 2, v101
v_cmp_gt_u32 vcc, 5, v104
s_nop 1
v_cndmask_b32 v103, v103, v102, vcc
v_subrev_u32 v104, 8, v101
v_cmp_gt_u32 vcc, 7, v104
s_nop 1
v_cndmask_b32 v103, v103, v102, vcc
v_add_u32 v101, s72, v100
v_and_b32 v101, 3, v101
v_and_b32 v102, 60, v100
v_or_b32 v101, v101, v102
v_add_u32 v13, v100, v103
s_and_b32 s82, s72, 1
v_and_b32 v101, 62, v100
v_cmp_eq_u32 vcc, 0, v101
v_xor_b32 v101, s82, v100
s_nop 0
v_cndmask_b32 v13, v13, v101, vcc
s_and_b32 s82, s24, 3
v_and_b32 v101, -5, v13
v_cmp_eq_u32 vcc, s82, v101
s_lshr_b32 s83, s24, 2
s_lshl_b32 s83, s83, 3
s_add_u32 s83, s83, 6
v_add_u32 v13, s83, v13
v_and_b32 v13, 15, v13
s_mov_b32 s79, vcc_lo
v_lshrrev_b32 v101, 3, v2
v_lshrrev_b32 v102, 4, v2
v_and_b32 v103, 7, v2
v_xor_b32 v104, v102, v103
v_lshlrev_b32 v104, 4, v104
s_lshl_b32 s82, s24, 19
s_lshl_b32 s83, s20, 17
s_add_u32 s82, s82, s83
v_lshl_add_u32 v104, v101, 11, v104
v_add_u32 v8, s82, v104
v_xor_b32 v9, 64, v8
v_add_u32 v9, 0x4000, v9
s_lshl_b32 s65, s20, 13
s_lshl_b32 s64, s20, 10
s_add_u32 s64, s64, 0x10000
s_lshl_b32 s82, s20, 3
v_add_u32 v101, s82, v101
v_and_b32 v102, 1, v102
s_lshl_b32 s82, s22, 1
v_or_b32 v102, s82, v102
v_lshlrev_b32 v102, 1, v102
v_xor_b32 v102, v102, v103
v_lshlrev_b32 v102, 4, v102
s_lshl_b32 s82, s25, 7
s_cmp_eq_u32 s26, 0
s_cselect_b32 s83, 2048, 0
s_add_u32 s82, s82, s83
v_mul_u32_u24 v10, 6144, v101
v_add3_u32 v10, v10, v102, s82
v_mul_u32_u24 v101, 7168, v101
v_add3_u32 v11, v101, v102, s76
v_add3_u32 v12, v101, v102, s77
s_cmp_eq_u32 s26, 1
s_cbranch_scc1 L_wide2
v_lshrrev_b32 v101, 2, v2
s_lshl_b32 s82, s22, 4
v_add_u32 v101, s82, v101
v_lshrrev_b32 v102, 5, v2
v_lshlrev_b32 v102, 1, v102
v_and_b32 v103, 3, v2
v_xor_b32 v102, v102, v103
v_lshlrev_b32 v102, 4, v102
v_mul_u32_u24 v101, 7168, v101
v_add3_u32 v12, v101, v102, s77
L_wide2:
v_readlane_b32 s68, v13, 0
s_waitcnt lgkmcnt(0)
s_mov_b32 s56, s4
s_and_b32 s57, s5, 0xffff
s_mov_b32 s58, 4194304
s_mov_b32 s59, 0x20000
s_lshl_b32 s69, s68, 7
s_add_u32 m0, s65, 0
s_nop 0
buffer_load_dwordx4 v8, s[56:59], s69 offen  lds
s_add_u32 m0, s65, 1024
s_nop 0
buffer_load_dwordx4 v9, s[56:59], s69 offen  lds
s_add_u32 m0, s65, 2048
s_add_u32 s69, s69, 0x8000
buffer_load_dwordx4 v8, s[56:59], s69 offen  lds
s_add_u32 m0, s65, 3072
s_nop 0
buffer_load_dwordx4 v9, s[56:59], s69 offen  lds
s_add_u32 m0, s65, 4096
s_add_u32 s69, s69, 0x8000
buffer_load_dwordx4 v8, s[56:59], s69 offen  lds
s_add_u32 m0, s65, 5120
s_nop 0
buffer_load_dwordx4 v9, s[56:59], s69 offen  lds
s_add_u32 m0, s65, 6144
s_add_u32 s69, s69, 0x8000
buffer_load_dwordx4 v8, s[56:59], s69 offen  lds
s_add_u32 m0, s65, 7168
s_nop 0
buffer_load_dwordx4 v9, s[56:59], s69 offen  lds
s_mov_b32 s96, s92
s_and_b32 s97, s93, 0xffff
s_mov_b32 s98, 256
s_mov_b32 s99, 0x20000
s_mov_b32 s28, s94
s_and_b32 s29, s95, 0xffff
s_mov_b32 s30, 25165824
s_mov_b32 s31, 0x20000
s_or_b32 s3, s2, s20
s_cmp_eq_u32 s3, 0
s_cbranch_scc0 L_notag
s_getreg_b32 s82, hwreg(HW_REG_XCC_ID, 0, 1)
s_lshl_b32 s82, s82, 1
s_and_b32 s3, s80, -4
s_or_b32 s3, s3, s82
s_or_b32 s3, s3, 1
v_mov_b32 v6, s3
s_mov_b64 exec, 1
buffer_store_dword v6, v4, s[96:99], 0 offen sc1
s_mov_b64 exec, -1
L_notag:
s_mov_b32 s32, s6
s_and_b32 s33, s7, 0xffff
s_mov_b32 s34, 6291456
s_mov_b32 s35, 0x20000
s_mov_b32 s36, s12
s_and_b32 s37, s13, 0xffff
s_mov_b32 s38, 7340032
s_mov_b32 s39, 0x20000
s_mov_b32 s40, s14
s_and_b32 s41, s15, 0xffff
s_mov_b32 s42, 7340032
s_mov_b32 s43, 0x20000
s_cmp_eq_u32 s21, 0
s_cselect_b32 s44, s12, s14
s_cselect_b32 s45, s13, s15
s_and_b32 s45, s45, 0xffff
s_mov_b32 s46, 7340032
s_mov_b32 s47, 0x20000
s_mov_b32 s48, s16
s_and_b32 s49, s17, 0xffff
s_mov_b32 s50, 7340032
s_mov_b32 s51, 0x20000
s_mov_b32 s52, s8
s_and_b32 s53, s9, 0xffff
s_mov_b32 s54, 2097152
s_mov_b32 s55, 0x20000
s_mov_b32 s60, s18
s_and_b32 s61, s19, 0xffff
s_mov_b32 s62, 4194304
s_mov_b32 s63, 0x20000
v_pk_mul_f32 v[24:25], 0, 0
v_pk_mul_f32 v[26:27], 0, 0
v_pk_mul_f32 v[28:29], 0, 0
v_pk_mul_f32 v[30:31], 0, 0
v_pk_mul_f32 v[32:33], 0, 0
v_pk_mul_f32 v[34:35], 0, 0
v_pk_mul_f32 v[36:37], 0, 0
v_pk_mul_f32 v[38:39], 0, 0
v_pk_mul_f32 v[40:41], 0, 0
v_pk_mul_f32 v[42:43], 0, 0
v_mov_b32 v44, 0x3f803f80
v_mov_b32 v45, 0x3f803f80
v_mov_b32 v46, 0x3f803f80
v_mov_b32 v47, 0x3f803f80
v_lshrrev_b32 v101, 4, v2
v_bfe_u32 v102, v2, 1, 3
v_xor_b32 v102, v102, v101
v_and_b32 v103, 15, v2
v_lshlrev_b32 v103, 7, v103
v_lshl_add_u32 v103, v102, 4, v103
s_lshl_b32 s82, s21, 14
v_add_u32 v16, s82, v103
v_xor_b32 v17, 64, v16
v_bfe_u32 v102, v2, 2, 2
v_lshl_add_u32 v103, v101, 3, v102
v_bfe_u32 v102, v2, 3, 2
s_lshl_b32 s82, s22, 1
v_xor_b32 v102, s82, v102
v_lshlrev_b32 v102, 5, v102
v_lshl_add_u32 v18, v103, 7, v102
v_and_b32 v102, 3, v2
v_lshl_add_u32 v18, v102, 3, v18
v_add_u32 v18, 0x10000, v18
v_xor_b32 v19, 32, v18
v_and_b32 v101, 1, v101
v_xor_b32 v101, s22, v101
v_lshlrev_b32 v101, 5, v101
v_lshl_add_u32 v20, v103, 6, v101
v_lshl_add_u32 v20, v102, 3, v20
v_add_u32 v20, 0x10000, v20
v_add_u32 v21, 40960, v18
v_add_u32 v22, 40960, v19
v_add_u32 v23, 40960, v20
s_lshl_b32 s78, s2, 2
s_add_u32 s78, s78, s20
s_lshl_b32 s83, s78, 10
v_lshrrev_b32 v101, 3, v2
v_lshl_add_u32 v15, v101, 7, s83
s_mov_b32 s89, 0
s_mul_i32 s70, s68, 393216
s_mul_i32 s71, s68, 458752
s_cmp_eq_u32 s26, 1
s_cbranch_scc1 L_typeQ
s_branch L_typeKV
.p2align 12
L_typeKV:
s_add_u32 s5, s71, 229376
s_add_u32 s4, s70, 196608
s_add_u32 m0, s64, 4096
s_nop 0
buffer_load_dwordx4 v11, s[36:39], s71 offen offset:0  lds
s_add_u32 m0, s64, 24576
s_nop 0
buffer_load_dwordx4 v11, s[36:39], s5 offen offset:0  lds
s_add_u32 m0, s64, 8192
s_nop 0
buffer_load_dwordx4 v11, s[40:43], s71 offen offset:0  lds
s_add_u32 m0, s64, 28672
s_nop 0
buffer_load_dwordx4 v11, s[40:43], s5 offen offset:0  lds
s_add_u32 m0, s64, 10240
s_nop 0
buffer_load_dwordx4 v10, s[32:35], s70 offen offset:2048  lds
s_add_u32 m0, s64, 30720
s_nop 0
buffer_load_dwordx4 v10, s[32:35], s4 offen offset:2048  lds
s_add_u32 m0, s64, 0
s_nop 0
buffer_load_dwordx4 v10, s[32:35], s70 offen offset:0  lds
s_add_u32 m0, s64, 20480
s_nop 0
buffer_load_dwordx4 v10, s[32:35], s4 offen offset:0  lds
s_getpc_b64 s[100:101]
s_add_u32 s100, s100, 40
s_addc_u32 s101, s101, 0
s_mov_b64 exec, 0
s_cmp_eq_u32 s20, 0
s_cbranch_scc1 L_iw1KV_0
s_cmp_eq_u32 s20, 1
s_cbranch_scc1 L_iw1KV_1
s_cmp_eq_u32 s20, 2
s_cbranch_scc1 L_iw1KV_2
s_branch L_iw1KV_3
s_mov_b32 s10, s71
s_mov_b32 s11, s5
v_readlane_b32 s68, v13, 2
s_nop 0
s_mul_i32 s70, s68, 393216
s_mul_i32 s71, s68, 458752
s_add_u32 s5, s71, 229376
s_add_u32 s4, s70, 196608
s_lshl_b32 s69, s68, 7
s_add_u32 m0, s64, 45056
s_nop 0
buffer_load_dwordx4 v11, s[36:39], s71 offen offset:0  lds
s_add_u32 m0, s64, 65536
s_nop 0
buffer_load_dwordx4 v11, s[36:39], s5 offen offset:0  lds
s_add_u32 m0, s64, 49152
s_nop 0
buffer_load_dwordx4 v11, s[40:43], s71 offen offset:0  lds
s_add_u32 m0, s64, 69632
s_nop 0
buffer_load_dwordx4 v11, s[40:43], s5 offen offset:0  lds
s_waitcnt vmcnt(4)
s_barrier
dt a[72:73],v18,4096
dt a[74:75],v18,4608
dt a[112:113],v18,24576
dt a[114:115],v18,25088
dq a[0:3],v16,0
dq a[32:35],v17,0
dq a[36:39],v17,2048
dq a[4:7],v16,2048
dq a[8:11],v16,4096
dq a[40:43],v17,4096
dq a[44:47],v17,6144
dq a[12:15],v16,6144
dq a[16:19],v16,8192
dq a[48:51],v17,8192
dq a[52:55],v17,10240
dq a[20:23],v16,10240
dq a[24:27],v16,12288
dq a[56:59],v17,12288
dq a[60:63],v17,14336
dq a[28:31],v16,14336
s_waitcnt lgkmcnt(14)
v_mfma_f32_16x16x32_bf16 v[48:51], a[72:75], a[0:3], 0
dt a[76:77],v19,4096
mf v[48:51],a[112:115],a[32:35]
s_waitcnt lgkmcnt(13)
dt a[78:79],v19,4608
v_mfma_f32_16x16x32_bf16 v[52:55], a[112:115], a[36:39], 0
s_add_u32 m0, s64, 51200
dt a[116:117],v19,24576
mf v[52:55],a[72:75],a[4:7]
s_waitcnt lgkmcnt(13)
dt a[118:119],v19,25088
buffer_load_dwordx4 v10, s[32:35], s70 offen offset:2048  lds
v_mfma_f32_16x16x32_bf16 v[56:59], a[72:75], a[8:11], 0
dt a[80:81],v18,8192
mf v[56:59],a[112:115],a[40:43]
s_waitcnt lgkmcnt(13)
dt a[82:83],v18,8704
v_mfma_f32_16x16x32_bf16 v[60:63], a[112:115], a[44:47], 0
s_add_u32 m0, s64, 71680
dt a[120:121],v18,28672
mf v[60:63],a[72:75],a[12:15]
s_waitcnt lgkmcnt(13)
dt a[122:123],v18,29184
buffer_load_dwordx4 v10, s[32:35], s4 offen offset:2048  lds
v_mfma_f32_16x16x32_bf16 v[64:67], a[72:75], a[16:19], 0
dt a[84:85],v19,8192
mf v[64:67],a[112:115],a[48:51]
s_waitcnt lgkmcnt(13)
dt a[86:87],v19,8704
v_mfma_f32_16x16x32_bf16 v[68:71], a[112:115], a[52:55], 0
s_add_u32 m0, s64, 40960
dt a[124:125],v19,28672
mf v[68:71],a[72:75],a[20:23]
s_waitcnt lgkmcnt(13)
dt a[126:127],v19,29184
buffer_load_dwordx4 v10, s[32:35], s70 offen offset:0  lds
v_mfma_f32_16x16x32_bf16 v[72:75], a[72:75], a[24:27], 0
dt a[88:89],v18,12288
mf v[72:75],a[112:115],a[56:59]
s_waitcnt lgkmcnt(13)
dt a[90:91],v18,12800
v_mfma_f32_16x16x32_bf16 v[76:79], a[112:115], a[60:63], 0
s_add_u32 m0, s64, 61440
dt a[128:129],v18,32768
mf v[76:79],a[72:75],a[28:31]
s_waitcnt lgkmcnt(11)
dt a[130:131],v18,33280
buffer_load_dwordx4 v10, s[32:35], s4 offen offset:0  lds
v_mfma_f32_16x16x32_bf16 v[108:111], a[76:79], a[28:31], 0
dt a[92:93],v19,12288
mf v[108:111],a[116:119],a[60:63]
dt a[94:95],v19,12800
v_mfma_f32_16x16x32_bf16 v[104:107], a[116:119], a[56:59], 0
s_add_u32 m0, s65, 32768
dt a[132:133],v19,32768
mf v[104:107],a[76:79],a[24:27]
dt a[134:135],v19,33280
buffer_load_dwordx4 v8, s[56:59], s69 offen  lds
v_mfma_f32_16x16x32_bf16 v[100:103], a[76:79], a[20:23], 0
dt a[64:65],v18,0
mf v[100:103],a[116:119],a[52:55]
dt a[66:67],v18,512
v_mfma_f32_16x16x32_bf16 v[96:99], a[116:119], a[48:51], 0
s_add_u32 m0, s65, 33792
dt a[104:105],v18,20480
mf v[96:99],a[76:79],a[16:19]
dt a[106:107],v18,20992
buffer_load_dwordx4 v9, s[56:59], s69 offen  lds
v_mfma_f32_16x16x32_bf16 v[92:95], a[76:79], a[12:15], 0
s_add_u32 s69, s69, 0x8000
dt a[68:69],v19,0
mf v[92:95],a[116:119],a[44:47]
dt a[70:71],v19,512
v_mfma_f32_16x16x32_bf16 v[88:91], a[116:119], a[40:43], 0
s_add_u32 m0, s65, 34816
dt a[108:109],v19,20480
mf v[88:91],a[76:79],a[8:11]
dt a[110:111],v19,20992
buffer_load_dwordx4 v8, s[56:59], s69 offen  lds
v_mfma_f32_16x16x32_bf16 v[84:87], a[76:79], a[4:7], 0
mf v[84:87],a[116:119],a[36:39]
v_mfma_f32_16x16x32_bf16 v[80:83], a[116:119], a[32:35], 0
s_add_u32 m0, s65, 35840
mf v[80:83],a[76:79],a[0:3]
s_waitcnt lgkmcnt(15)
buffer_load_dwordx4 v9, s[56:59], s69 offen  lds
v_mfma_f32_16x16x32_bf16 v[112:115], a[80:83], a[0:3], 0
s_add_u32 s69, s69, 0x8000
mf v[112:115],a[120:123],a[32:35]
v_mfma_f32_16x16x32_bf16 v[116:119], a[120:123], a[36:39], 0
s_add_u32 m0, s65, 36864
mf v[116:119],a[80:83],a[4:7]
buffer_load_dwordx4 v8, s[56:59], s69 offen  lds
v_mfma_f32_16x16x32_bf16 v[120:123], a[80:83], a[8:11], 0
mf v[120:123],a[120:123],a[40:43]
v_mfma_f32_16x16x32_bf16 v[124:127], a[120:123], a[44:47], 0
s_add_u32 m0, s65, 37888
mf v[124:127],a[80:83],a[12:15]
buffer_load_dwordx4 v9, s[56:59], s69 offen  lds
v_mfma_f32_16x16x32_bf16 v[128:131], a[80:83], a[16:19], 0
s_add_u32 s69, s69, 0x8000
mf v[128:131],a[120:123],a[48:51]
v_mfma_f32_16x16x32_bf16 v[132:135], a[120:123], a[52:55], 0
s_add_u32 m0, s65, 38912
mf v[132:135],a[80:83],a[20:23]
buffer_load_dwordx4 v8, s[56:59], s69 offen  lds
v_mfma_f32_16x16x32_bf16 v[136:139], a[80:83], a[24:27], 0
mf v[136:139],a[120:123],a[56:59]
v_mfma_f32_16x16x32_bf16 v[140:143], a[120:123], a[60:63], 0
s_add_u32 m0, s65, 39936
mf v[140:143],a[80:83],a[28:31]
s_waitcnt lgkmcnt(15)
buffer_load_dwordx4 v9, s[56:59], s69 offen  lds
v_mfma_f32_16x16x32_bf16 v[172:175], a[84:87], a[28:31], 0
mf v[172:175],a[124:127],a[60:63]
v_mfma_f32_16x16x32_bf16 v[168:171], a[124:127], a[56:59], 0
s_add_u32 m0, s64, 16384
mf v[168:171],a[84:87],a[24:27]
buffer_load_dwordx4 v12, s[44:47], s10 offen offset:0  lds
v_mfma_f32_16x16x32_bf16 v[164:167], a[84:87], a[20:23], 0
mf v[164:167],a[124:127],a[52:55]
v_mfma_f32_16x16x32_bf16 v[160:163], a[124:127], a[48:51], 0
s_add_u32 m0, s64, 36864
mf v[160:163],a[84:87],a[16:19]
buffer_load_dwordx4 v12, s[44:47], s11 offen offset:0  lds
v_mfma_f32_16x16x32_bf16 v[156:159], a[84:87], a[12:15], 0
mf v[156:159],a[124:127],a[44:47]
v_mfma_f32_16x16x32_bf16 v[152:155], a[124:127], a[40:43], 0
s_add_u32 m0, s64, 57344
mf v[152:155],a[84:87],a[8:11]
buffer_load_dwordx4 v12, s[44:47], s71 offen offset:0  lds
v_mfma_f32_16x16x32_bf16 v[148:151], a[84:87], a[4:7], 0
mf v[148:151],a[124:127],a[36:39]
v_mfma_f32_16x16x32_bf16 v[144:147], a[124:127], a[32:35], 0
s_add_u32 m0, s64, 77824
mf v[144:147],a[84:87],a[0:3]
buffer_load_dwordx4 v12, s[44:47], s5 offen offset:0  lds
s_waitcnt vmcnt(12) lgkmcnt(0)
s_barrier
s_add_u32 s100, s90, L_hcKV0-L_base
s_addc_u32 s101, s91, 0
s_bitcmp1_b32 s79, 0
s_cbranch_scc1 L_csA
L_hcKV0:
v_mfma_f32_16x16x32_bf16 v[176:179], a[0:3], a[88:91], 0
dt a[72:73],v21,4096
v_readlane_b32 s68, v13, 4
mf v[176:179],a[32:35],a[128:131]
s_mul_i32 s70, s68, 393216
dt a[74:75],v21,4608
v_mfma_f32_16x16x32_bf16 v[180:183], a[36:39], a[128:131], 0
s_mul_i32 s71, s68, 458752
dt a[112:113],v21,24576
mf v[180:183],a[4:7],a[88:91]
s_add_u32 s5, s71, 229376
dt a[114:115],v21,25088
v_mfma_f32_16x16x32_bf16 v[184:187], a[8:11], a[88:91], 0
s_add_u32 m0, s64, 4096
dt a[76:77],v22,4096
mf v[184:187],a[40:43],a[128:131]
dt a[78:79],v22,4608
buffer_load_dwordx4 v11, s[36:39], s71 offen offset:0  lds
v_mfma_f32_16x16x32_bf16 v[188:191], a[44:47], a[128:131], 0
s_add_u32 s4, s70, 196608
dt a[116:117],v22,24576
mf v[188:191],a[12:15],a[88:91]
dt a[118:119],v22,25088
v_mfma_f32_16x16x32_bf16 v[192:195], a[16:19], a[88:91], 0
s_lshl_b32 s69, s68, 7
dt a[80:81],v21,8192
mf v[192:195],a[48:51],a[128:131]
dt a[82:83],v21,8704
v_mfma_f32_16x16x32_bf16 v[196:199], a[52:55], a[128:131], 0
dt a[120:121],v21,28672
mf v[196:199],a[20:23],a[88:91]
dt a[122:123],v21,29184
v_mfma_f32_16x16x32_bf16 v[200:203], a[24:27], a[88:91], 0
s_add_u32 m0, s64, 24576
mf v[200:203],a[56:59],a[128:131]
buffer_load_dwordx4 v11, s[36:39], s5 offen offset:0  lds
v_mfma_f32_16x16x32_bf16 v[204:207], a[60:63], a[128:131], 0
mf v[204:207],a[28:31],a[88:91]
v_mfma_f32_16x16x32_bf16 v[236:239], a[28:31], a[92:95], 0
dt a[84:85],v22,8192
mf v[236:239],a[60:63],a[132:135]
dt a[86:87],v22,8704
v_mfma_f32_16x16x32_bf16 v[232:235], a[56:59], a[132:135], 0
s_add_u32 m0, s64, 8192
dt a[124:125],v22,28672
mf v[232:235],a[24:27],a[92:95]
dt a[126:127],v22,29184
buffer_load_dwordx4 v11, s[40:43], s71 offen offset:0  lds
v_mfma_f32_16x16x32_bf16 v[228:231], a[20:23], a[92:95], 0
dt a[88:89],v21,12288
mf v[228:231],a[52:55],a[132:135]
dt a[90:91],v21,12800
v_mfma_f32_16x16x32_bf16 v[224:227], a[48:51], a[132:135], 0
s_add_u32 m0, s64, 28672
dt a[128:129],v21,32768
mf v[224:227],a[16:19],a[92:95]
dt a[130:131],v21,33280
buffer_load_dwordx4 v11, s[40:43], s5 offen offset:0  lds
v_mfma_f32_16x16x32_bf16 v[220:223], a[12:15], a[92:95], 0
mf v[220:223],a[44:47],a[132:135]
v_mfma_f32_16x16x32_bf16 v[216:219], a[40:43], a[132:135], 0
s_add_u32 m0, s64, 10240
mf v[216:219],a[8:11],a[92:95]
buffer_load_dwordx4 v10, s[32:35], s70 offen offset:2048  lds
v_mfma_f32_16x16x32_bf16 v[212:215], a[4:7], a[92:95], 0
mf v[212:215],a[36:39],a[132:135]
v_mfma_f32_16x16x32_bf16 v[208:211], a[32:35], a[132:135], 0
s_add_u32 m0, s64, 30720
mf v[208:211],a[0:3],a[92:95]
buffer_load_dwordx4 v10, s[32:35], s4 offen offset:2048  lds
v_mfma_f32_16x16x32_bf16 a[144:147], a[0:3], a[64:67], 0
dt a[92:93],v22,12288
mf a[144:147],a[32:35],a[104:107]
dt a[94:95],v22,12800
v_mfma_f32_16x16x32_bf16 a[148:151], a[36:39], a[104:107], 0
dt a[132:133],v22,32768
mf a[148:151],a[4:7],a[64:67]
dt a[134:135],v22,33280
v_mfma_f32_16x16x32_bf16 a[152:155], a[8:11], a[64:67], 0
s_add_u32 m0, s64, 0
mf a[152:155],a[40:43],a[104:107]
buffer_load_dwordx4 v10, s[32:35], s70 offen offset:0  lds
v_mfma_f32_16x16x32_bf16 a[156:159], a[44:47], a[104:107], 0
mf a[156:159],a[12:15],a[64:67]
v_mfma_f32_16x16x32_bf16 a[160:163], a[16:19], a[64:67], 0
mf a[160:163],a[48:51],a[104:107]
v_mfma_f32_16x16x32_bf16 a[164:167], a[52:55], a[104:107], 0
mf a[164:167],a[20:23],a[64:67]
v_mfma_f32_16x16x32_bf16 a[168:171], a[24:27], a[64:67], 0
s_add_u32 m0, s64, 20480
mf a[168:171],a[56:59],a[104:107]
buffer_load_dwordx4 v10, s[32:35], s4 offen offset:0  lds
v_mfma_f32_16x16x32_bf16 a[172:175], a[60:63], a[104:107], 0
mf a[172:175],a[28:31],a[64:67]
s_waitcnt vmcnt(8) lgkmcnt(0)
s_barrier
v_mfma_f32_16x16x32_bf16 a[204:207], a[28:31], a[68:71], 0
dt a[96:97],v20,16384
mf a[204:207],a[60:63],a[108:111]
dt a[98:99],v20,16640
v_mfma_f32_16x16x32_bf16 a[200:203], a[56:59], a[108:111], 0
dt a[136:137],v20,36864
mf a[200:203],a[24:27],a[68:71]
dt a[138:139],v20,37120
v_mfma_f32_16x16x32_bf16 a[196:199], a[20:23], a[68:71], 0
s_add_u32 m0, s65, 0
dt a[100:101],v20,18432
mf a[196:199],a[52:55],a[108:111]
dt a[102:103],v20,18688
buffer_load_dwordx4 v8, s[56:59], s69 offen  lds
v_mfma_f32_16x16x32_bf16 a[192:195], a[48:51], a[108:111], 0
dt a[140:141],v20,38912
mf a[192:195],a[16:19],a[68:71]
dt a[142:143],v20,39168
v_mfma_f32_16x16x32_bf16 a[188:191], a[12:15], a[68:71], 0
dt a[64:65],v21,0
mf a[188:191],a[44:47],a[108:111]
dt a[66:67],v21,512
v_mfma_f32_16x16x32_bf16 a[184:187], a[40:43], a[108:111], 0
dt a[104:105],v21,20480
mf a[184:187],a[8:11],a[68:71]
dt a[106:107],v21,20992
v_mfma_f32_16x16x32_bf16 a[180:183], a[4:7], a[68:71], 0
s_add_u32 m0, s65, 1024
mf a[180:183],a[36:39],a[108:111]
buffer_load_dwordx4 v9, s[56:59], s69 offen  lds
v_mfma_f32_16x16x32_bf16 a[176:179], a[32:35], a[108:111], 0
mf a[176:179],a[0:3],a[68:71]
s_waitcnt lgkmcnt(4)
s_add_u32 s100, s90, L_hcKV1-L_base
s_addc_u32 s101, s91, 0
s_bitcmp1_b32 s79, 0
s_cbranch_scc1 L_csB
L_hcKV1:
v_mfma_f32_16x16x32_bf16 v[240:243], a[96:99], a[0:3], 0
s_add_u32 s69, s69, 0x8000
dt a[68:69],v22,0
mf v[240:243],a[136:139],a[32:35]
dt a[70:71],v22,512
v_mfma_f32_16x16x32_bf16 v[244:247], a[136:139], a[36:39], 0
s_add_u32 m0, s65, 2048
dt a[108:109],v22,20480
mf v[244:247],a[96:99],a[4:7]
dt a[110:111],v22,20992
buffer_load_dwordx4 v8, s[56:59], s69 offen  lds
v_mfma_f32_16x16x32_bf16 a[208:211], a[96:99], a[8:11], 0
mf a[208:211],a[136:139],a[40:43]
v_mfma_f32_16x16x32_bf16 a[212:215], a[136:139], a[44:47], 0
mf a[212:215],a[96:99],a[12:15]
v_mfma_f32_16x16x32_bf16 a[216:219], a[96:99], a[16:19], 0
s_add_u32 m0, s65, 3072
mf a[216:219],a[136:139],a[48:51]
buffer_load_dwordx4 v9, s[56:59], s69 offen  lds
v_mfma_f32_16x16x32_bf16 a[220:223], a[136:139], a[52:55], 0
s_add_u32 s69, s69, 0x8000
mf a[220:223],a[96:99],a[20:23]
v_mfma_f32_16x16x32_bf16 a[224:227], a[96:99], a[24:27], 0
s_add_u32 m0, s65, 4096
mf a[224:227],a[136:139],a[56:59]
buffer_load_dwordx4 v8, s[56:59], s69 offen  lds
v_mfma_f32_16x16x32_bf16 a[228:231], a[136:139], a[60:63], 0
mf a[228:231],a[96:99],a[28:31]
s_waitcnt lgkmcnt(0)
s_barrier
v_mfma_f32_16x16x32_bf16 v[248:251], a[100:103], a[0:3], 0
dq a[0:3],v16,32768
mf v[248:251],a[140:143],a[32:35]
dq a[32:35],v17,32768
v_mfma_f32_16x16x32_bf16 v[252:255], a[140:143], a[36:39], 0
dq a[36:39],v17,34816
mf v[252:255],a[100:103],a[4:7]
dq a[4:7],v16,34816
v_mfma_f32_16x16x32_bf16 a[232:235], a[100:103], a[8:11], 0
s_add_u32 m0, s65, 5120
dq a[8:11],v16,36864
mf a[232:235],a[140:143],a[40:43]
dq a[40:43],v17,36864
buffer_load_dwordx4 v9, s[56:59], s69 offen  lds
v_mfma_f32_16x16x32_bf16 a[236:239], a[140:143], a[44:47], 0
dq a[44:47],v17,38912
mf a[236:239],a[100:103],a[12:15]
dq a[12:15],v16,38912
v_mfma_f32_16x16x32_bf16 a[240:243], a[100:103], a[16:19], 0
dq a[16:19],v16,40960
mf a[240:243],a[140:143],a[48:51]
dq a[48:51],v17,40960
v_mfma_f32_16x16x32_bf16 a[244:247], a[140:143], a[52:55], 0
s_add_u32 s69, s69, 0x8000
dq a[52:55],v17,43008
mf a[244:247],a[100:103],a[20:23]
dq a[20:23],v16,43008
v_mfma_f32_16x16x32_bf16 a[248:251], a[100:103], a[24:27], 0
s_add_u32 m0, s65, 6144
dq a[24:27],v16,45056
mf a[248:251],a[140:143],a[56:59]
dq a[56:59],v17,45056
buffer_load_dwordx4 v8, s[56:59], s69 offen  lds
v_mfma_f32_16x16x32_bf16 a[252:255], a[140:143], a[60:63], 0
dq a[60:63],v17,47104
mf a[252:255],a[100:103],a[28:31]
s_waitcnt lgkmcnt(13)
dq a[28:31],v16,47104
mf v[48:51],a[72:75],a[0:3]
dt a[96:97],v23,16384
mf v[48:51],a[112:115],a[32:35]
s_waitcnt lgkmcnt(13)
dt a[98:99],v23,16640
mf v[52:55],a[112:115],a[36:39]
s_add_u32 m0, s65, 7168
dt a[136:137],v23,36864
mf v[52:55],a[72:75],a[4:7]
s_waitcnt lgkmcnt(13)
dt a[138:139],v23,37120
buffer_load_dwordx4 v9, s[56:59], s69 offen  lds
mf v[56:59],a[72:75],a[8:11]
dt a[100:101],v23,18432
mf v[56:59],a[112:115],a[40:43]
s_waitcnt lgkmcnt(13)
dt a[102:103],v23,18688
mf v[60:63],a[112:115],a[44:47]
dt a[140:141],v23,38912
mf v[60:63],a[72:75],a[12:15]
s_waitcnt lgkmcnt(13)
dt a[142:143],v23,39168
mf v[64:67],a[72:75],a[16:19]
s_add_u32 m0, s64, 16384
mf v[64:67],a[112:115],a[48:51]
s_waitcnt lgkmcnt(12)
buffer_load_dwordx4 v12, s[44:47], s71 offen offset:0  lds
mf v[68:71],a[112:115],a[52:55]
mf v[68:71],a[72:75],a[20:23]
s_waitcnt lgkmcnt(10)
mf v[72:75],a[72:75],a[24:27]
s_add_u32 m0, s64, 36864
mf v[72:75],a[112:115],a[56:59]
s_waitcnt lgkmcnt(8)
buffer_load_dwordx4 v12, s[44:47], s5 offen offset:0  lds
mf v[76:79],a[112:115],a[60:63]
mf v[76:79],a[72:75],a[28:31]
s_add_u32 s100, s90, L_csKV2_ret-L_base
s_addc_u32 s101, s91, 0
s_mov_b32 s66, 6
s_bitcmp1_b32 s79, 2
s_waitcnt vmcnt(12) lgkmcnt(0)
s_barrier
s_cbranch_scc1 L_cs
L_csKV2_ret:
L_g1loopKV:
mf v[108:111],a[76:79],a[28:31]
v_readlane_b32 s68, v13, s66
mf v[108:111],a[116:119],a[60:63]
dt a[72:73],v18,4096
mf v[104:107],a[116:119],a[56:59]
s_mul_i32 s70, s68, 393216
mf v[104:107],a[76:79],a[24:27]
s_mul_i32 s71, s68, 458752
dt a[74:75],v18,4608
mf v[100:103],a[76:79],a[20:23]
s_add_u32 s5, s71, 229376
mf v[100:103],a[116:119],a[52:55]
s_add_u32 s4, s70, 196608
dt a[112:113],v18,24576
mf v[96:99],a[116:119],a[48:51]
mf v[96:99],a[76:79],a[16:19]
dt a[114:115],v18,25088
mf v[92:95],a[76:79],a[12:15]
s_add_u32 m0, s64, 45056
mf v[92:95],a[116:119],a[44:47]
buffer_load_dwordx4 v11, s[36:39], s71 offen offset:0  lds
mf v[88:91],a[116:119],a[40:43]
mf v[88:91],a[76:79],a[8:11]
mf v[84:87],a[76:79],a[4:7]
s_add_u32 m0, s64, 65536
mf v[84:87],a[116:119],a[36:39]
buffer_load_dwordx4 v11, s[36:39], s5 offen offset:0  lds
mf v[80:83],a[116:119],a[32:35]
mf v[80:83],a[76:79],a[0:3]
mf v[112:115],a[80:83],a[0:3]
mf v[112:115],a[120:123],a[32:35]
dt a[76:77],v19,4096
mf v[116:119],a[120:123],a[36:39]
mf v[116:119],a[80:83],a[4:7]
dt a[78:79],v19,4608
mf v[120:123],a[80:83],a[8:11]
mf v[120:123],a[120:123],a[40:43]
dt a[116:117],v19,24576
mf v[124:127],a[120:123],a[44:47]
mf v[124:127],a[80:83],a[12:15]
dt a[118:119],v19,25088
mf v[128:131],a[80:83],a[16:19]
s_add_u32 m0, s64, 49152
mf v[128:131],a[120:123],a[48:51]
buffer_load_dwordx4 v11, s[40:43], s71 offen offset:0  lds
mf v[132:135],a[120:123],a[52:55]
mf v[132:135],a[80:83],a[20:23]
mf v[136:139],a[80:83],a[24:27]
s_add_u32 m0, s64, 69632
mf v[136:139],a[120:123],a[56:59]
buffer_load_dwordx4 v11, s[40:43], s5 offen offset:0  lds
mf v[140:143],a[120:123],a[60:63]
mf v[140:143],a[80:83],a[28:31]
mf v[172:175],a[84:87],a[28:31]
mf v[172:175],a[124:127],a[60:63]
dt a[80:81],v18,8192
mf v[168:171],a[124:127],a[56:59]
mf v[168:171],a[84:87],a[24:27]
dt a[82:83],v18,8704
mf v[164:167],a[84:87],a[20:23]
mf v[164:167],a[124:127],a[52:55]
dt a[120:121],v18,28672
mf v[160:163],a[124:127],a[48:51]
mf v[160:163],a[84:87],a[16:19]
dt a[122:123],v18,29184
mf v[156:159],a[84:87],a[12:15]
s_add_u32 m0, s64, 51200
mf v[156:159],a[124:127],a[44:47]
buffer_load_dwordx4 v10, s[32:35], s70 offen offset:2048  lds
mf v[152:155],a[124:127],a[40:43]
mf v[152:155],a[84:87],a[8:11]
mf v[148:151],a[84:87],a[4:7]
s_add_u32 m0, s64, 71680
mf v[148:151],a[124:127],a[36:39]
buffer_load_dwordx4 v10, s[32:35], s4 offen offset:2048  lds
mf v[144:147],a[124:127],a[32:35]
mf v[144:147],a[84:87],a[0:3]
mf v[176:179],a[0:3],a[88:91]
mf v[176:179],a[32:35],a[128:131]
L_iw1KV_0:
L_stub0:
s_cbranch_execz L_stub4
dt a[84:85],v19,8192
mf v[180:183],a[36:39],a[128:131]
mf v[180:183],a[4:7],a[88:91]
dt a[86:87],v19,8704
mf v[184:187],a[8:11],a[88:91]
mf v[184:187],a[40:43],a[128:131]
dt a[124:125],v19,28672
mf v[188:191],a[44:47],a[128:131]
mf v[188:191],a[12:15],a[88:91]
dt a[126:127],v19,29184
mf v[192:195],a[16:19],a[88:91]
s_add_u32 m0, s64, 40960
mf v[192:195],a[48:51],a[128:131]
buffer_load_dwordx4 v10, s[32:35], s70 offen offset:0  lds
mf v[196:199],a[52:55],a[128:131]
mf v[196:199],a[20:23],a[88:91]
mf v[200:203],a[24:27],a[88:91]
s_add_u32 m0, s64, 61440
mf v[200:203],a[56:59],a[128:131]
buffer_load_dwordx4 v10, s[32:35], s4 offen offset:0  lds
mf v[204:207],a[60:63],a[128:131]
mf v[204:207],a[28:31],a[88:91]
mf v[236:239],a[28:31],a[92:95]
mf v[236:239],a[60:63],a[132:135]
dt a[88:89],v18,12288
mf v[232:235],a[56:59],a[132:135]
mf v[232:235],a[24:27],a[92:95]
dt a[90:91],v18,12800
mf v[228:231],a[20:23],a[92:95]
mf v[228:231],a[52:55],a[132:135]
dt a[128:129],v18,32768
mf v[224:227],a[48:51],a[132:135]
mf v[224:227],a[16:19],a[92:95]
dt a[130:131],v18,33280
mf v[220:223],a[12:15],a[92:95]
s_add_u32 m0, s64, 57344
mf v[220:223],a[44:47],a[132:135]
buffer_load_dwordx4 v12, s[44:47], s71 offen offset:0  lds
mf v[216:219],a[40:43],a[132:135]
mf v[216:219],a[8:11],a[92:95]
mf v[212:215],a[4:7],a[92:95]
s_add_u32 m0, s64, 77824
mf v[212:215],a[36:39],a[132:135]
buffer_load_dwordx4 v12, s[44:47], s5 offen offset:0  lds
mf v[208:211],a[32:35],a[132:135]
mf v[208:211],a[0:3],a[92:95]
s_waitcnt vmcnt(10) lgkmcnt(0)
s_barrier
mf a[144:147],a[0:3],a[64:67]
s_lshl_b32 s69, s68, 7
mf a[144:147],a[32:35],a[104:107]
dt a[92:93],v19,12288
mf a[148:151],a[36:39],a[104:107]
mf a[148:151],a[4:7],a[64:67]
dt a[94:95],v19,12800
mf a[152:155],a[8:11],a[64:67]
mf a[152:155],a[40:43],a[104:107]
dt a[132:133],v19,32768
mf a[156:159],a[44:47],a[104:107]
mf a[156:159],a[12:15],a[64:67]
dt a[134:135],v19,33280
mf a[160:163],a[16:19],a[64:67]
s_add_u32 s66, s66, 2
s_add_u32 m0, s65, 32768
mf a[160:163],a[48:51],a[104:107]
buffer_load_dwordx4 v8, s[56:59], s69 offen  lds
mf a[164:167],a[52:55],a[104:107]
mf a[164:167],a[20:23],a[64:67]
mf a[168:171],a[24:27],a[64:67]
mf a[168:171],a[56:59],a[104:107]
mf a[172:175],a[60:63],a[104:107]
s_add_u32 m0, s65, 33792
mf a[172:175],a[28:31],a[64:67]
buffer_load_dwordx4 v9, s[56:59], s69 offen  lds
mf a[204:207],a[28:31],a[68:71]
s_sub_u32 s67, s66, 4
mf a[204:207],a[60:63],a[108:111]
dt a[64:65],v18,0
mf a[200:203],a[56:59],a[108:111]
mf a[200:203],a[24:27],a[68:71]
dt a[66:67],v18,512
mf a[196:199],a[20:23],a[68:71]
mf a[196:199],a[52:55],a[108:111]
dt a[104:105],v18,20480
mf a[192:195],a[48:51],a[108:111]
s_add_u32 s69, s69, 0x8000
mf a[192:195],a[16:19],a[68:71]
dt a[106:107],v18,20992
mf a[188:191],a[12:15],a[68:71]
s_add_u32 m0, s65, 34816
mf a[188:191],a[44:47],a[108:111]
buffer_load_dwordx4 v8, s[56:59], s69 offen  lds
mf a[184:187],a[40:43],a[108:111]
mf a[184:187],a[8:11],a[68:71]
mf a[180:183],a[4:7],a[68:71]
mf a[180:183],a[36:39],a[108:111]
mf a[176:179],a[32:35],a[108:111]
s_add_u32 m0, s65, 35840
mf a[176:179],a[0:3],a[68:71]
buffer_load_dwordx4 v9, s[56:59], s69 offen  lds
mf v[240:243],a[96:99],a[0:3]
mf v[240:243],a[136:139],a[32:35]
dt a[68:69],v19,0
mf v[244:247],a[136:139],a[36:39]
mf v[244:247],a[96:99],a[4:7]
dt a[70:71],v19,512
mf a[208:211],a[96:99],a[8:11]
mf a[208:211],a[136:139],a[40:43]
dt a[108:109],v19,20480
mf a[212:215],a[136:139],a[44:47]
s_add_u32 s69, s69, 0x8000
mf a[212:215],a[96:99],a[12:15]
dt a[110:111],v19,20992
mf a[216:219],a[96:99],a[16:19]
s_add_u32 m0, s65, 36864
mf a[216:219],a[136:139],a[48:51]
buffer_load_dwordx4 v8, s[56:59], s69 offen  lds
mf a[220:223],a[136:139],a[52:55]
mf a[220:223],a[96:99],a[20:23]
mf a[224:227],a[96:99],a[24:27]
mf a[224:227],a[136:139],a[56:59]
mf a[228:231],a[136:139],a[60:63]
s_add_u32 m0, s65, 37888
mf a[228:231],a[96:99],a[28:31]
buffer_load_dwordx4 v9, s[56:59], s69 offen  lds
mf v[248:251],a[100:103],a[0:3]
dq a[0:3],v16,0
mf v[248:251],a[140:143],a[32:35]
dq a[32:35],v17,0
mf v[252:255],a[140:143],a[36:39]
dq a[36:39],v17,2048
mf v[252:255],a[100:103],a[4:7]
dq a[4:7],v16,2048
mf a[232:235],a[100:103],a[8:11]
dq a[8:11],v16,4096
mf a[232:235],a[140:143],a[40:43]
dq a[40:43],v17,4096
mf a[236:239],a[140:143],a[44:47]
dq a[44:47],v17,6144
mf a[236:239],a[100:103],a[12:15]
dq a[12:15],v16,6144
mf a[240:243],a[100:103],a[16:19]
dq a[16:19],v16,8192
mf a[240:243],a[140:143],a[48:51]
dq a[48:51],v17,8192
mf a[244:247],a[140:143],a[52:55]
dq a[52:55],v17,10240
mf a[244:247],a[100:103],a[20:23]
dq a[20:23],v16,10240
mf a[248:251],a[100:103],a[24:27]
dq a[24:27],v16,12288
mf a[248:251],a[140:143],a[56:59]
dq a[56:59],v17,12288
mf a[252:255],a[140:143],a[60:63]
s_add_u32 s69, s69, 0x8000
dq a[60:63],v17,14336
mf a[252:255],a[100:103],a[28:31]
s_waitcnt lgkmcnt(13)
dq a[28:31],v16,14336
mf v[48:51],a[72:75],a[0:3]
s_add_u32 m0, s65, 38912
dt a[96:97],v20,16384
mf v[48:51],a[112:115],a[32:35]
s_waitcnt lgkmcnt(13)
dt a[98:99],v20,16640
buffer_load_dwordx4 v8, s[56:59], s69 offen  lds
mf v[52:55],a[112:115],a[36:39]
dt a[136:137],v20,36864
mf v[52:55],a[72:75],a[4:7]
s_waitcnt lgkmcnt(13)
dt a[138:139],v20,37120
mf v[56:59],a[72:75],a[8:11]
dt a[100:101],v20,18432
mf v[56:59],a[112:115],a[40:43]
s_waitcnt lgkmcnt(13)
dt a[102:103],v20,18688
mf v[60:63],a[112:115],a[44:47]
dt a[140:141],v20,38912
mf v[60:63],a[72:75],a[12:15]
s_waitcnt lgkmcnt(13)
dt a[142:143],v20,39168
mf v[64:67],a[72:75],a[16:19]
s_add_u32 m0, s65, 39936
mf v[64:67],a[112:115],a[48:51]
s_waitcnt lgkmcnt(12)
buffer_load_dwordx4 v9, s[56:59], s69 offen  lds
mf v[68:71],a[112:115],a[52:55]
s_add_u32 s100, s90, L_csKV4_ret-L_base
mf v[68:71],a[72:75],a[20:23]
s_waitcnt lgkmcnt(10)
mf v[72:75],a[72:75],a[24:27]
s_addc_u32 s101, s91, 0
mf v[72:75],a[112:115],a[56:59]
s_waitcnt lgkmcnt(8)
mf v[76:79],a[112:115],a[60:63]
s_bitcmp1_b32 s79, s67
mf v[76:79],a[72:75],a[28:31]
s_waitcnt vmcnt(12) lgkmcnt(0)
s_barrier
s_cbranch_scc1 L_cs
L_csKV4_ret:
mf v[108:111],a[76:79],a[28:31]
v_readlane_b32 s68, v13, s66
mf v[108:111],a[116:119],a[60:63]
dt a[72:73],v21,4096
mf v[104:107],a[116:119],a[56:59]
s_mul_i32 s70, s68, 393216
mf v[104:107],a[76:79],a[24:27]
s_mul_i32 s71, s68, 458752
dt a[74:75],v21,4608
mf v[100:103],a[76:79],a[20:23]
s_add_u32 s5, s71, 229376
mf v[100:103],a[116:119],a[52:55]
s_add_u32 s4, s70, 196608
dt a[112:113],v21,24576
mf v[96:99],a[116:119],a[48:51]
mf v[96:99],a[76:79],a[16:19]
dt a[114:115],v21,25088
mf v[92:95],a[76:79],a[12:15]
s_add_u32 m0, s64, 4096
mf v[92:95],a[116:119],a[44:47]
buffer_load_dwordx4 v11, s[36:39], s71 offen offset:0  lds
mf v[88:91],a[116:119],a[40:43]
mf v[88:91],a[76:79],a[8:11]
mf v[84:87],a[76:79],a[4:7]
s_add_u32 m0, s64, 24576
mf v[84:87],a[116:119],a[36:39]
buffer_load_dwordx4 v11, s[36:39], s5 offen offset:0  lds
mf v[80:83],a[116:119],a[32:35]
mf v[80:83],a[76:79],a[0:3]
mf v[112:115],a[80:83],a[0:3]
mf v[112:115],a[120:123],a[32:35]
dt a[76:77],v22,4096
mf v[116:119],a[120:123],a[36:39]
mf v[116:119],a[80:83],a[4:7]
dt a[78:79],v22,4608
mf v[120:123],a[80:83],a[8:11]
mf v[120:123],a[120:123],a[40:43]
dt a[116:117],v22,24576
mf v[124:127],a[120:123],a[44:47]
mf v[124:127],a[80:83],a[12:15]
dt a[118:119],v22,25088
mf v[128:131],a[80:83],a[16:19]
s_add_u32 m0, s64, 8192
mf v[128:131],a[120:123],a[48:51]
buffer_load_dwordx4 v11, s[40:43], s71 offen offset:0  lds
mf v[132:135],a[120:123],a[52:55]
mf v[132:135],a[80:83],a[20:23]
mf v[136:139],a[80:83],a[24:27]
s_add_u32 m0, s64, 28672
mf v[136:139],a[120:123],a[56:59]
buffer_load_dwordx4 v11, s[40:43], s5 offen offset:0  lds
mf v[140:143],a[120:123],a[60:63]
mf v[140:143],a[80:83],a[28:31]
mf v[172:175],a[84:87],a[28:31]
mf v[172:175],a[124:127],a[60:63]
dt a[80:81],v21,8192
mf v[168:171],a[124:127],a[56:59]
mf v[168:171],a[84:87],a[24:27]
dt a[82:83],v21,8704
mf v[164:167],a[84:87],a[20:23]
mf v[164:167],a[124:127],a[52:55]
dt a[120:121],v21,28672
mf v[160:163],a[124:127],a[48:51]
mf v[160:163],a[84:87],a[16:19]
dt a[122:123],v21,29184
mf v[156:159],a[84:87],a[12:15]
s_add_u32 m0, s64, 10240
mf v[156:159],a[124:127],a[44:47]
buffer_load_dwordx4 v10, s[32:35], s70 offen offset:2048  lds
mf v[152:155],a[124:127],a[40:43]
mf v[152:155],a[84:87],a[8:11]
mf v[148:151],a[84:87],a[4:7]
s_add_u32 m0, s64, 30720
mf v[148:151],a[124:127],a[36:39]
buffer_load_dwordx4 v10, s[32:35], s4 offen offset:2048  lds
mf v[144:147],a[124:127],a[32:35]
mf v[144:147],a[84:87],a[0:3]
mf v[176:179],a[0:3],a[88:91]
mf v[176:179],a[32:35],a[128:131]
dt a[84:85],v22,8192
mf v[180:183],a[36:39],a[128:131]
mf v[180:183],a[4:7],a[88:91]
dt a[86:87],v22,8704
mf v[184:187],a[8:11],a[88:91]
mf v[184:187],a[40:43],a[128:131]
dt a[124:125],v22,28672
mf v[188:191],a[44:47],a[128:131]
mf v[188:191],a[12:15],a[88:91]
dt a[126:127],v22,29184
mf v[192:195],a[16:19],a[88:91]
s_add_u32 m0, s64, 0
mf v[192:195],a[48:51],a[128:131]
buffer_load_dwordx4 v10, s[32:35], s70 offen offset:0  lds
mf v[196:199],a[52:55],a[128:131]
mf v[196:199],a[20:23],a[88:91]
mf v[200:203],a[24:27],a[88:91]
s_add_u32 m0, s64, 20480
mf v[200:203],a[56:59],a[128:131]
buffer_load_dwordx4 v10, s[32:35], s4 offen offset:0  lds
mf v[204:207],a[60:63],a[128:131]
mf v[204:207],a[28:31],a[88:91]
mf v[236:239],a[28:31],a[92:95]
mf v[236:239],a[60:63],a[132:135]
dt a[88:89],v21,12288
mf v[232:235],a[56:59],a[132:135]
mf v[232:235],a[24:27],a[92:95]
dt a[90:91],v21,12800
mf v[228:231],a[20:23],a[92:95]
mf v[228:231],a[52:55],a[132:135]
dt a[128:129],v21,32768
mf v[224:227],a[48:51],a[132:135]
mf v[224:227],a[16:19],a[92:95]
dt a[130:131],v21,33280
mf v[220:223],a[12:15],a[92:95]
s_add_u32 m0, s64, 16384
mf v[220:223],a[44:47],a[132:135]
buffer_load_dwordx4 v12, s[44:47], s71 offen offset:0  lds
mf v[216:219],a[40:43],a[132:135]
mf v[216:219],a[8:11],a[92:95]
mf v[212:215],a[4:7],a[92:95]
s_add_u32 m0, s64, 36864
mf v[212:215],a[36:39],a[132:135]
buffer_load_dwordx4 v12, s[44:47], s5 offen offset:0  lds
mf v[208:211],a[32:35],a[132:135]
mf v[208:211],a[0:3],a[92:95]
s_waitcnt vmcnt(10) lgkmcnt(0)
s_barrier
mf a[144:147],a[0:3],a[64:67]
s_lshl_b32 s69, s68, 7
mf a[144:147],a[32:35],a[104:107]
dt a[92:93],v22,12288
mf a[148:151],a[36:39],a[104:107]
mf a[148:151],a[4:7],a[64:67]
dt a[94:95],v22,12800
mf a[152:155],a[8:11],a[64:67]
mf a[152:155],a[40:43],a[104:107]
dt a[132:133],v22,32768
mf a[156:159],a[44:47],a[104:107]
mf a[156:159],a[12:15],a[64:67]
dt a[134:135],v22,33280
mf a[160:163],a[16:19],a[64:67]
s_add_u32 s66, s66, 2
s_add_u32 m0, s65, 0
mf a[160:163],a[48:51],a[104:107]
buffer_load_dwordx4 v8, s[56:59], s69 offen  lds
mf a[164:167],a[52:55],a[104:107]
mf a[164:167],a[20:23],a[64:67]
mf a[168:171],a[24:27],a[64:67]
mf a[168:171],a[56:59],a[104:107]
mf a[172:175],a[60:63],a[104:107]
s_add_u32 m0, s65, 1024
mf a[172:175],a[28:31],a[64:67]
buffer_load_dwordx4 v9, s[56:59], s69 offen  lds
mf a[204:207],a[28:31],a[68:71]
s_sub_u32 s67, s66, 4
mf a[204:207],a[60:63],a[108:111]
dt a[64:65],v21,0
mf a[200:203],a[56:59],a[108:111]
mf a[200:203],a[24:27],a[68:71]
dt a[66:67],v21,512
mf a[196:199],a[20:23],a[68:71]
mf a[196:199],a[52:55],a[108:111]
dt a[104:105],v21,20480
mf a[192:195],a[48:51],a[108:111]
s_add_u32 s69, s69, 0x8000
mf a[192:195],a[16:19],a[68:71]
dt a[106:107],v21,20992
mf a[188:191],a[12:15],a[68:71]
s_add_u32 m0, s65, 2048
mf a[188:191],a[44:47],a[108:111]
buffer_load_dwordx4 v8, s[56:59], s69 offen  lds
mf a[184:187],a[40:43],a[108:111]
s_cmp_lt_u32 s66, 18
s_cselect_b64 vcc, -1, 0
mf a[184:187],a[8:11],a[68:71]
mf a[180:183],a[4:7],a[68:71]
mf a[180:183],a[36:39],a[108:111]
mf a[176:179],a[32:35],a[108:111]
s_add_u32 m0, s65, 3072
mf a[176:179],a[0:3],a[68:71]
buffer_load_dwordx4 v9, s[56:59], s69 offen  lds
mf v[240:243],a[96:99],a[0:3]
mf v[240:243],a[136:139],a[32:35]
dt a[68:69],v22,0
mf v[244:247],a[136:139],a[36:39]
mf v[244:247],a[96:99],a[4:7]
dt a[70:71],v22,512
mf a[208:211],a[96:99],a[8:11]
mf a[208:211],a[136:139],a[40:43]
dt a[108:109],v22,20480
mf a[212:215],a[136:139],a[44:47]
s_add_u32 s69, s69, 0x8000
mf a[212:215],a[96:99],a[12:15]
dt a[110:111],v22,20992
mf a[216:219],a[96:99],a[16:19]
s_add_u32 m0, s65, 4096
mf a[216:219],a[136:139],a[48:51]
buffer_load_dwordx4 v8, s[56:59], s69 offen  lds
mf a[220:223],a[136:139],a[52:55]
mf a[220:223],a[96:99],a[20:23]
mf a[224:227],a[96:99],a[24:27]
mf a[224:227],a[136:139],a[56:59]
mf a[228:231],a[136:139],a[60:63]
s_add_u32 m0, s65, 5120
mf a[228:231],a[96:99],a[28:31]
buffer_load_dwordx4 v9, s[56:59], s69 offen  lds
mf v[248:251],a[100:103],a[0:3]
dq a[0:3],v16,32768
mf v[248:251],a[140:143],a[32:35]
dq a[32:35],v17,32768
mf v[252:255],a[140:143],a[36:39]
dq a[36:39],v17,34816
mf v[252:255],a[100:103],a[4:7]
dq a[4:7],v16,34816
mf a[232:235],a[100:103],a[8:11]
dq a[8:11],v16,36864
mf a[232:235],a[140:143],a[40:43]
dq a[40:43],v17,36864
mf a[236:239],a[140:143],a[44:47]
dq a[44:47],v17,38912
mf a[236:239],a[100:103],a[12:15]
dq a[12:15],v16,38912
mf a[240:243],a[100:103],a[16:19]
dq a[16:19],v16,40960
mf a[240:243],a[140:143],a[48:51]
dq a[48:51],v17,40960
mf a[244:247],a[140:143],a[52:55]
dq a[52:55],v17,43008
mf a[244:247],a[100:103],a[20:23]
dq a[20:23],v16,43008
mf a[248:251],a[100:103],a[24:27]
dq a[24:27],v16,45056
mf a[248:251],a[140:143],a[56:59]
dq a[56:59],v17,45056
mf a[252:255],a[140:143],a[60:63]
s_add_u32 s69, s69, 0x8000
dq a[60:63],v17,47104
mf a[252:255],a[100:103],a[28:31]
s_waitcnt lgkmcnt(13)
dq a[28:31],v16,47104
mf v[48:51],a[72:75],a[0:3]
s_add_u32 m0, s65, 6144
dt a[96:97],v23,16384
mf v[48:51],a[112:115],a[32:35]
s_waitcnt lgkmcnt(13)
dt a[98:99],v23,16640
buffer_load_dwordx4 v8, s[56:59], s69 offen  lds
mf v[52:55],a[112:115],a[36:39]
dt a[136:137],v23,36864
mf v[52:55],a[72:75],a[4:7]
s_waitcnt lgkmcnt(13)
dt a[138:139],v23,37120
mf v[56:59],a[72:75],a[8:11]
dt a[100:101],v23,18432
mf v[56:59],a[112:115],a[40:43]
s_waitcnt lgkmcnt(13)
dt a[102:103],v23,18688
mf v[60:63],a[112:115],a[44:47]
dt a[140:141],v23,38912
mf v[60:63],a[72:75],a[12:15]
s_waitcnt lgkmcnt(13)
dt a[142:143],v23,39168
mf v[64:67],a[72:75],a[16:19]
s_add_u32 m0, s65, 7168
mf v[64:67],a[112:115],a[48:51]
s_waitcnt lgkmcnt(12)
buffer_load_dwordx4 v9, s[56:59], s69 offen  lds
mf v[68:71],a[112:115],a[52:55]
s_add_u32 s100, s90, L_csKV14_ret-L_base
mf v[68:71],a[72:75],a[20:23]
s_waitcnt lgkmcnt(10)
mf v[72:75],a[72:75],a[24:27]
s_addc_u32 s101, s91, 0
mf v[72:75],a[112:115],a[56:59]
s_waitcnt lgkmcnt(8)
mf v[76:79],a[112:115],a[60:63]
s_bitcmp1_b32 s79, s67
mf v[76:79],a[72:75],a[28:31]
s_waitcnt vmcnt(12) lgkmcnt(0)
s_barrier
s_cbranch_scc1 L_cs
L_csKV14_ret:
s_cbranch_vccnz L_g1loopKV
mf v[108:111],a[76:79],a[28:31]
s_lshl_b32 s3, s78, 7
v_readlane_b32 s68, v13, 18
s_add_u32 s3, s3, 23592960
mf v[108:111],a[116:119],a[60:63]
dt a[72:73],v18,4096
mf v[104:107],a[116:119],a[56:59]
s_mul_i32 s70, s68, 393216
mf v[104:107],a[76:79],a[24:27]
s_mul_i32 s71, s68, 458752
dt a[74:75],v18,4608
mf v[100:103],a[76:79],a[20:23]
s_add_u32 s5, s71, 229376
mf v[100:103],a[116:119],a[52:55]
s_add_u32 s4, s70, 196608
dt a[112:113],v18,24576
mf v[96:99],a[116:119],a[48:51]
mf v[96:99],a[76:79],a[16:19]
dt a[114:115],v18,25088
mf v[92:95],a[76:79],a[12:15]
s_add_u32 m0, s64, 45056
mf v[92:95],a[116:119],a[44:47]
buffer_load_dwordx4 v11, s[36:39], s71 offen offset:0  lds
mf v[88:91],a[116:119],a[40:43]
mf v[88:91],a[76:79],a[8:11]
s_mov_b32 m0, 147456
s_nop 0
buffer_load_dword v4, s[28:31], s3 offen sc1 lds
mf v[84:87],a[76:79],a[4:7]
s_add_u32 m0, s64, 65536
mf v[84:87],a[116:119],a[36:39]
buffer_load_dwordx4 v11, s[36:39], s5 offen offset:0  lds
mf v[80:83],a[116:119],a[32:35]
mf v[80:83],a[76:79],a[0:3]
buffer_load_dword v5, v4, s[96:99], 0 offen sc1
mf v[112:115],a[80:83],a[0:3]
mf v[112:115],a[120:123],a[32:35]
dt a[76:77],v19,4096
mf v[116:119],a[120:123],a[36:39]
mf v[116:119],a[80:83],a[4:7]
dt a[78:79],v19,4608
mf v[120:123],a[80:83],a[8:11]
mf v[120:123],a[120:123],a[40:43]
dt a[116:117],v19,24576
mf v[124:127],a[120:123],a[44:47]
mf v[124:127],a[80:83],a[12:15]
dt a[118:119],v19,25088
mf v[128:131],a[80:83],a[16:19]
s_add_u32 m0, s64, 49152
mf v[128:131],a[120:123],a[48:51]
buffer_load_dwordx4 v11, s[40:43], s71 offen offset:0  lds
L_iw1KV_1:
L_stub1:
s_cbranch_execz L_stub5
mf v[132:135],a[120:123],a[52:55]
mf v[132:135],a[80:83],a[20:23]
mf v[136:139],a[80:83],a[24:27]
s_add_u32 m0, s64, 69632
mf v[136:139],a[120:123],a[56:59]
buffer_load_dwordx4 v11, s[40:43], s5 offen offset:0  lds
mf v[140:143],a[120:123],a[60:63]
mf v[140:143],a[80:83],a[28:31]
mf v[172:175],a[84:87],a[28:31]
mf v[172:175],a[124:127],a[60:63]
dt a[80:81],v18,8192
mf v[168:171],a[124:127],a[56:59]
mf v[168:171],a[84:87],a[24:27]
dt a[82:83],v18,8704
mf v[164:167],a[84:87],a[20:23]
mf v[164:167],a[124:127],a[52:55]
dt a[120:121],v18,28672
mf v[160:163],a[124:127],a[48:51]
mf v[160:163],a[84:87],a[16:19]
dt a[122:123],v18,29184
mf v[156:159],a[84:87],a[12:15]
s_add_u32 m0, s64, 51200
mf v[156:159],a[124:127],a[44:47]
buffer_load_dwordx4 v10, s[32:35], s70 offen offset:2048  lds
mf v[152:155],a[124:127],a[40:43]
mf v[152:155],a[84:87],a[8:11]
mf v[148:151],a[84:87],a[4:7]
s_add_u32 m0, s64, 71680
mf v[148:151],a[124:127],a[36:39]
buffer_load_dwordx4 v10, s[32:35], s4 offen offset:2048  lds
mf v[144:147],a[124:127],a[32:35]
mf v[144:147],a[84:87],a[0:3]
mf v[176:179],a[0:3],a[88:91]
mf v[176:179],a[32:35],a[128:131]
dt a[84:85],v19,8192
mf v[180:183],a[36:39],a[128:131]
mf v[180:183],a[4:7],a[88:91]
dt a[86:87],v19,8704
mf v[184:187],a[8:11],a[88:91]
mf v[184:187],a[40:43],a[128:131]
dt a[124:125],v19,28672
mf v[188:191],a[44:47],a[128:131]
mf v[188:191],a[12:15],a[88:91]
dt a[126:127],v19,29184
mf v[192:195],a[16:19],a[88:91]
s_add_u32 m0, s64, 40960
mf v[192:195],a[48:51],a[128:131]
buffer_load_dwordx4 v10, s[32:35], s70 offen offset:0  lds
mf v[196:199],a[52:55],a[128:131]
mf v[196:199],a[20:23],a[88:91]
mf v[200:203],a[24:27],a[88:91]
s_add_u32 m0, s64, 61440
mf v[200:203],a[56:59],a[128:131]
buffer_load_dwordx4 v10, s[32:35], s4 offen offset:0  lds
mf v[204:207],a[60:63],a[128:131]
mf v[204:207],a[28:31],a[88:91]
mf v[236:239],a[28:31],a[92:95]
mf v[236:239],a[60:63],a[132:135]
dt a[88:89],v18,12288
mf v[232:235],a[56:59],a[132:135]
mf v[232:235],a[24:27],a[92:95]
dt a[90:91],v18,12800
mf v[228:231],a[20:23],a[92:95]
mf v[228:231],a[52:55],a[132:135]
dt a[128:129],v18,32768
mf v[224:227],a[48:51],a[132:135]
mf v[224:227],a[16:19],a[92:95]
dt a[130:131],v18,33280
mf v[220:223],a[12:15],a[92:95]
s_add_u32 m0, s64, 57344
mf v[220:223],a[44:47],a[132:135]
buffer_load_dwordx4 v12, s[44:47], s71 offen offset:0  lds
mf v[216:219],a[40:43],a[132:135]
mf v[216:219],a[8:11],a[92:95]
mf v[212:215],a[4:7],a[92:95]
s_add_u32 m0, s64, 77824
mf v[212:215],a[36:39],a[132:135]
buffer_load_dwordx4 v12, s[44:47], s5 offen offset:0  lds
mf v[208:211],a[32:35],a[132:135]
mf v[208:211],a[0:3],a[92:95]
s_waitcnt vmcnt(12) lgkmcnt(0)
s_barrier
mf a[144:147],a[0:3],a[64:67]
s_lshl_b32 s69, s68, 7
mf a[144:147],a[32:35],a[104:107]
dt a[92:93],v19,12288
mf a[148:151],a[36:39],a[104:107]
mf a[148:151],a[4:7],a[64:67]
dt a[94:95],v19,12800
mf a[152:155],a[8:11],a[64:67]
mf a[152:155],a[40:43],a[104:107]
dt a[132:133],v19,32768
mf a[156:159],a[44:47],a[104:107]
mf a[156:159],a[12:15],a[64:67]
dt a[134:135],v19,33280
mf a[160:163],a[16:19],a[64:67]
s_add_u32 m0, s65, 32768
mf a[160:163],a[48:51],a[104:107]
buffer_load_dwordx4 v8, s[56:59], s69 offen  lds
mf a[164:167],a[52:55],a[104:107]
mf a[164:167],a[20:23],a[64:67]
s_mov_b32 m0, 147456
s_nop 0
buffer_load_dword v15, s[48:51], s89 offen lds
mf a[168:171],a[24:27],a[64:67]
s_add_u32 s89, s89, 0x100000
mf a[168:171],a[56:59],a[104:107]
s_mov_b32 m0, 147456
s_nop 0
buffer_load_dword v15, s[48:51], s89 offen lds
mf a[172:175],a[60:63],a[104:107]
s_add_u32 m0, s65, 33792
s_add_u32 s89, s89, 0x100000
v_and_b32 v6, 15, v2
mf a[172:175],a[28:31],a[64:67]
buffer_load_dwordx4 v9, s[56:59], s69 offen  lds
mf a[204:207],a[28:31],a[68:71]
v_cmp_eq_u32 vcc, 1, v6
mf a[204:207],a[60:63],a[108:111]
dt a[64:65],v18,0
v_cndmask_b32 v24, v24, v28, vcc
mf a[200:203],a[56:59],a[108:111]
v_cndmask_b32 v25, v25, v29, vcc
v_cndmask_b32 v26, v26, v30, vcc
mf a[200:203],a[24:27],a[68:71]
dt a[66:67],v18,512
v_cndmask_b32 v27, v27, v31, vcc
mf a[196:199],a[20:23],a[68:71]
v_cmp_eq_u32 vcc, 2, v6
mf a[196:199],a[52:55],a[108:111]
dt a[104:105],v18,20480
v_cndmask_b32 v24, v24, v32, vcc
mf a[192:195],a[48:51],a[108:111]
s_add_u32 s69, s69, 0x8000
v_cndmask_b32 v25, v25, v33, vcc
v_cndmask_b32 v26, v26, v34, vcc
mf a[192:195],a[16:19],a[68:71]
dt a[106:107],v18,20992
v_cndmask_b32 v27, v27, v35, vcc
mf a[188:191],a[12:15],a[68:71]
s_add_u32 m0, s65, 34816
v_cmp_eq_u32 vcc, 3, v6
mf a[188:191],a[44:47],a[108:111]
buffer_load_dwordx4 v8, s[56:59], s69 offen  lds
mf a[184:187],a[40:43],a[108:111]
v_cndmask_b32 v24, v24, v36, vcc
v_cndmask_b32 v25, v25, v37, vcc
mf a[184:187],a[8:11],a[68:71]
v_cndmask_b32 v26, v26, v38, vcc
v_cndmask_b32 v27, v27, v39, vcc
mf a[180:183],a[4:7],a[68:71]
v_cmp_eq_u32 vcc, 4, v6
mf a[180:183],a[36:39],a[108:111]
mf a[176:179],a[32:35],a[108:111]
s_add_u32 m0, s65, 35840
v_cndmask_b32 v24, v24, v40, vcc
v_cndmask_b32 v25, v25, v41, vcc
mf a[176:179],a[0:3],a[68:71]
buffer_load_dwordx4 v9, s[56:59], s69 offen  lds
mf v[240:243],a[96:99],a[0:3]
v_cndmask_b32 v26, v26, v42, vcc
v_cndmask_b32 v27, v27, v43, vcc
mf v[240:243],a[136:139],a[32:35]
dt a[68:69],v19,0
v_cmp_gt_u32 vcc, 5, v6
mf v[244:247],a[136:139],a[36:39]
v_and_b32 v7, 48, v2
v_lshl_add_u32 v6, v6, 6, v7
mf v[244:247],a[96:99],a[4:7]
dt a[70:71],v19,512
v_mov_b32 v7, 0x7fff0000
mf a[208:211],a[96:99],a[8:11]
v_cndmask_b32 v6, v7, v6, vcc
s_lshl_b32 s82, s23, 3
mf a[208:211],a[136:139],a[40:43]
s_add_u32 s82, s82, s24
dt a[108:109],v19,20480
s_mul_i32 s82, s82, 1280
mf a[212:215],a[136:139],a[44:47]
s_add_u32 s69, s69, 0x8000
s_mul_i32 s83, s22, 640
s_add_u32 s82, s82, s83
mf a[212:215],a[96:99],a[12:15]
s_mul_i32 s83, s21, 320
dt a[110:111],v19,20992
s_add_u32 s82, s82, s83
mf a[216:219],a[96:99],a[16:19]
s_add_u32 m0, s65, 36864
s_add_u32 s82, s82, 23265280
mf a[216:219],a[136:139],a[48:51]
buffer_load_dwordx4 v8, s[56:59], s69 offen  lds
mf a[220:223],a[136:139],a[52:55]
mf a[220:223],a[96:99],a[20:23]
buffer_store_dwordx4 v[24:27], v6, s[28:31], s82 offen sc1
mf a[224:227],a[96:99],a[24:27]
v_mov_b32 v28, 0
v_mov_b32 v29, 0
mf a[224:227],a[136:139],a[56:59]
v_mov_b32 v30, 0
v_mov_b32 v31, 0
mf a[228:231],a[136:139],a[60:63]
s_add_u32 m0, s65, 37888
v_cmp_gt_u32 vcc, 24, v2
s_mul_i32 s82, s25, 12288
mf a[228:231],a[96:99],a[28:31]
s_lshl_b32 s83, s24, 2
buffer_load_dwordx4 v9, s[56:59], s69 offen  lds
s_add_u32 s83, s83, s20
mf v[248:251],a[100:103],a[0:3]
s_mul_i32 s83, s83, 384
dq a[0:3],v16,0
s_add_u32 s82, s82, s83
mf v[248:251],a[140:143],a[32:35]
s_add_u32 s82, s82, 23068672
dq a[32:35],v17,0
v_cndmask_b32 v6, v7, v3, vcc
mf v[252:255],a[140:143],a[36:39]
dq a[36:39],v17,2048
mf v[252:255],a[100:103],a[4:7]
dq a[4:7],v16,2048
buffer_store_dwordx4 v[28:31], v6, s[28:31], s82 offen sc1
mf a[232:235],a[100:103],a[8:11]
dq a[8:11],v16,4096
mf a[232:235],a[140:143],a[40:43]
dq a[40:43],v17,4096
mf a[236:239],a[140:143],a[44:47]
dq a[44:47],v17,6144
mf a[236:239],a[100:103],a[12:15]
dq a[12:15],v16,6144
mf a[240:243],a[100:103],a[16:19]
dq a[16:19],v16,8192
mf a[240:243],a[140:143],a[48:51]
dq a[48:51],v17,8192
mf a[244:247],a[140:143],a[52:55]
dq a[52:55],v17,10240
mf a[244:247],a[100:103],a[20:23]
dq a[20:23],v16,10240
mf a[248:251],a[100:103],a[24:27]
dq a[24:27],v16,12288
mf a[248:251],a[140:143],a[56:59]
dq a[56:59],v17,12288
mf a[252:255],a[140:143],a[60:63]
s_add_u32 s69, s69, 0x8000
dq a[60:63],v17,14336
mf a[252:255],a[100:103],a[28:31]
s_waitcnt lgkmcnt(13)
dq a[28:31],v16,14336
mf v[48:51],a[72:75],a[0:3]
s_add_u32 m0, s65, 38912
dt a[96:97],v20,16384
mf v[48:51],a[112:115],a[32:35]
s_waitcnt lgkmcnt(13)
dt a[98:99],v20,16640
buffer_load_dwordx4 v8, s[56:59], s69 offen  lds
mf v[52:55],a[112:115],a[36:39]
dt a[136:137],v20,36864
mf v[52:55],a[72:75],a[4:7]
s_waitcnt lgkmcnt(13)
dt a[138:139],v20,37120
mf v[56:59],a[72:75],a[8:11]
dt a[100:101],v20,18432
mf v[56:59],a[112:115],a[40:43]
s_waitcnt lgkmcnt(13)
dt a[102:103],v20,18688
mf v[60:63],a[112:115],a[44:47]
dt a[140:141],v20,38912
mf v[60:63],a[72:75],a[12:15]
s_waitcnt lgkmcnt(13)
dt a[142:143],v20,39168
mf v[64:67],a[72:75],a[16:19]
s_add_u32 m0, s65, 39936
mf v[64:67],a[112:115],a[48:51]
s_waitcnt lgkmcnt(12)
buffer_load_dwordx4 v9, s[56:59], s69 offen  lds
mf v[68:71],a[112:115],a[52:55]
mf v[68:71],a[72:75],a[20:23]
s_waitcnt lgkmcnt(10)
mf v[72:75],a[72:75],a[24:27]
mf v[72:75],a[112:115],a[56:59]
s_waitcnt lgkmcnt(8)
mf v[76:79],a[112:115],a[60:63]
mf v[76:79],a[72:75],a[28:31]
s_waitcnt vmcnt(16) lgkmcnt(0)
s_barrier
mf v[108:111],a[76:79],a[28:31]
s_lshl_b32 s82, s24, 8
v_readlane_b32 s68, v13, 20
s_lshl_b32 s83, s23, 3
mf v[108:111],a[116:119],a[60:63]
s_add_u32 s82, s82, s83
dt a[72:73],v21,4096
s_lshl_b32 s83, s20, 1
mf v[104:107],a[116:119],a[56:59]
s_mul_i32 s70, s68, 393216
s_add_u32 s82, s82, s83
s_lshl_b32 s82, s82, 11
mf v[104:107],a[76:79],a[24:27]
s_mul_i32 s71, s68, 458752
dt a[74:75],v21,4608
v_lshrrev_b32 v6, 5, v2
mf v[100:103],a[76:79],a[20:23]
s_add_u32 s5, s71, 229376
v_mul_u32_u24 v6, 1536, v6
v_add3_u32 v6, v6, v3, s82
mf v[100:103],a[116:119],a[52:55]
s_add_u32 s4, s70, 196608
dt a[112:113],v21,24576
mf v[96:99],a[116:119],a[48:51]
mf v[96:99],a[76:79],a[16:19]
dt a[114:115],v21,25088
mf v[92:95],a[76:79],a[12:15]
s_add_u32 m0, s64, 4096
mf v[92:95],a[116:119],a[44:47]
buffer_load_dwordx4 v11, s[36:39], s71 offen offset:0  lds
mf v[88:91],a[116:119],a[40:43]
mf v[88:91],a[76:79],a[8:11]
buffer_load_dwordx4 v[24:27], v6, s[56:59], 0 offen offset:0
mf v[84:87],a[76:79],a[4:7]
s_add_u32 m0, s64, 24576
mf v[84:87],a[116:119],a[36:39]
buffer_load_dwordx4 v11, s[36:39], s5 offen offset:0  lds
mf v[80:83],a[116:119],a[32:35]
mf v[80:83],a[76:79],a[0:3]
mf v[112:115],a[80:83],a[0:3]
mf v[112:115],a[120:123],a[32:35]
dt a[76:77],v22,4096
buffer_load_dwordx4 v[28:31], v6, s[56:59], 0 offen offset:512
mf v[116:119],a[120:123],a[36:39]
mf v[116:119],a[80:83],a[4:7]
dt a[78:79],v22,4608
mf v[120:123],a[80:83],a[8:11]
mf v[120:123],a[120:123],a[40:43]
dt a[116:117],v22,24576
mf v[124:127],a[120:123],a[44:47]
mf v[124:127],a[80:83],a[12:15]
dt a[118:119],v22,25088
buffer_load_dwordx4 v[32:35], v6, s[56:59], 0 offen offset:1024
mf v[128:131],a[80:83],a[16:19]
s_add_u32 m0, s64, 8192
mf v[128:131],a[120:123],a[48:51]
buffer_load_dwordx4 v11, s[40:43], s71 offen offset:0  lds
mf v[132:135],a[120:123],a[52:55]
mf v[132:135],a[80:83],a[20:23]
mf v[136:139],a[80:83],a[24:27]
s_add_u32 m0, s64, 28672
mf v[136:139],a[120:123],a[56:59]
buffer_load_dwordx4 v11, s[40:43], s5 offen offset:0  lds
mf v[140:143],a[120:123],a[60:63]
mf v[140:143],a[80:83],a[28:31]
buffer_load_dwordx4 v[36:39], v6, s[56:59], 0 offen offset:1536
mf v[172:175],a[84:87],a[28:31]
mf v[172:175],a[124:127],a[60:63]
dt a[80:81],v21,8192
mf v[168:171],a[124:127],a[56:59]
mf v[168:171],a[84:87],a[24:27]
dt a[82:83],v21,8704
mf v[164:167],a[84:87],a[20:23]
mf v[164:167],a[124:127],a[52:55]
dt a[120:121],v21,28672
mf v[160:163],a[124:127],a[48:51]
mf v[160:163],a[84:87],a[16:19]
dt a[122:123],v21,29184
mf v[156:159],a[84:87],a[12:15]
s_add_u32 m0, s64, 10240
mf v[156:159],a[124:127],a[44:47]
buffer_load_dwordx4 v10, s[32:35], s70 offen offset:2048  lds
mf v[152:155],a[124:127],a[40:43]
mf v[152:155],a[84:87],a[8:11]
mf v[148:151],a[84:87],a[4:7]
s_add_u32 m0, s64, 30720
mf v[148:151],a[124:127],a[36:39]
buffer_load_dwordx4 v10, s[32:35], s4 offen offset:2048  lds
mf v[144:147],a[124:127],a[32:35]
mf v[144:147],a[84:87],a[0:3]
mf v[176:179],a[0:3],a[88:91]
mf v[176:179],a[32:35],a[128:131]
dt a[84:85],v22,8192
mf v[180:183],a[36:39],a[128:131]
mf v[180:183],a[4:7],a[88:91]
dt a[86:87],v22,8704
mf v[184:187],a[8:11],a[88:91]
mf v[184:187],a[40:43],a[128:131]
dt a[124:125],v22,28672
mf v[188:191],a[44:47],a[128:131]
mf v[188:191],a[12:15],a[88:91]
dt a[126:127],v22,29184
mf v[192:195],a[16:19],a[88:91]
s_add_u32 m0, s64, 0
mf v[192:195],a[48:51],a[128:131]
buffer_load_dwordx4 v10, s[32:35], s70 offen offset:0  lds
mf v[196:199],a[52:55],a[128:131]
mf v[196:199],a[20:23],a[88:91]
mf v[200:203],a[24:27],a[88:91]
s_add_u32 m0, s64, 20480
mf v[200:203],a[56:59],a[128:131]
buffer_load_dwordx4 v10, s[32:35], s4 offen offset:0  lds
mf v[204:207],a[60:63],a[128:131]
mf v[204:207],a[28:31],a[88:91]
mf v[236:239],a[28:31],a[92:95]
mf v[236:239],a[60:63],a[132:135]
dt a[88:89],v21,12288
mf v[232:235],a[56:59],a[132:135]
mf v[232:235],a[24:27],a[92:95]
dt a[90:91],v21,12800
mf v[228:231],a[20:23],a[92:95]
mf v[228:231],a[52:55],a[132:135]
dt a[128:129],v21,32768
mf v[224:227],a[48:51],a[132:135]
mf v[224:227],a[16:19],a[92:95]
dt a[130:131],v21,33280
mf v[220:223],a[12:15],a[92:95]
s_add_u32 m0, s64, 16384
mf v[220:223],a[44:47],a[132:135]
buffer_load_dwordx4 v12, s[44:47], s71 offen offset:0  lds
mf v[216:219],a[40:43],a[132:135]
mf v[216:219],a[8:11],a[92:95]
mf v[212:215],a[4:7],a[92:95]
s_add_u32 m0, s64, 36864
mf v[212:215],a[36:39],a[132:135]
buffer_load_dwordx4 v12, s[44:47], s5 offen offset:0  lds
mf v[208:211],a[32:35],a[132:135]
mf v[208:211],a[0:3],a[92:95]
s_waitcnt vmcnt(14) lgkmcnt(0)
s_barrier
mf a[144:147],a[0:3],a[64:67]
s_lshl_b32 s69, s68, 7
mf a[144:147],a[32:35],a[104:107]
dt a[92:93],v22,12288
mf a[148:151],a[36:39],a[104:107]
mf a[148:151],a[4:7],a[64:67]
dt a[94:95],v22,12800
mf a[152:155],a[8:11],a[64:67]
mf a[152:155],a[40:43],a[104:107]
dt a[132:133],v22,32768
mf a[156:159],a[44:47],a[104:107]
mf a[156:159],a[12:15],a[64:67]
dt a[134:135],v22,33280
mf a[160:163],a[16:19],a[64:67]
s_add_u32 m0, s65, 0
mf a[160:163],a[48:51],a[104:107]
buffer_load_dwordx4 v8, s[56:59], s69 offen  lds
mf a[164:167],a[52:55],a[104:107]
mf a[164:167],a[20:23],a[64:67]
s_mov_b32 m0, 147456
s_nop 0
buffer_load_dword v15, s[48:51], s89 offen lds
mf a[168:171],a[24:27],a[64:67]
s_add_u32 s89, s89, 0x100000
mf a[168:171],a[56:59],a[104:107]
s_mov_b32 m0, 147456
s_nop 0
buffer_load_dword v15, s[48:51], s89 offen lds
mf a[172:175],a[60:63],a[104:107]
s_add_u32 m0, s65, 1024
s_add_u32 s89, s89, 0x100000
mf a[172:175],a[28:31],a[64:67]
buffer_load_dwordx4 v9, s[56:59], s69 offen  lds
mf a[204:207],a[28:31],a[68:71]
mf a[204:207],a[60:63],a[108:111]
dt a[64:65],v21,0
mf a[200:203],a[56:59],a[108:111]
mf a[200:203],a[24:27],a[68:71]
dt a[66:67],v21,512
mf a[196:199],a[20:23],a[68:71]
mf a[196:199],a[52:55],a[108:111]
dt a[104:105],v21,20480
mf a[192:195],a[48:51],a[108:111]
s_add_u32 s69, s69, 0x8000
mf a[192:195],a[16:19],a[68:71]
dt a[106:107],v21,20992
mf a[188:191],a[12:15],a[68:71]
s_add_u32 m0, s65, 2048
mf a[188:191],a[44:47],a[108:111]
buffer_load_dwordx4 v8, s[56:59], s69 offen  lds
mf a[184:187],a[40:43],a[108:111]
mf a[184:187],a[8:11],a[68:71]
mf a[180:183],a[4:7],a[68:71]
mf a[180:183],a[36:39],a[108:111]
mf a[176:179],a[32:35],a[108:111]
s_add_u32 m0, s65, 3072
mf a[176:179],a[0:3],a[68:71]
buffer_load_dwordx4 v9, s[56:59], s69 offen  lds
mf v[240:243],a[96:99],a[0:3]
mf v[240:243],a[136:139],a[32:35]
dt a[68:69],v22,0
mf v[244:247],a[136:139],a[36:39]
mf v[244:247],a[96:99],a[4:7]
dt a[70:71],v22,512
mf a[208:211],a[96:99],a[8:11]
mf a[208:211],a[136:139],a[40:43]
dt a[108:109],v22,20480
mf a[212:215],a[136:139],a[44:47]
s_add_u32 s69, s69, 0x8000
mf a[212:215],a[96:99],a[12:15]
dt a[110:111],v22,20992
mf a[216:219],a[96:99],a[16:19]
s_add_u32 m0, s65, 4096
mf a[216:219],a[136:139],a[48:51]
buffer_load_dwordx4 v8, s[56:59], s69 offen  lds
mf a[220:223],a[136:139],a[52:55]
mf a[220:223],a[96:99],a[20:23]
mf a[224:227],a[96:99],a[24:27]
mf a[224:227],a[136:139],a[56:59]
mf a[228:231],a[136:139],a[60:63]
s_add_u32 m0, s65, 5120
mf a[228:231],a[96:99],a[28:31]
buffer_load_dwordx4 v9, s[56:59], s69 offen  lds
mf v[248:251],a[100:103],a[0:3]
dq a[0:3],v16,32768
mf v[248:251],a[140:143],a[32:35]
dq a[32:35],v17,32768
mf v[252:255],a[140:143],a[36:39]
dq a[36:39],v17,34816
mf v[252:255],a[100:103],a[4:7]
dq a[4:7],v16,34816
mf a[232:235],a[100:103],a[8:11]
dq a[8:11],v16,36864
mf a[232:235],a[140:143],a[40:43]
dq a[40:43],v17,36864
mf a[236:239],a[140:143],a[44:47]
dq a[44:47],v17,38912
mf a[236:239],a[100:103],a[12:15]
dq a[12:15],v16,38912
mf a[240:243],a[100:103],a[16:19]
dq a[16:19],v16,40960
mf a[240:243],a[140:143],a[48:51]
dq a[48:51],v17,40960
mf a[244:247],a[140:143],a[52:55]
dq a[52:55],v17,43008
mf a[244:247],a[100:103],a[20:23]
dq a[20:23],v16,43008
mf a[248:251],a[100:103],a[24:27]
dq a[24:27],v16,45056
mf a[248:251],a[140:143],a[56:59]
dq a[56:59],v17,45056
mf a[252:255],a[140:143],a[60:63]
s_add_u32 s69, s69, 0x8000
dq a[60:63],v17,47104
mf a[252:255],a[100:103],a[28:31]
s_waitcnt lgkmcnt(13)
dq a[28:31],v16,47104
mf v[48:51],a[72:75],a[0:3]
s_add_u32 m0, s65, 6144
dt a[96:97],v23,16384
mf v[48:51],a[112:115],a[32:35]
L_iw1KV_2:
L_stub2:
s_cbranch_execz L_stub6
s_waitcnt lgkmcnt(13)
dt a[98:99],v23,16640
buffer_load_dwordx4 v8, s[56:59], s69 offen  lds
mf v[52:55],a[112:115],a[36:39]
dt a[136:137],v23,36864
mf v[52:55],a[72:75],a[4:7]
s_waitcnt lgkmcnt(13)
dt a[138:139],v23,37120
mf v[56:59],a[72:75],a[8:11]
dt a[100:101],v23,18432
mf v[56:59],a[112:115],a[40:43]
s_waitcnt lgkmcnt(13)
dt a[102:103],v23,18688
mf v[60:63],a[112:115],a[44:47]
dt a[140:141],v23,38912
mf v[60:63],a[72:75],a[12:15]
s_waitcnt lgkmcnt(13)
dt a[142:143],v23,39168
mf v[64:67],a[72:75],a[16:19]
s_add_u32 m0, s65, 7168
mf v[64:67],a[112:115],a[48:51]
s_waitcnt lgkmcnt(12)
buffer_load_dwordx4 v9, s[56:59], s69 offen  lds
mf v[68:71],a[112:115],a[52:55]
mf v[68:71],a[72:75],a[20:23]
s_waitcnt lgkmcnt(10)
mf v[72:75],a[72:75],a[24:27]
mf v[72:75],a[112:115],a[56:59]
s_waitcnt lgkmcnt(8)
mf v[76:79],a[112:115],a[60:63]
mf v[76:79],a[72:75],a[28:31]
s_waitcnt vmcnt(14) lgkmcnt(0)
s_barrier
v_cmp_eq_u32 vcc, 0, v5
s_nop 0
s_cbranch_vccnz L_tagKV_slow
L_tagKV_back:
mf v[108:111],a[76:79],a[28:31]
v_readlane_b32 s68, v13, 22
v_readfirstlane_b32 s15, v5
mf v[108:111],a[116:119],a[60:63]
dt a[72:73],v18,4096
v_and_b32 v5, -4, v5
mf v[104:107],a[116:119],a[56:59]
s_mul_i32 s70, s68, 393216
v_lshlrev_b32 v6, 16, v24
v_and_b32 v7, 0xffff0000, v24
mf v[104:107],a[76:79],a[24:27]
s_mul_i32 s71, s68, 458752
dt a[74:75],v18,4608
v_mov_b32 v40, v6
mf v[100:103],a[76:79],a[20:23]
s_add_u32 s5, s71, 229376
v_mov_b32 v41, v7
v_lshlrev_b32 v6, 16, v25
mf v[100:103],a[116:119],a[52:55]
s_add_u32 s4, s70, 196608
dt a[112:113],v18,24576
v_and_b32 v7, 0xffff0000, v25
mf v[96:99],a[116:119],a[48:51]
v_add_f32 v40, v40, v6
v_add_f32 v41, v41, v7
mf v[96:99],a[76:79],a[16:19]
dt a[114:115],v18,25088
v_lshlrev_b32 v6, 16, v26
mf v[92:95],a[76:79],a[12:15]
s_add_u32 m0, s64, 45056
v_and_b32 v7, 0xffff0000, v26
v_add_f32 v40, v40, v6
mf v[92:95],a[116:119],a[44:47]
buffer_load_dwordx4 v11, s[36:39], s71 offen offset:0  lds
mf v[88:91],a[116:119],a[40:43]
v_add_f32 v41, v41, v7
v_lshlrev_b32 v6, 16, v27
mf v[88:91],a[76:79],a[8:11]
v_and_b32 v7, 0xffff0000, v27
v_add_f32 v40, v40, v6
mf v[84:87],a[76:79],a[4:7]
s_add_u32 m0, s64, 65536
v_add_f32 v41, v41, v7
v_lshlrev_b32 v6, 16, v28
mf v[84:87],a[116:119],a[36:39]
buffer_load_dwordx4 v11, s[36:39], s5 offen offset:0  lds
mf v[80:83],a[116:119],a[32:35]
v_and_b32 v7, 0xffff0000, v28
v_add_f32 v40, v40, v6
mf v[80:83],a[76:79],a[0:3]
v_add_f32 v41, v41, v7
v_lshlrev_b32 v6, 16, v29
mf v[112:115],a[80:83],a[0:3]
v_and_b32 v7, 0xffff0000, v29
v_add_f32 v40, v40, v6
mf v[112:115],a[120:123],a[32:35]
dt a[76:77],v19,4096
v_add_f32 v41, v41, v7
mf v[116:119],a[120:123],a[36:39]
v_lshlrev_b32 v6, 16, v30
v_and_b32 v7, 0xffff0000, v30
mf v[116:119],a[80:83],a[4:7]
dt a[78:79],v19,4608
v_add_f32 v40, v40, v6
mf v[120:123],a[80:83],a[8:11]
v_add_f32 v41, v41, v7
v_lshlrev_b32 v6, 16, v31
mf v[120:123],a[120:123],a[40:43]
dt a[116:117],v19,24576
v_and_b32 v7, 0xffff0000, v31
mf v[124:127],a[120:123],a[44:47]
v_add_f32 v40, v40, v6
v_add_f32 v41, v41, v7
mf v[124:127],a[80:83],a[12:15]
dt a[118:119],v19,25088
v_lshlrev_b32 v6, 16, v32
mf v[128:131],a[80:83],a[16:19]
s_add_u32 m0, s64, 49152
v_and_b32 v7, 0xffff0000, v32
v_add_f32 v40, v40, v6
mf v[128:131],a[120:123],a[48:51]
buffer_load_dwordx4 v11, s[40:43], s71 offen offset:0  lds
mf v[132:135],a[120:123],a[52:55]
v_add_f32 v41, v41, v7
v_lshlrev_b32 v6, 16, v33
mf v[132:135],a[80:83],a[20:23]
v_and_b32 v7, 0xffff0000, v33
v_add_f32 v40, v40, v6
mf v[136:139],a[80:83],a[24:27]
s_add_u32 m0, s64, 69632
v_add_f32 v41, v41, v7
v_lshlrev_b32 v6, 16, v34
mf v[136:139],a[120:123],a[56:59]
buffer_load_dwordx4 v11, s[40:43], s5 offen offset:0  lds
mf v[140:143],a[120:123],a[60:63]
v_and_b32 v7, 0xffff0000, v34
v_add_f32 v40, v40, v6
mf v[140:143],a[80:83],a[28:31]
v_add_f32 v41, v41, v7
v_lshlrev_b32 v6, 16, v35
mf v[172:175],a[84:87],a[28:31]
v_and_b32 v7, 0xffff0000, v35
v_add_f32 v40, v40, v6
mf v[172:175],a[124:127],a[60:63]
dt a[80:81],v18,8192
v_add_f32 v41, v41, v7
mf v[168:171],a[124:127],a[56:59]
v_lshlrev_b32 v6, 16, v36
v_and_b32 v7, 0xffff0000, v36
mf v[168:171],a[84:87],a[24:27]
dt a[82:83],v18,8704
v_add_f32 v40, v40, v6
mf v[164:167],a[84:87],a[20:23]
v_add_f32 v41, v41, v7
v_lshlrev_b32 v6, 16, v37
mf v[164:167],a[124:127],a[52:55]
dt a[120:121],v18,28672
v_and_b32 v7, 0xffff0000, v37
mf v[160:163],a[124:127],a[48:51]
v_add_f32 v40, v40, v6
v_add_f32 v41, v41, v7
mf v[160:163],a[84:87],a[16:19]
dt a[122:123],v18,29184
v_lshlrev_b32 v6, 16, v38
mf v[156:159],a[84:87],a[12:15]
s_add_u32 m0, s64, 51200
v_and_b32 v7, 0xffff0000, v38
v_add_f32 v40, v40, v6
mf v[156:159],a[124:127],a[44:47]
buffer_load_dwordx4 v10, s[32:35], s70 offen offset:2048  lds
mf v[152:155],a[124:127],a[40:43]
v_add_f32 v41, v41, v7
v_lshlrev_b32 v6, 16, v39
mf v[152:155],a[84:87],a[8:11]
v_and_b32 v7, 0xffff0000, v39
v_add_f32 v40, v40, v6
mf v[148:151],a[84:87],a[4:7]
s_add_u32 m0, s64, 71680
v_add_f32 v41, v41, v7
v_add_f32 v40, v40, v41
mf v[148:151],a[124:127],a[36:39]
buffer_load_dwordx4 v10, s[32:35], s4 offen offset:2048  lds
mf v[144:147],a[124:127],a[32:35]
v_add_f32_dpp v40, v40, v40 quad_perm:[1,0,3,2] row_mask:0xf bank_mask:0xf
mf v[144:147],a[84:87],a[0:3]
mf v[176:179],a[0:3],a[88:91]
v_add_f32_dpp v40, v40, v40 quad_perm:[2,3,0,1] row_mask:0xf bank_mask:0xf
mf v[176:179],a[32:35],a[128:131]
dt a[84:85],v19,8192
v_add_f32_dpp v40, v40, v40 row_half_mirror row_mask:0xf bank_mask:0xf
mf v[180:183],a[36:39],a[128:131]
mf v[180:183],a[4:7],a[88:91]
dt a[86:87],v19,8704
v_add_f32_dpp v40, v40, v40 row_mirror row_mask:0xf bank_mask:0xf
mf v[184:187],a[8:11],a[88:91]
v_mov_b32 v41, v40
mf v[184:187],a[40:43],a[128:131]
dt a[124:125],v19,28672
v_permlane16_swap_b32 v41, v40
mf v[188:191],a[44:47],a[128:131]
mf v[188:191],a[12:15],a[88:91]
dt a[126:127],v19,29184
v_add_f32 v40, v40, v41
mf v[192:195],a[16:19],a[88:91]
s_add_u32 m0, s64, 40960
v_mul_f32 v40, 0x3a800000, v40
v_lshlrev_b32 v6, 16, v24
mf v[192:195],a[48:51],a[128:131]
buffer_load_dwordx4 v10, s[32:35], s70 offen offset:0  lds
mf v[196:199],a[52:55],a[128:131]
v_and_b32 v7, 0xffff0000, v24
v_sub_f32 v6, v6, v40
mf v[196:199],a[20:23],a[88:91]
v_sub_f32 v7, v7, v40
v_mul_f32 v42, v6, v6
mf v[200:203],a[24:27],a[88:91]
s_add_u32 m0, s64, 61440
v_mul_f32 v43, v7, v7
v_lshlrev_b32 v6, 16, v25
mf v[200:203],a[56:59],a[128:131]
buffer_load_dwordx4 v10, s[32:35], s4 offen offset:0  lds
mf v[204:207],a[60:63],a[128:131]
v_and_b32 v7, 0xffff0000, v25
v_sub_f32 v6, v6, v40
mf v[204:207],a[28:31],a[88:91]
v_sub_f32 v7, v7, v40
v_fmac_f32 v42, v6, v6
mf v[236:239],a[28:31],a[92:95]
v_fmac_f32 v43, v7, v7
v_lshlrev_b32 v6, 16, v26
mf v[236:239],a[60:63],a[132:135]
dt a[88:89],v18,12288
v_and_b32 v7, 0xffff0000, v26
mf v[232:235],a[56:59],a[132:135]
v_sub_f32 v6, v6, v40
v_sub_f32 v7, v7, v40
mf v[232:235],a[24:27],a[92:95]
dt a[90:91],v18,12800
v_fmac_f32 v42, v6, v6
mf v[228:231],a[20:23],a[92:95]
v_fmac_f32 v43, v7, v7
v_lshlrev_b32 v6, 16, v27
mf v[228:231],a[52:55],a[132:135]
dt a[128:129],v18,32768
v_and_b32 v7, 0xffff0000, v27
mf v[224:227],a[48:51],a[132:135]
v_sub_f32 v6, v6, v40
v_sub_f32 v7, v7, v40
mf v[224:227],a[16:19],a[92:95]
dt a[130:131],v18,33280
v_fmac_f32 v42, v6, v6
mf v[220:223],a[12:15],a[92:95]
s_add_u32 m0, s64, 57344
v_fmac_f32 v43, v7, v7
v_lshlrev_b32 v6, 16, v28
mf v[220:223],a[44:47],a[132:135]
buffer_load_dwordx4 v12, s[44:47], s71 offen offset:0  lds
mf v[216:219],a[40:43],a[132:135]
v_and_b32 v7, 0xffff0000, v28
v_sub_f32 v6, v6, v40
mf v[216:219],a[8:11],a[92:95]
v_sub_f32 v7, v7, v40
v_fmac_f32 v42, v6, v6
mf v[212:215],a[4:7],a[92:95]
s_add_u32 m0, s64, 77824
v_fmac_f32 v43, v7, v7
v_lshlrev_b32 v6, 16, v29
mf v[212:215],a[36:39],a[132:135]
buffer_load_dwordx4 v12, s[44:47], s5 offen offset:0  lds
mf v[208:211],a[32:35],a[132:135]
v_and_b32 v7, 0xffff0000, v29
v_sub_f32 v6, v6, v40
mf v[208:211],a[0:3],a[92:95]
s_waitcnt vmcnt(10) lgkmcnt(0)
s_barrier
mf a[144:147],a[0:3],a[64:67]
s_lshl_b32 s69, s68, 7
v_sub_f32 v7, v7, v40
v_fmac_f32 v42, v6, v6
mf a[144:147],a[32:35],a[104:107]
dt a[92:93],v19,12288
v_fmac_f32 v43, v7, v7
mf a[148:151],a[36:39],a[104:107]
v_lshlrev_b32 v6, 16, v30
v_and_b32 v7, 0xffff0000, v30
mf a[148:151],a[4:7],a[64:67]
dt a[94:95],v19,12800
v_sub_f32 v6, v6, v40
mf a[152:155],a[8:11],a[64:67]
v_sub_f32 v7, v7, v40
v_fmac_f32 v42, v6, v6
mf a[152:155],a[40:43],a[104:107]
dt a[132:133],v19,32768
v_fmac_f32 v43, v7, v7
mf a[156:159],a[44:47],a[104:107]
v_lshlrev_b32 v6, 16, v31
v_and_b32 v7, 0xffff0000, v31
mf a[156:159],a[12:15],a[64:67]
dt a[134:135],v19,33280
v_sub_f32 v6, v6, v40
mf a[160:163],a[16:19],a[64:67]
s_add_u32 m0, s65, 32768
v_sub_f32 v7, v7, v40
v_fmac_f32 v42, v6, v6
mf a[160:163],a[48:51],a[104:107]
buffer_load_dwordx4 v8, s[56:59], s69 offen  lds
mf a[164:167],a[52:55],a[104:107]
v_fmac_f32 v43, v7, v7
v_lshlrev_b32 v6, 16, v32
mf a[164:167],a[20:23],a[64:67]
v_and_b32 v7, 0xffff0000, v32
v_sub_f32 v6, v6, v40
mf a[168:171],a[24:27],a[64:67]
v_sub_f32 v7, v7, v40
v_fmac_f32 v42, v6, v6
mf a[168:171],a[56:59],a[104:107]
v_fmac_f32 v43, v7, v7
v_lshlrev_b32 v6, 16, v33
mf a[172:175],a[60:63],a[104:107]
s_add_u32 m0, s65, 33792
v_and_b32 v7, 0xffff0000, v33
v_sub_f32 v6, v6, v40
mf a[172:175],a[28:31],a[64:67]
buffer_load_dwordx4 v9, s[56:59], s69 offen  lds
mf a[204:207],a[28:31],a[68:71]
v_sub_f32 v7, v7, v40
v_fmac_f32 v42, v6, v6
mf a[204:207],a[60:63],a[108:111]
dt a[64:65],v18,0
v_fmac_f32 v43, v7, v7
mf a[200:203],a[56:59],a[108:111]
v_lshlrev_b32 v6, 16, v34
v_and_b32 v7, 0xffff0000, v34
mf a[200:203],a[24:27],a[68:71]
dt a[66:67],v18,512
v_sub_f32 v6, v6, v40
mf a[196:199],a[20:23],a[68:71]
v_sub_f32 v7, v7, v40
v_fmac_f32 v42, v6, v6
mf a[196:199],a[52:55],a[108:111]
dt a[104:105],v18,20480
v_fmac_f32 v43, v7, v7
mf a[192:195],a[48:51],a[108:111]
s_add_u32 s69, s69, 0x8000
v_lshlrev_b32 v6, 16, v35
v_and_b32 v7, 0xffff0000, v35
mf a[192:195],a[16:19],a[68:71]
dt a[106:107],v18,20992
v_sub_f32 v6, v6, v40
mf a[188:191],a[12:15],a[68:71]
s_add_u32 m0, s65, 34816
v_sub_f32 v7, v7, v40
v_fmac_f32 v42, v6, v6
mf a[188:191],a[44:47],a[108:111]
buffer_load_dwordx4 v8, s[56:59], s69 offen  lds
mf a[184:187],a[40:43],a[108:111]
v_fmac_f32 v43, v7, v7
v_lshlrev_b32 v6, 16, v36
mf a[184:187],a[8:11],a[68:71]
v_and_b32 v7, 0xffff0000, v36
v_sub_f32 v6, v6, v40
mf a[180:183],a[4:7],a[68:71]
v_sub_f32 v7, v7, v40
v_fmac_f32 v42, v6, v6
mf a[180:183],a[36:39],a[108:111]
v_fmac_f32 v43, v7, v7
v_lshlrev_b32 v6, 16, v37
mf a[176:179],a[32:35],a[108:111]
s_add_u32 m0, s65, 35840
v_and_b32 v7, 0xffff0000, v37
v_sub_f32 v6, v6, v40
mf a[176:179],a[0:3],a[68:71]
buffer_load_dwordx4 v9, s[56:59], s69 offen  lds
mf v[240:243],a[96:99],a[0:3]
v_sub_f32 v7, v7, v40
v_fmac_f32 v42, v6, v6
mf v[240:243],a[136:139],a[32:35]
dt a[68:69],v19,0
v_fmac_f32 v43, v7, v7
mf v[244:247],a[136:139],a[36:39]
v_lshlrev_b32 v6, 16, v38
v_and_b32 v7, 0xffff0000, v38
mf v[244:247],a[96:99],a[4:7]
dt a[70:71],v19,512
v_sub_f32 v6, v6, v40
mf a[208:211],a[96:99],a[8:11]
v_sub_f32 v7, v7, v40
v_fmac_f32 v42, v6, v6
mf a[208:211],a[136:139],a[40:43]
dt a[108:109],v19,20480
v_fmac_f32 v43, v7, v7
mf a[212:215],a[136:139],a[44:47]
s_add_u32 s69, s69, 0x8000
v_lshlrev_b32 v6, 16, v39
v_and_b32 v7, 0xffff0000, v39
mf a[212:215],a[96:99],a[12:15]
dt a[110:111],v19,20992
v_sub_f32 v6, v6, v40
mf a[216:219],a[96:99],a[16:19]
s_add_u32 m0, s65, 36864
v_sub_f32 v7, v7, v40
v_fmac_f32 v42, v6, v6
mf a[216:219],a[136:139],a[48:51]
buffer_load_dwordx4 v8, s[56:59], s69 offen  lds
mf a[220:223],a[136:139],a[52:55]
v_fmac_f32 v43, v7, v7
v_add_f32 v42, v42, v43
mf a[220:223],a[96:99],a[20:23]
mf a[224:227],a[96:99],a[24:27]
v_add_f32_dpp v42, v42, v42 quad_perm:[1,0,3,2] row_mask:0xf bank_mask:0xf
mf a[224:227],a[136:139],a[56:59]
mf a[228:231],a[136:139],a[60:63]
s_add_u32 m0, s65, 37888
v_add_f32_dpp v42, v42, v42 quad_perm:[2,3,0,1] row_mask:0xf bank_mask:0xf
mf a[228:231],a[96:99],a[28:31]
buffer_load_dwordx4 v9, s[56:59], s69 offen  lds
mf v[248:251],a[100:103],a[0:3]
dq a[0:3],v16,0
v_add_f32_dpp v42, v42, v42 row_half_mirror row_mask:0xf bank_mask:0xf
mf v[248:251],a[140:143],a[32:35]
dq a[32:35],v17,0
v_add_f32_dpp v42, v42, v42 row_mirror row_mask:0xf bank_mask:0xf
mf v[252:255],a[140:143],a[36:39]
dq a[36:39],v17,2048
v_mov_b32 v43, v42
mf v[252:255],a[100:103],a[4:7]
dq a[4:7],v16,2048
v_permlane16_swap_b32 v43, v42
mf a[232:235],a[100:103],a[8:11]
dq a[8:11],v16,4096
v_add_f32 v42, v42, v43
mf a[232:235],a[140:143],a[40:43]
dq a[40:43],v17,4096
v_mul_f32 v42, 0x3a800000, v42
mf a[236:239],a[140:143],a[44:47]
dq a[44:47],v17,6144
v_cvt_pk_bf16_f32 v40, v40, v40
mf a[236:239],a[100:103],a[12:15]
dq a[12:15],v16,6144
v_lshlrev_b32 v40, 16, v40
mf a[240:243],a[100:103],a[16:19]
dq a[16:19],v16,8192
v_cvt_pk_bf16_f32 v42, v42, v42
mf a[240:243],a[140:143],a[48:51]
dq a[48:51],v17,8192
v_lshlrev_b32 v42, 16, v42
mf a[244:247],a[140:143],a[52:55]
dq a[52:55],v17,10240
v_add_f32 v42, 0x3727c5ac, v42
mf a[244:247],a[100:103],a[20:23]
dq a[20:23],v16,10240
v_cvt_pk_bf16_f32 v42, v42, v42
mf a[248:251],a[100:103],a[24:27]
dq a[24:27],v16,12288
v_lshlrev_b32 v42, 16, v42
mf a[248:251],a[140:143],a[56:59]
dq a[56:59],v17,12288
mf a[252:255],a[140:143],a[60:63]
s_add_u32 s69, s69, 0x8000
dq a[60:63],v17,14336
mf a[252:255],a[100:103],a[28:31]
s_waitcnt lgkmcnt(13)
dq a[28:31],v16,14336
mf v[48:51],a[72:75],a[0:3]
s_add_u32 m0, s65, 38912
dt a[96:97],v20,16384
mf v[48:51],a[112:115],a[32:35]
s_waitcnt lgkmcnt(13)
dt a[98:99],v20,16640
buffer_load_dwordx4 v8, s[56:59], s69 offen  lds
mf v[52:55],a[112:115],a[36:39]
dt a[136:137],v20,36864
mf v[52:55],a[72:75],a[4:7]
s_waitcnt lgkmcnt(13)
dt a[138:139],v20,37120
mf v[56:59],a[72:75],a[8:11]
dt a[100:101],v20,18432
mf v[56:59],a[112:115],a[40:43]
s_waitcnt lgkmcnt(13)
dt a[102:103],v20,18688
mf v[60:63],a[112:115],a[44:47]
dt a[140:141],v20,38912
mf v[60:63],a[72:75],a[12:15]
s_waitcnt lgkmcnt(13)
dt a[142:143],v20,39168
mf v[64:67],a[72:75],a[16:19]
s_add_u32 m0, s65, 39936
v_sqrt_f32 v42, v42
mf v[64:67],a[112:115],a[48:51]
s_waitcnt lgkmcnt(12)
buffer_load_dwordx4 v9, s[56:59], s69 offen  lds
mf v[68:71],a[112:115],a[52:55]
v_cvt_pk_bf16_f32 v42, v42, v42
v_lshlrev_b32 v42, 16, v42
mf v[68:71],a[72:75],a[20:23]
s_waitcnt lgkmcnt(10)
v_rcp_f32 v6, v42
mf v[72:75],a[72:75],a[24:27]
v_sub_f32 v44, 0, v40
v_mul_f32 v47, v42, v42
mf v[72:75],a[112:115],a[56:59]
s_waitcnt lgkmcnt(8)
v_mul_f32 v45, 0xc0135761, v6
v_mul_f32 v46, v6, v6
mf v[76:79],a[112:115],a[60:63]
v_mul_f32 v46, v46, v6
v_mul_f32 v46, 0xbdd2d3e8, v46
mf v[76:79],a[72:75],a[28:31]
s_waitcnt vmcnt(12) lgkmcnt(0)
s_barrier
mf v[108:111],a[76:79],a[28:31]
s_lshl_b32 s82, s23, 3
v_readlane_b32 s68, v13, 24
s_lshl_b32 s83, s20, 1
mf v[108:111],a[116:119],a[60:63]
s_add_u32 s82, s82, s83
dt a[72:73],v21,4096
s_mul_i32 s3, s24, 6144
mf v[104:107],a[116:119],a[56:59]
s_mul_i32 s70, s68, 393216
s_add_u32 s3, s3, 23592960
s_lshl_b32 s83, s82, 4
mf v[104:107],a[76:79],a[24:27]
s_mul_i32 s71, s68, 458752
dt a[74:75],v21,4608
s_add_u32 s83, s83, s3
mf v[100:103],a[76:79],a[20:23]
s_add_u32 s5, s71, 229376
s_lshl_b32 s82, s82, 2
s_add_u32 s82, s82, s3
mf v[100:103],a[116:119],a[52:55]
s_add_u32 s4, s70, 196608
dt a[112:113],v21,24576
s_add_u32 s82, s82, 4096
mf v[96:99],a[116:119],a[48:51]
v_and_b32 v40, 31, v2
v_lshlrev_b32 v40, 26, v40
mf v[96:99],a[76:79],a[16:19]
dt a[114:115],v21,25088
v_lshrrev_b32 v7, 1, v2
mf v[92:95],a[76:79],a[12:15]
s_add_u32 m0, s64, 4096
v_or_b32 v7, v7, v40
v_lshrrev_b32 v42, 3, v2
mf v[92:95],a[116:119],a[44:47]
buffer_load_dwordx4 v11, s[36:39], s71 offen offset:0  lds
mf v[88:91],a[116:119],a[40:43]
v_or_b32 v42, v42, v40
mf v[88:91],a[76:79],a[8:11]
buffer_store_dwordx4 v[44:47], v7, s[28:31], s83 offen sc1
mf v[84:87],a[76:79],a[4:7]
s_add_u32 m0, s64, 24576
mf v[84:87],a[116:119],a[36:39]
buffer_load_dwordx4 v11, s[36:39], s5 offen offset:0  lds
mf v[80:83],a[116:119],a[32:35]
mf v[80:83],a[76:79],a[0:3]
buffer_store_dword v44, v42, s[28:31], s82 offen sc1
mf v[112:115],a[80:83],a[0:3]
mf v[112:115],a[120:123],a[32:35]
dt a[76:77],v22,4096
buffer_store_dword v6, v42, s[28:31], s82 offen offset:1024 sc1
mf v[116:119],a[120:123],a[36:39]
mf v[116:119],a[80:83],a[4:7]
dt a[78:79],v22,4608
mf v[120:123],a[80:83],a[8:11]
mf v[120:123],a[120:123],a[40:43]
dt a[116:117],v22,24576
mf v[124:127],a[120:123],a[44:47]
mf v[124:127],a[80:83],a[12:15]
dt a[118:119],v22,25088
mf v[128:131],a[80:83],a[16:19]
s_add_u32 m0, s64, 8192
mf v[128:131],a[120:123],a[48:51]
buffer_load_dwordx4 v11, s[40:43], s71 offen offset:0  lds
mf v[132:135],a[120:123],a[52:55]
mf v[132:135],a[80:83],a[20:23]
mf v[136:139],a[80:83],a[24:27]
s_add_u32 m0, s64, 28672
mf v[136:139],a[120:123],a[56:59]
buffer_load_dwordx4 v11, s[40:43], s5 offen offset:0  lds
mf v[140:143],a[120:123],a[60:63]
mf v[140:143],a[80:83],a[28:31]
mf v[172:175],a[84:87],a[28:31]
mf v[172:175],a[124:127],a[60:63]
dt a[80:81],v21,8192
mf v[168:171],a[124:127],a[56:59]
mf v[168:171],a[84:87],a[24:27]
dt a[82:83],v21,8704
mf v[164:167],a[84:87],a[20:23]
mf v[164:167],a[124:127],a[52:55]
dt a[120:121],v21,28672
mf v[160:163],a[124:127],a[48:51]
mf v[160:163],a[84:87],a[16:19]
dt a[122:123],v21,29184
mf v[156:159],a[84:87],a[12:15]
s_add_u32 m0, s64, 10240
mf v[156:159],a[124:127],a[44:47]
buffer_load_dwordx4 v10, s[32:35], s70 offen offset:2048  lds
mf v[152:155],a[124:127],a[40:43]
mf v[152:155],a[84:87],a[8:11]
mf v[148:151],a[84:87],a[4:7]
s_add_u32 m0, s64, 30720
mf v[148:151],a[124:127],a[36:39]
buffer_load_dwordx4 v10, s[32:35], s4 offen offset:2048  lds
mf v[144:147],a[124:127],a[32:35]
mf v[144:147],a[84:87],a[0:3]
mf v[176:179],a[0:3],a[88:91]
mf v[176:179],a[32:35],a[128:131]
L_iw1KV_3:
L_stub3:
s_cbranch_execz L_stub7
dt a[84:85],v22,8192
mf v[180:183],a[36:39],a[128:131]
mf v[180:183],a[4:7],a[88:91]
dt a[86:87],v22,8704
mf v[184:187],a[8:11],a[88:91]
mf v[184:187],a[40:43],a[128:131]
dt a[124:125],v22,28672
mf v[188:191],a[44:47],a[128:131]
mf v[188:191],a[12:15],a[88:91]
dt a[126:127],v22,29184
mf v[192:195],a[16:19],a[88:91]
s_add_u32 m0, s64, 0
mf v[192:195],a[48:51],a[128:131]
buffer_load_dwordx4 v10, s[32:35], s70 offen offset:0  lds
mf v[196:199],a[52:55],a[128:131]
mf v[196:199],a[20:23],a[88:91]
mf v[200:203],a[24:27],a[88:91]
s_add_u32 m0, s64, 20480
mf v[200:203],a[56:59],a[128:131]
buffer_load_dwordx4 v10, s[32:35], s4 offen offset:0  lds
mf v[204:207],a[60:63],a[128:131]
mf v[204:207],a[28:31],a[88:91]
mf v[236:239],a[28:31],a[92:95]
mf v[236:239],a[60:63],a[132:135]
dt a[88:89],v21,12288
mf v[232:235],a[56:59],a[132:135]
mf v[232:235],a[24:27],a[92:95]
dt a[90:91],v21,12800
mf v[228:231],a[20:23],a[92:95]
mf v[228:231],a[52:55],a[132:135]
dt a[128:129],v21,32768
mf v[224:227],a[48:51],a[132:135]
mf v[224:227],a[16:19],a[92:95]
dt a[130:131],v21,33280
mf v[220:223],a[12:15],a[92:95]
s_add_u32 m0, s64, 16384
mf v[220:223],a[44:47],a[132:135]
buffer_load_dwordx4 v12, s[44:47], s71 offen offset:0  lds
mf v[216:219],a[40:43],a[132:135]
mf v[216:219],a[8:11],a[92:95]
mf v[212:215],a[4:7],a[92:95]
s_add_u32 m0, s64, 36864
mf v[212:215],a[36:39],a[132:135]
buffer_load_dwordx4 v12, s[44:47], s5 offen offset:0  lds
mf v[208:211],a[32:35],a[132:135]
mf v[208:211],a[0:3],a[92:95]
s_waitcnt vmcnt(13) lgkmcnt(0)
s_barrier
mf a[144:147],a[0:3],a[64:67]
s_lshl_b32 s69, s68, 7
s_lshl_b32 s3, s78, 11
v_lshrrev_b32 v6, 2, v2
mf a[144:147],a[32:35],a[104:107]
dt a[92:93],v22,12288
v_lshl_add_u32 v6, v6, 7, s3
mf a[148:151],a[36:39],a[104:107]
mf a[148:151],a[4:7],a[64:67]
dt a[94:95],v22,12800
mf a[152:155],a[8:11],a[64:67]
mf a[152:155],a[40:43],a[104:107]
dt a[132:133],v22,32768
mf a[156:159],a[44:47],a[104:107]
mf a[156:159],a[12:15],a[64:67]
dt a[134:135],v22,33280
mf a[160:163],a[16:19],a[64:67]
s_add_u32 m0, s65, 0
mf a[160:163],a[48:51],a[104:107]
buffer_load_dwordx4 v8, s[56:59], s69 offen  lds
mf a[164:167],a[52:55],a[104:107]
mf a[164:167],a[20:23],a[64:67]
s_mov_b32 m0, 147456
s_nop 0
buffer_load_dword v6, s[52:55], 0 offen lds
mf a[168:171],a[24:27],a[64:67]
mf a[168:171],a[56:59],a[104:107]
s_mov_b32 m0, 147456
s_nop 0
buffer_load_dword v15, s[48:51], s89 offen lds
mf a[172:175],a[60:63],a[104:107]
s_add_u32 m0, s65, 1024
s_add_u32 s89, s89, 0x100000
mf a[172:175],a[28:31],a[64:67]
buffer_load_dwordx4 v9, s[56:59], s69 offen  lds
mf a[204:207],a[28:31],a[68:71]
mf a[204:207],a[60:63],a[108:111]
dt a[64:65],v21,0
mf a[200:203],a[56:59],a[108:111]
mf a[200:203],a[24:27],a[68:71]
dt a[66:67],v21,512
mf a[196:199],a[20:23],a[68:71]
mf a[196:199],a[52:55],a[108:111]
dt a[104:105],v21,20480
mf a[192:195],a[48:51],a[108:111]
s_add_u32 s69, s69, 0x8000
mf a[192:195],a[16:19],a[68:71]
dt a[106:107],v21,20992
mf a[188:191],a[12:15],a[68:71]
s_add_u32 m0, s65, 2048
mf a[188:191],a[44:47],a[108:111]
buffer_load_dwordx4 v8, s[56:59], s69 offen  lds
mf a[184:187],a[40:43],a[108:111]
mf a[184:187],a[8:11],a[68:71]
s_mov_b32 m0, 147456
s_nop 0
buffer_load_dword v15, s[48:51], s89 offen lds
mf a[180:183],a[4:7],a[68:71]
s_add_u32 s89, s89, 0x100000
mf a[180:183],a[36:39],a[108:111]
mf a[176:179],a[32:35],a[108:111]
s_add_u32 m0, s65, 3072
mf a[176:179],a[0:3],a[68:71]
buffer_load_dwordx4 v9, s[56:59], s69 offen  lds
mf v[240:243],a[96:99],a[0:3]
mf v[240:243],a[136:139],a[32:35]
dt a[68:69],v22,0
mf v[244:247],a[136:139],a[36:39]
mf v[244:247],a[96:99],a[4:7]
dt a[70:71],v22,512
mf a[208:211],a[96:99],a[8:11]
mf a[208:211],a[136:139],a[40:43]
dt a[108:109],v22,20480
mf a[212:215],a[136:139],a[44:47]
s_add_u32 s69, s69, 0x8000
mf a[212:215],a[96:99],a[12:15]
dt a[110:111],v22,20992
mf a[216:219],a[96:99],a[16:19]
s_add_u32 m0, s65, 4096
mf a[216:219],a[136:139],a[48:51]
buffer_load_dwordx4 v8, s[56:59], s69 offen  lds
mf a[220:223],a[136:139],a[52:55]
mf a[220:223],a[96:99],a[20:23]
mf a[224:227],a[96:99],a[24:27]
mf a[224:227],a[136:139],a[56:59]
mf a[228:231],a[136:139],a[60:63]
s_add_u32 m0, s65, 5120
mf a[228:231],a[96:99],a[28:31]
buffer_load_dwordx4 v9, s[56:59], s69 offen  lds
mf v[248:251],a[100:103],a[0:3]
dq a[0:3],v16,32768
mf v[248:251],a[140:143],a[32:35]
dq a[32:35],v17,32768
mf v[252:255],a[140:143],a[36:39]
dq a[36:39],v17,34816
mf v[252:255],a[100:103],a[4:7]
dq a[4:7],v16,34816
mf a[232:235],a[100:103],a[8:11]
dq a[8:11],v16,36864
mf a[232:235],a[140:143],a[40:43]
dq a[40:43],v17,36864
mf a[236:239],a[140:143],a[44:47]
dq a[44:47],v17,38912
mf a[236:239],a[100:103],a[12:15]
dq a[12:15],v16,38912
mf a[240:243],a[100:103],a[16:19]
dq a[16:19],v16,40960
mf a[240:243],a[140:143],a[48:51]
dq a[48:51],v17,40960
mf a[244:247],a[140:143],a[52:55]
dq a[52:55],v17,43008
mf a[244:247],a[100:103],a[20:23]
dq a[20:23],v16,43008
mf a[248:251],a[100:103],a[24:27]
dq a[24:27],v16,45056
mf a[248:251],a[140:143],a[56:59]
dq a[56:59],v17,45056
mf a[252:255],a[140:143],a[60:63]
s_add_u32 s69, s69, 0x8000
dq a[60:63],v17,47104
mf a[252:255],a[100:103],a[28:31]
s_waitcnt lgkmcnt(13)
dq a[28:31],v16,47104
mf v[48:51],a[72:75],a[0:3]
s_add_u32 m0, s65, 6144
dt a[96:97],v23,16384
mf v[48:51],a[112:115],a[32:35]
s_waitcnt lgkmcnt(13)
dt a[98:99],v23,16640
buffer_load_dwordx4 v8, s[56:59], s69 offen  lds
mf v[52:55],a[112:115],a[36:39]
dt a[136:137],v23,36864
mf v[52:55],a[72:75],a[4:7]
s_waitcnt lgkmcnt(13)
dt a[138:139],v23,37120
mf v[56:59],a[72:75],a[8:11]
dt a[100:101],v23,18432
mf v[56:59],a[112:115],a[40:43]
s_waitcnt lgkmcnt(13)
dt a[102:103],v23,18688
mf v[60:63],a[112:115],a[44:47]
dt a[140:141],v23,38912
mf v[60:63],a[72:75],a[12:15]
s_waitcnt lgkmcnt(13)
dt a[142:143],v23,39168
mf v[64:67],a[72:75],a[16:19]
s_add_u32 m0, s65, 7168
mf v[64:67],a[112:115],a[48:51]
s_waitcnt lgkmcnt(12)
buffer_load_dwordx4 v9, s[56:59], s69 offen  lds
mf v[68:71],a[112:115],a[52:55]
mf v[68:71],a[72:75],a[20:23]
s_waitcnt lgkmcnt(10)
mf v[72:75],a[72:75],a[24:27]
mf v[72:75],a[112:115],a[56:59]
s_waitcnt lgkmcnt(8)
mf v[76:79],a[112:115],a[60:63]
mf v[76:79],a[72:75],a[28:31]
s_waitcnt vmcnt(15) lgkmcnt(0)
s_barrier
mf v[108:111],a[76:79],a[28:31]
s_lshl_b32 s82, s24, 5
v_readlane_b32 s68, v13, 26
s_add_u32 s82, s82, s23
mf v[108:111],a[116:119],a[60:63]
s_lshl_b32 s82, s82, 5
dt a[72:73],v18,4096
s_add_u32 s82, s82, 23642112
mf v[104:107],a[116:119],a[56:59]
s_mul_i32 s70, s68, 393216
v_or_b32 v7, s20, v2
v_lshlrev_b32 v7, 25, v7
mf v[104:107],a[76:79],a[24:27]
s_mul_i32 s71, s68, 458752
dt a[74:75],v18,4608
v_add_u32 v6, 1, v5
mf v[100:103],a[76:79],a[20:23]
s_add_u32 s5, s71, 229376
mf v[100:103],a[116:119],a[52:55]
s_add_u32 s4, s70, 196608
dt a[112:113],v18,24576
buffer_store_dword v6, v7, s[28:31], s82 offen sc1
mf v[96:99],a[116:119],a[48:51]
s_and_b32 s83, s23, 3
s_xor_b32 s83, s83, 1
s_mov_b32 s82, s24
mf v[96:99],a[76:79],a[16:19]
s_and_b32 s3, s2, 7
dt a[114:115],v18,25088
s_and_b32 s75, s3, 1
mf v[92:95],a[76:79],a[12:15]
s_add_u32 m0, s64, 45056
s_bfe_u32 s74, s3, 0x10001
s_lshl_b32 s74, s74, 2
mf v[92:95],a[116:119],a[44:47]
s_add_u32 s74, s74, s83
buffer_load_dwordx4 v11, s[36:39], s71 offen offset:0  lds
s_lshr_b32 s73, s3, 2
mf v[88:91],a[116:119],a[40:43]
s_lshl_b32 s73, s73, 3
s_add_u32 s73, s73, s82
s_add_u32 s72, s83, s82
mf v[88:91],a[76:79],a[8:11]
s_lshr_b32 s15, s15, 1
s_xor_b32 s15, s15, s2
s_xor_b32 s15, s15, 0
mf v[84:87],a[76:79],a[4:7]
s_add_u32 m0, s64, 65536
s_and_b32 s15, s15, 1
s_lshl_b32 s15, s15, 2
mf v[84:87],a[116:119],a[36:39]
s_sub_u32 s17, 13, s15
buffer_load_dwordx4 v11, s[36:39], s5 offen offset:0  lds
mf v[80:83],a[116:119],a[32:35]
v_subrev_u32 v47, 20, v2
v_cmp_gt_u32 vcc, 10, v47
mf v[80:83],a[76:79],a[0:3]
v_subrev_u32 v47, s15, v2
mf v[112:115],a[80:83],a[0:3]
v_cndmask_b32 v47, v2, v47, vcc
v_subrev_u32 v6, s72, v47
mf v[112:115],a[120:123],a[32:35]
dt a[76:77],v19,4096
v_add_u32 v6, 1, v6
mf v[116:119],a[120:123],a[36:39]
v_and_b32 v6, 3, v6
v_cmp_ge_u32 vcc, 1, v6
mf v[116:119],a[80:83],a[4:7]
dt a[78:79],v19,4608
v_mov_b32 v45, -1
mf v[120:123],a[80:83],a[8:11]
v_mov_b32 v46, 1
v_cndmask_b32 v7, 0, v45, vcc
mf v[120:123],a[120:123],a[40:43]
dt a[116:117],v19,24576
v_cmp_eq_u32 vcc, 0, v6
mf v[124:127],a[120:123],a[44:47]
v_sub_u32 v6, v47, v6
v_mov_b32 v45, 0
mf v[124:127],a[80:83],a[12:15]
dt a[118:119],v19,25088
v_cndmask_b32 v7, v7, v46, vcc
mf v[128:131],a[80:83],a[16:19]
s_add_u32 m0, s64, 49152
v_subrev_u32 v46, 4, v6
v_cmp_gt_u32 vcc, 11, v46
mf v[128:131],a[120:123],a[48:51]
buffer_load_dwordx4 v11, s[40:43], s71 offen offset:0  lds
mf v[132:135],a[120:123],a[52:55]
v_cndmask_b32 v45, v45, v7, vcc
v_subrev_u32 v46, 16, v6
mf v[132:135],a[80:83],a[20:23]
v_cmp_gt_u32 vcc, s17, v46
mf v[136:139],a[80:83],a[24:27]
s_add_u32 m0, s64, 69632
v_cndmask_b32 v45, v45, v7, vcc
v_subrev_u32 v46, 30, v6
mf v[136:139],a[120:123],a[56:59]
buffer_load_dwordx4 v11, s[40:43], s5 offen offset:0  lds
mf v[140:143],a[120:123],a[60:63]
v_cmp_gt_u32 vcc, 15, v46
mf v[140:143],a[80:83],a[28:31]
mf v[172:175],a[84:87],a[28:31]
v_cndmask_b32 v45, v45, v7, vcc
v_add_u32 v6, s72, v47
mf v[172:175],a[124:127],a[60:63]
dt a[80:81],v18,8192
v_and_b32 v6, 3, v6
mf v[168:171],a[124:127],a[56:59]
v_and_b32 v7, 60, v47
v_or_b32 v6, v6, v7
mf v[168:171],a[84:87],a[24:27]
dt a[82:83],v18,8704
v_add_u32 v24, v47, v45
mf v[164:167],a[84:87],a[20:23]
v_cmp_eq_u32 vcc, 0, v7
mf v[164:167],a[124:127],a[52:55]
dt a[120:121],v18,28672
v_cndmask_b32 v24, v24, v6, vcc
mf v[160:163],a[124:127],a[48:51]
v_subrev_u32 v47, 24, v24
v_bfe_u32 v6, v24, 1, 2
mf v[160:163],a[84:87],a[16:19]
dt a[122:123],v18,29184
v_mul_u32_u24 v6, 14, v6
mf v[156:159],a[84:87],a[12:15]
s_add_u32 m0, s64, 51200
v_lshrrev_b32 v7, 3, v24
v_lshlrev_b32 v7, 1, v7
mf v[156:159],a[124:127],a[44:47]
buffer_load_dwordx4 v10, s[32:35], s70 offen offset:2048  lds
mf v[152:155],a[124:127],a[40:43]
v_and_b32 v45, 1, v24
v_or_b32 v7, v7, v45
mf v[152:155],a[84:87],a[8:11]
v_lshlrev_b32 v7, 2, v7
v_mov_b32 v45, 0x514260
mf v[148:151],a[84:87],a[4:7]
s_add_u32 m0, s64, 71680
v_bfe_u32 v7, v45, v7, 4
v_add_u32 v6, v6, v7
mf v[148:151],a[124:127],a[36:39]
buffer_load_dwordx4 v10, s[32:35], s4 offen offset:2048  lds
mf v[144:147],a[124:127],a[32:35]
v_mad_u32_u24 v45, v47, 14, 3
v_cmp_le_u32 vcc, 24, v24
mf v[144:147],a[84:87],a[0:3]
s_mul_i32 s82, s75, 7
mf v[176:179],a[0:3],a[88:91]
v_cndmask_b32 v6, v6, v45, vcc
v_add_u32 v6, s82, v6
mf v[176:179],a[32:35],a[128:131]
s_add_u32 s82, s82, 21
dt a[84:85],v19,8192
v_cmp_le_u32 vcc, 28, v24
mf v[180:183],a[36:39],a[128:131]
v_subrev_u32 v45, s82, v45
mf v[180:183],a[4:7],a[88:91]
dt a[86:87],v19,8704
v_cndmask_b32 v6, v6, v45, vcc
mf v[184:187],a[8:11],a[88:91]
v_cmp_le_u32 vcc, 30, v24
v_subrev_u32 v45, 30, v24
mf v[184:187],a[40:43],a[128:131]
dt a[124:125],v19,28672
v_cndmask_b32 v24, v6, v45, vcc
mf v[188:191],a[44:47],a[128:131]
v_cmp_gt_u32 vcc, 6, v47
v_lshlrev_b32 v25, 17, v24
mf v[188:191],a[12:15],a[88:91]
dt a[126:127],v19,29184
v_lshlrev_b32 v24, 14, v24
mf v[192:195],a[16:19],a[88:91]
s_add_u32 m0, s64, 40960
s_lshl_b32 s82, s22, 14
v_mov_b32 v6, s82
mf v[192:195],a[48:51],a[128:131]
buffer_load_dwordx4 v10, s[32:35], s70 offen offset:0  lds
mf v[196:199],a[52:55],a[128:131]
v_mov_b32 v7, 0x4000
v_cndmask_b32 v6, 0, v6, vcc
mf v[196:199],a[20:23],a[88:91]
v_cndmask_b32 v7, 0, v7, vcc
v_sub_u32 v25, v25, v6
mf v[200:203],a[24:27],a[88:91]
s_add_u32 m0, s64, 61440
v_add_u32 v26, 0x4000, v25
v_add_u32 v26, v26, v7
mf v[200:203],a[56:59],a[128:131]
s_lshl_b32 s80, s73, 11
buffer_load_dwordx4 v10, s[32:35], s4 offen offset:0  lds
s_add_u32 s80, s80, 23658496
mf v[204:207],a[60:63],a[128:131]
s_lshl_b32 s83, s20, 9
s_add_u32 s83, s83, s80
v_lshrrev_b32 v7, 2, v2
mf v[204:207],a[28:31],a[88:91]
v_lshl_add_u32 v28, v7, 5, s83
s_lshl_b32 s83, s21, 5
mf v[236:239],a[28:31],a[92:95]
s_add_u32 s80, s80, s83
s_lshl_b32 s83, s75, 8
s_add_u32 s83, s83, s80
mf v[236:239],a[60:63],a[132:135]
dt a[88:89],v18,12288
v_lshrrev_b32 v6, 4, v2
mf v[232:235],a[56:59],a[132:135]
v_lshl_add_u32 v6, v6, 9, s83
v_and_b32 v7, 3, v7
mf v[232:235],a[24:27],a[92:95]
dt a[90:91],v18,12800
v_lshl_add_u32 v27, v7, 6, v6
mf v[228:231],a[20:23],a[92:95]
s_add_u32 s80, s80, 64
s_lshl_b32 s78, s24, 1
s_add_u32 s78, s78, s21
mf v[228:231],a[52:55],a[132:135]
s_lshl_b32 s79, s78, 6
dt a[128:129],v18,32768
s_lshl_b32 s82, s23, 1
mf v[224:227],a[48:51],a[132:135]
s_add_u32 s79, s79, s82
s_add_u32 s79, s79, s22
s_lshl_b32 s79, s79, 5
mf v[224:227],a[16:19],a[92:95]
s_add_u32 s79, s79, 23658496
dt a[130:131],v18,33280
s_mul_i32 s78, s78, 1179648
mf v[220:223],a[12:15],a[92:95]
s_add_u32 m0, s64, 57344
s_add_u32 s78, s78, 262144
s_lshl_b32 s14, s73, 3
mf v[220:223],a[44:47],a[132:135]
s_add_u32 s14, s14, s74
buffer_load_dwordx4 v12, s[44:47], s71 offen offset:0  lds
s_lshl_b32 s14, s14, 1
mf v[216:219],a[40:43],a[132:135]
s_add_u32 s14, s14, s75
s_lshl_b32 s14, s14, 2
s_add_u32 s14, s14, s20
mf v[216:219],a[8:11],a[92:95]
s_lshl_b32 s66, s20, 12
s_mul_i32 s82, s73, 1179648
s_add_u32 s82, s82, s66
mf v[212:215],a[4:7],a[92:95]
s_add_u32 m0, s64, 77824
s_add_u32 s83, s82, 262144
v_add_u32 v29, s83, v3
mf v[212:215],a[36:39],a[132:135]
s_lshl_b32 s3, s75, 11
buffer_load_dwordx4 v12, s[44:47], s5 offen offset:0  lds
s_add_u32 s83, s82, s3
mf v[208:211],a[32:35],a[132:135]
v_add_u32 v30, s83, v3
s_add_u32 s66, s66, s3
mf v[208:211],a[0:3],a[92:95]
s_waitcnt vmcnt(11) lgkmcnt(0)
s_barrier
mf a[144:147],a[0:3],a[64:67]
s_lshl_b32 s69, s68, 7
v_lshrrev_b32 v6, 3, v2
s_lshl_b32 s82, s20, 4
mf a[144:147],a[32:35],a[104:107]
dt a[92:93],v19,12288
v_add_u32 v6, s82, v6
mf a[148:151],a[36:39],a[104:107]
v_lshlrev_b32 v6, 11, v6
v_lshrrev_b32 v7, 4, v2
mf a[148:151],a[4:7],a[64:67]
dt a[94:95],v19,12800
v_lshlrev_b32 v7, 1, v7
mf a[152:155],a[8:11],a[64:67]
v_and_b32 v45, 7, v2
v_xor_b32 v7, v7, v45
mf a[152:155],a[40:43],a[104:107]
dt a[132:133],v19,32768
v_lshl_add_u32 v6, v7, 4, v6
mf a[156:159],a[44:47],a[104:107]
s_lshl_b32 s81, s74, 7
s_and_b32 s82, s81, 127
s_andn2_b32 s81, s81, 127
mf a[156:159],a[12:15],a[64:67]
s_lshl_b32 s81, s81, 1
dt a[134:135],v19,33280
s_or_b32 s81, s81, s82
mf a[160:163],a[16:19],a[64:67]
s_add_u32 m0, s65, 32768
v_add_u32 v31, s81, v6
s_lshl_b32 s67, s20, 11
mf a[160:163],a[48:51],a[104:107]
s_add_u32 s67, s67, 0x10000
buffer_load_dwordx4 v8, s[56:59], s69 offen  lds
s_lshl_b32 s82, s21, 12
mf a[164:167],a[52:55],a[104:107]
s_add_u32 s82, s82, s3
v_add_u32 v32, s82, v3
v_xor_b32 v33, 2048, v32
mf a[164:167],a[20:23],a[64:67]
v_lshrrev_b32 v6, 2, v2
v_lshlrev_b32 v6, 7, v6
mf a[168:171],a[24:27],a[64:67]
v_and_b32 v7, 3, v2
v_lshl_add_u32 v6, v7, 3, v6
mf a[168:171],a[56:59],a[104:107]
v_bfe_u32 v7, v2, 3, 2
v_lshl_add_u32 v6, v7, 5, v6
mf a[172:175],a[60:63],a[104:107]
s_add_u32 m0, s65, 33792
s_lshl_b32 s82, s22, 13
s_add_u32 s82, s82, 0x10000
mf a[172:175],a[28:31],a[64:67]
buffer_load_dwordx4 v9, s[56:59], s69 offen  lds
mf a[204:207],a[28:31],a[68:71]
v_add_u32 v34, s82, v6
v_xor_b32 v35, 32, v34
mf a[204:207],a[60:63],a[108:111]
dt a[64:65],v18,0
v_xor_b32 v36, 64, v34
mf a[200:203],a[56:59],a[108:111]
v_xor_b32 v37, 96, v34
s_lshl_b32 s82, s73, 7
mf a[200:203],a[24:27],a[68:71]
s_lshl_b32 s83, s21, 6
dt a[66:67],v18,512
s_add_u32 s82, s82, s83
mf a[196:199],a[20:23],a[68:71]
s_lshl_b32 s83, s75, 5
s_add_u32 s82, s82, s83
v_and_b32 v45, 15, v2
mf a[196:199],a[52:55],a[108:111]
dt a[104:105],v18,20480
v_lshrrev_b32 v6, 3, v2
mf a[192:195],a[48:51],a[108:111]
s_add_u32 s69, s69, 0x8000
v_add_u32 v6, s82, v6
v_lshlrev_b32 v6, 11, v6
mf a[192:195],a[16:19],a[68:71]
dt a[106:107],v18,20992
v_and_b32 v7, 7, v2
mf a[188:191],a[12:15],a[68:71]
s_add_u32 m0, s65, 34816
v_lshl_add_u32 v6, v7, 4, v6
s_mul_i32 s83, s22, 128
mf a[188:191],a[44:47],a[108:111]
s_add_u32 s82, s81, s83
buffer_load_dwordx4 v8, s[56:59], s69 offen  lds
mf a[184:187],a[40:43],a[108:111]
v_add_u32 v38, s82, v6
s_mov_b32 s18, 0x3fb8aa3b
mf a[184:187],a[8:11],a[68:71]
s_mov_b32 s19, s18
v_mov_b32 v40, 0x358637bd
s_mov_b32 s16, 32768
mf a[180:183],a[4:7],a[68:71]
s_lshl_b32 s82, s21, 11
s_add_u32 s82, s82, 157696
v_lshl_add_u32 v43, v45, 4, s82
mf a[180:183],a[36:39],a[108:111]
s_mul_i32 s82, s22, 640
s_add_u32 s82, s82, 156416
v_and_b32 v6, 48, v2
mf a[176:179],a[32:35],a[108:111]
s_add_u32 m0, s65, 35840
v_add_u32 v44, s82, v6
s_mul_i32 s82, s20, 320
mf a[176:179],a[0:3],a[68:71]
s_add_u32 s82, s82, 147456
buffer_load_dwordx4 v9, s[56:59], s69 offen  lds
mf v[240:243],a[96:99],a[0:3]
v_min_u32 v6, 39, v2
v_lshl_add_u32 v47, v6, 3, s82
mf v[240:243],a[136:139],a[32:35]
dt a[68:69],v19,0
mf v[244:247],a[136:139],a[36:39]
mf v[244:247],a[96:99],a[4:7]
dt a[70:71],v19,512
mf a[208:211],a[96:99],a[8:11]
mf a[208:211],a[136:139],a[40:43]
dt a[108:109],v19,20480
mf a[212:215],a[136:139],a[44:47]
s_add_u32 s69, s69, 0x8000
mf a[212:215],a[96:99],a[12:15]
dt a[110:111],v19,20992
mf a[216:219],a[96:99],a[16:19]
s_add_u32 m0, s65, 36864
mf a[216:219],a[136:139],a[48:51]
buffer_load_dwordx4 v8, s[56:59], s69 offen  lds
mf a[220:223],a[136:139],a[52:55]
mf a[220:223],a[96:99],a[20:23]
s_mov_b32 m0, 147456
s_nop 0
buffer_load_dword v15, s[48:51], s89 offen lds
L_stub4:
s_cbranch_execz L_stub8
mf a[224:227],a[96:99],a[24:27]
s_add_u32 s89, s89, 0x100000
mf a[224:227],a[136:139],a[56:59]
mf a[228:231],a[136:139],a[60:63]
s_add_u32 m0, s65, 37888
mf a[228:231],a[96:99],a[28:31]
buffer_load_dwordx4 v9, s[56:59], s69 offen  lds
mf v[248:251],a[100:103],a[0:3]
dq a[0:3],v16,0
mf v[248:251],a[140:143],a[32:35]
dq a[32:35],v17,0
mf v[252:255],a[140:143],a[36:39]
dq a[36:39],v17,2048
mf v[252:255],a[100:103],a[4:7]
dq a[4:7],v16,2048
mf a[232:235],a[100:103],a[8:11]
dq a[8:11],v16,4096
mf a[232:235],a[140:143],a[40:43]
dq a[40:43],v17,4096
mf a[236:239],a[140:143],a[44:47]
dq a[44:47],v17,6144
mf a[236:239],a[100:103],a[12:15]
dq a[12:15],v16,6144
mf a[240:243],a[100:103],a[16:19]
dq a[16:19],v16,8192
mf a[240:243],a[140:143],a[48:51]
dq a[48:51],v17,8192
mf a[244:247],a[140:143],a[52:55]
dq a[52:55],v17,10240
mf a[244:247],a[100:103],a[20:23]
dq a[20:23],v16,10240
mf a[248:251],a[100:103],a[24:27]
dq a[24:27],v16,12288
mf a[248:251],a[140:143],a[56:59]
dq a[56:59],v17,12288
mf a[252:255],a[140:143],a[60:63]
s_add_u32 s69, s69, 0x8000
dq a[60:63],v17,14336
mf a[252:255],a[100:103],a[28:31]
s_waitcnt lgkmcnt(13)
dq a[28:31],v16,14336
mf v[48:51],a[72:75],a[0:3]
s_add_u32 m0, s65, 38912
dt a[96:97],v20,16384
mf v[48:51],a[112:115],a[32:35]
s_waitcnt lgkmcnt(13)
dt a[98:99],v20,16640
buffer_load_dwordx4 v8, s[56:59], s69 offen  lds
mf v[52:55],a[112:115],a[36:39]
dt a[136:137],v20,36864
mf v[52:55],a[72:75],a[4:7]
s_waitcnt lgkmcnt(13)
dt a[138:139],v20,37120
mf v[56:59],a[72:75],a[8:11]
dt a[100:101],v20,18432
mf v[56:59],a[112:115],a[40:43]
s_waitcnt lgkmcnt(13)
dt a[102:103],v20,18688
mf v[60:63],a[112:115],a[44:47]
dt a[140:141],v20,38912
mf v[60:63],a[72:75],a[12:15]
s_waitcnt lgkmcnt(13)
dt a[142:143],v20,39168
mf v[64:67],a[72:75],a[16:19]
s_add_u32 m0, s65, 39936
mf v[64:67],a[112:115],a[48:51]
s_waitcnt lgkmcnt(12)
buffer_load_dwordx4 v9, s[56:59], s69 offen  lds
mf v[68:71],a[112:115],a[52:55]
mf v[68:71],a[72:75],a[20:23]
s_waitcnt lgkmcnt(10)
mf v[72:75],a[72:75],a[24:27]
mf v[72:75],a[112:115],a[56:59]
s_waitcnt lgkmcnt(8)
mf v[76:79],a[112:115],a[60:63]
mf v[76:79],a[72:75],a[28:31]
s_waitcnt vmcnt(13) lgkmcnt(0)
s_barrier
mf v[108:111],a[76:79],a[28:31]
v_readlane_b32 s68, v13, 28
mf v[108:111],a[116:119],a[60:63]
dt a[72:73],v21,4096
mf v[104:107],a[116:119],a[56:59]
s_mul_i32 s70, s68, 393216
mf v[104:107],a[76:79],a[24:27]
s_mul_i32 s71, s68, 458752
dt a[74:75],v21,4608
mf v[100:103],a[76:79],a[20:23]
s_add_u32 s5, s71, 229376
mf v[100:103],a[116:119],a[52:55]
s_add_u32 s4, s70, 196608
dt a[112:113],v21,24576
mf v[96:99],a[116:119],a[48:51]
mf v[96:99],a[76:79],a[16:19]
dt a[114:115],v21,25088
mf v[92:95],a[76:79],a[12:15]
s_add_u32 m0, s64, 4096
mf v[92:95],a[116:119],a[44:47]
buffer_load_dwordx4 v11, s[36:39], s71 offen offset:0  lds
mf v[88:91],a[116:119],a[40:43]
mf v[88:91],a[76:79],a[8:11]
mf v[84:87],a[76:79],a[4:7]
s_add_u32 m0, s64, 24576
mf v[84:87],a[116:119],a[36:39]
buffer_load_dwordx4 v11, s[36:39], s5 offen offset:0  lds
mf v[80:83],a[116:119],a[32:35]
mf v[80:83],a[76:79],a[0:3]
mf v[112:115],a[80:83],a[0:3]
mf v[112:115],a[120:123],a[32:35]
dt a[76:77],v22,4096
mf v[116:119],a[120:123],a[36:39]
mf v[116:119],a[80:83],a[4:7]
dt a[78:79],v22,4608
mf v[120:123],a[80:83],a[8:11]
mf v[120:123],a[120:123],a[40:43]
dt a[116:117],v22,24576
mf v[124:127],a[120:123],a[44:47]
mf v[124:127],a[80:83],a[12:15]
dt a[118:119],v22,25088
mf v[128:131],a[80:83],a[16:19]
s_add_u32 m0, s64, 8192
mf v[128:131],a[120:123],a[48:51]
buffer_load_dwordx4 v11, s[40:43], s71 offen offset:0  lds
mf v[132:135],a[120:123],a[52:55]
mf v[132:135],a[80:83],a[20:23]
mf v[136:139],a[80:83],a[24:27]
s_add_u32 m0, s64, 28672
mf v[136:139],a[120:123],a[56:59]
buffer_load_dwordx4 v11, s[40:43], s5 offen offset:0  lds
mf v[140:143],a[120:123],a[60:63]
mf v[140:143],a[80:83],a[28:31]
mf v[172:175],a[84:87],a[28:31]
mf v[172:175],a[124:127],a[60:63]
dt a[80:81],v21,8192
mf v[168:171],a[124:127],a[56:59]
mf v[168:171],a[84:87],a[24:27]
dt a[82:83],v21,8704
mf v[164:167],a[84:87],a[20:23]
mf v[164:167],a[124:127],a[52:55]
dt a[120:121],v21,28672
mf v[160:163],a[124:127],a[48:51]
mf v[160:163],a[84:87],a[16:19]
dt a[122:123],v21,29184
mf v[156:159],a[84:87],a[12:15]
s_add_u32 m0, s64, 10240
mf v[156:159],a[124:127],a[44:47]
buffer_load_dwordx4 v10, s[32:35], s70 offen offset:2048  lds
mf v[152:155],a[124:127],a[40:43]
mf v[152:155],a[84:87],a[8:11]
mf v[148:151],a[84:87],a[4:7]
s_add_u32 m0, s64, 30720
mf v[148:151],a[124:127],a[36:39]
buffer_load_dwordx4 v10, s[32:35], s4 offen offset:2048  lds
mf v[144:147],a[124:127],a[32:35]
mf v[144:147],a[84:87],a[0:3]
mf v[176:179],a[0:3],a[88:91]
mf v[176:179],a[32:35],a[128:131]
dt a[84:85],v22,8192
mf v[180:183],a[36:39],a[128:131]
mf v[180:183],a[4:7],a[88:91]
dt a[86:87],v22,8704
mf v[184:187],a[8:11],a[88:91]
mf v[184:187],a[40:43],a[128:131]
dt a[124:125],v22,28672
mf v[188:191],a[44:47],a[128:131]
mf v[188:191],a[12:15],a[88:91]
dt a[126:127],v22,29184
mf v[192:195],a[16:19],a[88:91]
s_add_u32 m0, s64, 0
mf v[192:195],a[48:51],a[128:131]
buffer_load_dwordx4 v10, s[32:35], s70 offen offset:0  lds
mf v[196:199],a[52:55],a[128:131]
mf v[196:199],a[20:23],a[88:91]
mf v[200:203],a[24:27],a[88:91]
s_add_u32 m0, s64, 20480
mf v[200:203],a[56:59],a[128:131]
buffer_load_dwordx4 v10, s[32:35], s4 offen offset:0  lds
mf v[204:207],a[60:63],a[128:131]
mf v[204:207],a[28:31],a[88:91]
mf v[236:239],a[28:31],a[92:95]
mf v[236:239],a[60:63],a[132:135]
dt a[88:89],v21,12288
mf v[232:235],a[56:59],a[132:135]
mf v[232:235],a[24:27],a[92:95]
dt a[90:91],v21,12800
mf v[228:231],a[20:23],a[92:95]
mf v[228:231],a[52:55],a[132:135]
dt a[128:129],v21,32768
mf v[224:227],a[48:51],a[132:135]
mf v[224:227],a[16:19],a[92:95]
dt a[130:131],v21,33280
mf v[220:223],a[12:15],a[92:95]
s_add_u32 m0, s64, 16384
mf v[220:223],a[44:47],a[132:135]
buffer_load_dwordx4 v12, s[44:47], s71 offen offset:0  lds
mf v[216:219],a[40:43],a[132:135]
mf v[216:219],a[8:11],a[92:95]
mf v[212:215],a[4:7],a[92:95]
s_add_u32 m0, s64, 36864
mf v[212:215],a[36:39],a[132:135]
buffer_load_dwordx4 v12, s[44:47], s5 offen offset:0  lds
mf v[208:211],a[32:35],a[132:135]
mf v[208:211],a[0:3],a[92:95]
s_waitcnt vmcnt(10) lgkmcnt(0)
s_barrier
mf a[144:147],a[0:3],a[64:67]
s_lshl_b32 s69, s68, 7
s_lshl_b32 s82, s24, 5
v_add_u32 v6, s82, v2
mf a[144:147],a[32:35],a[104:107]
dt a[92:93],v22,12288
v_and_b32 v7, 7, v2
mf a[148:151],a[36:39],a[104:107]
v_cmp_gt_u32 vcc, 32, v2
v_lshlrev_b32 v7, 5, v7
mf a[148:151],a[4:7],a[64:67]
dt a[94:95],v22,12800
v_add_u32 v7, s23, v7
mf a[152:155],a[8:11],a[64:67]
v_cndmask_b32 v6, v7, v6, vcc
v_lshlrev_b32 v6, 5, v6
mf a[152:155],a[40:43],a[104:107]
dt a[132:133],v22,32768
v_add_u32 v41, 23642112, v6
mf a[156:159],a[44:47],a[104:107]
mf a[156:159],a[12:15],a[64:67]
dt a[134:135],v22,33280
buffer_load_dword v42, v41, s[28:31], 0 offen sc1
mf a[160:163],a[16:19],a[64:67]
s_add_u32 m0, s65, 0
mf a[160:163],a[48:51],a[104:107]
buffer_load_dwordx4 v8, s[56:59], s69 offen  lds
mf a[164:167],a[52:55],a[104:107]
mf a[164:167],a[20:23],a[64:67]
mf a[168:171],a[24:27],a[64:67]
mf a[168:171],a[56:59],a[104:107]
mf a[172:175],a[60:63],a[104:107]
s_add_u32 m0, s65, 1024
mf a[172:175],a[28:31],a[64:67]
buffer_load_dwordx4 v9, s[56:59], s69 offen  lds
mf a[204:207],a[28:31],a[68:71]
mf a[204:207],a[60:63],a[108:111]
dt a[64:65],v21,0
mf a[200:203],a[56:59],a[108:111]
mf a[200:203],a[24:27],a[68:71]
dt a[66:67],v21,512
mf a[196:199],a[20:23],a[68:71]
mf a[196:199],a[52:55],a[108:111]
dt a[104:105],v21,20480
mf a[192:195],a[48:51],a[108:111]
s_add_u32 s69, s69, 0x8000
mf a[192:195],a[16:19],a[68:71]
dt a[106:107],v21,20992
mf a[188:191],a[12:15],a[68:71]
s_add_u32 m0, s65, 2048
mf a[188:191],a[44:47],a[108:111]
buffer_load_dwordx4 v8, s[56:59], s69 offen  lds
mf a[184:187],a[40:43],a[108:111]
mf a[184:187],a[8:11],a[68:71]
mf a[180:183],a[4:7],a[68:71]
mf a[180:183],a[36:39],a[108:111]
mf a[176:179],a[32:35],a[108:111]
s_add_u32 m0, s65, 3072
mf a[176:179],a[0:3],a[68:71]
buffer_load_dwordx4 v9, s[56:59], s69 offen  lds
mf v[240:243],a[96:99],a[0:3]
mf v[240:243],a[136:139],a[32:35]
dt a[68:69],v22,0
mf v[244:247],a[136:139],a[36:39]
mf v[244:247],a[96:99],a[4:7]
dt a[70:71],v22,512
mf a[208:211],a[96:99],a[8:11]
mf a[208:211],a[136:139],a[40:43]
dt a[108:109],v22,20480
mf a[212:215],a[136:139],a[44:47]
s_add_u32 s69, s69, 0x8000
mf a[212:215],a[96:99],a[12:15]
dt a[110:111],v22,20992
mf a[216:219],a[96:99],a[16:19]
s_add_u32 m0, s65, 4096
mf a[216:219],a[136:139],a[48:51]
buffer_load_dwordx4 v8, s[56:59], s69 offen  lds
mf a[220:223],a[136:139],a[52:55]
mf a[220:223],a[96:99],a[20:23]
mf a[224:227],a[96:99],a[24:27]
mf a[224:227],a[136:139],a[56:59]
mf a[228:231],a[136:139],a[60:63]
s_add_u32 m0, s65, 5120
mf a[228:231],a[96:99],a[28:31]
buffer_load_dwordx4 v9, s[56:59], s69 offen  lds
mf v[248:251],a[100:103],a[0:3]
dq a[0:3],v16,32768
mf v[248:251],a[140:143],a[32:35]
dq a[32:35],v17,32768
mf v[252:255],a[140:143],a[36:39]
dq a[36:39],v17,34816
mf v[252:255],a[100:103],a[4:7]
dq a[4:7],v16,34816
mf a[232:235],a[100:103],a[8:11]
dq a[8:11],v16,36864
mf a[232:235],a[140:143],a[40:43]
dq a[40:43],v17,36864
mf a[236:239],a[140:143],a[44:47]
dq a[44:47],v17,38912
mf a[236:239],a[100:103],a[12:15]
dq a[12:15],v16,38912
mf a[240:243],a[100:103],a[16:19]
dq a[16:19],v16,40960
mf a[240:243],a[140:143],a[48:51]
dq a[48:51],v17,40960
mf a[244:247],a[140:143],a[52:55]
dq a[52:55],v17,43008
mf a[244:247],a[100:103],a[20:23]
dq a[20:23],v16,43008
mf a[248:251],a[100:103],a[24:27]
dq a[24:27],v16,45056
mf a[248:251],a[140:143],a[56:59]
dq a[56:59],v17,45056
mf a[252:255],a[140:143],a[60:63]
s_add_u32 s69, s69, 0x8000
dq a[60:63],v17,47104
mf a[252:255],a[100:103],a[28:31]
s_waitcnt lgkmcnt(13)
dq a[28:31],v16,47104
mf v[48:51],a[72:75],a[0:3]
s_add_u32 m0, s65, 6144
dt a[96:97],v23,16384
mf v[48:51],a[112:115],a[32:35]
s_waitcnt lgkmcnt(13)
dt a[98:99],v23,16640
buffer_load_dwordx4 v8, s[56:59], s69 offen  lds
mf v[52:55],a[112:115],a[36:39]
dt a[136:137],v23,36864
mf v[52:55],a[72:75],a[4:7]
s_waitcnt lgkmcnt(13)
dt a[138:139],v23,37120
mf v[56:59],a[72:75],a[8:11]
dt a[100:101],v23,18432
mf v[56:59],a[112:115],a[40:43]
s_waitcnt lgkmcnt(13)
dt a[102:103],v23,18688
mf v[60:63],a[112:115],a[44:47]
dt a[140:141],v23,38912
mf v[60:63],a[72:75],a[12:15]
s_waitcnt lgkmcnt(13)
dt a[142:143],v23,39168
mf v[64:67],a[72:75],a[16:19]
s_add_u32 m0, s65, 7168
mf v[64:67],a[112:115],a[48:51]
s_waitcnt lgkmcnt(12)
buffer_load_dwordx4 v9, s[56:59], s69 offen  lds
mf v[68:71],a[112:115],a[52:55]
mf v[68:71],a[72:75],a[20:23]
s_waitcnt lgkmcnt(10)
mf v[72:75],a[72:75],a[24:27]
mf v[72:75],a[112:115],a[56:59]
s_waitcnt lgkmcnt(8)
mf v[76:79],a[112:115],a[60:63]
mf v[76:79],a[72:75],a[28:31]
s_waitcnt vmcnt(8) lgkmcnt(0)
s_barrier
v_sub_u32 v42, v42, v5
v_subrev_u32 v42, 1, v42
v_cmp_lt_u32 vcc, 2, v42
s_nop 0
s_cbranch_vccnz L_eKV_slow
L_eKV_back:
mf v[108:111],a[76:79],a[28:31]
s_mul_i32 s10, s23, 10240
v_readlane_b32 s68, v13, 30
s_add_u32 s10, s10, 23265280
mf v[108:111],a[116:119],a[60:63]
s_mul_i32 s11, s24, 6144
dt a[72:73],v18,4096
s_add_u32 s11, s11, 23582720
mf v[104:107],a[116:119],a[56:59]
s_mul_i32 s70, s68, 393216
s_lshl_b32 s12, s20, 12
s_add_u32 s10, s10, s12
mf v[104:107],a[76:79],a[24:27]
s_mul_i32 s71, s68, 458752
dt a[74:75],v18,4608
s_add_u32 s11, s11, s12
mf v[100:103],a[76:79],a[20:23]
s_add_u32 s5, s71, 229376
s_add_u32 s13, s12, 147456
mf v[100:103],a[116:119],a[52:55]
s_add_u32 s4, s70, 196608
dt a[112:113],v18,24576
mf v[96:99],a[116:119],a[48:51]
mf v[96:99],a[76:79],a[16:19]
dt a[114:115],v18,25088
mf v[92:95],a[76:79],a[12:15]
s_add_u32 m0, s64, 45056
mf v[92:95],a[116:119],a[44:47]
buffer_load_dwordx4 v11, s[36:39], s71 offen offset:0  lds
mf v[88:91],a[116:119],a[40:43]
mf v[88:91],a[76:79],a[8:11]
s_cmp_lt_u32 s20, 3
s_cselect_b32 s12, s10, s11
mf v[84:87],a[76:79],a[4:7]
s_add_u32 m0, s64, 65536
mf v[84:87],a[116:119],a[36:39]
buffer_load_dwordx4 v11, s[36:39], s5 offen offset:0  lds
mf v[80:83],a[116:119],a[32:35]
mf v[80:83],a[76:79],a[0:3]
s_cmp_lt_u32 s20, 2
s_cselect_b32 s11, s10, s11
mf v[112:115],a[80:83],a[0:3]
mf v[112:115],a[120:123],a[32:35]
dt a[76:77],v19,4096
mf v[116:119],a[120:123],a[36:39]
mf v[116:119],a[80:83],a[4:7]
dt a[78:79],v19,4608
mf v[120:123],a[80:83],a[8:11]
mf v[120:123],a[120:123],a[40:43]
dt a[116:117],v19,24576
mf v[124:127],a[120:123],a[44:47]
mf v[124:127],a[80:83],a[12:15]
dt a[118:119],v19,25088
mf v[128:131],a[80:83],a[16:19]
s_add_u32 m0, s64, 49152
mf v[128:131],a[120:123],a[48:51]
buffer_load_dwordx4 v11, s[40:43], s71 offen offset:0  lds
mf v[132:135],a[120:123],a[52:55]
mf v[132:135],a[80:83],a[20:23]
s_mov_b32 m0, s13
s_nop 0
buffer_load_dwordx4 v3, s[28:31], s12 offen offset:0 sc1 lds
mf v[136:139],a[80:83],a[24:27]
s_add_u32 m0, s64, 69632
mf v[136:139],a[120:123],a[56:59]
buffer_load_dwordx4 v11, s[40:43], s5 offen offset:0  lds
mf v[140:143],a[120:123],a[60:63]
mf v[140:143],a[80:83],a[28:31]
s_mov_b32 m0, s13
s_nop 0
buffer_load_dwordx4 v3, s[28:31], s12 offen offset:1024 sc1 lds
mf v[172:175],a[84:87],a[28:31]
mf v[172:175],a[124:127],a[60:63]
dt a[80:81],v18,8192
mf v[168:171],a[124:127],a[56:59]
mf v[168:171],a[84:87],a[24:27]
dt a[82:83],v18,8704
mf v[164:167],a[84:87],a[20:23]
mf v[164:167],a[124:127],a[52:55]
dt a[120:121],v18,28672
mf v[160:163],a[124:127],a[48:51]
mf v[160:163],a[84:87],a[16:19]
dt a[122:123],v18,29184
mf v[156:159],a[84:87],a[12:15]
s_add_u32 m0, s64, 51200
mf v[156:159],a[124:127],a[44:47]
buffer_load_dwordx4 v10, s[32:35], s70 offen offset:2048  lds
mf v[152:155],a[124:127],a[40:43]
mf v[152:155],a[84:87],a[8:11]
s_mov_b32 m0, s13
s_nop 0
buffer_load_dwordx4 v3, s[28:31], s11 offen offset:2048 sc1 lds
mf v[148:151],a[84:87],a[4:7]
s_add_u32 m0, s64, 71680
mf v[148:151],a[124:127],a[36:39]
buffer_load_dwordx4 v10, s[32:35], s4 offen offset:2048  lds
mf v[144:147],a[124:127],a[32:35]
mf v[144:147],a[84:87],a[0:3]
s_mov_b32 m0, s13
s_nop 0
buffer_load_dwordx4 v3, s[28:31], s11 offen offset:3072 sc1 lds
mf v[176:179],a[0:3],a[88:91]
mf v[176:179],a[32:35],a[128:131]
dt a[84:85],v19,8192
mf v[180:183],a[36:39],a[128:131]
mf v[180:183],a[4:7],a[88:91]
dt a[86:87],v19,8704
mf v[184:187],a[8:11],a[88:91]
mf v[184:187],a[40:43],a[128:131]
dt a[124:125],v19,28672
mf v[188:191],a[44:47],a[128:131]
mf v[188:191],a[12:15],a[88:91]
dt a[126:127],v19,29184
mf v[192:195],a[16:19],a[88:91]
s_add_u32 m0, s64, 40960
mf v[192:195],a[48:51],a[128:131]
buffer_load_dwordx4 v10, s[32:35], s70 offen offset:0  lds
mf v[196:199],a[52:55],a[128:131]
mf v[196:199],a[20:23],a[88:91]
mf v[200:203],a[24:27],a[88:91]
s_add_u32 m0, s64, 61440
mf v[200:203],a[56:59],a[128:131]
buffer_load_dwordx4 v10, s[32:35], s4 offen offset:0  lds
mf v[204:207],a[60:63],a[128:131]
mf v[204:207],a[28:31],a[88:91]
mf v[236:239],a[28:31],a[92:95]
mf v[236:239],a[60:63],a[132:135]
dt a[88:89],v18,12288
mf v[232:235],a[56:59],a[132:135]
mf v[232:235],a[24:27],a[92:95]
dt a[90:91],v18,12800
mf v[228:231],a[20:23],a[92:95]
mf v[228:231],a[52:55],a[132:135]
dt a[128:129],v18,32768
mf v[224:227],a[48:51],a[132:135]
mf v[224:227],a[16:19],a[92:95]
dt a[130:131],v18,33280
mf v[220:223],a[12:15],a[92:95]
s_add_u32 m0, s64, 57344
mf v[220:223],a[44:47],a[132:135]
buffer_load_dwordx4 v12, s[44:47], s71 offen offset:0  lds
mf v[216:219],a[40:43],a[132:135]
mf v[216:219],a[8:11],a[92:95]
mf v[212:215],a[4:7],a[92:95]
s_add_u32 m0, s64, 77824
mf v[212:215],a[36:39],a[132:135]
buffer_load_dwordx4 v12, s[44:47], s5 offen offset:0  lds
mf v[208:211],a[32:35],a[132:135]
mf v[208:211],a[0:3],a[92:95]
s_waitcnt vmcnt(14) lgkmcnt(0)
s_barrier
mf a[144:147],a[0:3],a[64:67]
s_lshl_b32 s69, s68, 7
v_mov_b32 v41, 0xb5c1a2a0
v_mov_b32 v42, v15
mf a[144:147],a[32:35],a[104:107]
dt a[92:93],v19,12288
mf a[148:151],a[36:39],a[104:107]
mf a[148:151],a[4:7],a[64:67]
dt a[94:95],v19,12800
mf a[152:155],a[8:11],a[64:67]
mf a[152:155],a[40:43],a[104:107]
dt a[132:133],v19,32768
mf a[156:159],a[44:47],a[104:107]
mf a[156:159],a[12:15],a[64:67]
dt a[134:135],v19,33280
mf a[160:163],a[16:19],a[64:67]
s_add_u32 m0, s65, 32768
mf a[160:163],a[48:51],a[104:107]
buffer_load_dwordx4 v8, s[56:59], s69 offen  lds
mf a[164:167],a[52:55],a[104:107]
s_add_u32 m0, s65, 33792
mf a[164:167],a[20:23],a[64:67]
buffer_load_dwordx4 v9, s[56:59], s69 offen  lds
L_stub5:
s_cbranch_execz L_stub9
mf a[168:171],a[24:27],a[64:67]
s_add_u32 s69, s69, 0x8000
mf a[168:171],a[56:59],a[104:107]
mf a[172:175],a[60:63],a[104:107]
s_add_u32 m0, s65, 34816
mf a[172:175],a[28:31],a[64:67]
buffer_load_dwordx4 v8, s[56:59], s69 offen  lds
mf a[204:207],a[28:31],a[68:71]
mf a[204:207],a[60:63],a[108:111]
dt a[64:65],v18,0
mf a[200:203],a[56:59],a[108:111]
mf a[200:203],a[24:27],a[68:71]
dt a[66:67],v18,512
mf a[196:199],a[20:23],a[68:71]
mf a[196:199],a[52:55],a[108:111]
dt a[104:105],v18,20480
mf a[192:195],a[48:51],a[108:111]
mf a[192:195],a[16:19],a[68:71]
dt a[106:107],v18,20992
mf a[188:191],a[12:15],a[68:71]
s_add_u32 m0, s65, 35840
mf a[188:191],a[44:47],a[108:111]
buffer_load_dwordx4 v9, s[56:59], s69 offen  lds
mf a[184:187],a[40:43],a[108:111]
s_add_u32 s69, s69, 0x8000
mf a[184:187],a[8:11],a[68:71]
mf a[180:183],a[4:7],a[68:71]
s_add_u32 m0, s65, 36864
mf a[180:183],a[36:39],a[108:111]
buffer_load_dwordx4 v8, s[56:59], s69 offen  lds
mf a[176:179],a[32:35],a[108:111]
s_add_u32 m0, s65, 37888
mf a[176:179],a[0:3],a[68:71]
buffer_load_dwordx4 v9, s[56:59], s69 offen  lds
mf v[240:243],a[96:99],a[0:3]
mf v[240:243],a[136:139],a[32:35]
dt a[68:69],v19,0
mf v[244:247],a[136:139],a[36:39]
mf v[244:247],a[96:99],a[4:7]
dt a[70:71],v19,512
mf a[208:211],a[96:99],a[8:11]
mf a[208:211],a[136:139],a[40:43]
dt a[108:109],v19,20480
mf a[212:215],a[136:139],a[44:47]
s_add_u32 s69, s69, 0x8000
mf a[212:215],a[96:99],a[12:15]
dt a[110:111],v19,20992
mf a[216:219],a[96:99],a[16:19]
s_add_u32 m0, s65, 38912
mf a[216:219],a[136:139],a[48:51]
buffer_load_dwordx4 v8, s[56:59], s69 offen  lds
mf a[220:223],a[136:139],a[52:55]
mf a[220:223],a[96:99],a[20:23]
mf a[224:227],a[96:99],a[24:27]
s_add_u32 m0, s65, 39936
mf a[224:227],a[136:139],a[56:59]
buffer_load_dwordx4 v9, s[56:59], s69 offen  lds
mf a[228:231],a[136:139],a[60:63]
mf a[228:231],a[96:99],a[28:31]
mf v[248:251],a[100:103],a[0:3]
dq a[0:3],v16,0
mf v[248:251],a[140:143],a[32:35]
dq a[32:35],v17,0
mf v[252:255],a[140:143],a[36:39]
dq a[36:39],v17,2048
mf v[252:255],a[100:103],a[4:7]
dq a[4:7],v16,2048
mf a[232:235],a[100:103],a[8:11]
dq a[8:11],v16,4096
mf a[232:235],a[140:143],a[40:43]
dq a[40:43],v17,4096
mf a[236:239],a[140:143],a[44:47]
dq a[44:47],v17,6144
mf a[236:239],a[100:103],a[12:15]
dq a[12:15],v16,6144
mf a[240:243],a[100:103],a[16:19]
dq a[16:19],v16,8192
mf a[240:243],a[140:143],a[48:51]
dq a[48:51],v17,8192
mf a[244:247],a[140:143],a[52:55]
dq a[52:55],v17,10240
mf a[244:247],a[100:103],a[20:23]
dq a[20:23],v16,10240
mf a[248:251],a[100:103],a[24:27]
dq a[24:27],v16,12288
mf a[248:251],a[140:143],a[56:59]
dq a[56:59],v17,12288
mf a[252:255],a[140:143],a[60:63]
dq a[60:63],v17,14336
mf a[252:255],a[100:103],a[28:31]
s_waitcnt lgkmcnt(13)
dq a[28:31],v16,14336
mf v[48:51],a[72:75],a[0:3]
dt a[96:97],v20,16384
mf v[48:51],a[112:115],a[32:35]
s_waitcnt lgkmcnt(13)
dt a[98:99],v20,16640
mf v[52:55],a[112:115],a[36:39]
dt a[136:137],v20,36864
mf v[52:55],a[72:75],a[4:7]
s_waitcnt lgkmcnt(13)
dt a[138:139],v20,37120
mf v[56:59],a[72:75],a[8:11]
dt a[100:101],v20,18432
mf v[56:59],a[112:115],a[40:43]
s_waitcnt lgkmcnt(13)
dt a[102:103],v20,18688
mf v[60:63],a[112:115],a[44:47]
dt a[140:141],v20,38912
mf v[60:63],a[72:75],a[12:15]
s_waitcnt lgkmcnt(13)
dt a[142:143],v20,39168
mf v[64:67],a[72:75],a[16:19]
mf v[64:67],a[112:115],a[48:51]
s_waitcnt lgkmcnt(12)
mf v[68:71],a[112:115],a[52:55]
mf v[68:71],a[72:75],a[20:23]
s_waitcnt lgkmcnt(10)
mf v[72:75],a[72:75],a[24:27]
mf v[72:75],a[112:115],a[56:59]
s_waitcnt lgkmcnt(8)
mf v[76:79],a[112:115],a[60:63]
mf v[76:79],a[72:75],a[28:31]
s_waitcnt vmcnt(8) lgkmcnt(0)
s_barrier
mf v[108:111],a[76:79],a[28:31]
ds_read_b64 v[8:9], v47 offset:0
mf v[108:111],a[116:119],a[60:63]
ds_read_b64 v[10:11], v47 offset:1280
mf v[104:107],a[116:119],a[56:59]
ds_read_b64 v[12:13], v47 offset:2560
mf v[104:107],a[76:79],a[24:27]
ds_read_b64 v[14:15], v47 offset:3840
mf v[100:103],a[76:79],a[20:23]
dt a[72:73],v21,4096
mf v[100:103],a[116:119],a[52:55]
dt a[74:75],v21,4608
mf v[96:99],a[116:119],a[48:51]
dt a[112:113],v21,24576
s_waitcnt lgkmcnt(3)
mf v[96:99],a[76:79],a[16:19]
dt a[114:115],v21,25088
v_add_f32 v8, v8, v10
mf v[92:95],a[76:79],a[12:15]
v_add_f32 v12, v12, v14
v_add_f32 v9, v9, v11
mf v[92:95],a[116:119],a[44:47]
v_add_f32 v13, v13, v15
v_add_f32 v6, v8, v12
mf v[88:91],a[116:119],a[40:43]
v_add_f32 v7, v9, v13
mf v[88:91],a[76:79],a[8:11]
ds_read_b64 v[8:9], v47 offset:5120
mf v[84:87],a[76:79],a[4:7]
ds_read_b64 v[10:11], v47 offset:6400
mf v[84:87],a[116:119],a[36:39]
ds_read_b64 v[12:13], v47 offset:7680
mf v[80:83],a[116:119],a[32:35]
ds_read_b64 v[14:15], v47 offset:8960
mf v[80:83],a[76:79],a[0:3]
mf v[112:115],a[80:83],a[0:3]
mf v[112:115],a[120:123],a[32:35]
mf v[116:119],a[120:123],a[36:39]
mf v[116:119],a[80:83],a[4:7]
mf v[120:123],a[80:83],a[8:11]
s_waitcnt lgkmcnt(0)
v_add_f32 v8, v8, v10
v_add_f32 v12, v12, v14
mf v[120:123],a[120:123],a[40:43]
v_add_f32 v9, v9, v11
v_add_f32 v13, v13, v15
mf v[124:127],a[120:123],a[44:47]
v_add_f32 v6, v6, v8
v_add_f32 v6, v6, v12
mf v[124:127],a[80:83],a[12:15]
v_add_f32 v7, v7, v9
v_add_f32 v7, v7, v13
mf v[128:131],a[80:83],a[16:19]
ds_write_b64 v47, v[6:7] offset:8960
s_lshl_b32 s65, s20, 12
mf v[128:131],a[120:123],a[48:51]
mf v[132:135],a[120:123],a[52:55]
mf v[132:135],a[80:83],a[20:23]
mf v[136:139],a[80:83],a[24:27]
mf v[136:139],a[120:123],a[56:59]
mf v[140:143],a[120:123],a[60:63]
mf v[140:143],a[80:83],a[28:31]
ds_read2st64_b32 v[8:9], v43 offset0:0 offset1:1
ds_read2st64_b32 v[10:11], v43 offset0:2 offset1:3
ds_read2st64_b32 v[12:13], v43 offset0:4 offset1:5
ds_read2st64_b32 v[14:15], v43 offset0:6 offset1:7
s_waitcnt vmcnt(0) lgkmcnt(4)
s_barrier
ds_read_b64 v[6:7], v44 offset:256
ds_read_b64 v[46:47], v44 offset:264
ds_read_b64 v[18:19], v44 offset:128
ds_read_b32 v20, v44 offset:136
ds_read_b32 v45, v44 offset:140
mf v[144:147],a[84:87],a[0:3]
dq a[0:3],v16,32768
mf v[144:147],a[124:127],a[32:35]
s_waitcnt lgkmcnt(4)
dq a[32:35],v17,32768
v_fmac_f32 v112, v8, v6
mf v[148:151],a[124:127],a[36:39]
dq a[36:39],v17,34816
v_fmac_f32 v113, v8, v7
mf v[148:151],a[84:87],a[4:7]
dq a[4:7],v16,34816
v_fmac_f32 v114, v8, v46
mf v[152:155],a[84:87],a[8:11]
dq a[8:11],v16,36864
v_fmac_f32 v115, v8, v47
mf v[152:155],a[124:127],a[40:43]
dq a[40:43],v17,36864
v_fmac_f32 v116, v9, v6
mf v[156:159],a[124:127],a[44:47]
dq a[44:47],v17,38912
v_fmac_f32 v117, v9, v7
mf v[156:159],a[84:87],a[12:15]
dq a[12:15],v16,38912
v_fmac_f32 v118, v9, v46
mf v[160:163],a[84:87],a[16:19]
dq a[16:19],v16,40960
v_fmac_f32 v119, v9, v47
mf v[160:163],a[124:127],a[48:51]
dq a[48:51],v17,40960
v_fmac_f32 v120, v10, v6
mf v[164:167],a[124:127],a[52:55]
dq a[52:55],v17,43008
v_fmac_f32 v121, v10, v7
mf v[164:167],a[84:87],a[20:23]
dq a[20:23],v16,43008
v_fmac_f32 v122, v10, v46
mf v[168:171],a[84:87],a[24:27]
dq a[24:27],v16,45056
v_fmac_f32 v123, v10, v47
mf v[168:171],a[124:127],a[56:59]
dq a[56:59],v17,45056
v_fmac_f32 v124, v11, v6
mf v[172:175],a[124:127],a[60:63]
dq a[60:63],v17,47104
v_fmac_f32 v125, v11, v7
mf v[172:175],a[84:87],a[28:31]
s_waitcnt lgkmcnt(13)
dq a[28:31],v16,47104
v_fmac_f32 v126, v11, v46
mf v[48:51],a[72:75],a[0:3]
dt a[76:77],v22,4096
v_fmac_f32 v127, v11, v47
mf v[48:51],a[112:115],a[32:35]
s_waitcnt lgkmcnt(13)
dt a[78:79],v22,4608
v_fmac_f32 v128, v12, v6
mf v[52:55],a[112:115],a[36:39]
dt a[116:117],v22,24576
v_fmac_f32 v129, v12, v7
mf v[52:55],a[72:75],a[4:7]
s_waitcnt lgkmcnt(13)
dt a[118:119],v22,25088
v_fmac_f32 v130, v12, v46
mf v[56:59],a[72:75],a[8:11]
dt a[80:81],v21,8192
v_fmac_f32 v131, v12, v47
mf v[56:59],a[112:115],a[40:43]
s_waitcnt lgkmcnt(13)
dt a[82:83],v21,8704
v_fmac_f32 v132, v13, v6
mf v[60:63],a[112:115],a[44:47]
dt a[120:121],v21,28672
v_fmac_f32 v133, v13, v7
mf v[60:63],a[72:75],a[12:15]
s_waitcnt lgkmcnt(13)
dt a[122:123],v21,29184
v_fmac_f32 v134, v13, v46
mf v[64:67],a[72:75],a[16:19]
v_fmac_f32 v135, v13, v47
v_fmac_f32 v136, v14, v6
mf v[64:67],a[112:115],a[48:51]
s_waitcnt lgkmcnt(12)
v_fmac_f32 v137, v14, v7
v_fmac_f32 v138, v14, v46
mf v[68:71],a[112:115],a[52:55]
v_fmac_f32 v139, v14, v47
v_fmac_f32 v140, v15, v6
mf v[68:71],a[72:75],a[20:23]
s_waitcnt lgkmcnt(10)
v_fmac_f32 v141, v15, v7
v_fmac_f32 v142, v15, v46
mf v[72:75],a[72:75],a[24:27]
v_fmac_f32 v143, v15, v47
mf v[72:75],a[112:115],a[56:59]
s_waitcnt lgkmcnt(8)
ds_read_b64 v[6:7], v44 offset:192
mf v[76:79],a[112:115],a[60:63]
ds_read_b64 v[46:47], v44 offset:200
mf v[76:79],a[72:75],a[28:31]
s_waitcnt lgkmcnt(6)
mf v[108:111],a[76:79],a[28:31]
s_waitcnt lgkmcnt(15)
v_fmac_f32 v48, v8, v18
v_fmac_f32 v49, v8, v19
mf v[108:111],a[116:119],a[60:63]
dt a[84:85],v22,8192
v_fmac_f32 v50, v8, v20
mf v[104:107],a[116:119],a[56:59]
v_fmac_f32 v51, v8, v45
v_fmac_f32 v52, v9, v18
mf v[104:107],a[76:79],a[24:27]
dt a[86:87],v22,8704
v_fmac_f32 v53, v9, v19
mf v[100:103],a[76:79],a[20:23]
v_fmac_f32 v54, v9, v20
v_fmac_f32 v55, v9, v45
mf v[100:103],a[116:119],a[52:55]
dt a[124:125],v22,28672
v_fmac_f32 v56, v10, v18
mf v[96:99],a[116:119],a[48:51]
v_fmac_f32 v57, v10, v19
v_fmac_f32 v58, v10, v20
mf v[96:99],a[76:79],a[16:19]
dt a[126:127],v22,29184
v_fmac_f32 v59, v10, v45
mf v[92:95],a[76:79],a[12:15]
v_fmac_f32 v60, v11, v18
v_fmac_f32 v61, v11, v19
mf v[92:95],a[116:119],a[44:47]
v_fmac_f32 v62, v11, v20
v_fmac_f32 v63, v11, v45
mf v[88:91],a[116:119],a[40:43]
v_fmac_f32 v64, v12, v18
v_fmac_f32 v65, v12, v19
mf v[88:91],a[76:79],a[8:11]
v_fmac_f32 v66, v12, v20
v_fmac_f32 v67, v12, v45
mf v[84:87],a[76:79],a[4:7]
v_fmac_f32 v68, v13, v18
v_fmac_f32 v69, v13, v19
mf v[84:87],a[116:119],a[36:39]
v_fmac_f32 v70, v13, v20
v_fmac_f32 v71, v13, v45
mf v[80:83],a[116:119],a[32:35]
v_fmac_f32 v72, v14, v18
v_fmac_f32 v73, v14, v19
mf v[80:83],a[76:79],a[0:3]
s_waitcnt lgkmcnt(6)
v_fmac_f32 v74, v14, v20
v_fmac_f32 v75, v14, v45
mf v[112:115],a[80:83],a[0:3]
v_fmac_f32 v76, v15, v18
v_fmac_f32 v77, v15, v19
mf v[112:115],a[120:123],a[32:35]
v_fmac_f32 v78, v15, v20
v_fmac_f32 v79, v15, v45
mf v[116:119],a[120:123],a[36:39]
ds_read_b64 v[18:19], v44 offset:320
mf v[116:119],a[80:83],a[4:7]
ds_read_b32 v20, v44 offset:328
mf v[120:123],a[80:83],a[8:11]
ds_read_b32 v45, v44 offset:332
s_waitcnt lgkmcnt(7)
mf v[120:123],a[120:123],a[40:43]
v_fmac_f32 v80, v8, v6
v_fmac_f32 v81, v8, v7
mf v[124:127],a[120:123],a[44:47]
v_fmac_f32 v82, v8, v46
v_fmac_f32 v83, v8, v47
mf v[124:127],a[80:83],a[12:15]
v_fmac_f32 v84, v9, v6
v_fmac_f32 v85, v9, v7
mf v[128:131],a[80:83],a[16:19]
v_fmac_f32 v86, v9, v46
v_fmac_f32 v87, v9, v47
mf v[128:131],a[120:123],a[48:51]
v_fmac_f32 v88, v10, v6
v_fmac_f32 v89, v10, v7
mf v[132:135],a[120:123],a[52:55]
v_fmac_f32 v90, v10, v46
v_fmac_f32 v91, v10, v47
mf v[132:135],a[80:83],a[20:23]
v_fmac_f32 v92, v11, v6
v_fmac_f32 v93, v11, v7
mf v[136:139],a[80:83],a[24:27]
v_fmac_f32 v94, v11, v46
v_fmac_f32 v95, v11, v47
mf v[136:139],a[120:123],a[56:59]
v_fmac_f32 v96, v12, v6
v_fmac_f32 v97, v12, v7
mf v[140:143],a[120:123],a[60:63]
v_fmac_f32 v98, v12, v46
v_fmac_f32 v99, v12, v47
mf v[140:143],a[80:83],a[28:31]
s_waitcnt lgkmcnt(3)
v_fmac_f32 v100, v13, v6
v_fmac_f32 v101, v13, v7
mf v[144:147],a[84:87],a[0:3]
dq a[0:3],v16,0
v_fmac_f32 v102, v13, v46
mf v[144:147],a[124:127],a[32:35]
dq a[32:35],v17,0
v_fmac_f32 v103, v13, v47
mf v[148:151],a[124:127],a[36:39]
dq a[36:39],v17,2048
v_fmac_f32 v104, v14, v6
mf v[148:151],a[84:87],a[4:7]
dq a[4:7],v16,2048
v_fmac_f32 v105, v14, v7
mf v[152:155],a[84:87],a[8:11]
dq a[8:11],v16,4096
v_fmac_f32 v106, v14, v46
mf v[152:155],a[124:127],a[40:43]
dq a[40:43],v17,4096
v_fmac_f32 v107, v14, v47
mf v[156:159],a[124:127],a[44:47]
dq a[44:47],v17,6144
v_fmac_f32 v108, v15, v6
mf v[156:159],a[84:87],a[12:15]
dq a[12:15],v16,6144
v_fmac_f32 v109, v15, v7
mf v[160:163],a[84:87],a[16:19]
dq a[16:19],v16,8192
v_fmac_f32 v110, v15, v46
mf v[160:163],a[124:127],a[48:51]
dq a[48:51],v17,8192
v_fmac_f32 v111, v15, v47
mf v[164:167],a[124:127],a[52:55]
dq a[52:55],v17,10240
mf v[164:167],a[84:87],a[20:23]
dq a[20:23],v16,10240
mf v[168:171],a[84:87],a[24:27]
dq a[24:27],v16,12288
mf v[168:171],a[124:127],a[56:59]
dq a[56:59],v17,12288
mf v[172:175],a[124:127],a[60:63]
dq a[60:63],v17,14336
mf v[172:175],a[84:87],a[28:31]
s_waitcnt lgkmcnt(13)
dq a[28:31],v16,14336
mf v[176:179],a[0:3],a[88:91]
ds_read_b64 v[6:7], v43 offset:8
mf v[176:179],a[32:35],a[128:131]
s_waitcnt lgkmcnt(13)
ds_read_b32 v46, v43 offset:4
s_waitcnt lgkmcnt(15)
mf v[180:183],a[36:39],a[128:131]
v_fmac_f32 v144, v8, v18
v_fmac_f32 v145, v8, v19
mf v[180:183],a[4:7],a[88:91]
s_waitcnt lgkmcnt(12)
v_fmac_f32 v146, v8, v20
v_fmac_f32 v147, v8, v45
mf v[184:187],a[8:11],a[88:91]
v_fmac_f32 v148, v9, v18
v_fmac_f32 v149, v9, v19
mf v[184:187],a[40:43],a[128:131]
s_waitcnt lgkmcnt(10)
v_fmac_f32 v150, v9, v20
v_fmac_f32 v151, v9, v45
mf v[188:191],a[44:47],a[128:131]
v_fmac_f32 v152, v10, v18
v_fmac_f32 v153, v10, v19
mf v[188:191],a[12:15],a[88:91]
s_waitcnt lgkmcnt(8)
v_fmac_f32 v154, v10, v20
v_fmac_f32 v155, v10, v45
mf v[192:195],a[16:19],a[88:91]
v_fmac_f32 v156, v11, v18
v_fmac_f32 v157, v11, v19
mf v[192:195],a[48:51],a[128:131]
s_waitcnt lgkmcnt(6)
v_fmac_f32 v158, v11, v20
v_fmac_f32 v159, v11, v45
mf v[196:199],a[52:55],a[128:131]
v_fmac_f32 v160, v12, v18
v_fmac_f32 v161, v12, v19
mf v[196:199],a[20:23],a[88:91]
s_waitcnt lgkmcnt(4)
v_fmac_f32 v162, v12, v20
v_fmac_f32 v163, v12, v45
mf v[200:203],a[24:27],a[88:91]
v_fmac_f32 v164, v13, v18
v_fmac_f32 v165, v13, v19
mf v[200:203],a[56:59],a[128:131]
s_waitcnt lgkmcnt(2)
v_fmac_f32 v166, v13, v20
v_fmac_f32 v167, v13, v45
mf v[204:207],a[60:63],a[128:131]
v_fmac_f32 v168, v14, v18
v_fmac_f32 v169, v14, v19
mf v[204:207],a[28:31],a[88:91]
v_fmac_f32 v170, v14, v20
v_fmac_f32 v171, v14, v45
mf v[236:239],a[28:31],a[92:95]
v_fmac_f32 v172, v15, v18
v_fmac_f32 v173, v15, v19
mf v[236:239],a[60:63],a[132:135]
dt a[88:89],v21,12288
v_fmac_f32 v174, v15, v20
mf v[232:235],a[56:59],a[132:135]
v_fmac_f32 v175, v15, v45
s_lshr_b32 s10, s76, 6
mf v[232:235],a[24:27],a[92:95]
s_add_u32 s10, s10, s22
dt a[90:91],v21,12800
s_lshl_b32 s10, s10, 13
mf v[228:231],a[20:23],a[92:95]
s_add_u32 s10, s10, s78
v_mul_f32 v8, v48, v48
v_mul_f32 v9, v49, v49
mf v[228:231],a[52:55],a[132:135]
dt a[128:129],v21,32768
v_mul_f32 v10, v50, v50
mf v[224:227],a[48:51],a[132:135]
v_mul_f32 v11, v51, v51
v_mul_f32 v12, v80, v80
mf v[224:227],a[16:19],a[92:95]
dt a[130:131],v21,33280
v_mul_f32 v13, v81, v81
mf v[220:223],a[12:15],a[92:95]
v_mul_f32 v14, v82, v82
v_mul_f32 v15, v83, v83
mf v[220:223],a[44:47],a[132:135]
s_waitcnt lgkmcnt(4)
v_fma_f32 v8, v8, v6, v46
v_fma_f32 v9, v9, v6, v46
mf v[216:219],a[40:43],a[132:135]
v_fma_f32 v10, v10, v6, v46
v_fma_f32 v11, v11, v6, v46
mf v[216:219],a[8:11],a[92:95]
v_fma_f32 v12, v12, v6, v46
v_fma_f32 v13, v13, v6, v46
mf v[212:215],a[4:7],a[92:95]
v_fma_f32 v14, v14, v6, v46
v_fma_f32 v15, v15, v6, v46
mf v[212:215],a[36:39],a[132:135]
v_mul_f32 v8, v8, v48
v_mul_f32 v9, v9, v49
mf v[208:211],a[32:35],a[132:135]
v_mul_f32 v10, v10, v50
v_mul_f32 v11, v11, v51
mf v[208:211],a[0:3],a[92:95]
v_mul_f32 v12, v12, v80
v_mul_f32 v13, v13, v81
mf a[144:147],a[0:3],a[64:67]
v_readlane_b32 s70, v25, 0
v_readlane_b32 s71, v26, 0
mf a[144:147],a[32:35],a[104:107]
dt a[92:93],v22,12288
v_mul_f32 v14, v14, v82
mf a[148:151],a[36:39],a[104:107]
v_mul_f32 v15, v15, v83
v_mul_f32 v112, v48, v112
mf a[148:151],a[4:7],a[64:67]
dt a[94:95],v22,12800
v_mul_f32 v113, v49, v113
mf a[152:155],a[8:11],a[64:67]
s_add_u32 m0, s67, 0
v_mul_f32 v114, v50, v114
v_mul_f32 v115, v51, v115
mf a[152:155],a[40:43],a[104:107]
dt a[132:133],v22,32768
buffer_load_dwordx4 v31, s[48:51], s70 offen offset:0 sc1 lds
mf a[156:159],a[44:47],a[104:107]
v_mul_f32 v144, v80, v144
v_mul_f32 v145, v81, v145
mf a[156:159],a[12:15],a[64:67]
dt a[134:135],v22,33280
v_mul_f32 v146, v82, v146
mf a[160:163],a[16:19],a[64:67]
s_add_u32 m0, s67, 8064
v_mul_f32 v147, v83, v147
mf a[160:163],a[48:51],a[104:107]
buffer_load_dwordx4 v31, s[48:51], s70 offen offset:128 sc1 lds
dq v[80:83],v43,256
mf a[164:167],a[52:55],a[104:107]
s_add_u32 m0, s67, 1024
v_exp_f32 v8, v8
mf a[164:167],a[20:23],a[64:67]
buffer_load_dwordx4 v31, s[48:51], s71 offen offset:0 sc1 lds
mf a[168:171],a[24:27],a[64:67]
v_exp_f32 v9, v9
mf a[168:171],a[56:59],a[104:107]
v_exp_f32 v10, v10
mf a[172:175],a[60:63],a[104:107]
s_add_u32 m0, s67, 9088
v_exp_f32 v11, v11
mf a[172:175],a[28:31],a[64:67]
buffer_load_dwordx4 v31, s[48:51], s71 offen offset:128 sc1 lds
mf a[204:207],a[28:31],a[68:71]
v_readlane_b32 s70, v25, 1
v_readlane_b32 s71, v26, 1
mf a[204:207],a[60:63],a[108:111]
dt a[64:65],v21,0
mf a[200:203],a[56:59],a[108:111]
v_exp_f32 v12, v12
mf a[200:203],a[24:27],a[68:71]
dt a[66:67],v21,512
mf a[196:199],a[20:23],a[68:71]
s_add_u32 m0, s67, 16384
v_exp_f32 v13, v13
mf a[196:199],a[52:55],a[108:111]
dt a[104:105],v21,20480
buffer_load_dwordx4 v31, s[48:51], s70 offen offset:0 sc1 lds
mf a[192:195],a[48:51],a[108:111]
v_exp_f32 v14, v14
mf a[192:195],a[16:19],a[68:71]
dt a[106:107],v21,20992
mf a[188:191],a[12:15],a[68:71]
s_add_u32 m0, s67, 24448
v_exp_f32 v15, v15
mf a[188:191],a[44:47],a[108:111]
buffer_load_dwordx4 v31, s[48:51], s70 offen offset:128 sc1 lds
v_fma_f32 v8, v8, v7, v7
mf a[184:187],a[40:43],a[108:111]
s_add_u32 m0, s67, 17408
v_fma_f32 v9, v9, v7, v7
v_fma_f32 v10, v10, v7, v7
mf a[184:187],a[8:11],a[68:71]
buffer_load_dwordx4 v31, s[48:51], s71 offen offset:0 sc1 lds
v_fma_f32 v11, v11, v7, v7
mf a[180:183],a[4:7],a[68:71]
L_stub6:
s_cbranch_execz L_stub20
v_fma_f32 v12, v12, v7, v7
v_fma_f32 v13, v13, v7, v7
mf a[180:183],a[36:39],a[108:111]
v_fma_f32 v14, v14, v7, v7
v_fma_f32 v15, v15, v7, v7
mf a[176:179],a[32:35],a[108:111]
s_add_u32 m0, s67, 25472
v_rcp_f32 v8, v8
mf a[176:179],a[0:3],a[68:71]
buffer_load_dwordx4 v31, s[48:51], s71 offen offset:128 sc1 lds
mf v[240:243],a[96:99],a[0:3]
v_rcp_f32 v9, v9
mf v[240:243],a[136:139],a[32:35]
dt a[68:69],v22,0
mf v[244:247],a[136:139],a[36:39]
v_rcp_f32 v10, v10
mf v[244:247],a[96:99],a[4:7]
dt a[70:71],v22,512
mf a[208:211],a[96:99],a[8:11]
v_rcp_f32 v11, v11
mf a[208:211],a[136:139],a[40:43]
dt a[108:109],v22,20480
mf a[212:215],a[136:139],a[44:47]
v_rcp_f32 v12, v12
mf a[212:215],a[96:99],a[12:15]
dt a[110:111],v22,20992
mf a[216:219],a[96:99],a[16:19]
v_rcp_f32 v13, v13
mf a[216:219],a[136:139],a[48:51]
v_rcp_f32 v14, v14
mf a[220:223],a[136:139],a[52:55]
v_rcp_f32 v15, v15
mf a[220:223],a[96:99],a[20:23]
v_mul_f32 v8, v8, v112
v_mul_f32 v9, v9, v113
mf a[224:227],a[96:99],a[24:27]
v_mul_f32 v10, v10, v114
v_mul_f32 v11, v11, v115
mf a[224:227],a[136:139],a[56:59]
v_mul_f32 v12, v12, v144
v_mul_f32 v13, v13, v145
mf a[228:231],a[136:139],a[60:63]
v_mul_f32 v14, v14, v146
v_mul_f32 v15, v15, v147
mf a[228:231],a[96:99],a[28:31]
v_cvt_pk_bf16_f32 v48, v8, v9
v_cvt_pk_bf16_f32 v49, v10, v11
mf v[248:251],a[100:103],a[0:3]
dq a[0:3],v16,32768
v_cvt_pk_bf16_f32 v50, v12, v13
mf v[248:251],a[140:143],a[32:35]
dq a[32:35],v17,32768
v_cvt_pk_bf16_f32 v51, v14, v15
mf v[252:255],a[140:143],a[36:39]
dq a[36:39],v17,34816
mf v[252:255],a[100:103],a[4:7]
dq a[4:7],v16,34816
buffer_store_dwordx4 v[48:51], v3, s[28:31], s10 offen offset:0 sc1
mf a[232:235],a[100:103],a[8:11]
dq a[8:11],v16,36864
v_mul_f32 v8, v52, v52
mf a[232:235],a[140:143],a[40:43]
dq a[40:43],v17,36864
v_mul_f32 v9, v53, v53
mf a[236:239],a[140:143],a[44:47]
dq a[44:47],v17,38912
v_mul_f32 v10, v54, v54
mf a[236:239],a[100:103],a[12:15]
dq a[12:15],v16,38912
v_mul_f32 v11, v55, v55
mf a[240:243],a[100:103],a[16:19]
dq a[16:19],v16,40960
v_mul_f32 v12, v84, v84
mf a[240:243],a[140:143],a[48:51]
dq a[48:51],v17,40960
v_mul_f32 v13, v85, v85
mf a[244:247],a[140:143],a[52:55]
dq a[52:55],v17,43008
v_mul_f32 v14, v86, v86
mf a[244:247],a[100:103],a[20:23]
dq a[20:23],v16,43008
v_mul_f32 v15, v87, v87
mf a[248:251],a[100:103],a[24:27]
s_waitcnt lgkmcnt(15)
dq a[24:27],v16,45056
v_fma_f32 v8, v8, v82, v81
mf a[248:251],a[140:143],a[56:59]
dq a[56:59],v17,45056
v_fma_f32 v9, v9, v82, v81
mf a[252:255],a[140:143],a[60:63]
dq a[60:63],v17,47104
v_fma_f32 v10, v10, v82, v81
mf a[252:255],a[100:103],a[28:31]
s_waitcnt lgkmcnt(13)
dq a[28:31],v16,47104
v_fma_f32 v11, v11, v82, v81
mf v[176:179],a[0:3],a[88:91]
dt a[96:97],v23,16384
v_fma_f32 v12, v12, v82, v81
mf v[176:179],a[32:35],a[128:131]
s_waitcnt lgkmcnt(13)
dt a[98:99],v23,16640
v_fma_f32 v13, v13, v82, v81
mf v[180:183],a[36:39],a[128:131]
dt a[136:137],v23,36864
v_fma_f32 v14, v14, v82, v81
mf v[180:183],a[4:7],a[88:91]
s_waitcnt lgkmcnt(13)
dt a[138:139],v23,37120
v_fma_f32 v15, v15, v82, v81
mf v[184:187],a[8:11],a[88:91]
dt a[100:101],v23,18432
v_mul_f32 v8, v8, v52
mf v[184:187],a[40:43],a[128:131]
s_waitcnt lgkmcnt(13)
dt a[102:103],v23,18688
v_mul_f32 v9, v9, v53
mf v[188:191],a[44:47],a[128:131]
dt a[140:141],v23,38912
v_mul_f32 v10, v10, v54
mf v[188:191],a[12:15],a[88:91]
s_waitcnt lgkmcnt(13)
dt a[142:143],v23,39168
v_mul_f32 v11, v11, v55
mf v[192:195],a[16:19],a[88:91]
v_mul_f32 v12, v12, v84
v_mul_f32 v13, v13, v85
mf v[192:195],a[48:51],a[128:131]
s_waitcnt lgkmcnt(12)
v_mul_f32 v14, v14, v86
v_mul_f32 v15, v15, v87
mf v[196:199],a[52:55],a[128:131]
v_mul_f32 v116, v52, v116
v_mul_f32 v117, v53, v117
mf v[196:199],a[20:23],a[88:91]
s_waitcnt lgkmcnt(10)
v_mul_f32 v118, v54, v118
v_mul_f32 v119, v55, v119
mf v[200:203],a[24:27],a[88:91]
v_mul_f32 v148, v84, v148
v_mul_f32 v149, v85, v149
mf v[200:203],a[56:59],a[128:131]
s_waitcnt lgkmcnt(8)
v_mul_f32 v150, v86, v150
v_mul_f32 v151, v87, v151
mf v[204:207],a[60:63],a[128:131]
dq v[84:87],v43,512
mf v[204:207],a[28:31],a[88:91]
s_waitcnt lgkmcnt(1)
s_barrier
mf v[236:239],a[28:31],a[92:95]
v_readlane_b32 s70, v25, 2
v_readlane_b32 s71, v26, 2
mf v[236:239],a[60:63],a[132:135]
v_exp_f32 v8, v8
mf v[232:235],a[56:59],a[132:135]
v_exp_f32 v9, v9
mf v[232:235],a[24:27],a[92:95]
v_exp_f32 v10, v10
mf v[228:231],a[20:23],a[92:95]
s_add_u32 m0, s67, 32768
v_exp_f32 v11, v11
mf v[228:231],a[52:55],a[132:135]
buffer_load_dwordx4 v31, s[48:51], s70 offen offset:0 sc1 lds
mf v[224:227],a[48:51],a[132:135]
v_exp_f32 v12, v12
mf v[224:227],a[16:19],a[92:95]
v_exp_f32 v13, v13
mf v[220:223],a[12:15],a[92:95]
s_add_u32 m0, s67, 40832
v_exp_f32 v14, v14
mf v[220:223],a[44:47],a[132:135]
buffer_load_dwordx4 v31, s[48:51], s70 offen offset:128 sc1 lds
mf v[216:219],a[40:43],a[132:135]
s_add_u32 m0, s67, 33792
v_exp_f32 v15, v15
mf v[216:219],a[8:11],a[92:95]
buffer_load_dwordx4 v31, s[48:51], s71 offen offset:0 sc1 lds
v_fma_f32 v8, v8, v83, v83
mf v[212:215],a[4:7],a[92:95]
v_fma_f32 v9, v9, v83, v83
v_fma_f32 v10, v10, v83, v83
mf v[212:215],a[36:39],a[132:135]
v_fma_f32 v11, v11, v83, v83
v_fma_f32 v12, v12, v83, v83
mf v[208:211],a[32:35],a[132:135]
s_add_u32 m0, s67, 41856
v_fma_f32 v13, v13, v83, v83
v_fma_f32 v14, v14, v83, v83
mf v[208:211],a[0:3],a[92:95]
buffer_load_dwordx4 v31, s[48:51], s71 offen offset:128 sc1 lds
v_fma_f32 v15, v15, v83, v83
mf a[144:147],a[0:3],a[64:67]
v_readlane_b32 s70, v25, 3
v_readlane_b32 s71, v26, 3
mf a[144:147],a[32:35],a[104:107]
v_rcp_f32 v8, v8
mf a[148:151],a[36:39],a[104:107]
v_rcp_f32 v9, v9
mf a[148:151],a[4:7],a[64:67]
v_rcp_f32 v10, v10
mf a[152:155],a[8:11],a[64:67]
s_add_u32 m0, s67, 49152
v_rcp_f32 v11, v11
mf a[152:155],a[40:43],a[104:107]
buffer_load_dwordx4 v31, s[48:51], s70 offen offset:0 sc1 lds
mf a[156:159],a[44:47],a[104:107]
v_rcp_f32 v12, v12
mf a[156:159],a[12:15],a[64:67]
v_rcp_f32 v13, v13
mf a[160:163],a[16:19],a[64:67]
s_add_u32 m0, s67, 57216
v_rcp_f32 v14, v14
mf a[160:163],a[48:51],a[104:107]
buffer_load_dwordx4 v31, s[48:51], s70 offen offset:128 sc1 lds
mf a[164:167],a[52:55],a[104:107]
s_add_u32 m0, s67, 50176
v_rcp_f32 v15, v15
mf a[164:167],a[20:23],a[64:67]
buffer_load_dwordx4 v31, s[48:51], s71 offen offset:0 sc1 lds
v_mul_f32 v8, v8, v116
mf a[168:171],a[24:27],a[64:67]
v_mul_f32 v9, v9, v117
v_mul_f32 v10, v10, v118
mf a[168:171],a[56:59],a[104:107]
v_mul_f32 v11, v11, v119
v_mul_f32 v12, v12, v148
mf a[172:175],a[60:63],a[104:107]
s_add_u32 m0, s67, 58240
v_mul_f32 v13, v13, v149
v_mul_f32 v14, v14, v150
mf a[172:175],a[28:31],a[64:67]
buffer_load_dwordx4 v31, s[48:51], s71 offen offset:128 sc1 lds
v_mul_f32 v15, v15, v151
mf a[204:207],a[28:31],a[68:71]
v_lshrrev_b32 v39, 3, v2
v_lshlrev_b32 v39, 4, v39
mf a[204:207],a[60:63],a[108:111]
s_mov_b32 s3, 0
v_xor_b32 v39, v39, v38
v_cvt_pk_bf16_f32 v52, v8, v9
mf a[200:203],a[56:59],a[108:111]
s_add_u32 m0, s65, 16384
v_cvt_pk_bf16_f32 v53, v10, v11
v_cvt_pk_bf16_f32 v54, v12, v13
mf a[200:203],a[24:27],a[68:71]
buffer_load_dwordx4 v39, s[56:59], s3 offen lds
v_cvt_pk_bf16_f32 v55, v14, v15
mf a[196:199],a[20:23],a[68:71]
v_mul_f32 v8, v56, v56
v_mul_f32 v9, v57, v57
mf a[196:199],a[52:55],a[108:111]
s_mov_b32 s3, 16384
v_mul_f32 v10, v58, v58
v_mul_f32 v11, v59, v59
mf a[192:195],a[48:51],a[108:111]
s_add_u32 m0, s65, 17408
v_mul_f32 v12, v88, v88
v_mul_f32 v13, v89, v89
mf a[192:195],a[16:19],a[68:71]
buffer_load_dwordx4 v39, s[56:59], s3 offen lds
v_mul_f32 v14, v90, v90
mf a[188:191],a[12:15],a[68:71]
v_mul_f32 v15, v91, v91
s_waitcnt lgkmcnt(0)
mf a[188:191],a[44:47],a[108:111]
s_mov_b32 s3, 32768
v_fma_f32 v8, v8, v86, v85
v_fma_f32 v9, v9, v86, v85
mf a[184:187],a[40:43],a[108:111]
s_add_u32 m0, s65, 18432
v_fma_f32 v10, v10, v86, v85
v_fma_f32 v11, v11, v86, v85
mf a[184:187],a[8:11],a[68:71]
buffer_load_dwordx4 v39, s[56:59], s3 offen lds
v_fma_f32 v12, v12, v86, v85
mf a[180:183],a[4:7],a[68:71]
v_fma_f32 v13, v13, v86, v85
v_fma_f32 v14, v14, v86, v85
mf a[180:183],a[36:39],a[108:111]
s_mov_b32 s3, 49152
v_fma_f32 v15, v15, v86, v85
v_mul_f32 v8, v8, v56
mf a[176:179],a[32:35],a[108:111]
s_add_u32 m0, s65, 19456
v_mul_f32 v9, v9, v57
v_mul_f32 v10, v10, v58
mf a[176:179],a[0:3],a[68:71]
buffer_load_dwordx4 v39, s[56:59], s3 offen lds
v_mul_f32 v11, v11, v59
mf v[240:243],a[96:99],a[0:3]
dq v[20:23],v43,768
v_mul_f32 v12, v12, v88
mf v[240:243],a[136:139],a[32:35]
v_mul_f32 v13, v13, v89
v_mul_f32 v14, v14, v90
mf v[244:247],a[136:139],a[36:39]
v_mul_f32 v15, v15, v91
v_mul_f32 v120, v56, v120
mf v[244:247],a[96:99],a[4:7]
v_mul_f32 v121, v57, v121
v_mul_f32 v122, v58, v122
mf a[208:211],a[96:99],a[8:11]
v_mul_f32 v123, v59, v123
v_mul_f32 v152, v88, v152
mf a[208:211],a[136:139],a[40:43]
v_mul_f32 v153, v89, v153
v_mul_f32 v154, v90, v154
mf a[212:215],a[136:139],a[44:47]
v_mul_f32 v155, v91, v155
mf a[212:215],a[96:99],a[12:15]
v_exp_f32 v8, v8
mf a[216:219],a[96:99],a[16:19]
v_exp_f32 v9, v9
mf a[216:219],a[136:139],a[48:51]
v_exp_f32 v10, v10
mf a[220:223],a[136:139],a[52:55]
v_exp_f32 v11, v11
mf a[220:223],a[96:99],a[20:23]
v_exp_f32 v12, v12
mf a[224:227],a[96:99],a[24:27]
v_exp_f32 v13, v13
mf a[224:227],a[136:139],a[56:59]
v_exp_f32 v14, v14
mf a[228:231],a[136:139],a[60:63]
v_exp_f32 v15, v15
mf a[228:231],a[96:99],a[28:31]
v_fma_f32 v8, v8, v87, v87
v_fma_f32 v9, v9, v87, v87
mf v[248:251],a[100:103],a[0:3]
v_fma_f32 v10, v10, v87, v87
v_fma_f32 v11, v11, v87, v87
mf v[248:251],a[140:143],a[32:35]
v_fma_f32 v12, v12, v87, v87
v_fma_f32 v13, v13, v87, v87
mf v[252:255],a[140:143],a[36:39]
v_fma_f32 v14, v14, v87, v87
v_fma_f32 v15, v15, v87, v87
mf v[252:255],a[100:103],a[4:7]
v_rcp_f32 v8, v8
mf a[232:235],a[100:103],a[8:11]
v_rcp_f32 v9, v9
mf a[232:235],a[140:143],a[40:43]
v_rcp_f32 v10, v10
mf a[236:239],a[140:143],a[44:47]
v_rcp_f32 v11, v11
mf a[236:239],a[100:103],a[12:15]
v_rcp_f32 v12, v12
mf a[240:243],a[100:103],a[16:19]
v_rcp_f32 v13, v13
mf a[240:243],a[140:143],a[48:51]
v_rcp_f32 v14, v14
mf a[244:247],a[140:143],a[52:55]
v_rcp_f32 v15, v15
mf a[244:247],a[100:103],a[20:23]
v_mul_f32 v8, v8, v120
v_mul_f32 v9, v9, v121
mf a[248:251],a[100:103],a[24:27]
v_mul_f32 v10, v10, v122
v_mul_f32 v11, v11, v123
mf a[248:251],a[140:143],a[56:59]
v_mul_f32 v12, v12, v152
v_mul_f32 v13, v13, v153
mf a[252:255],a[140:143],a[60:63]
v_mul_f32 v14, v14, v154
v_mul_f32 v15, v15, v155
mf a[252:255],a[100:103],a[28:31]
v_cvt_pk_bf16_f32 v56, v8, v9
v_cvt_pk_bf16_f32 v57, v10, v11
v_cvt_pk_bf16_f32 v58, v12, v13
v_cvt_pk_bf16_f32 v59, v14, v15
buffer_store_dwordx4 v[52:55], v3, s[28:31], s10 offen offset:1024 sc1
buffer_store_dwordx4 v[56:59], v3, s[28:31], s10 offen offset:2048 sc1
L_epiKV:
s_lshr_b32 s70, s76, 6
s_add_u32 s70, s70, s22
s_lshl_b32 s70, s70, 13
s_add_u32 s70, s70, s78
s_add_u32 s71, s70, 4096
s_lshl_b32 s82, s21, 9
s_add_u32 s82, s82, 161792
v_and_b32 v45, 48, v2
v_add_u32 v45, s82, v45
s_mul_i32 s82, s22, 640
s_add_u32 s82, s82, 156416
v_and_b32 v46, 15, v2
v_lshl_add_u32 v46, v46, 2, s82
ds_read_b32 v144, v46 offset:0
ds_read_b32 v145, v46 offset:64
ds_read_b32 v146, v46 offset:384
ds_read_b32 v147, v46 offset:448
dq v[80:83],v45,0
dq v[112:115],v45,1024
dq v[84:87],v45,64
dq v[116:119],v45,1088
dq v[148:151],v44,512
dq v[152:155],v44,576
dq v[88:91],v45,128
dq v[120:123],v45,1152
s_waitcnt lgkmcnt(12)
s_nop 0
dq v[16:19],v43,1024
v_pk_mul_f32 v[8:9], v[60:61], v[60:61]
v_pk_mul_f32 v[10:11], v[62:63], v[62:63]
v_pk_mul_f32 v[12:13], v[92:93], v[92:93]
v_pk_mul_f32 v[14:15], v[94:95], v[94:95]
v_pk_fma_f32 v[8:9], v[8:9], v[22:23], v[20:21] op_sel:[0,0,1] op_sel_hi:[1,0,1]
v_pk_fma_f32 v[10:11], v[10:11], v[22:23], v[20:21] op_sel:[0,0,1] op_sel_hi:[1,0,1]
v_pk_fma_f32 v[12:13], v[12:13], v[22:23], v[20:21] op_sel:[0,0,1] op_sel_hi:[1,0,1]
v_pk_fma_f32 v[14:15], v[14:15], v[22:23], v[20:21] op_sel:[0,0,1] op_sel_hi:[1,0,1]
v_pk_mul_f32 v[8:9], v[8:9], v[60:61]
v_pk_mul_f32 v[10:11], v[10:11], v[62:63]
v_pk_mul_f32 v[12:13], v[12:13], v[92:93]
v_pk_mul_f32 v[14:15], v[14:15], v[94:95]
v_exp_f32 v8, v8
v_exp_f32 v9, v9
v_exp_f32 v10, v10
v_exp_f32 v11, v11
v_exp_f32 v12, v12
v_exp_f32 v13, v13
v_exp_f32 v14, v14
v_exp_f32 v15, v15
v_pk_mul_f32 v[124:125], v[60:61], v[124:125]
v_pk_mul_f32 v[126:127], v[62:63], v[126:127]
v_pk_mul_f32 v[156:157], v[92:93], v[156:157]
v_pk_mul_f32 v[158:159], v[94:95], v[158:159]
v_pk_fma_f32 v[8:9], v[8:9], v[22:23], v[22:23] op_sel:[0,1,1] op_sel_hi:[1,1,1]
v_pk_fma_f32 v[10:11], v[10:11], v[22:23], v[22:23] op_sel:[0,1,1] op_sel_hi:[1,1,1]
v_pk_fma_f32 v[12:13], v[12:13], v[22:23], v[22:23] op_sel:[0,1,1] op_sel_hi:[1,1,1]
v_pk_fma_f32 v[14:15], v[14:15], v[22:23], v[22:23] op_sel:[0,1,1] op_sel_hi:[1,1,1]
v_rcp_f32 v8, v8
v_rcp_f32 v9, v9
v_rcp_f32 v10, v10
v_rcp_f32 v11, v11
v_rcp_f32 v12, v12
v_rcp_f32 v13, v13
v_rcp_f32 v14, v14
v_rcp_f32 v15, v15
v_pk_mul_f32 v[8:9], v[8:9], v[124:125]
v_pk_mul_f32 v[10:11], v[10:11], v[126:127]
v_pk_mul_f32 v[12:13], v[12:13], v[156:157]
v_pk_mul_f32 v[14:15], v[14:15], v[158:159]
v_cvt_pk_bf16_f32 v60, v8, v9
v_cvt_pk_bf16_f32 v61, v10, v11
v_cvt_pk_bf16_f32 v62, v12, v13
v_cvt_pk_bf16_f32 v63, v14, v15
buffer_store_dwordx4 v[60:63], v3, s[28:31], s70 offen offset:3072 sc1
dq v[92:95],v45,192
dq v[124:127],v45,1216
s_waitcnt lgkmcnt(2)
s_nop 0
dq v[20:23],v43,1280
v_pk_mul_f32 v[8:9], v[64:65], v[64:65]
v_pk_mul_f32 v[10:11], v[66:67], v[66:67]
v_pk_mul_f32 v[12:13], v[96:97], v[96:97]
v_pk_mul_f32 v[14:15], v[98:99], v[98:99]
v_pk_fma_f32 v[8:9], v[8:9], v[18:19], v[16:17] op_sel:[0,0,1] op_sel_hi:[1,0,1]
v_pk_fma_f32 v[10:11], v[10:11], v[18:19], v[16:17] op_sel:[0,0,1] op_sel_hi:[1,0,1]
v_pk_fma_f32 v[12:13], v[12:13], v[18:19], v[16:17] op_sel:[0,0,1] op_sel_hi:[1,0,1]
v_pk_fma_f32 v[14:15], v[14:15], v[18:19], v[16:17] op_sel:[0,0,1] op_sel_hi:[1,0,1]
v_pk_mul_f32 v[8:9], v[8:9], v[64:65]
v_pk_mul_f32 v[10:11], v[10:11], v[66:67]
v_pk_mul_f32 v[12:13], v[12:13], v[96:97]
v_pk_mul_f32 v[14:15], v[14:15], v[98:99]
v_exp_f32 v8, v8
v_exp_f32 v9, v9
v_exp_f32 v10, v10
v_exp_f32 v11, v11
v_exp_f32 v12, v12
v_exp_f32 v13, v13
v_exp_f32 v14, v14
v_exp_f32 v15, v15
v_pk_mul_f32 v[128:129], v[64:65], v[128:129]
v_pk_mul_f32 v[130:131], v[66:67], v[130:131]
v_pk_mul_f32 v[160:161], v[96:97], v[160:161]
v_pk_mul_f32 v[162:163], v[98:99], v[162:163]
v_pk_fma_f32 v[8:9], v[8:9], v[18:19], v[18:19] op_sel:[0,1,1] op_sel_hi:[1,1,1]
v_pk_fma_f32 v[10:11], v[10:11], v[18:19], v[18:19] op_sel:[0,1,1] op_sel_hi:[1,1,1]
v_pk_fma_f32 v[12:13], v[12:13], v[18:19], v[18:19] op_sel:[0,1,1] op_sel_hi:[1,1,1]
v_pk_fma_f32 v[14:15], v[14:15], v[18:19], v[18:19] op_sel:[0,1,1] op_sel_hi:[1,1,1]
v_rcp_f32 v8, v8
v_rcp_f32 v9, v9
v_rcp_f32 v10, v10
v_rcp_f32 v11, v11
v_rcp_f32 v12, v12
v_rcp_f32 v13, v13
v_rcp_f32 v14, v14
v_rcp_f32 v15, v15
v_pk_mul_f32 v[8:9], v[8:9], v[128:129]
v_pk_mul_f32 v[10:11], v[10:11], v[130:131]
v_pk_mul_f32 v[12:13], v[12:13], v[160:161]
v_pk_mul_f32 v[14:15], v[14:15], v[162:163]
v_cvt_pk_bf16_f32 v64, v8, v9
v_cvt_pk_bf16_f32 v65, v10, v11
v_cvt_pk_bf16_f32 v66, v12, v13
v_cvt_pk_bf16_f32 v67, v14, v15
buffer_store_dwordx4 v[64:67], v3, s[28:31], s71 offen offset:0 sc1
dq v[96:99],v45,256
dq v[128:131],v45,1280
s_waitcnt lgkmcnt(2)
s_nop 0
dq v[16:19],v43,1536
v_pk_mul_f32 v[8:9], v[68:69], v[68:69]
v_pk_mul_f32 v[10:11], v[70:71], v[70:71]
v_pk_mul_f32 v[12:13], v[100:101], v[100:101]
v_pk_mul_f32 v[14:15], v[102:103], v[102:103]
v_pk_fma_f32 v[8:9], v[8:9], v[22:23], v[20:21] op_sel:[0,0,1] op_sel_hi:[1,0,1]
v_pk_fma_f32 v[10:11], v[10:11], v[22:23], v[20:21] op_sel:[0,0,1] op_sel_hi:[1,0,1]
v_pk_fma_f32 v[12:13], v[12:13], v[22:23], v[20:21] op_sel:[0,0,1] op_sel_hi:[1,0,1]
v_pk_fma_f32 v[14:15], v[14:15], v[22:23], v[20:21] op_sel:[0,0,1] op_sel_hi:[1,0,1]
v_pk_mul_f32 v[8:9], v[8:9], v[68:69]
v_pk_mul_f32 v[10:11], v[10:11], v[70:71]
v_pk_mul_f32 v[12:13], v[12:13], v[100:101]
v_pk_mul_f32 v[14:15], v[14:15], v[102:103]
v_exp_f32 v8, v8
v_exp_f32 v9, v9
v_exp_f32 v10, v10
v_exp_f32 v11, v11
v_exp_f32 v12, v12
v_exp_f32 v13, v13
v_exp_f32 v14, v14
v_exp_f32 v15, v15
v_pk_mul_f32 v[132:133], v[68:69], v[132:133]
v_pk_mul_f32 v[134:135], v[70:71], v[134:135]
v_pk_mul_f32 v[164:165], v[100:101], v[164:165]
v_pk_mul_f32 v[166:167], v[102:103], v[166:167]
v_pk_fma_f32 v[8:9], v[8:9], v[22:23], v[22:23] op_sel:[0,1,1] op_sel_hi:[1,1,1]
v_pk_fma_f32 v[10:11], v[10:11], v[22:23], v[22:23] op_sel:[0,1,1] op_sel_hi:[1,1,1]
v_pk_fma_f32 v[12:13], v[12:13], v[22:23], v[22:23] op_sel:[0,1,1] op_sel_hi:[1,1,1]
v_pk_fma_f32 v[14:15], v[14:15], v[22:23], v[22:23] op_sel:[0,1,1] op_sel_hi:[1,1,1]
v_rcp_f32 v8, v8
v_rcp_f32 v9, v9
v_rcp_f32 v10, v10
v_rcp_f32 v11, v11
v_rcp_f32 v12, v12
v_rcp_f32 v13, v13
v_rcp_f32 v14, v14
v_rcp_f32 v15, v15
v_pk_mul_f32 v[8:9], v[8:9], v[132:133]
v_pk_mul_f32 v[10:11], v[10:11], v[134:135]
v_pk_mul_f32 v[12:13], v[12:13], v[164:165]
v_pk_mul_f32 v[14:15], v[14:15], v[166:167]
v_cvt_pk_bf16_f32 v68, v8, v9
v_cvt_pk_bf16_f32 v69, v10, v11
v_cvt_pk_bf16_f32 v70, v12, v13
v_cvt_pk_bf16_f32 v71, v14, v15
buffer_store_dwordx4 v[68:71], v3, s[28:31], s71 offen offset:1024 sc1
dq v[100:103],v45,320
dq v[132:135],v45,1344
s_waitcnt lgkmcnt(2)
s_nop 0
dq v[20:23],v43,1792
v_pk_mul_f32 v[8:9], v[72:73], v[72:73]
v_pk_mul_f32 v[10:11], v[74:75], v[74:75]
v_pk_mul_f32 v[12:13], v[104:105], v[104:105]
v_pk_mul_f32 v[14:15], v[106:107], v[106:107]
v_pk_fma_f32 v[8:9], v[8:9], v[18:19], v[16:17] op_sel:[0,0,1] op_sel_hi:[1,0,1]
v_pk_fma_f32 v[10:11], v[10:11], v[18:19], v[16:17] op_sel:[0,0,1] op_sel_hi:[1,0,1]
v_pk_fma_f32 v[12:13], v[12:13], v[18:19], v[16:17] op_sel:[0,0,1] op_sel_hi:[1,0,1]
v_pk_fma_f32 v[14:15], v[14:15], v[18:19], v[16:17] op_sel:[0,0,1] op_sel_hi:[1,0,1]
v_pk_mul_f32 v[8:9], v[8:9], v[72:73]
v_pk_mul_f32 v[10:11], v[10:11], v[74:75]
v_pk_mul_f32 v[12:13], v[12:13], v[104:105]
v_pk_mul_f32 v[14:15], v[14:15], v[106:107]
v_exp_f32 v8, v8
v_exp_f32 v9, v9
v_exp_f32 v10, v10
v_exp_f32 v11, v11
v_exp_f32 v12, v12
v_exp_f32 v13, v13
v_exp_f32 v14, v14
v_exp_f32 v15, v15
v_pk_mul_f32 v[136:137], v[72:73], v[136:137]
v_pk_mul_f32 v[138:139], v[74:75], v[138:139]
v_pk_mul_f32 v[168:169], v[104:105], v[168:169]
v_pk_mul_f32 v[170:171], v[106:107], v[170:171]
v_pk_fma_f32 v[8:9], v[8:9], v[18:19], v[18:19] op_sel:[0,1,1] op_sel_hi:[1,1,1]
v_pk_fma_f32 v[10:11], v[10:11], v[18:19], v[18:19] op_sel:[0,1,1] op_sel_hi:[1,1,1]
v_pk_fma_f32 v[12:13], v[12:13], v[18:19], v[18:19] op_sel:[0,1,1] op_sel_hi:[1,1,1]
v_pk_fma_f32 v[14:15], v[14:15], v[18:19], v[18:19] op_sel:[0,1,1] op_sel_hi:[1,1,1]
v_rcp_f32 v8, v8
v_rcp_f32 v9, v9
v_rcp_f32 v10, v10
v_rcp_f32 v11, v11
v_rcp_f32 v12, v12
v_rcp_f32 v13, v13
v_rcp_f32 v14, v14
v_rcp_f32 v15, v15
v_pk_mul_f32 v[8:9], v[8:9], v[136:137]
v_pk_mul_f32 v[10:11], v[10:11], v[138:139]
v_pk_mul_f32 v[12:13], v[12:13], v[168:169]
v_pk_mul_f32 v[14:15], v[14:15], v[170:171]
v_cvt_pk_bf16_f32 v72, v8, v9
v_cvt_pk_bf16_f32 v73, v10, v11
v_cvt_pk_bf16_f32 v74, v12, v13
v_cvt_pk_bf16_f32 v75, v14, v15
buffer_store_dwordx4 v[72:75], v3, s[28:31], s71 offen offset:2048 sc1
dq v[104:107],v45,384
dq v[136:139],v45,1408
s_waitcnt lgkmcnt(2)
s_nop 0
dq v[16:19],v43,0
v_pk_mul_f32 v[8:9], v[76:77], v[76:77]
v_pk_mul_f32 v[10:11], v[78:79], v[78:79]
v_pk_mul_f32 v[12:13], v[108:109], v[108:109]
v_pk_mul_f32 v[14:15], v[110:111], v[110:111]
v_pk_fma_f32 v[8:9], v[8:9], v[22:23], v[20:21] op_sel:[0,0,1] op_sel_hi:[1,0,1]
v_pk_fma_f32 v[10:11], v[10:11], v[22:23], v[20:21] op_sel:[0,0,1] op_sel_hi:[1,0,1]
v_pk_fma_f32 v[12:13], v[12:13], v[22:23], v[20:21] op_sel:[0,0,1] op_sel_hi:[1,0,1]
v_pk_fma_f32 v[14:15], v[14:15], v[22:23], v[20:21] op_sel:[0,0,1] op_sel_hi:[1,0,1]
v_pk_mul_f32 v[8:9], v[8:9], v[76:77]
v_pk_mul_f32 v[10:11], v[10:11], v[78:79]
v_pk_mul_f32 v[12:13], v[12:13], v[108:109]
v_pk_mul_f32 v[14:15], v[14:15], v[110:111]
v_exp_f32 v8, v8
v_exp_f32 v9, v9
v_exp_f32 v10, v10
v_exp_f32 v11, v11
v_exp_f32 v12, v12
v_exp_f32 v13, v13
L_stub7:
s_cbranch_execz L_stub21
v_exp_f32 v14, v14
v_exp_f32_e64 v15, v15
v_pk_mul_f32 v[140:141], v[76:77], v[140:141]
v_pk_mul_f32 v[142:143], v[78:79], v[142:143]
v_pk_mul_f32 v[172:173], v[108:109], v[172:173]
v_pk_mul_f32 v[174:175], v[110:111], v[174:175]
v_pk_fma_f32 v[8:9], v[8:9], v[22:23], v[22:23] op_sel:[0,1,1] op_sel_hi:[1,1,1]
v_pk_fma_f32 v[10:11], v[10:11], v[22:23], v[22:23] op_sel:[0,1,1] op_sel_hi:[1,1,1]
v_pk_fma_f32 v[12:13], v[12:13], v[22:23], v[22:23] op_sel:[0,1,1] op_sel_hi:[1,1,1]
v_pk_fma_f32 v[14:15], v[14:15], v[22:23], v[22:23] op_sel:[0,1,1] op_sel_hi:[1,1,1]
v_rcp_f32 v8, v8
v_rcp_f32 v9, v9
v_rcp_f32 v10, v10
v_rcp_f32 v11, v11
v_rcp_f32 v12, v12
v_rcp_f32 v13, v13
v_rcp_f32 v14, v14
v_rcp_f32 v15, v15
v_pk_mul_f32 v[8:9], v[8:9], v[140:141]
v_pk_mul_f32 v[10:11], v[10:11], v[142:143]
v_pk_mul_f32 v[12:13], v[12:13], v[172:173]
v_pk_mul_f32 v[14:15], v[14:15], v[174:175]
v_cvt_pk_bf16_f32 v76, v8, v9
v_cvt_pk_bf16_f32 v77, v10, v11
v_cvt_pk_bf16_f32 v78, v12, v13
v_cvt_pk_bf16_f32 v79, v14, v15
buffer_store_dwordx4 v[76:79], v3, s[28:31], s71 offen offset:3072 sc1
dq v[108:111],v45,448
dq v[140:143],v45,1472
dq v[20:23],v43,256
v_pk_fma_f32 v[176:177], v[80:81], v[146:147], v[176:177] op_sel:[0,0,0] op_sel_hi:[1,0,1]
v_pk_fma_f32 v[178:179], v[82:83], v[146:147], v[178:179] op_sel:[0,0,0] op_sel_hi:[1,0,1]
v_pk_fma_f32 v[180:181], v[84:85], v[146:147], v[180:181] op_sel:[0,0,0] op_sel_hi:[1,0,1]
v_pk_fma_f32 v[182:183], v[86:87], v[146:147], v[182:183] op_sel:[0,0,0] op_sel_hi:[1,0,1]
v_pk_fma_f32 v[208:209], v[80:81], v[146:147], v[208:209] op_sel:[0,1,0] op_sel_hi:[1,1,1]
v_pk_fma_f32 v[210:211], v[82:83], v[146:147], v[210:211] op_sel:[0,1,0] op_sel_hi:[1,1,1]
v_pk_fma_f32 v[212:213], v[84:85], v[146:147], v[212:213] op_sel:[0,1,0] op_sel_hi:[1,1,1]
v_pk_fma_f32 v[214:215], v[86:87], v[146:147], v[214:215] op_sel:[0,1,0] op_sel_hi:[1,1,1]
v_pk_mul_f32 v[176:177], v[176:177], v[112:113]
v_pk_mul_f32 v[178:179], v[178:179], v[114:115]
v_pk_mul_f32 v[180:181], v[180:181], v[116:117]
v_pk_mul_f32 v[182:183], v[182:183], v[118:119]
v_pk_mul_f32 v[208:209], v[208:209], v[112:113]
v_pk_mul_f32 v[210:211], v[210:211], v[114:115]
v_pk_mul_f32 v[212:213], v[212:213], v[116:117]
v_pk_mul_f32 v[214:215], v[214:215], v[118:119]
v_cvt_pk_bf16_f32 v176, v176, v177
v_cvt_pk_bf16_f32 v177, v178, v179
v_cvt_pk_bf16_f32 v178, v180, v181
v_cvt_pk_bf16_f32 v179, v182, v183
v_cvt_pk_bf16_f32 v208, v208, v209
v_cvt_pk_bf16_f32 v209, v210, v211
v_cvt_pk_bf16_f32 v210, v212, v213
v_cvt_pk_bf16_f32 v211, v214, v215
v_pk_fma_f32 v[184:185], v[88:89], v[146:147], v[184:185] op_sel:[0,0,0] op_sel_hi:[1,0,1]
v_pk_fma_f32 v[186:187], v[90:91], v[146:147], v[186:187] op_sel:[0,0,0] op_sel_hi:[1,0,1]
v_pk_fma_f32 v[188:189], v[92:93], v[146:147], v[188:189] op_sel:[0,0,0] op_sel_hi:[1,0,1]
v_pk_fma_f32 v[190:191], v[94:95], v[146:147], v[190:191] op_sel:[0,0,0] op_sel_hi:[1,0,1]
v_pk_fma_f32 v[216:217], v[88:89], v[146:147], v[216:217] op_sel:[0,1,0] op_sel_hi:[1,1,1]
v_pk_fma_f32 v[218:219], v[90:91], v[146:147], v[218:219] op_sel:[0,1,0] op_sel_hi:[1,1,1]
v_pk_fma_f32 v[220:221], v[92:93], v[146:147], v[220:221] op_sel:[0,1,0] op_sel_hi:[1,1,1]
v_pk_fma_f32 v[222:223], v[94:95], v[146:147], v[222:223] op_sel:[0,1,0] op_sel_hi:[1,1,1]
v_pk_mul_f32 v[184:185], v[184:185], v[120:121]
v_pk_mul_f32 v[186:187], v[186:187], v[122:123]
v_pk_mul_f32 v[188:189], v[188:189], v[124:125]
v_pk_mul_f32 v[190:191], v[190:191], v[126:127]
v_pk_mul_f32 v[216:217], v[216:217], v[120:121]
v_pk_mul_f32 v[218:219], v[218:219], v[122:123]
v_pk_mul_f32 v[220:221], v[220:221], v[124:125]
v_pk_mul_f32 v[222:223], v[222:223], v[126:127]
v_cvt_pk_bf16_f32 v184, v184, v185
v_cvt_pk_bf16_f32 v185, v186, v187
v_cvt_pk_bf16_f32 v186, v188, v189
v_cvt_pk_bf16_f32 v187, v190, v191
v_cvt_pk_bf16_f32 v216, v216, v217
v_cvt_pk_bf16_f32 v217, v218, v219
v_cvt_pk_bf16_f32 v218, v220, v221
v_cvt_pk_bf16_f32 v219, v222, v223
v_pk_fma_f32 v[192:193], v[96:97], v[146:147], v[192:193] op_sel:[0,0,0] op_sel_hi:[1,0,1]
v_pk_fma_f32 v[194:195], v[98:99], v[146:147], v[194:195] op_sel:[0,0,0] op_sel_hi:[1,0,1]
v_pk_fma_f32 v[196:197], v[100:101], v[146:147], v[196:197] op_sel:[0,0,0] op_sel_hi:[1,0,1]
v_pk_fma_f32 v[198:199], v[102:103], v[146:147], v[198:199] op_sel:[0,0,0] op_sel_hi:[1,0,1]
v_pk_fma_f32 v[224:225], v[96:97], v[146:147], v[224:225] op_sel:[0,1,0] op_sel_hi:[1,1,1]
v_pk_fma_f32 v[226:227], v[98:99], v[146:147], v[226:227] op_sel:[0,1,0] op_sel_hi:[1,1,1]
v_pk_fma_f32 v[228:229], v[100:101], v[146:147], v[228:229] op_sel:[0,1,0] op_sel_hi:[1,1,1]
v_pk_fma_f32 v[230:231], v[102:103], v[146:147], v[230:231] op_sel:[0,1,0] op_sel_hi:[1,1,1]
v_pk_mul_f32 v[192:193], v[192:193], v[128:129]
v_pk_mul_f32 v[194:195], v[194:195], v[130:131]
v_pk_mul_f32 v[196:197], v[196:197], v[132:133]
v_pk_mul_f32 v[198:199], v[198:199], v[134:135]
v_pk_mul_f32 v[224:225], v[224:225], v[128:129]
v_pk_mul_f32 v[226:227], v[226:227], v[130:131]
v_pk_mul_f32 v[228:229], v[228:229], v[132:133]
v_pk_mul_f32 v[230:231], v[230:231], v[134:135]
v_cvt_pk_bf16_f32 v192, v192, v193
v_cvt_pk_bf16_f32 v193, v194, v195
v_cvt_pk_bf16_f32 v194, v196, v197
v_cvt_pk_bf16_f32 v195, v198, v199
v_cvt_pk_bf16_f32 v224, v224, v225
v_cvt_pk_bf16_f32 v225, v226, v227
v_cvt_pk_bf16_f32 v226, v228, v229
v_cvt_pk_bf16_f32 v227, v230, v231
s_waitcnt lgkmcnt(0)
s_nop 0
v_pk_fma_f32 v[200:201], v[104:105], v[146:147], v[200:201] op_sel:[0,0,0] op_sel_hi:[1,0,1]
v_pk_fma_f32 v[202:203], v[106:107], v[146:147], v[202:203] op_sel:[0,0,0] op_sel_hi:[1,0,1]
v_pk_fma_f32 v[204:205], v[108:109], v[146:147], v[204:205] op_sel:[0,0,0] op_sel_hi:[1,0,1]
v_pk_fma_f32 v[206:207], v[110:111], v[146:147], v[206:207] op_sel:[0,0,0] op_sel_hi:[1,0,1]
v_pk_fma_f32 v[232:233], v[104:105], v[146:147], v[232:233] op_sel:[0,1,0] op_sel_hi:[1,1,1]
v_pk_fma_f32 v[234:235], v[106:107], v[146:147], v[234:235] op_sel:[0,1,0] op_sel_hi:[1,1,1]
v_pk_fma_f32 v[236:237], v[108:109], v[146:147], v[236:237] op_sel:[0,1,0] op_sel_hi:[1,1,1]
v_pk_fma_f32 v[238:239], v[110:111], v[146:147], v[238:239] op_sel:[0,1,0] op_sel_hi:[1,1,1]
v_pk_mul_f32 v[200:201], v[200:201], v[136:137]
v_pk_mul_f32 v[202:203], v[202:203], v[138:139]
v_pk_mul_f32 v[204:205], v[204:205], v[140:141]
v_pk_mul_f32 v[206:207], v[206:207], v[142:143]
v_pk_mul_f32 v[232:233], v[232:233], v[136:137]
v_pk_mul_f32 v[234:235], v[234:235], v[138:139]
v_pk_mul_f32 v[236:237], v[236:237], v[140:141]
v_pk_mul_f32 v[238:239], v[238:239], v[142:143]
v_cvt_pk_bf16_f32 v200, v200, v201
v_cvt_pk_bf16_f32 v201, v202, v203
v_cvt_pk_bf16_f32 v202, v204, v205
v_cvt_pk_bf16_f32 v203, v206, v207
v_cvt_pk_bf16_f32 v232, v232, v233
v_cvt_pk_bf16_f32 v233, v234, v235
v_cvt_pk_bf16_f32 v234, v236, v237
v_cvt_pk_bf16_f32 v235, v238, v239
v_mov_b32 v228, 0x3f803f80
v_mov_b32 v229, 0x3f803f80
v_mov_b32 v230, 0x3f803f80
v_mov_b32 v231, 0x3f803f80
v_accvgpr_read_b32 v156, a144
v_accvgpr_read_b32 v157, a145
v_accvgpr_read_b32 v158, a146
v_accvgpr_read_b32 v159, a147
v_accvgpr_read_b32 v160, a148
v_accvgpr_read_b32 v161, a149
v_accvgpr_read_b32 v162, a150
v_accvgpr_read_b32 v163, a151
v_pk_fma_f32 v[156:157], v[80:81], v[144:145], v[156:157] op_sel:[0,0,0] op_sel_hi:[1,0,1]
v_pk_fma_f32 v[158:159], v[82:83], v[144:145], v[158:159] op_sel:[0,0,0] op_sel_hi:[1,0,1]
v_pk_fma_f32 v[160:161], v[84:85], v[144:145], v[160:161] op_sel:[0,0,0] op_sel_hi:[1,0,1]
v_pk_fma_f32 v[162:163], v[86:87], v[144:145], v[162:163] op_sel:[0,0,0] op_sel_hi:[1,0,1]
v_pk_fma_f32 v[156:157], v[156:157], v[112:113], v[40:41] op_sel_hi:[1,1,0]
v_pk_fma_f32 v[158:159], v[158:159], v[114:115], v[40:41] op_sel_hi:[1,1,0]
v_pk_fma_f32 v[160:161], v[160:161], v[116:117], v[40:41] op_sel_hi:[1,1,0]
v_pk_fma_f32 v[162:163], v[162:163], v[118:119], v[40:41] op_sel_hi:[1,1,0]
v_pk_fma_f32 v[8:9], v[156:157], s[18:19], v[40:41] op_sel:[0,0,1] op_sel_hi:[1,1,1]
v_pk_fma_f32 v[10:11], v[158:159], s[18:19], v[40:41] op_sel:[0,0,1] op_sel_hi:[1,1,1]
v_pk_fma_f32 v[12:13], v[160:161], s[18:19], v[40:41] op_sel:[0,0,1] op_sel_hi:[1,1,1]
v_pk_fma_f32 v[14:15], v[162:163], s[18:19], v[40:41] op_sel:[0,0,1] op_sel_hi:[1,1,1]
v_exp_f32_e64 v8, v8 clamp
v_exp_f32_e64 v9, v9 clamp
v_exp_f32_e64 v10, v10 clamp
v_exp_f32_e64 v11, v11 clamp
v_exp_f32_e64 v12, v12 clamp
v_exp_f32_e64 v13, v13 clamp
v_exp_f32_e64 v14, v14 clamp
v_exp_f32_e64 v15, v15 clamp
v_max_f32 v156, v40, v156
v_max_f32 v157, v40, v157
v_max_f32 v158, v40, v158
v_max_f32 v159, v40, v159
v_max_f32 v160, v40, v160
v_max_f32 v161, v40, v161
v_max_f32 v162, v40, v162
v_max_f32 v163, v40, v163
v_pk_add_f32 v[8:9], v[8:9], v[156:157]
v_pk_add_f32 v[10:11], v[10:11], v[158:159]
v_pk_add_f32 v[12:13], v[12:13], v[160:161]
v_pk_add_f32 v[14:15], v[14:15], v[162:163]
v_cvt_pk_bf16_f32 v236, v8, v9
v_cvt_pk_bf16_f32 v237, v10, v11
v_cvt_pk_bf16_f32 v238, v12, v13
v_cvt_pk_bf16_f32 v239, v14, v15
s_nop 1
v_mfma_f32_16x16x32_bf16 v[180:183], v[236:239], v[176:179], 0
v_mfma_f32_16x16x32_bf16 v[188:191], v[236:239], v[208:211], 0
v_mfma_f32_16x16x32_bf16 v[212:215], v[236:239], v[228:231], 0
s_waitcnt vmcnt(0)
v_add_u32 v6, 1, v5
s_mov_b64 exec, 1
buffer_store_dword v6, v4, s[28:31], s79 offen sc1
s_mov_b64 exec, -1
s_nop 0
v_accvgpr_read_b32 v156, a176
v_accvgpr_read_b32 v157, a177
v_accvgpr_read_b32 v158, a178
v_accvgpr_read_b32 v159, a179
v_accvgpr_read_b32 v160, a180
v_accvgpr_read_b32 v161, a181
v_accvgpr_read_b32 v162, a182
v_accvgpr_read_b32 v163, a183
v_pk_fma_f32 v[156:157], v[80:81], v[144:145], v[156:157] op_sel:[0,1,0] op_sel_hi:[1,1,1]
v_pk_fma_f32 v[158:159], v[82:83], v[144:145], v[158:159] op_sel:[0,1,0] op_sel_hi:[1,1,1]
v_pk_fma_f32 v[160:161], v[84:85], v[144:145], v[160:161] op_sel:[0,1,0] op_sel_hi:[1,1,1]
v_pk_fma_f32 v[162:163], v[86:87], v[144:145], v[162:163] op_sel:[0,1,0] op_sel_hi:[1,1,1]
v_pk_fma_f32 v[156:157], v[156:157], v[112:113], v[40:41] op_sel_hi:[1,1,0]
v_pk_fma_f32 v[158:159], v[158:159], v[114:115], v[40:41] op_sel_hi:[1,1,0]
v_pk_fma_f32 v[160:161], v[160:161], v[116:117], v[40:41] op_sel_hi:[1,1,0]
v_pk_fma_f32 v[162:163], v[162:163], v[118:119], v[40:41] op_sel_hi:[1,1,0]
v_pk_fma_f32 v[8:9], v[156:157], s[18:19], v[40:41] op_sel:[0,0,1] op_sel_hi:[1,1,1]
v_pk_fma_f32 v[10:11], v[158:159], s[18:19], v[40:41] op_sel:[0,0,1] op_sel_hi:[1,1,1]
v_pk_fma_f32 v[12:13], v[160:161], s[18:19], v[40:41] op_sel:[0,0,1] op_sel_hi:[1,1,1]
v_pk_fma_f32 v[14:15], v[162:163], s[18:19], v[40:41] op_sel:[0,0,1] op_sel_hi:[1,1,1]
v_exp_f32_e64 v8, v8 clamp
v_exp_f32_e64 v9, v9 clamp
v_exp_f32_e64 v10, v10 clamp
v_exp_f32_e64 v11, v11 clamp
v_exp_f32_e64 v12, v12 clamp
v_exp_f32_e64 v13, v13 clamp
v_exp_f32_e64 v14, v14 clamp
v_exp_f32_e64 v15, v15 clamp
v_max_f32 v156, v40, v156
v_max_f32 v157, v40, v157
v_max_f32 v158, v40, v158
v_max_f32 v159, v40, v159
v_max_f32 v160, v40, v160
v_max_f32 v161, v40, v161
v_max_f32 v162, v40, v162
v_max_f32 v163, v40, v163
v_pk_add_f32 v[8:9], v[8:9], v[156:157]
v_pk_add_f32 v[10:11], v[10:11], v[158:159]
v_pk_add_f32 v[12:13], v[12:13], v[160:161]
v_pk_add_f32 v[14:15], v[14:15], v[162:163]
v_cvt_pk_bf16_f32 v236, v8, v9
v_cvt_pk_bf16_f32 v237, v10, v11
v_cvt_pk_bf16_f32 v238, v12, v13
v_cvt_pk_bf16_f32 v239, v14, v15
s_nop 1
v_mfma_f32_16x16x32_bf16 v[196:199], v[236:239], v[176:179], 0
v_mfma_f32_16x16x32_bf16 v[204:207], v[236:239], v[208:211], 0
v_mfma_f32_16x16x32_bf16 v[220:223], v[236:239], v[228:231], 0
s_nop 0
v_accvgpr_read_b32 v156, a152
v_accvgpr_read_b32 v157, a153
v_accvgpr_read_b32 v158, a154
v_accvgpr_read_b32 v159, a155
v_accvgpr_read_b32 v160, a156
v_accvgpr_read_b32 v161, a157
v_accvgpr_read_b32 v162, a158
v_accvgpr_read_b32 v163, a159
v_pk_fma_f32 v[156:157], v[88:89], v[144:145], v[156:157] op_sel:[0,0,0] op_sel_hi:[1,0,1]
v_pk_fma_f32 v[158:159], v[90:91], v[144:145], v[158:159] op_sel:[0,0,0] op_sel_hi:[1,0,1]
v_pk_fma_f32 v[160:161], v[92:93], v[144:145], v[160:161] op_sel:[0,0,0] op_sel_hi:[1,0,1]
v_pk_fma_f32 v[162:163], v[94:95], v[144:145], v[162:163] op_sel:[0,0,0] op_sel_hi:[1,0,1]
v_pk_fma_f32 v[156:157], v[156:157], v[120:121], v[40:41] op_sel_hi:[1,1,0]
v_pk_fma_f32 v[158:159], v[158:159], v[122:123], v[40:41] op_sel_hi:[1,1,0]
v_pk_fma_f32 v[160:161], v[160:161], v[124:125], v[40:41] op_sel_hi:[1,1,0]
v_pk_fma_f32 v[162:163], v[162:163], v[126:127], v[40:41] op_sel_hi:[1,1,0]
v_pk_fma_f32 v[8:9], v[156:157], s[18:19], v[40:41] op_sel:[0,0,1] op_sel_hi:[1,1,1]
v_pk_fma_f32 v[10:11], v[158:159], s[18:19], v[40:41] op_sel:[0,0,1] op_sel_hi:[1,1,1]
v_pk_fma_f32 v[12:13], v[160:161], s[18:19], v[40:41] op_sel:[0,0,1] op_sel_hi:[1,1,1]
v_pk_fma_f32 v[14:15], v[162:163], s[18:19], v[40:41] op_sel:[0,0,1] op_sel_hi:[1,1,1]
v_exp_f32_e64 v8, v8 clamp
v_exp_f32_e64 v9, v9 clamp
v_exp_f32_e64 v10, v10 clamp
v_exp_f32_e64 v11, v11 clamp
v_exp_f32_e64 v12, v12 clamp
v_exp_f32_e64 v13, v13 clamp
v_exp_f32_e64 v14, v14 clamp
v_exp_f32_e64 v15, v15 clamp
v_max_f32 v156, v40, v156
v_max_f32 v157, v40, v157
v_max_f32 v158, v40, v158
v_max_f32 v159, v40, v159
v_max_f32 v160, v40, v160
v_max_f32 v161, v40, v161
v_max_f32 v162, v40, v162
v_max_f32 v163, v40, v163
v_pk_add_f32 v[8:9], v[8:9], v[156:157]
v_pk_add_f32 v[10:11], v[10:11], v[158:159]
v_pk_add_f32 v[12:13], v[12:13], v[160:161]
v_pk_add_f32 v[14:15], v[14:15], v[162:163]
v_cvt_pk_bf16_f32 v236, v8, v9
v_cvt_pk_bf16_f32 v237, v10, v11
v_cvt_pk_bf16_f32 v238, v12, v13
v_cvt_pk_bf16_f32 v239, v14, v15
s_nop 1
mf v[180:183],v[236:239],v[184:187]
mf v[188:191],v[236:239],v[216:219]
mf v[212:215],v[236:239],v[228:231]
s_nop 0
v_accvgpr_read_b32 v156, a184
v_accvgpr_read_b32 v157, a185
v_accvgpr_read_b32 v158, a186
v_accvgpr_read_b32 v159, a187
v_accvgpr_read_b32 v160, a188
v_accvgpr_read_b32 v161, a189
v_accvgpr_read_b32 v162, a190
v_accvgpr_read_b32 v163, a191
v_pk_fma_f32 v[156:157], v[88:89], v[144:145], v[156:157] op_sel:[0,1,0] op_sel_hi:[1,1,1]
v_pk_fma_f32 v[158:159], v[90:91], v[144:145], v[158:159] op_sel:[0,1,0] op_sel_hi:[1,1,1]
v_pk_fma_f32 v[160:161], v[92:93], v[144:145], v[160:161] op_sel:[0,1,0] op_sel_hi:[1,1,1]
v_pk_fma_f32 v[162:163], v[94:95], v[144:145], v[162:163] op_sel:[0,1,0] op_sel_hi:[1,1,1]
v_pk_fma_f32 v[156:157], v[156:157], v[120:121], v[40:41] op_sel_hi:[1,1,0]
v_pk_fma_f32 v[158:159], v[158:159], v[122:123], v[40:41] op_sel_hi:[1,1,0]
v_pk_fma_f32 v[160:161], v[160:161], v[124:125], v[40:41] op_sel_hi:[1,1,0]
v_pk_fma_f32 v[162:163], v[162:163], v[126:127], v[40:41] op_sel_hi:[1,1,0]
v_pk_fma_f32 v[8:9], v[156:157], s[18:19], v[40:41] op_sel:[0,0,1] op_sel_hi:[1,1,1]
v_pk_fma_f32 v[10:11], v[158:159], s[18:19], v[40:41] op_sel:[0,0,1] op_sel_hi:[1,1,1]
v_pk_fma_f32 v[12:13], v[160:161], s[18:19], v[40:41] op_sel:[0,0,1] op_sel_hi:[1,1,1]
v_pk_fma_f32 v[14:15], v[162:163], s[18:19], v[40:41] op_sel:[0,0,1] op_sel_hi:[1,1,1]
v_exp_f32_e64 v8, v8 clamp
v_exp_f32_e64 v9, v9 clamp
v_exp_f32_e64 v10, v10 clamp
v_exp_f32_e64 v11, v11 clamp
v_exp_f32_e64 v12, v12 clamp
v_exp_f32_e64 v13, v13 clamp
v_exp_f32_e64 v14, v14 clamp
v_exp_f32_e64 v15, v15 clamp
v_max_f32 v156, v40, v156
v_max_f32 v157, v40, v157
v_max_f32 v158, v40, v158
v_max_f32 v159, v40, v159
v_max_f32 v160, v40, v160
v_max_f32 v161, v40, v161
v_max_f32 v162, v40, v162
v_max_f32 v163, v40, v163
v_pk_add_f32 v[8:9], v[8:9], v[156:157]
v_pk_add_f32 v[10:11], v[10:11], v[158:159]
v_pk_add_f32 v[12:13], v[12:13], v[160:161]
v_pk_add_f32 v[14:15], v[14:15], v[162:163]
v_cvt_pk_bf16_f32 v236, v8, v9
v_cvt_pk_bf16_f32 v237, v10, v11
v_cvt_pk_bf16_f32 v238, v12, v13
v_cvt_pk_bf16_f32 v239, v14, v15
s_nop 1
mf v[196:199],v[236:239],v[184:187]
mf v[204:207],v[236:239],v[216:219]
mf v[220:223],v[236:239],v[228:231]
s_nop 0
v_accvgpr_read_b32 v156, a160
v_accvgpr_read_b32 v157, a161
v_accvgpr_read_b32 v158, a162
v_accvgpr_read_b32 v159, a163
v_accvgpr_read_b32 v160, a164
v_accvgpr_read_b32 v161, a165
v_accvgpr_read_b32 v162, a166
v_accvgpr_read_b32 v163, a167
v_pk_fma_f32 v[156:157], v[96:97], v[144:145], v[156:157] op_sel:[0,0,0] op_sel_hi:[1,0,1]
v_pk_fma_f32 v[158:159], v[98:99], v[144:145], v[158:159] op_sel:[0,0,0] op_sel_hi:[1,0,1]
v_pk_fma_f32 v[160:161], v[100:101], v[144:145], v[160:161] op_sel:[0,0,0] op_sel_hi:[1,0,1]
v_pk_fma_f32 v[162:163], v[102:103], v[144:145], v[162:163] op_sel:[0,0,0] op_sel_hi:[1,0,1]
v_pk_fma_f32 v[156:157], v[156:157], v[128:129], v[40:41] op_sel_hi:[1,1,0]
v_pk_fma_f32 v[158:159], v[158:159], v[130:131], v[40:41] op_sel_hi:[1,1,0]
v_pk_fma_f32 v[160:161], v[160:161], v[132:133], v[40:41] op_sel_hi:[1,1,0]
v_pk_fma_f32 v[162:163], v[162:163], v[134:135], v[40:41] op_sel_hi:[1,1,0]
v_pk_fma_f32 v[8:9], v[156:157], s[18:19], v[40:41] op_sel:[0,0,1] op_sel_hi:[1,1,1]
v_pk_fma_f32 v[10:11], v[158:159], s[18:19], v[40:41] op_sel:[0,0,1] op_sel_hi:[1,1,1]
v_pk_fma_f32 v[12:13], v[160:161], s[18:19], v[40:41] op_sel:[0,0,1] op_sel_hi:[1,1,1]
v_pk_fma_f32 v[14:15], v[162:163], s[18:19], v[40:41] op_sel:[0,0,1] op_sel_hi:[1,1,1]
v_exp_f32_e64 v8, v8 clamp
v_exp_f32_e64 v9, v9 clamp
v_exp_f32_e64 v10, v10 clamp
v_exp_f32_e64 v11, v11 clamp
v_exp_f32_e64 v12, v12 clamp
v_exp_f32_e64 v13, v13 clamp
v_exp_f32_e64 v14, v14 clamp
v_exp_f32_e64 v15, v15 clamp
v_max_f32 v156, v40, v156
v_max_f32 v157, v40, v157
v_max_f32 v158, v40, v158
v_max_f32 v159, v40, v159
v_max_f32 v160, v40, v160
v_max_f32 v161, v40, v161
v_max_f32 v162, v40, v162
v_max_f32 v163, v40, v163
v_pk_add_f32 v[8:9], v[8:9], v[156:157]
v_pk_add_f32 v[10:11], v[10:11], v[158:159]
v_pk_add_f32 v[12:13], v[12:13], v[160:161]
v_pk_add_f32 v[14:15], v[14:15], v[162:163]
v_cvt_pk_bf16_f32 v236, v8, v9
v_cvt_pk_bf16_f32 v237, v10, v11
v_cvt_pk_bf16_f32 v238, v12, v13
v_cvt_pk_bf16_f32 v239, v14, v15
s_nop 1
mf v[180:183],v[236:239],v[192:195]
mf v[188:191],v[236:239],v[224:227]
mf v[212:215],v[236:239],v[228:231]
v_and_b32 v64, 15, v2
v_lshrrev_b32 v65, 5, v2
v_and_b32 v66, 7, v2
v_xor_b32 v65, v65, v66
v_lshlrev_b32 v65, 4, v65
v_lshl_add_u32 v64, v64, 7, v65
v_bfe_u32 v65, v2, 4, 1
v_lshl_add_u32 v64, v65, 3, v64
v_add_u32 v64, s65, v64
v_xor_b32 v65, 32, v64
v_xor_b32_e64 v66, 64, v64
v_xor_b32 v67, 96, v64
ds_read_b64 v[48:49], v64 offset:16384
ds_read_b64 v[50:51], v65 offset:16384
ds_read_b64 v[52:53], v66 offset:16384
ds_read_b64 v[54:55], v67 offset:16384
ds_read_b64 v[56:57], v64 offset:18432
ds_read_b64 v[58:59], v65 offset:18432
ds_read_b64 v[60:61], v66 offset:18432
ds_read_b64 v[62:63], v67 offset:18432
v_accvgpr_read_b32 v156, a192
v_accvgpr_read_b32 v157, a193
v_accvgpr_read_b32 v158, a194
v_accvgpr_read_b32 v159, a195
v_accvgpr_read_b32 v160, a196
v_accvgpr_read_b32 v161, a197
v_accvgpr_read_b32 v162, a198
v_accvgpr_read_b32 v163, a199
v_pk_fma_f32 v[156:157], v[96:97], v[144:145], v[156:157] op_sel:[0,1,0] op_sel_hi:[1,1,1]
v_pk_fma_f32 v[158:159], v[98:99], v[144:145], v[158:159] op_sel:[0,1,0] op_sel_hi:[1,1,1]
v_pk_fma_f32 v[160:161], v[100:101], v[144:145], v[160:161] op_sel:[0,1,0] op_sel_hi:[1,1,1]
v_pk_fma_f32 v[162:163], v[102:103], v[144:145], v[162:163] op_sel:[0,1,0] op_sel_hi:[1,1,1]
v_pk_fma_f32 v[156:157], v[156:157], v[128:129], v[40:41] op_sel_hi:[1,1,0]
v_pk_fma_f32 v[158:159], v[158:159], v[130:131], v[40:41] op_sel_hi:[1,1,0]
v_pk_fma_f32 v[160:161], v[160:161], v[132:133], v[40:41] op_sel_hi:[1,1,0]
v_pk_fma_f32 v[162:163], v[162:163], v[134:135], v[40:41] op_sel_hi:[1,1,0]
v_pk_fma_f32 v[8:9], v[156:157], s[18:19], v[40:41] op_sel:[0,0,1] op_sel_hi:[1,1,1]
v_pk_fma_f32 v[10:11], v[158:159], s[18:19], v[40:41] op_sel:[0,0,1] op_sel_hi:[1,1,1]
v_pk_fma_f32 v[12:13], v[160:161], s[18:19], v[40:41] op_sel:[0,0,1] op_sel_hi:[1,1,1]
v_pk_fma_f32 v[14:15], v[162:163], s[18:19], v[40:41] op_sel:[0,0,1] op_sel_hi:[1,1,1]
v_exp_f32_e64 v8, v8 clamp
v_exp_f32_e64 v9, v9 clamp
v_exp_f32_e64 v10, v10 clamp
v_exp_f32_e64 v11, v11 clamp
v_exp_f32_e64 v12, v12 clamp
v_exp_f32_e64 v13, v13 clamp
v_exp_f32_e64 v14, v14 clamp
v_exp_f32_e64 v15, v15 clamp
v_max_f32 v156, v40, v156
v_max_f32 v157, v40, v157
v_max_f32 v158, v40, v158
v_max_f32 v159, v40, v159
v_max_f32 v160, v40, v160
v_max_f32 v161, v40, v161
v_max_f32 v162, v40, v162
v_max_f32 v163, v40, v163
v_pk_add_f32 v[8:9], v[8:9], v[156:157]
v_pk_add_f32 v[10:11], v[10:11], v[158:159]
v_pk_add_f32 v[12:13], v[12:13], v[160:161]
v_pk_add_f32 v[14:15], v[14:15], v[162:163]
v_cvt_pk_bf16_f32 v236, v8, v9
v_cvt_pk_bf16_f32 v237, v10, v11
v_cvt_pk_bf16_f32 v238, v12, v13
v_cvt_pk_bf16_f32 v239, v14, v15
s_nop 1
mf v[196:199],v[236:239],v[192:195]
mf v[204:207],v[236:239],v[224:227]
mf v[220:223],v[236:239],v[228:231]
s_nop 0
v_accvgpr_read_b32 v156, a168
v_accvgpr_read_b32 v157, a169
v_accvgpr_read_b32 v158, a170
v_accvgpr_read_b32 v159, a171
v_accvgpr_read_b32 v160, a172
v_accvgpr_read_b32 v161, a173
v_accvgpr_read_b32 v162, a174
v_accvgpr_read_b32 v163, a175
v_pk_fma_f32 v[156:157], v[104:105], v[144:145], v[156:157] op_sel:[0,0,0] op_sel_hi:[1,0,1]
v_pk_fma_f32 v[158:159], v[106:107], v[144:145], v[158:159] op_sel:[0,0,0] op_sel_hi:[1,0,1]
v_pk_fma_f32 v[160:161], v[108:109], v[144:145], v[160:161] op_sel:[0,0,0] op_sel_hi:[1,0,1]
v_pk_fma_f32 v[162:163], v[110:111], v[144:145], v[162:163] op_sel:[0,0,0] op_sel_hi:[1,0,1]
v_pk_fma_f32 v[156:157], v[156:157], v[136:137], v[40:41] op_sel_hi:[1,1,0]
v_pk_fma_f32 v[158:159], v[158:159], v[138:139], v[40:41] op_sel_hi:[1,1,0]
v_pk_fma_f32 v[160:161], v[160:161], v[140:141], v[40:41] op_sel_hi:[1,1,0]
v_pk_fma_f32 v[162:163], v[162:163], v[142:143], v[40:41] op_sel_hi:[1,1,0]
v_pk_fma_f32 v[8:9], v[156:157], s[18:19], v[40:41] op_sel:[0,0,1] op_sel_hi:[1,1,1]
v_pk_fma_f32 v[10:11], v[158:159], s[18:19], v[40:41] op_sel:[0,0,1] op_sel_hi:[1,1,1]
v_pk_fma_f32 v[12:13], v[160:161], s[18:19], v[40:41] op_sel:[0,0,1] op_sel_hi:[1,1,1]
v_pk_fma_f32 v[14:15], v[162:163], s[18:19], v[40:41] op_sel:[0,0,1] op_sel_hi:[1,1,1]
v_exp_f32_e64 v8, v8 clamp
v_exp_f32_e64 v9, v9 clamp
v_exp_f32_e64 v10, v10 clamp
v_exp_f32_e64 v11, v11 clamp
v_exp_f32_e64 v12, v12 clamp
v_exp_f32_e64 v13, v13 clamp
v_exp_f32_e64 v14, v14 clamp
v_exp_f32_e64 v15, v15 clamp
v_max_f32 v156, v40, v156
v_max_f32 v157, v40, v157
v_max_f32 v158, v40, v158
v_max_f32 v159, v40, v159
v_max_f32 v160, v40, v160
v_max_f32 v161, v40, v161
v_max_f32 v162, v40, v162
v_max_f32 v163, v40, v163
v_pk_add_f32 v[8:9], v[8:9], v[156:157]
v_pk_add_f32 v[10:11], v[10:11], v[158:159]
v_pk_add_f32 v[12:13], v[12:13], v[160:161]
v_pk_add_f32 v[14:15], v[14:15], v[162:163]
v_cvt_pk_bf16_f32 v236, v8, v9
v_cvt_pk_bf16_f32 v237, v10, v11
v_cvt_pk_bf16_f32 v238, v12, v13
v_cvt_pk_bf16_f32 v239, v14, v15
s_nop 1
mf v[180:183],v[236:239],v[200:203]
mf v[188:191],v[236:239],v[232:235]
mf v[212:215],v[236:239],v[228:231]
buffer_load_dword v39, v27, s[28:31], 0 offen sc1
s_mov_b32 s9, 0
v_accvgpr_read_b32 v156, a200
v_accvgpr_read_b32 v157, a201
v_accvgpr_read_b32 v158, a202
v_accvgpr_read_b32 v159, a203
v_accvgpr_read_b32 v160, a204
v_accvgpr_read_b32 v161, a205
v_accvgpr_read_b32 v162, a206
v_accvgpr_read_b32 v163, a207
v_pk_fma_f32 v[156:157], v[104:105], v[144:145], v[156:157] op_sel:[0,1,0] op_sel_hi:[1,1,1]
v_pk_fma_f32 v[158:159], v[106:107], v[144:145], v[158:159] op_sel:[0,1,0] op_sel_hi:[1,1,1]
v_pk_fma_f32 v[160:161], v[108:109], v[144:145], v[160:161] op_sel:[0,1,0] op_sel_hi:[1,1,1]
v_pk_fma_f32 v[162:163], v[110:111], v[144:145], v[162:163] op_sel:[0,1,0] op_sel_hi:[1,1,1]
v_pk_fma_f32 v[156:157], v[156:157], v[136:137], v[40:41] op_sel_hi:[1,1,0]
v_pk_fma_f32 v[158:159], v[158:159], v[138:139], v[40:41] op_sel_hi:[1,1,0]
v_pk_fma_f32 v[160:161], v[160:161], v[140:141], v[40:41] op_sel_hi:[1,1,0]
v_pk_fma_f32 v[162:163], v[162:163], v[142:143], v[40:41] op_sel_hi:[1,1,0]
v_pk_fma_f32 v[8:9], v[156:157], s[18:19], v[40:41] op_sel:[0,0,1] op_sel_hi:[1,1,1]
v_pk_fma_f32 v[10:11], v[158:159], s[18:19], v[40:41] op_sel:[0,0,1] op_sel_hi:[1,1,1]
v_pk_fma_f32 v[12:13], v[160:161], s[18:19], v[40:41] op_sel:[0,0,1] op_sel_hi:[1,1,1]
v_pk_fma_f32 v[14:15], v[162:163], s[18:19], v[40:41] op_sel:[0,0,1] op_sel_hi:[1,1,1]
v_exp_f32_e64 v8, v8 clamp
v_exp_f32_e64 v9, v9 clamp
v_exp_f32_e64 v10, v10 clamp
v_exp_f32_e64 v11, v11 clamp
v_exp_f32_e64 v12, v12 clamp
v_exp_f32_e64 v13, v13 clamp
v_exp_f32_e64 v14, v14 clamp
v_exp_f32_e64 v15, v15 clamp
v_max_f32 v156, v40, v156
v_max_f32 v157, v40, v157
v_max_f32 v158, v40, v158
v_max_f32 v159, v40, v159
v_max_f32 v160, v40, v160
v_max_f32 v161, v40, v161
v_max_f32 v162, v40, v162
v_max_f32 v163, v40, v163
v_pk_add_f32 v[8:9], v[8:9], v[156:157]
v_pk_add_f32 v[10:11], v[10:11], v[158:159]
v_pk_add_f32 v[12:13], v[12:13], v[160:161]
v_pk_add_f32 v[14:15], v[14:15], v[162:163]
v_cvt_pk_bf16_f32 v236, v8, v9
v_cvt_pk_bf16_f32 v237, v10, v11
v_cvt_pk_bf16_f32 v238, v12, v13
v_cvt_pk_bf16_f32 v239, v14, v15
s_nop 1
mf v[196:199],v[236:239],v[200:203]
mf v[204:207],v[236:239],v[232:235]
mf v[220:223],v[236:239],v[228:231]
s_mul_i32 s82, s20, 6144
s_add_u32 s82, s82, 131072
v_add_u32 v6, s82, v3
s_lshr_b32 s70, s77, 6
s_add_u32 s70, s70, 0
s_lshl_b32 s70, s70, 13
s_add_u32 s70, s70, s78
s_add_u32 s71, s70, 4096
ds_write_b128 v6, v[180:183] offset:0
ds_write_b128 v6, v[188:191] offset:1024
ds_write_b128 v6, v[196:199] offset:2048
ds_write_b128 v6, v[204:207] offset:3072
ds_write_b128 v6, v[212:215] offset:4096
ds_write_b128 v6, v[220:223] offset:5120
v_lshrrev_b32 v47, 5, v2
v_lshlrev_b32_e64 v47, 9, v47
s_lshl_b32 s82, s22, 9
v_add3_u32 v47, v47, v3, s82
L_stub8:
s_cbranch_execz L_stub22
s_nop 0
dq v[80:83],v43,512
dq v[84:87],v43,768
v_pk_fma_f32 v[240:241], v[148:149], v[16:17], v[240:241] op_sel_hi:[1,0,1]
v_pk_fma_f32 v[242:243], v[150:151], v[16:17], v[242:243] op_sel_hi:[1,0,1]
v_pk_fma_f32 v[244:245], v[148:149], v[20:21], v[244:245] op_sel_hi:[1,0,1]
v_pk_fma_f32 v[246:247], v[150:151], v[20:21], v[246:247] op_sel_hi:[1,0,1]
v_pk_fma_f32 v[248:249], v[152:153], v[16:17], v[248:249] op_sel_hi:[1,0,1]
v_pk_fma_f32 v[250:251], v[154:155], v[16:17], v[250:251] op_sel_hi:[1,0,1]
v_pk_fma_f32 v[252:253], v[152:153], v[20:21], v[252:253] op_sel_hi:[1,0,1]
v_pk_fma_f32 v[254:255], v[154:155], v[20:21], v[254:255] op_sel_hi:[1,0,1]
v_pk_mul_f32 v[8:9], v[240:241], v[240:241]
v_pk_mul_f32 v[10:11], v[242:243], v[242:243]
v_pk_mul_f32 v[12:13], v[244:245], v[244:245]
v_pk_mul_f32 v[14:15], v[246:247], v[246:247]
v_pk_fma_f32 v[8:9], v[8:9], v[18:19], v[16:17] op_sel:[0,0,1] op_sel_hi:[1,0,1]
v_pk_fma_f32 v[10:11], v[10:11], v[18:19], v[16:17] op_sel:[0,0,1] op_sel_hi:[1,0,1]
v_pk_fma_f32 v[12:13], v[12:13], v[22:23], v[20:21] op_sel:[0,0,1] op_sel_hi:[1,0,1]
v_pk_fma_f32 v[14:15], v[14:15], v[22:23], v[20:21] op_sel:[0,0,1] op_sel_hi:[1,0,1]
v_pk_mul_f32 v[8:9], v[8:9], v[240:241]
v_pk_mul_f32 v[10:11], v[10:11], v[242:243]
v_pk_mul_f32 v[12:13], v[12:13], v[244:245]
v_pk_mul_f32 v[14:15], v[14:15], v[246:247]
v_exp_f32 v8, v8
v_exp_f32 v9, v9
v_exp_f32 v10, v10
v_exp_f32 v11, v11
v_exp_f32 v12, v12
v_exp_f32 v13, v13
v_exp_f32 v14, v14
v_exp_f32 v15, v15
v_pk_mul_f32 v[248:249], v[240:241], v[248:249]
v_pk_mul_f32 v[250:251], v[242:243], v[250:251]
v_pk_mul_f32 v[252:253], v[244:245], v[252:253]
v_pk_mul_f32 v[254:255], v[246:247], v[254:255]
v_pk_fma_f32 v[8:9], v[8:9], v[18:19], v[18:19] op_sel:[0,1,1] op_sel_hi:[1,1,1]
v_pk_fma_f32 v[10:11], v[10:11], v[18:19], v[18:19] op_sel:[0,1,1] op_sel_hi:[1,1,1]
v_pk_fma_f32 v[12:13], v[12:13], v[22:23], v[22:23] op_sel:[0,1,1] op_sel_hi:[1,1,1]
v_pk_fma_f32 v[14:15], v[14:15], v[22:23], v[22:23] op_sel:[0,1,1] op_sel_hi:[1,1,1]
v_rcp_f32 v8, v8
v_rcp_f32 v9, v9
v_rcp_f32 v10, v10
v_rcp_f32 v11, v11
v_rcp_f32 v12, v12
v_rcp_f32 v13, v13
v_rcp_f32 v14, v14
v_rcp_f32 v15, v15
v_pk_mul_f32 v[8:9], v[8:9], v[248:249]
v_pk_mul_f32 v[10:11], v[10:11], v[250:251]
v_pk_mul_f32 v[12:13], v[12:13], v[252:253]
v_pk_mul_f32 v[14:15], v[14:15], v[254:255]
v_cvt_pk_bf16_f32 v112, v8, v9
v_cvt_pk_bf16_f32 v113, v10, v11
v_cvt_pk_bf16_f32 v114, v12, v13
v_cvt_pk_bf16_f32 v115, v14, v15
s_nop 1
v_permlane32_swap_b32 v112, v114
v_permlane32_swap_b32 v113, v115
buffer_store_dwordx4 v[112:115], v47, s[28:31], s70 offen offset:0 sc1
s_waitcnt lgkmcnt(0)
s_waitcnt vmcnt(1)
v_sub_u32 v39, v39, v5
v_subrev_u32 v39, 1, v39
v_cmp_lt_u32 vcc, 2, v39
s_nop 0
s_cbranch_vccz L_ckKV0_a
buffer_load_dword v39, v27, s[28:31], 0 offen sc1
s_branch L_ckKV0_e
L_ckKV0_a:
s_mov_b32 s9, 1
v_readlane_b32 s69, v24, 0
s_nop 2
s_add_u32 m0, s65, 0
s_nop 0
s_nop 0
buffer_load_dwordx4 v29, s[28:31], s69 offen offset:0 sc1 lds
buffer_load_dwordx4 v29, s[28:31], s69 offen offset:1024 sc1 lds
buffer_load_dwordx4 v29, s[28:31], s69 offen offset:2048 sc1 lds
buffer_load_dwordx4 v29, s[28:31], s69 offen offset:3072 sc1 lds
v_readlane_b32 s69, v24, 1
s_nop 2
s_add_u32 m0, s65, 16384
s_nop 0
buffer_load_dwordx4 v29, s[28:31], s69 offen offset:0 sc1 lds
buffer_load_dwordx4 v29, s[28:31], s69 offen offset:1024 sc1 lds
buffer_load_dwordx4 v29, s[28:31], s69 offen offset:2048 sc1 lds
buffer_load_dwordx4 v29, s[28:31], s69 offen offset:3072 sc1 lds
L_ckKV0_e:
s_mul_i32 s82, s22, 6144
s_lshl_b32 s83, s21, 11
s_add_u32 s3, s82, s83
s_add_u32 s3, s3, 131072
v_lshl_add_u32 v6, v2, 2, s3
s_mul_i32 s12, s27, 6144
s_add_u32 s12, s12, 23068672
v_lshl_add_u32 v45, v2, 2, s83
s_lshl_b32 s83, s21, 10
s_add_u32 s3, s82, s83
s_add_u32 s3, s3, 135168
v_bfe_u32 v7, v2, 2, 2
v_lshlrev_b32 v7, 8, v7
v_and_b32 v46, 3, v2
v_lshl_add_u32 v7, v46, 2, v7
v_add_u32 v7, s3, v7
s_lshl_b32 s83, s21, 6
s_add_u32 s83, s83, 4096
v_lshl_add_u32 v46, v2, 2, s83
v_lshrrev_b32 v8, 4, v2
v_lshl_add_u32 v46, v8, 28, v46
s_waitcnt lgkmcnt(0)
s_barrier
s_nop 0
ds_read2st64_b32 v[176:177], v6 offset0:0 offset1:48
ds_read2st64_b32 v[178:179], v6 offset0:1 offset1:49
ds_read2st64_b32 v[184:185], v6 offset0:2 offset1:50
ds_read2st64_b32 v[186:187], v6 offset0:3 offset1:51
ds_read2st64_b32 v[192:193], v6 offset0:4 offset1:52
ds_read2st64_b32 v[194:195], v6 offset0:5 offset1:53
ds_read2st64_b32 v[200:201], v6 offset0:6 offset1:54
ds_read2st64_b32 v[202:203], v6 offset0:7 offset1:55
ds_read2st64_b32 v[208:209], v7 offset0:0 offset1:48
dq v[16:19],v43,1024
dq v[20:23],v43,1280
v_accvgpr_read_b32 v168, a208
v_accvgpr_read_b32 v169, a209
v_accvgpr_read_b32 v170, a210
v_accvgpr_read_b32 v171, a211
v_accvgpr_read_b32 v164, a232
v_accvgpr_read_b32 v165, a233
v_accvgpr_read_b32 v166, a234
v_accvgpr_read_b32 v167, a235
v_accvgpr_read_b32 v160, a212
v_accvgpr_read_b32 v161, a213
v_accvgpr_read_b32 v162, a214
v_accvgpr_read_b32 v163, a215
v_accvgpr_read_b32 v156, a236
v_accvgpr_read_b32 v157, a237
v_accvgpr_read_b32 v158, a238
v_accvgpr_read_b32 v159, a239
v_pk_fma_f32 v[168:169], v[148:149], v[80:81], v[168:169] op_sel_hi:[1,0,1]
v_pk_fma_f32 v[170:171], v[150:151], v[80:81], v[170:171] op_sel_hi:[1,0,1]
v_pk_fma_f32 v[160:161], v[148:149], v[84:85], v[160:161] op_sel_hi:[1,0,1]
v_pk_fma_f32 v[162:163], v[150:151], v[84:85], v[162:163] op_sel_hi:[1,0,1]
v_pk_fma_f32 v[164:165], v[152:153], v[80:81], v[164:165] op_sel_hi:[1,0,1]
v_pk_fma_f32 v[166:167], v[154:155], v[80:81], v[166:167] op_sel_hi:[1,0,1]
v_pk_fma_f32 v[156:157], v[152:153], v[84:85], v[156:157] op_sel_hi:[1,0,1]
v_pk_fma_f32 v[158:159], v[154:155], v[84:85], v[158:159] op_sel_hi:[1,0,1]
v_pk_mul_f32 v[8:9], v[168:169], v[168:169]
v_pk_mul_f32 v[10:11], v[170:171], v[170:171]
v_pk_mul_f32 v[12:13], v[160:161], v[160:161]
v_pk_mul_f32 v[14:15], v[162:163], v[162:163]
v_pk_fma_f32 v[8:9], v[8:9], v[82:83], v[80:81] op_sel:[0,0,1] op_sel_hi:[1,0,1]
v_pk_fma_f32 v[10:11], v[10:11], v[82:83], v[80:81] op_sel:[0,0,1] op_sel_hi:[1,0,1]
v_pk_fma_f32 v[12:13], v[12:13], v[86:87], v[84:85] op_sel:[0,0,1] op_sel_hi:[1,0,1]
v_pk_fma_f32 v[14:15], v[14:15], v[86:87], v[84:85] op_sel:[0,0,1] op_sel_hi:[1,0,1]
v_pk_mul_f32 v[8:9], v[8:9], v[168:169]
v_pk_mul_f32 v[10:11], v[10:11], v[170:171]
v_pk_mul_f32 v[12:13], v[12:13], v[160:161]
v_pk_mul_f32 v[14:15], v[14:15], v[162:163]
v_exp_f32 v8, v8
v_exp_f32 v9, v9
v_exp_f32 v10, v10
v_exp_f32 v11, v11
v_exp_f32 v12, v12
v_exp_f32 v13, v13
v_exp_f32 v14, v14
v_exp_f32 v15, v15
v_pk_mul_f32 v[164:165], v[168:169], v[164:165]
v_pk_mul_f32 v[166:167], v[170:171], v[166:167]
v_pk_mul_f32 v[156:157], v[160:161], v[156:157]
v_pk_mul_f32 v[158:159], v[162:163], v[158:159]
v_pk_fma_f32 v[8:9], v[8:9], v[82:83], v[82:83] op_sel:[0,1,1] op_sel_hi:[1,1,1]
v_pk_fma_f32 v[10:11], v[10:11], v[82:83], v[82:83] op_sel:[0,1,1] op_sel_hi:[1,1,1]
v_pk_fma_f32 v[12:13], v[12:13], v[86:87], v[86:87] op_sel:[0,1,1] op_sel_hi:[1,1,1]
v_pk_fma_f32 v[14:15], v[14:15], v[86:87], v[86:87] op_sel:[0,1,1] op_sel_hi:[1,1,1]
v_rcp_f32 v8, v8
v_rcp_f32 v9, v9
v_rcp_f32 v10, v10
v_rcp_f32 v11, v11
v_rcp_f32 v12, v12
v_rcp_f32 v13, v13
v_rcp_f32 v14, v14
v_rcp_f32 v15, v15
v_pk_mul_f32 v[8:9], v[8:9], v[164:165]
v_pk_mul_f32 v[10:11], v[10:11], v[166:167]
v_pk_mul_f32 v[12:13], v[12:13], v[156:157]
v_pk_mul_f32 v[14:15], v[14:15], v[158:159]
v_cvt_pk_bf16_f32 v116, v8, v9
v_cvt_pk_bf16_f32 v117, v10, v11
v_cvt_pk_bf16_f32 v118, v12, v13
v_cvt_pk_bf16_f32 v119, v14, v15
s_nop 1
v_permlane32_swap_b32 v116, v118
v_permlane32_swap_b32 v117, v119
buffer_store_dwordx4 v[116:119], v47, s[28:31], s70 offen offset:2048 sc1
s_waitcnt lgkmcnt(0)
v_add_f32 v176, v176, v177
v_add_f32 v178, v178, v179
v_add_f32 v184, v184, v185
v_add_f32 v186, v186, v187
v_add_f32 v192, v192, v193
v_add_f32 v194, v194, v195
v_add_f32 v200, v200, v201
v_add_f32 v202, v202, v203
v_add_f32_e64 v208, v208, v209
buffer_atomic_add_f32 v176, v45, s[28:31], s12 offen offset:0 sc1
buffer_atomic_add_f32 v178, v45, s[28:31], s12 offen offset:256 sc1
buffer_atomic_add_f32 v184, v45, s[28:31], s12 offen offset:512 sc1
buffer_atomic_add_f32 v186, v45, s[28:31], s12 offen offset:768 sc1
buffer_atomic_add_f32 v192, v45, s[28:31], s12 offen offset:1024 sc1
dq v[80:83],v43,1536
dq v[84:87],v43,1792
v_accvgpr_read_b32 v168, a216
v_accvgpr_read_b32 v169, a217
v_accvgpr_read_b32 v170, a218
v_accvgpr_read_b32 v171, a219
v_accvgpr_read_b32 v164, a240
v_accvgpr_read_b32 v165, a241
v_accvgpr_read_b32 v166, a242
v_accvgpr_read_b32 v167, a243
v_accvgpr_read_b32 v160, a220
v_accvgpr_read_b32 v161, a221
v_accvgpr_read_b32 v162, a222
v_accvgpr_read_b32 v163, a223
v_accvgpr_read_b32 v156, a244
v_accvgpr_read_b32 v157, a245
v_accvgpr_read_b32 v158, a246
v_accvgpr_read_b32 v159, a247
v_pk_fma_f32 v[168:169], v[148:149], v[16:17], v[168:169] op_sel_hi:[1,0,1]
v_pk_fma_f32 v[170:171], v[150:151], v[16:17], v[170:171] op_sel_hi:[1,0,1]
v_pk_fma_f32 v[160:161], v[148:149], v[20:21], v[160:161] op_sel_hi:[1,0,1]
v_pk_fma_f32 v[162:163], v[150:151], v[20:21], v[162:163] op_sel_hi:[1,0,1]
v_pk_fma_f32 v[164:165], v[152:153], v[16:17], v[164:165] op_sel_hi:[1,0,1]
v_pk_fma_f32 v[166:167], v[154:155], v[16:17], v[166:167] op_sel_hi:[1,0,1]
v_pk_fma_f32 v[156:157], v[152:153], v[20:21], v[156:157] op_sel_hi:[1,0,1]
v_pk_fma_f32 v[158:159], v[154:155], v[20:21], v[158:159] op_sel_hi:[1,0,1]
v_pk_mul_f32 v[8:9], v[168:169], v[168:169]
v_pk_mul_f32 v[10:11], v[170:171], v[170:171]
v_pk_mul_f32 v[12:13], v[160:161], v[160:161]
v_pk_mul_f32 v[14:15], v[162:163], v[162:163]
v_pk_fma_f32 v[8:9], v[8:9], v[18:19], v[16:17] op_sel:[0,0,1] op_sel_hi:[1,0,1]
v_pk_fma_f32 v[10:11], v[10:11], v[18:19], v[16:17] op_sel:[0,0,1] op_sel_hi:[1,0,1]
v_pk_fma_f32 v[12:13], v[12:13], v[22:23], v[20:21] op_sel:[0,0,1] op_sel_hi:[1,0,1]
v_pk_fma_f32 v[14:15], v[14:15], v[22:23], v[20:21] op_sel:[0,0,1] op_sel_hi:[1,0,1]
v_pk_mul_f32 v[8:9], v[8:9], v[168:169]
v_pk_mul_f32 v[10:11], v[10:11], v[170:171]
v_pk_mul_f32 v[12:13], v[12:13], v[160:161]
v_pk_mul_f32 v[14:15], v[14:15], v[162:163]
v_exp_f32 v8, v8
v_exp_f32 v9, v9
v_exp_f32 v10, v10
v_exp_f32 v11, v11
v_exp_f32 v12, v12
v_exp_f32 v13, v13
v_exp_f32 v14, v14
v_exp_f32 v15, v15
v_pk_mul_f32 v[164:165], v[168:169], v[164:165]
v_pk_mul_f32 v[166:167], v[170:171], v[166:167]
v_pk_mul_f32 v[156:157], v[160:161], v[156:157]
v_pk_mul_f32 v[158:159], v[162:163], v[158:159]
v_pk_fma_f32 v[8:9], v[8:9], v[18:19], v[18:19] op_sel:[0,1,1] op_sel_hi:[1,1,1]
v_pk_fma_f32 v[10:11], v[10:11], v[18:19], v[18:19] op_sel:[0,1,1] op_sel_hi:[1,1,1]
v_pk_fma_f32 v[12:13], v[12:13], v[22:23], v[22:23] op_sel:[0,1,1] op_sel_hi:[1,1,1]
v_pk_fma_f32 v[14:15], v[14:15], v[22:23], v[22:23] op_sel:[0,1,1] op_sel_hi:[1,1,1]
v_rcp_f32 v8, v8
v_rcp_f32 v9, v9
v_rcp_f32 v10, v10
v_rcp_f32 v11, v11
v_rcp_f32 v12, v12
v_rcp_f32 v13, v13
v_rcp_f32 v14, v14
v_rcp_f32 v15, v15
v_pk_mul_f32 v[8:9], v[8:9], v[164:165]
v_pk_mul_f32 v[10:11], v[10:11], v[166:167]
v_pk_mul_f32 v[12:13], v[12:13], v[156:157]
v_pk_mul_f32 v[14:15], v[14:15], v[158:159]
v_cvt_pk_bf16_f32 v120, v8, v9
v_cvt_pk_bf16_f32 v121, v10, v11
v_cvt_pk_bf16_f32 v122, v12, v13
v_cvt_pk_bf16_f32 v123, v14, v15
s_nop 1
v_permlane32_swap_b32 v120, v122
v_permlane32_swap_b32 v121, v123
s_nop 0
buffer_store_dwordx4 v[120:123], v47, s[28:31], s71 offen offset:0 sc1
buffer_atomic_add_f32 v194, v45, s[28:31], s12 offen offset:1280 sc1
buffer_atomic_add_f32 v200, v45, s[28:31], s12 offen offset:1536 sc1
buffer_atomic_add_f32 v202, v45, s[28:31], s12 offen offset:1792 sc1
buffer_atomic_add_f32 v208, v46, s[28:31], s12 offen offset:0 sc1
s_waitcnt lgkmcnt(0)
s_nop 0
v_accvgpr_read_b32 v168, a224
v_accvgpr_read_b32 v169, a225
v_accvgpr_read_b32 v170, a226
v_accvgpr_read_b32 v171, a227
v_accvgpr_read_b32 v164, a248
v_accvgpr_read_b32 v165, a249
v_accvgpr_read_b32 v166, a250
v_accvgpr_read_b32 v167, a251
v_accvgpr_read_b32 v160, a228
v_accvgpr_read_b32 v161, a229
v_accvgpr_read_b32 v162, a230
v_accvgpr_read_b32 v163, a231
v_accvgpr_read_b32 v156, a252
v_accvgpr_read_b32 v157, a253
v_accvgpr_read_b32 v158, a254
v_accvgpr_read_b32 v159, a255
v_pk_fma_f32 v[168:169], v[148:149], v[80:81], v[168:169] op_sel_hi:[1,0,1]
v_pk_fma_f32 v[170:171], v[150:151], v[80:81], v[170:171] op_sel_hi:[1,0,1]
v_pk_fma_f32 v[160:161], v[148:149], v[84:85], v[160:161] op_sel_hi:[1,0,1]
v_pk_fma_f32 v[162:163], v[150:151], v[84:85], v[162:163] op_sel_hi:[1,0,1]
v_pk_fma_f32 v[164:165], v[152:153], v[80:81], v[164:165] op_sel_hi:[1,0,1]
v_pk_fma_f32 v[166:167], v[154:155], v[80:81], v[166:167] op_sel_hi:[1,0,1]
v_pk_fma_f32 v[156:157], v[152:153], v[84:85], v[156:157] op_sel_hi:[1,0,1]
v_pk_fma_f32 v[158:159], v[154:155], v[84:85], v[158:159] op_sel_hi:[1,0,1]
v_pk_mul_f32 v[8:9], v[168:169], v[168:169]
v_pk_mul_f32 v[10:11], v[170:171], v[170:171]
v_pk_mul_f32 v[12:13], v[160:161], v[160:161]
v_pk_mul_f32 v[14:15], v[162:163], v[162:163]
v_pk_fma_f32 v[8:9], v[8:9], v[82:83], v[80:81] op_sel:[0,0,1] op_sel_hi:[1,0,1]
v_pk_fma_f32 v[10:11], v[10:11], v[82:83], v[80:81] op_sel:[0,0,1] op_sel_hi:[1,0,1]
v_pk_fma_f32 v[12:13], v[12:13], v[86:87], v[84:85] op_sel:[0,0,1] op_sel_hi:[1,0,1]
v_pk_fma_f32 v[14:15], v[14:15], v[86:87], v[84:85] op_sel:[0,0,1] op_sel_hi:[1,0,1]
v_pk_mul_f32 v[8:9], v[8:9], v[168:169]
v_pk_mul_f32 v[10:11], v[10:11], v[170:171]
v_pk_mul_f32 v[12:13], v[12:13], v[160:161]
v_pk_mul_f32 v[14:15], v[14:15], v[162:163]
v_exp_f32 v8, v8
v_exp_f32 v9, v9
v_exp_f32 v10, v10
v_exp_f32 v11, v11
v_exp_f32 v12, v12
v_exp_f32 v13, v13
v_exp_f32 v14, v14
v_exp_f32 v15, v15
v_pk_mul_f32 v[164:165], v[168:169], v[164:165]
v_pk_mul_f32 v[166:167], v[170:171], v[166:167]
v_pk_mul_f32 v[156:157], v[160:161], v[156:157]
v_pk_mul_f32 v[158:159], v[162:163], v[158:159]
v_pk_fma_f32 v[8:9], v[8:9], v[82:83], v[82:83] op_sel:[0,1,1] op_sel_hi:[1,1,1]
v_pk_fma_f32 v[10:11], v[10:11], v[82:83], v[82:83] op_sel:[0,1,1] op_sel_hi:[1,1,1]
v_pk_fma_f32 v[12:13], v[12:13], v[86:87], v[86:87] op_sel:[0,1,1] op_sel_hi:[1,1,1]
v_pk_fma_f32 v[14:15], v[14:15], v[86:87], v[86:87] op_sel:[0,1,1] op_sel_hi:[1,1,1]
v_rcp_f32 v8, v8
v_rcp_f32 v9, v9
v_rcp_f32 v10, v10
v_rcp_f32 v11, v11
v_rcp_f32 v12, v12
v_rcp_f32 v13, v13
v_rcp_f32 v14, v14
v_rcp_f32 v15, v15
v_pk_mul_f32 v[8:9], v[8:9], v[164:165]
v_pk_mul_f32 v[10:11], v[10:11], v[166:167]
v_pk_mul_f32 v[12:13], v[12:13], v[156:157]
v_pk_mul_f32 v[14:15], v[14:15], v[158:159]
v_cvt_pk_bf16_f32 v124, v8, v9
v_cvt_pk_bf16_f32 v125, v10, v11
v_cvt_pk_bf16_f32 v126, v12, v13
v_cvt_pk_bf16_f32 v127, v14, v15
s_nop 1
v_permlane32_swap_b32 v124, v126
v_permlane32_swap_b32 v125, v127
buffer_store_dwordx4 v[124:127], v47, s[28:31], s71 offen offset:2048 sc1
v_readlane_b32 s4, v24, 2
v_readlane_b32 s5, v24, 3
s_waitcnt vmcnt(12)
s_cmp_eq_u32 s9, 1
s_cbranch_scc0 L_lateKV
L_lateKV_ret:
s_barrier
s_branch L_g2
L_cs:
L_stub9:
s_cbranch_execz L_stub23
s_cmp_eq_u32 s21, 0
s_cbranch_scc0 L_cs_1
mf v[24:27],a[64:67],v[44:47]
mf v[28:31],a[68:71],v[44:47]
mf v[32:35],a[72:75],v[44:47]
mf v[36:39],a[76:79],v[44:47]
mf v[40:43],a[80:83],v[44:47]
mf v[24:27],a[104:107],v[44:47]
mf v[28:31],a[108:111],v[44:47]
mf v[32:35],a[112:115],v[44:47]
mf v[36:39],a[116:119],v[44:47]
mf v[40:43],a[120:123],v[44:47]
s_setpc_b64 s[100:101]
L_cs_1:
mf v[24:27],a[84:87],v[44:47]
mf v[28:31],a[88:91],v[44:47]
mf v[32:35],a[92:95],v[44:47]
mf v[36:39],a[96:99],v[44:47]
mf v[40:43],a[100:103],v[44:47]
mf v[24:27],a[124:127],v[44:47]
mf v[28:31],a[128:131],v[44:47]
mf v[32:35],a[132:135],v[44:47]
mf v[36:39],a[136:139],v[44:47]
mf v[40:43],a[140:143],v[44:47]
s_setpc_b64 s[100:101]
L_csA:
s_cmp_eq_u32 s21, 0
s_cbranch_scc1 L_cs
mf v[24:27],a[84:87],v[44:47]
mf v[28:31],a[88:91],v[44:47]
mf v[32:35],a[92:95],v[44:47]
mf v[24:27],a[124:127],v[44:47]
mf v[28:31],a[128:131],v[44:47]
mf v[32:35],a[132:135],v[44:47]
s_setpc_b64 s[100:101]
L_csB:
s_cmp_eq_u32 s21, 0
s_cbranch_scc1 L_csR
mf v[36:39],a[96:99],v[44:47]
mf v[40:43],a[100:103],v[44:47]
mf v[36:39],a[136:139],v[44:47]
mf v[40:43],a[140:143],v[44:47]
L_csR:
s_setpc_b64 s[100:101]
L_tagKV_slow:
s_mov_b32 s3, 0
L_tagKV:
buffer_load_dword v5, v4, s[96:99], 0 offen sc1
s_waitcnt vmcnt(0)
v_cmp_eq_u32 vcc, 0, v5
s_add_u32 s3, s3, 1
s_cbranch_vccz L_tagKV_ok
s_sleep 1
s_cmp_lt_u32 s3, 262144
s_cbranch_scc1 L_tagKV
L_tagKV_ok:
s_branch L_tagKV_back
L_eKV_slow:
s_mov_b32 s3, 0
L_eKV:
buffer_load_dword v42, v41, s[28:31], 0 offen sc1
s_waitcnt vmcnt(0)
v_sub_u32 v42, v42, v5
v_subrev_u32 v42, 1, v42
v_cmp_lt_u32 vcc, 2, v42
s_add_u32 s3, s3, 1
s_cbranch_vccz L_eKV_ok
s_sleep 1
s_cmp_lt_u32 s3, 262144
s_cbranch_scc1 L_eKV
L_eKV_ok:
s_branch L_eKV_back
L_lateKV:
v_sub_u32 v39, v39, v5
v_subrev_u32 v39, 1, v39
v_cmp_lt_u32 vcc, 2, v39
s_nop 0
s_cbranch_vccz L_aKV_ok
s_mov_b32 s3, 0
L_aKV:
buffer_load_dword v39, v27, s[28:31], 0 offen sc1
s_waitcnt vmcnt(0)
v_sub_u32 v39, v39, v5
v_subrev_u32 v39, 1, v39
v_cmp_lt_u32 vcc, 2, v39
s_add_u32 s3, s3, 1
s_cbranch_vccz L_aKV_ok
s_sleep 1
s_cmp_lt_u32 s3, 262144
s_cbranch_scc1 L_aKV
L_aKV_ok:
v_readlane_b32 s69, v24, 0
s_nop 2
s_add_u32 m0, s65, 0
s_nop 0
buffer_load_dwordx4 v29, s[28:31], s69 offen offset:0 sc1 lds
buffer_load_dwordx4 v29, s[28:31], s69 offen offset:1024 sc1 lds
buffer_load_dwordx4 v29, s[28:31], s69 offen offset:2048 sc1 lds
buffer_load_dwordx4 v29, s[28:31], s69 offen offset:3072 sc1 lds
v_readlane_b32 s69, v24, 1
s_nop 2
s_add_u32 m0, s65, 16384
s_nop 0
buffer_load_dwordx4 v29, s[28:31], s69 offen offset:0 sc1 lds
buffer_load_dwordx4 v29, s[28:31], s69 offen offset:1024 sc1 lds
buffer_load_dwordx4 v29, s[28:31], s69 offen offset:2048 sc1 lds
buffer_load_dwordx4 v29, s[28:31], s69 offen offset:3072 sc1 lds
s_waitcnt vmcnt(4)
s_branch L_lateKV_ret
L_iwret:
s_mov_b64 exec, -1
s_setpc_b64 s[100:101]
L_typeQ:
s_add_u32 s5, s71, 229376
s_add_u32 s4, s70, 196608
s_add_u32 m0, s64, 4096
s_nop 0
buffer_load_dwordx4 v11, s[36:39], s71 offen offset:0  lds
s_add_u32 m0, s64, 24576
s_nop 0
buffer_load_dwordx4 v11, s[36:39], s5 offen offset:0  lds
s_add_u32 m0, s64, 8192
s_nop 0
buffer_load_dwordx4 v11, s[40:43], s71 offen offset:0  lds
s_add_u32 m0, s64, 28672
s_nop 0
buffer_load_dwordx4 v11, s[40:43], s5 offen offset:0  lds
s_add_u32 m0, s64, 12288
s_nop 0
buffer_load_dwordx4 v12, s[36:39], s71 offen offset:0  lds
s_add_u32 m0, s64, 32768
s_nop 0
buffer_load_dwordx4 v12, s[36:39], s5 offen offset:0  lds
s_add_u32 m0, s64, 0
s_nop 0
buffer_load_dwordx4 v10, s[32:35], s70 offen offset:0  lds
s_add_u32 m0, s64, 20480
s_nop 0
buffer_load_dwordx4 v10, s[32:35], s4 offen offset:0  lds
s_getpc_b64 s[100:101]
s_add_u32 s100, s100, 40
s_addc_u32 s101, s101, 0
s_mov_b64 exec, 0
s_cmp_eq_u32 s20, 0
s_cbranch_scc1 L_iw1Q_0
s_cmp_eq_u32 s20, 1
s_cbranch_scc1 L_iw1Q_1
s_cmp_eq_u32 s20, 2
s_cbranch_scc1 L_iw1Q_2
s_branch L_iw1Q_3
s_mov_b32 s10, s71
s_mov_b32 s11, s5
v_readlane_b32 s68, v13, 2
s_nop 0
s_mul_i32 s70, s68, 393216
s_mul_i32 s71, s68, 458752
s_add_u32 s5, s71, 229376
s_add_u32 s4, s70, 196608
s_lshl_b32 s69, s68, 7
s_add_u32 m0, s64, 45056
s_nop 0
buffer_load_dwordx4 v11, s[36:39], s71 offen offset:0  lds
s_add_u32 m0, s64, 65536
s_nop 0
buffer_load_dwordx4 v11, s[36:39], s5 offen offset:0  lds
s_add_u32 m0, s64, 49152
s_nop 0
buffer_load_dwordx4 v11, s[40:43], s71 offen offset:0  lds
s_add_u32 m0, s64, 69632
s_nop 0
buffer_load_dwordx4 v11, s[40:43], s5 offen offset:0  lds
s_waitcnt vmcnt(4)
s_barrier
dt a[72:73],v18,4096
dt a[74:75],v18,4608
dt a[112:113],v18,24576
dt a[114:115],v18,25088
dq a[0:3],v16,0
dq a[32:35],v17,0
dq a[36:39],v17,2048
dq a[4:7],v16,2048
dq a[8:11],v16,4096
dq a[40:43],v17,4096
dq a[44:47],v17,6144
dq a[12:15],v16,6144
dq a[16:19],v16,8192
dq a[48:51],v17,8192
dq a[52:55],v17,10240
dq a[20:23],v16,10240
dq a[24:27],v16,12288
dq a[56:59],v17,12288
dq a[60:63],v17,14336
dq a[28:31],v16,14336
s_waitcnt lgkmcnt(14)
v_mfma_f32_16x16x32_bf16 v[48:51], a[72:75], a[0:3], 0
dt a[76:77],v19,4096
mf v[48:51],a[112:115],a[32:35]
s_waitcnt lgkmcnt(13)
dt a[78:79],v19,4608
v_mfma_f32_16x16x32_bf16 v[52:55], a[112:115], a[36:39], 0
s_add_u32 m0, s64, 53248
dt a[116:117],v19,24576
mf v[52:55],a[72:75],a[4:7]
s_waitcnt lgkmcnt(13)
dt a[118:119],v19,25088
buffer_load_dwordx4 v12, s[36:39], s71 offen offset:0  lds
v_mfma_f32_16x16x32_bf16 v[56:59], a[72:75], a[8:11], 0
dt a[80:81],v18,8192
mf v[56:59],a[112:115],a[40:43]
s_waitcnt lgkmcnt(13)
dt a[82:83],v18,8704
v_mfma_f32_16x16x32_bf16 v[60:63], a[112:115], a[44:47], 0
s_add_u32 m0, s64, 73728
dt a[120:121],v18,28672
mf v[60:63],a[72:75],a[12:15]
s_waitcnt lgkmcnt(13)
dt a[122:123],v18,29184
buffer_load_dwordx4 v12, s[36:39], s5 offen offset:0  lds
v_mfma_f32_16x16x32_bf16 v[64:67], a[72:75], a[16:19], 0
dt a[84:85],v19,8192
mf v[64:67],a[112:115],a[48:51]
s_waitcnt lgkmcnt(13)
dt a[86:87],v19,8704
v_mfma_f32_16x16x32_bf16 v[68:71], a[112:115], a[52:55], 0
s_add_u32 m0, s64, 40960
dt a[124:125],v19,28672
mf v[68:71],a[72:75],a[20:23]
s_waitcnt lgkmcnt(13)
dt a[126:127],v19,29184
buffer_load_dwordx4 v10, s[32:35], s70 offen offset:0  lds
v_mfma_f32_16x16x32_bf16 v[72:75], a[72:75], a[24:27], 0
dt a[88:89],v18,12288
mf v[72:75],a[112:115],a[56:59]
s_waitcnt lgkmcnt(13)
dt a[90:91],v18,12800
v_mfma_f32_16x16x32_bf16 v[76:79], a[112:115], a[60:63], 0
s_add_u32 m0, s64, 61440
dt a[128:129],v18,32768
mf v[76:79],a[72:75],a[28:31]
s_waitcnt lgkmcnt(11)
dt a[130:131],v18,33280
buffer_load_dwordx4 v10, s[32:35], s4 offen offset:0  lds
v_mfma_f32_16x16x32_bf16 v[108:111], a[76:79], a[28:31], 0
dt a[92:93],v19,12288
mf v[108:111],a[116:119],a[60:63]
dt a[94:95],v19,12800
v_mfma_f32_16x16x32_bf16 v[104:107], a[116:119], a[56:59], 0
s_add_u32 m0, s65, 32768
dt a[132:133],v19,32768
mf v[104:107],a[76:79],a[24:27]
dt a[134:135],v19,33280
buffer_load_dwordx4 v8, s[56:59], s69 offen  lds
v_mfma_f32_16x16x32_bf16 v[100:103], a[76:79], a[20:23], 0
dt a[64:65],v18,0
mf v[100:103],a[116:119],a[52:55]
dt a[66:67],v18,512
v_mfma_f32_16x16x32_bf16 v[96:99], a[116:119], a[48:51], 0
s_add_u32 m0, s65, 33792
dt a[104:105],v18,20480
mf v[96:99],a[76:79],a[16:19]
dt a[106:107],v18,20992
buffer_load_dwordx4 v9, s[56:59], s69 offen  lds
v_mfma_f32_16x16x32_bf16 v[92:95], a[76:79], a[12:15], 0
L_iw1Q_0:
L_stub10:
s_cbranch_execz L_stub14
s_add_u32 s69, s69, 0x8000
dt a[68:69],v19,0
mf v[92:95],a[116:119],a[44:47]
dt a[70:71],v19,512
v_mfma_f32_16x16x32_bf16 v[88:91], a[116:119], a[40:43], 0
s_add_u32 m0, s65, 34816
dt a[108:109],v19,20480
mf v[88:91],a[76:79],a[8:11]
dt a[110:111],v19,20992
buffer_load_dwordx4 v8, s[56:59], s69 offen  lds
v_mfma_f32_16x16x32_bf16 v[84:87], a[76:79], a[4:7], 0
mf v[84:87],a[116:119],a[36:39]
v_mfma_f32_16x16x32_bf16 v[80:83], a[116:119], a[32:35], 0
s_add_u32 m0, s65, 35840
mf v[80:83],a[76:79],a[0:3]
s_waitcnt lgkmcnt(15)
buffer_load_dwordx4 v9, s[56:59], s69 offen  lds
v_mfma_f32_16x16x32_bf16 v[112:115], a[80:83], a[0:3], 0
s_add_u32 s69, s69, 0x8000
mf v[112:115],a[120:123],a[32:35]
v_mfma_f32_16x16x32_bf16 v[116:119], a[120:123], a[36:39], 0
s_add_u32 m0, s65, 36864
mf v[116:119],a[80:83],a[4:7]
buffer_load_dwordx4 v8, s[56:59], s69 offen  lds
v_mfma_f32_16x16x32_bf16 v[120:123], a[80:83], a[8:11], 0
mf v[120:123],a[120:123],a[40:43]
v_mfma_f32_16x16x32_bf16 v[124:127], a[120:123], a[44:47], 0
s_add_u32 m0, s65, 37888
mf v[124:127],a[80:83],a[12:15]
buffer_load_dwordx4 v9, s[56:59], s69 offen  lds
v_mfma_f32_16x16x32_bf16 v[128:131], a[80:83], a[16:19], 0
s_add_u32 s69, s69, 0x8000
mf v[128:131],a[120:123],a[48:51]
v_mfma_f32_16x16x32_bf16 v[132:135], a[120:123], a[52:55], 0
s_add_u32 m0, s65, 38912
mf v[132:135],a[80:83],a[20:23]
buffer_load_dwordx4 v8, s[56:59], s69 offen  lds
v_mfma_f32_16x16x32_bf16 v[136:139], a[80:83], a[24:27], 0
mf v[136:139],a[120:123],a[56:59]
v_mfma_f32_16x16x32_bf16 v[140:143], a[120:123], a[60:63], 0
s_add_u32 m0, s65, 39936
mf v[140:143],a[80:83],a[28:31]
s_waitcnt lgkmcnt(15)
buffer_load_dwordx4 v9, s[56:59], s69 offen  lds
v_mfma_f32_16x16x32_bf16 v[172:175], a[84:87], a[28:31], 0
mf v[172:175],a[124:127],a[60:63]
v_mfma_f32_16x16x32_bf16 v[168:171], a[124:127], a[56:59], 0
s_add_u32 m0, s64, 16384
mf v[168:171],a[84:87],a[24:27]
buffer_load_dwordx4 v12, s[40:43], s10 offen offset:0  lds
v_mfma_f32_16x16x32_bf16 v[164:167], a[84:87], a[20:23], 0
mf v[164:167],a[124:127],a[52:55]
v_mfma_f32_16x16x32_bf16 v[160:163], a[124:127], a[48:51], 0
s_add_u32 m0, s64, 36864
mf v[160:163],a[84:87],a[16:19]
buffer_load_dwordx4 v12, s[40:43], s11 offen offset:0  lds
v_mfma_f32_16x16x32_bf16 v[156:159], a[84:87], a[12:15], 0
mf v[156:159],a[124:127],a[44:47]
v_mfma_f32_16x16x32_bf16 v[152:155], a[124:127], a[40:43], 0
s_add_u32 m0, s64, 57344
mf v[152:155],a[84:87],a[8:11]
buffer_load_dwordx4 v12, s[40:43], s71 offen offset:0  lds
v_mfma_f32_16x16x32_bf16 v[148:151], a[84:87], a[4:7], 0
mf v[148:151],a[124:127],a[36:39]
v_mfma_f32_16x16x32_bf16 v[144:147], a[124:127], a[32:35], 0
s_add_u32 m0, s64, 77824
mf v[144:147],a[84:87],a[0:3]
buffer_load_dwordx4 v12, s[40:43], s5 offen offset:0  lds
s_waitcnt vmcnt(12) lgkmcnt(0)
s_barrier
s_add_u32 s100, s90, L_hcQ0-L_base
s_addc_u32 s101, s91, 0
s_bitcmp1_b32 s79, 0
s_cbranch_scc1 L_csA
L_hcQ0:
v_mfma_f32_16x16x32_bf16 v[176:179], a[88:91], a[0:3], 0
dt a[72:73],v21,4096
v_readlane_b32 s68, v13, 4
mf v[176:179],a[128:131],a[32:35]
s_mul_i32 s70, s68, 393216
dt a[74:75],v21,4608
v_mfma_f32_16x16x32_bf16 v[180:183], a[128:131], a[36:39], 0
s_mul_i32 s71, s68, 458752
dt a[112:113],v21,24576
mf v[180:183],a[88:91],a[4:7]
s_add_u32 s5, s71, 229376
dt a[114:115],v21,25088
v_mfma_f32_16x16x32_bf16 v[184:187], a[88:91], a[8:11], 0
s_add_u32 m0, s64, 4096
dt a[76:77],v22,4096
mf v[184:187],a[128:131],a[40:43]
dt a[78:79],v22,4608
buffer_load_dwordx4 v11, s[36:39], s71 offen offset:0  lds
v_mfma_f32_16x16x32_bf16 v[188:191], a[128:131], a[44:47], 0
s_add_u32 s4, s70, 196608
dt a[116:117],v22,24576
mf v[188:191],a[88:91],a[12:15]
dt a[118:119],v22,25088
v_mfma_f32_16x16x32_bf16 v[192:195], a[88:91], a[16:19], 0
s_lshl_b32 s69, s68, 7
dt a[80:81],v21,8192
mf v[192:195],a[128:131],a[48:51]
dt a[82:83],v21,8704
v_mfma_f32_16x16x32_bf16 v[196:199], a[128:131], a[52:55], 0
dt a[120:121],v21,28672
mf v[196:199],a[88:91],a[20:23]
dt a[122:123],v21,29184
v_mfma_f32_16x16x32_bf16 v[200:203], a[88:91], a[24:27], 0
s_add_u32 m0, s64, 24576
mf v[200:203],a[128:131],a[56:59]
buffer_load_dwordx4 v11, s[36:39], s5 offen offset:0  lds
v_mfma_f32_16x16x32_bf16 v[204:207], a[128:131], a[60:63], 0
mf v[204:207],a[88:91],a[28:31]
v_mfma_f32_16x16x32_bf16 v[236:239], a[92:95], a[28:31], 0
dt a[84:85],v22,8192
mf v[236:239],a[132:135],a[60:63]
dt a[86:87],v22,8704
v_mfma_f32_16x16x32_bf16 v[232:235], a[132:135], a[56:59], 0
s_add_u32 m0, s64, 8192
dt a[124:125],v22,28672
mf v[232:235],a[92:95],a[24:27]
dt a[126:127],v22,29184
buffer_load_dwordx4 v11, s[40:43], s71 offen offset:0  lds
v_mfma_f32_16x16x32_bf16 v[228:231], a[92:95], a[20:23], 0
dt a[88:89],v21,12288
mf v[228:231],a[132:135],a[52:55]
dt a[90:91],v21,12800
v_mfma_f32_16x16x32_bf16 v[224:227], a[132:135], a[48:51], 0
s_add_u32 m0, s64, 28672
dt a[128:129],v21,32768
mf v[224:227],a[92:95],a[16:19]
dt a[130:131],v21,33280
buffer_load_dwordx4 v11, s[40:43], s5 offen offset:0  lds
v_mfma_f32_16x16x32_bf16 v[220:223], a[92:95], a[12:15], 0
mf v[220:223],a[132:135],a[44:47]
v_mfma_f32_16x16x32_bf16 v[216:219], a[132:135], a[40:43], 0
s_add_u32 m0, s64, 12288
mf v[216:219],a[92:95],a[8:11]
buffer_load_dwordx4 v12, s[36:39], s71 offen offset:0  lds
v_mfma_f32_16x16x32_bf16 v[212:215], a[92:95], a[4:7], 0
mf v[212:215],a[132:135],a[36:39]
v_mfma_f32_16x16x32_bf16 v[208:211], a[132:135], a[32:35], 0
s_add_u32 m0, s64, 32768
mf v[208:211],a[92:95],a[0:3]
buffer_load_dwordx4 v12, s[36:39], s5 offen offset:0  lds
v_mfma_f32_16x16x32_bf16 a[144:147], a[64:67], a[0:3], 0
dt a[92:93],v22,12288
mf a[144:147],a[104:107],a[32:35]
dt a[94:95],v22,12800
v_mfma_f32_16x16x32_bf16 a[148:151], a[104:107], a[36:39], 0
dt a[132:133],v22,32768
mf a[148:151],a[64:67],a[4:7]
dt a[134:135],v22,33280
v_mfma_f32_16x16x32_bf16 a[152:155], a[64:67], a[8:11], 0
s_add_u32 m0, s64, 0
mf a[152:155],a[104:107],a[40:43]
buffer_load_dwordx4 v10, s[32:35], s70 offen offset:0  lds
v_mfma_f32_16x16x32_bf16 a[156:159], a[104:107], a[44:47], 0
mf a[156:159],a[64:67],a[12:15]
v_mfma_f32_16x16x32_bf16 a[160:163], a[64:67], a[16:19], 0
mf a[160:163],a[104:107],a[48:51]
v_mfma_f32_16x16x32_bf16 a[164:167], a[104:107], a[52:55], 0
mf a[164:167],a[64:67],a[20:23]
v_mfma_f32_16x16x32_bf16 a[168:171], a[64:67], a[24:27], 0
s_add_u32 m0, s64, 20480
mf a[168:171],a[104:107],a[56:59]
buffer_load_dwordx4 v10, s[32:35], s4 offen offset:0  lds
v_mfma_f32_16x16x32_bf16 a[172:175], a[104:107], a[60:63], 0
mf a[172:175],a[64:67],a[28:31]
s_waitcnt vmcnt(8) lgkmcnt(0)
s_barrier
v_mfma_f32_16x16x32_bf16 a[204:207], a[68:71], a[28:31], 0
dt a[96:97],v18,16384
mf a[204:207],a[108:111],a[60:63]
dt a[98:99],v18,16896
v_mfma_f32_16x16x32_bf16 a[200:203], a[108:111], a[56:59], 0
dt a[136:137],v18,36864
mf a[200:203],a[68:71],a[24:27]
dt a[138:139],v18,37376
v_mfma_f32_16x16x32_bf16 a[196:199], a[68:71], a[20:23], 0
s_add_u32 m0, s65, 0
dt a[100:101],v19,16384
mf a[196:199],a[108:111],a[52:55]
dt a[102:103],v19,16896
buffer_load_dwordx4 v8, s[56:59], s69 offen  lds
v_mfma_f32_16x16x32_bf16 a[192:195], a[108:111], a[48:51], 0
dt a[140:141],v19,36864
mf a[192:195],a[68:71],a[16:19]
dt a[142:143],v19,37376
v_mfma_f32_16x16x32_bf16 a[188:191], a[68:71], a[12:15], 0
dt a[64:65],v21,0
mf a[188:191],a[108:111],a[44:47]
dt a[66:67],v21,512
v_mfma_f32_16x16x32_bf16 a[184:187], a[108:111], a[40:43], 0
dt a[104:105],v21,20480
mf a[184:187],a[68:71],a[8:11]
dt a[106:107],v21,20992
v_mfma_f32_16x16x32_bf16 a[180:183], a[68:71], a[4:7], 0
s_add_u32 m0, s65, 1024
mf a[180:183],a[108:111],a[36:39]
buffer_load_dwordx4 v9, s[56:59], s69 offen  lds
v_mfma_f32_16x16x32_bf16 a[176:179], a[108:111], a[32:35], 0
mf a[176:179],a[68:71],a[0:3]
s_waitcnt lgkmcnt(4)
s_add_u32 s100, s90, L_hcQ1-L_base
s_addc_u32 s101, s91, 0
s_bitcmp1_b32 s79, 0
s_cbranch_scc1 L_csB
L_hcQ1:
v_mfma_f32_16x16x32_bf16 v[240:243], a[96:99], a[0:3], 0
s_add_u32 s69, s69, 0x8000
dt a[68:69],v22,0
mf v[240:243],a[136:139],a[32:35]
dt a[70:71],v22,512
v_mfma_f32_16x16x32_bf16 v[244:247], a[136:139], a[36:39], 0
s_add_u32 m0, s65, 2048
dt a[108:109],v22,20480
mf v[244:247],a[96:99],a[4:7]
dt a[110:111],v22,20992
buffer_load_dwordx4 v8, s[56:59], s69 offen  lds
v_mfma_f32_16x16x32_bf16 a[208:211], a[96:99], a[8:11], 0
mf a[208:211],a[136:139],a[40:43]
v_mfma_f32_16x16x32_bf16 a[212:215], a[136:139], a[44:47], 0
mf a[212:215],a[96:99],a[12:15]
v_mfma_f32_16x16x32_bf16 a[216:219], a[96:99], a[16:19], 0
s_add_u32 m0, s65, 3072
mf a[216:219],a[136:139],a[48:51]
buffer_load_dwordx4 v9, s[56:59], s69 offen  lds
v_mfma_f32_16x16x32_bf16 a[220:223], a[136:139], a[52:55], 0
s_add_u32 s69, s69, 0x8000
mf a[220:223],a[96:99],a[20:23]
v_mfma_f32_16x16x32_bf16 a[224:227], a[96:99], a[24:27], 0
s_add_u32 m0, s65, 4096
mf a[224:227],a[136:139],a[56:59]
buffer_load_dwordx4 v8, s[56:59], s69 offen  lds
v_mfma_f32_16x16x32_bf16 a[228:231], a[136:139], a[60:63], 0
mf a[228:231],a[96:99],a[28:31]
s_waitcnt lgkmcnt(0)
s_barrier
v_mfma_f32_16x16x32_bf16 v[248:251], a[100:103], a[0:3], 0
dq a[0:3],v16,32768
mf v[248:251],a[140:143],a[32:35]
dq a[32:35],v17,32768
v_mfma_f32_16x16x32_bf16 v[252:255], a[140:143], a[36:39], 0
dq a[36:39],v17,34816
mf v[252:255],a[100:103],a[4:7]
dq a[4:7],v16,34816
v_mfma_f32_16x16x32_bf16 a[232:235], a[100:103], a[8:11], 0
s_add_u32 m0, s65, 5120
dq a[8:11],v16,36864
mf a[232:235],a[140:143],a[40:43]
dq a[40:43],v17,36864
buffer_load_dwordx4 v9, s[56:59], s69 offen  lds
v_mfma_f32_16x16x32_bf16 a[236:239], a[140:143], a[44:47], 0
dq a[44:47],v17,38912
mf a[236:239],a[100:103],a[12:15]
dq a[12:15],v16,38912
v_mfma_f32_16x16x32_bf16 a[240:243], a[100:103], a[16:19], 0
dq a[16:19],v16,40960
mf a[240:243],a[140:143],a[48:51]
dq a[48:51],v17,40960
v_mfma_f32_16x16x32_bf16 a[244:247], a[140:143], a[52:55], 0
s_add_u32 s69, s69, 0x8000
dq a[52:55],v17,43008
mf a[244:247],a[100:103],a[20:23]
dq a[20:23],v16,43008
v_mfma_f32_16x16x32_bf16 a[248:251], a[100:103], a[24:27], 0
s_add_u32 m0, s65, 6144
dq a[24:27],v16,45056
mf a[248:251],a[140:143],a[56:59]
dq a[56:59],v17,45056
buffer_load_dwordx4 v8, s[56:59], s69 offen  lds
v_mfma_f32_16x16x32_bf16 a[252:255], a[140:143], a[60:63], 0
dq a[60:63],v17,47104
mf a[252:255],a[100:103],a[28:31]
s_waitcnt lgkmcnt(13)
dq a[28:31],v16,47104
mf v[48:51],a[72:75],a[0:3]
dt a[96:97],v21,16384
mf v[48:51],a[112:115],a[32:35]
s_waitcnt lgkmcnt(13)
dt a[98:99],v21,16896
mf v[52:55],a[112:115],a[36:39]
s_add_u32 m0, s65, 7168
dt a[136:137],v21,36864
mf v[52:55],a[72:75],a[4:7]
s_waitcnt lgkmcnt(13)
dt a[138:139],v21,37376
buffer_load_dwordx4 v9, s[56:59], s69 offen  lds
mf v[56:59],a[72:75],a[8:11]
dt a[100:101],v22,16384
mf v[56:59],a[112:115],a[40:43]
s_waitcnt lgkmcnt(13)
dt a[102:103],v22,16896
mf v[60:63],a[112:115],a[44:47]
dt a[140:141],v22,36864
mf v[60:63],a[72:75],a[12:15]
s_waitcnt lgkmcnt(13)
dt a[142:143],v22,37376
mf v[64:67],a[72:75],a[16:19]
s_add_u32 m0, s64, 16384
mf v[64:67],a[112:115],a[48:51]
s_waitcnt lgkmcnt(12)
buffer_load_dwordx4 v12, s[40:43], s71 offen offset:0  lds
mf v[68:71],a[112:115],a[52:55]
mf v[68:71],a[72:75],a[20:23]
s_waitcnt lgkmcnt(10)
mf v[72:75],a[72:75],a[24:27]
s_add_u32 m0, s64, 36864
mf v[72:75],a[112:115],a[56:59]
s_waitcnt lgkmcnt(8)
buffer_load_dwordx4 v12, s[40:43], s5 offen offset:0  lds
mf v[76:79],a[112:115],a[60:63]
mf v[76:79],a[72:75],a[28:31]
s_add_u32 s100, s90, L_csQ2_ret-L_base
s_addc_u32 s101, s91, 0
s_mov_b32 s66, 6
s_bitcmp1_b32 s79, 2
s_waitcnt vmcnt(12) lgkmcnt(0)
s_barrier
s_cbranch_scc1 L_cs
L_csQ2_ret:
L_g1loopQ:
mf v[108:111],a[76:79],a[28:31]
v_readlane_b32 s68, v13, s66
mf v[108:111],a[116:119],a[60:63]
dt a[72:73],v18,4096
mf v[104:107],a[116:119],a[56:59]
s_mul_i32 s70, s68, 393216
mf v[104:107],a[76:79],a[24:27]
s_mul_i32 s71, s68, 458752
dt a[74:75],v18,4608
mf v[100:103],a[76:79],a[20:23]
s_add_u32 s5, s71, 229376
mf v[100:103],a[116:119],a[52:55]
s_add_u32 s4, s70, 196608
dt a[112:113],v18,24576
mf v[96:99],a[116:119],a[48:51]
mf v[96:99],a[76:79],a[16:19]
dt a[114:115],v18,25088
mf v[92:95],a[76:79],a[12:15]
s_add_u32 m0, s64, 45056
mf v[92:95],a[116:119],a[44:47]
buffer_load_dwordx4 v11, s[36:39], s71 offen offset:0  lds
mf v[88:91],a[116:119],a[40:43]
mf v[88:91],a[76:79],a[8:11]
mf v[84:87],a[76:79],a[4:7]
s_add_u32 m0, s64, 65536
mf v[84:87],a[116:119],a[36:39]
buffer_load_dwordx4 v11, s[36:39], s5 offen offset:0  lds
mf v[80:83],a[116:119],a[32:35]
mf v[80:83],a[76:79],a[0:3]
mf v[112:115],a[80:83],a[0:3]
mf v[112:115],a[120:123],a[32:35]
dt a[76:77],v19,4096
mf v[116:119],a[120:123],a[36:39]
mf v[116:119],a[80:83],a[4:7]
dt a[78:79],v19,4608
mf v[120:123],a[80:83],a[8:11]
mf v[120:123],a[120:123],a[40:43]
dt a[116:117],v19,24576
mf v[124:127],a[120:123],a[44:47]
mf v[124:127],a[80:83],a[12:15]
dt a[118:119],v19,25088
mf v[128:131],a[80:83],a[16:19]
s_add_u32 m0, s64, 49152
mf v[128:131],a[120:123],a[48:51]
buffer_load_dwordx4 v11, s[40:43], s71 offen offset:0  lds
mf v[132:135],a[120:123],a[52:55]
mf v[132:135],a[80:83],a[20:23]
mf v[136:139],a[80:83],a[24:27]
s_add_u32 m0, s64, 69632
mf v[136:139],a[120:123],a[56:59]
buffer_load_dwordx4 v11, s[40:43], s5 offen offset:0  lds
mf v[140:143],a[120:123],a[60:63]
mf v[140:143],a[80:83],a[28:31]
mf v[172:175],a[84:87],a[28:31]
mf v[172:175],a[124:127],a[60:63]
dt a[80:81],v18,8192
mf v[168:171],a[124:127],a[56:59]
mf v[168:171],a[84:87],a[24:27]
dt a[82:83],v18,8704
mf v[164:167],a[84:87],a[20:23]
mf v[164:167],a[124:127],a[52:55]
dt a[120:121],v18,28672
mf v[160:163],a[124:127],a[48:51]
mf v[160:163],a[84:87],a[16:19]
dt a[122:123],v18,29184
mf v[156:159],a[84:87],a[12:15]
s_add_u32 m0, s64, 53248
mf v[156:159],a[124:127],a[44:47]
buffer_load_dwordx4 v12, s[36:39], s71 offen offset:0  lds
mf v[152:155],a[124:127],a[40:43]
mf v[152:155],a[84:87],a[8:11]
mf v[148:151],a[84:87],a[4:7]
s_add_u32 m0, s64, 73728
mf v[148:151],a[124:127],a[36:39]
buffer_load_dwordx4 v12, s[36:39], s5 offen offset:0  lds
mf v[144:147],a[124:127],a[32:35]
mf v[144:147],a[84:87],a[0:3]
mf v[176:179],a[88:91],a[0:3]
mf v[176:179],a[128:131],a[32:35]
dt a[84:85],v19,8192
mf v[180:183],a[128:131],a[36:39]
mf v[180:183],a[88:91],a[4:7]
dt a[86:87],v19,8704
mf v[184:187],a[88:91],a[8:11]
mf v[184:187],a[128:131],a[40:43]
dt a[124:125],v19,28672
mf v[188:191],a[128:131],a[44:47]
mf v[188:191],a[88:91],a[12:15]
dt a[126:127],v19,29184
mf v[192:195],a[88:91],a[16:19]
s_add_u32 m0, s64, 40960
mf v[192:195],a[128:131],a[48:51]
buffer_load_dwordx4 v10, s[32:35], s70 offen offset:0  lds
mf v[196:199],a[128:131],a[52:55]
mf v[196:199],a[88:91],a[20:23]
mf v[200:203],a[88:91],a[24:27]
s_add_u32 m0, s64, 61440
mf v[200:203],a[128:131],a[56:59]
buffer_load_dwordx4 v10, s[32:35], s4 offen offset:0  lds
mf v[204:207],a[128:131],a[60:63]
mf v[204:207],a[88:91],a[28:31]
mf v[236:239],a[92:95],a[28:31]
mf v[236:239],a[132:135],a[60:63]
dt a[88:89],v18,12288
mf v[232:235],a[132:135],a[56:59]
mf v[232:235],a[92:95],a[24:27]
dt a[90:91],v18,12800
mf v[228:231],a[92:95],a[20:23]
mf v[228:231],a[132:135],a[52:55]
dt a[128:129],v18,32768
mf v[224:227],a[132:135],a[48:51]
mf v[224:227],a[92:95],a[16:19]
dt a[130:131],v18,33280
mf v[220:223],a[92:95],a[12:15]
s_add_u32 m0, s64, 57344
mf v[220:223],a[132:135],a[44:47]
buffer_load_dwordx4 v12, s[40:43], s71 offen offset:0  lds
mf v[216:219],a[132:135],a[40:43]
mf v[216:219],a[92:95],a[8:11]
mf v[212:215],a[92:95],a[4:7]
s_add_u32 m0, s64, 77824
mf v[212:215],a[132:135],a[36:39]
buffer_load_dwordx4 v12, s[40:43], s5 offen offset:0  lds
mf v[208:211],a[132:135],a[32:35]
mf v[208:211],a[92:95],a[0:3]
s_waitcnt vmcnt(10) lgkmcnt(0)
s_barrier
mf a[144:147],a[64:67],a[0:3]
s_lshl_b32 s69, s68, 7
mf a[144:147],a[104:107],a[32:35]
dt a[92:93],v19,12288
mf a[148:151],a[104:107],a[36:39]
mf a[148:151],a[64:67],a[4:7]
dt a[94:95],v19,12800
mf a[152:155],a[64:67],a[8:11]
mf a[152:155],a[104:107],a[40:43]
dt a[132:133],v19,32768
mf a[156:159],a[104:107],a[44:47]
mf a[156:159],a[64:67],a[12:15]
dt a[134:135],v19,33280
mf a[160:163],a[64:67],a[16:19]
s_add_u32 s66, s66, 2
s_add_u32 m0, s65, 32768
mf a[160:163],a[104:107],a[48:51]
buffer_load_dwordx4 v8, s[56:59], s69 offen  lds
mf a[164:167],a[104:107],a[52:55]
mf a[164:167],a[64:67],a[20:23]
mf a[168:171],a[64:67],a[24:27]
mf a[168:171],a[104:107],a[56:59]
mf a[172:175],a[104:107],a[60:63]
s_add_u32 m0, s65, 33792
mf a[172:175],a[64:67],a[28:31]
buffer_load_dwordx4 v9, s[56:59], s69 offen  lds
mf a[204:207],a[68:71],a[28:31]
s_sub_u32 s67, s66, 4
mf a[204:207],a[108:111],a[60:63]
dt a[64:65],v18,0
mf a[200:203],a[108:111],a[56:59]
mf a[200:203],a[68:71],a[24:27]
dt a[66:67],v18,512
mf a[196:199],a[68:71],a[20:23]
mf a[196:199],a[108:111],a[52:55]
dt a[104:105],v18,20480
mf a[192:195],a[108:111],a[48:51]
s_add_u32 s69, s69, 0x8000
mf a[192:195],a[68:71],a[16:19]
dt a[106:107],v18,20992
mf a[188:191],a[68:71],a[12:15]
s_add_u32 m0, s65, 34816
mf a[188:191],a[108:111],a[44:47]
buffer_load_dwordx4 v8, s[56:59], s69 offen  lds
mf a[184:187],a[108:111],a[40:43]
mf a[184:187],a[68:71],a[8:11]
mf a[180:183],a[68:71],a[4:7]
mf a[180:183],a[108:111],a[36:39]
mf a[176:179],a[108:111],a[32:35]
s_add_u32 m0, s65, 35840
mf a[176:179],a[68:71],a[0:3]
buffer_load_dwordx4 v9, s[56:59], s69 offen  lds
mf v[240:243],a[96:99],a[0:3]
mf v[240:243],a[136:139],a[32:35]
dt a[68:69],v19,0
mf v[244:247],a[136:139],a[36:39]
mf v[244:247],a[96:99],a[4:7]
dt a[70:71],v19,512
mf a[208:211],a[96:99],a[8:11]
mf a[208:211],a[136:139],a[40:43]
dt a[108:109],v19,20480
mf a[212:215],a[136:139],a[44:47]
s_add_u32 s69, s69, 0x8000
mf a[212:215],a[96:99],a[12:15]
dt a[110:111],v19,20992
mf a[216:219],a[96:99],a[16:19]
s_add_u32 m0, s65, 36864
mf a[216:219],a[136:139],a[48:51]
buffer_load_dwordx4 v8, s[56:59], s69 offen  lds
mf a[220:223],a[136:139],a[52:55]
mf a[220:223],a[96:99],a[20:23]
mf a[224:227],a[96:99],a[24:27]
mf a[224:227],a[136:139],a[56:59]
mf a[228:231],a[136:139],a[60:63]
s_add_u32 m0, s65, 37888
mf a[228:231],a[96:99],a[28:31]
buffer_load_dwordx4 v9, s[56:59], s69 offen  lds
mf v[248:251],a[100:103],a[0:3]
dq a[0:3],v16,0
mf v[248:251],a[140:143],a[32:35]
dq a[32:35],v17,0
mf v[252:255],a[140:143],a[36:39]
dq a[36:39],v17,2048
mf v[252:255],a[100:103],a[4:7]
L_iw1Q_1:
L_stub11:
s_cbranch_execz L_stub15
dq a[4:7],v16,2048
mf a[232:235],a[100:103],a[8:11]
dq a[8:11],v16,4096
mf a[232:235],a[140:143],a[40:43]
dq a[40:43],v17,4096
mf a[236:239],a[140:143],a[44:47]
dq a[44:47],v17,6144
mf a[236:239],a[100:103],a[12:15]
dq a[12:15],v16,6144
mf a[240:243],a[100:103],a[16:19]
dq a[16:19],v16,8192
mf a[240:243],a[140:143],a[48:51]
dq a[48:51],v17,8192
mf a[244:247],a[140:143],a[52:55]
dq a[52:55],v17,10240
mf a[244:247],a[100:103],a[20:23]
dq a[20:23],v16,10240
mf a[248:251],a[100:103],a[24:27]
dq a[24:27],v16,12288
mf a[248:251],a[140:143],a[56:59]
dq a[56:59],v17,12288
mf a[252:255],a[140:143],a[60:63]
s_add_u32 s69, s69, 0x8000
dq a[60:63],v17,14336
mf a[252:255],a[100:103],a[28:31]
s_waitcnt lgkmcnt(13)
dq a[28:31],v16,14336
mf v[48:51],a[72:75],a[0:3]
s_add_u32 m0, s65, 38912
dt a[96:97],v18,16384
mf v[48:51],a[112:115],a[32:35]
s_waitcnt lgkmcnt(13)
dt a[98:99],v18,16896
buffer_load_dwordx4 v8, s[56:59], s69 offen  lds
mf v[52:55],a[112:115],a[36:39]
dt a[136:137],v18,36864
mf v[52:55],a[72:75],a[4:7]
s_waitcnt lgkmcnt(13)
dt a[138:139],v18,37376
mf v[56:59],a[72:75],a[8:11]
dt a[100:101],v19,16384
mf v[56:59],a[112:115],a[40:43]
s_waitcnt lgkmcnt(13)
dt a[102:103],v19,16896
mf v[60:63],a[112:115],a[44:47]
dt a[140:141],v19,36864
mf v[60:63],a[72:75],a[12:15]
s_waitcnt lgkmcnt(13)
dt a[142:143],v19,37376
mf v[64:67],a[72:75],a[16:19]
s_add_u32 m0, s65, 39936
mf v[64:67],a[112:115],a[48:51]
s_waitcnt lgkmcnt(12)
buffer_load_dwordx4 v9, s[56:59], s69 offen  lds
mf v[68:71],a[112:115],a[52:55]
s_add_u32 s100, s90, L_csQ4_ret-L_base
mf v[68:71],a[72:75],a[20:23]
s_waitcnt lgkmcnt(10)
mf v[72:75],a[72:75],a[24:27]
s_addc_u32 s101, s91, 0
mf v[72:75],a[112:115],a[56:59]
s_waitcnt lgkmcnt(8)
mf v[76:79],a[112:115],a[60:63]
s_bitcmp1_b32 s79, s67
mf v[76:79],a[72:75],a[28:31]
s_waitcnt vmcnt(12) lgkmcnt(0)
s_barrier
s_cbranch_scc1 L_cs
L_csQ4_ret:
mf v[108:111],a[76:79],a[28:31]
v_readlane_b32 s68, v13, s66
mf v[108:111],a[116:119],a[60:63]
dt a[72:73],v21,4096
mf v[104:107],a[116:119],a[56:59]
s_mul_i32 s70, s68, 393216
mf v[104:107],a[76:79],a[24:27]
s_mul_i32 s71, s68, 458752
dt a[74:75],v21,4608
mf v[100:103],a[76:79],a[20:23]
s_add_u32 s5, s71, 229376
mf v[100:103],a[116:119],a[52:55]
s_add_u32 s4, s70, 196608
dt a[112:113],v21,24576
mf v[96:99],a[116:119],a[48:51]
mf v[96:99],a[76:79],a[16:19]
dt a[114:115],v21,25088
mf v[92:95],a[76:79],a[12:15]
s_add_u32 m0, s64, 4096
mf v[92:95],a[116:119],a[44:47]
buffer_load_dwordx4 v11, s[36:39], s71 offen offset:0  lds
mf v[88:91],a[116:119],a[40:43]
mf v[88:91],a[76:79],a[8:11]
mf v[84:87],a[76:79],a[4:7]
s_add_u32 m0, s64, 24576
mf v[84:87],a[116:119],a[36:39]
buffer_load_dwordx4 v11, s[36:39], s5 offen offset:0  lds
mf v[80:83],a[116:119],a[32:35]
mf v[80:83],a[76:79],a[0:3]
mf v[112:115],a[80:83],a[0:3]
mf v[112:115],a[120:123],a[32:35]
dt a[76:77],v22,4096
mf v[116:119],a[120:123],a[36:39]
mf v[116:119],a[80:83],a[4:7]
dt a[78:79],v22,4608
mf v[120:123],a[80:83],a[8:11]
mf v[120:123],a[120:123],a[40:43]
dt a[116:117],v22,24576
mf v[124:127],a[120:123],a[44:47]
mf v[124:127],a[80:83],a[12:15]
dt a[118:119],v22,25088
mf v[128:131],a[80:83],a[16:19]
s_add_u32 m0, s64, 8192
mf v[128:131],a[120:123],a[48:51]
buffer_load_dwordx4 v11, s[40:43], s71 offen offset:0  lds
mf v[132:135],a[120:123],a[52:55]
mf v[132:135],a[80:83],a[20:23]
mf v[136:139],a[80:83],a[24:27]
s_add_u32 m0, s64, 28672
mf v[136:139],a[120:123],a[56:59]
buffer_load_dwordx4 v11, s[40:43], s5 offen offset:0  lds
mf v[140:143],a[120:123],a[60:63]
mf v[140:143],a[80:83],a[28:31]
mf v[172:175],a[84:87],a[28:31]
mf v[172:175],a[124:127],a[60:63]
dt a[80:81],v21,8192
mf v[168:171],a[124:127],a[56:59]
mf v[168:171],a[84:87],a[24:27]
dt a[82:83],v21,8704
mf v[164:167],a[84:87],a[20:23]
mf v[164:167],a[124:127],a[52:55]
dt a[120:121],v21,28672
mf v[160:163],a[124:127],a[48:51]
mf v[160:163],a[84:87],a[16:19]
dt a[122:123],v21,29184
mf v[156:159],a[84:87],a[12:15]
s_add_u32 m0, s64, 12288
mf v[156:159],a[124:127],a[44:47]
buffer_load_dwordx4 v12, s[36:39], s71 offen offset:0  lds
mf v[152:155],a[124:127],a[40:43]
mf v[152:155],a[84:87],a[8:11]
mf v[148:151],a[84:87],a[4:7]
s_add_u32 m0, s64, 32768
mf v[148:151],a[124:127],a[36:39]
buffer_load_dwordx4 v12, s[36:39], s5 offen offset:0  lds
mf v[144:147],a[124:127],a[32:35]
mf v[144:147],a[84:87],a[0:3]
mf v[176:179],a[88:91],a[0:3]
mf v[176:179],a[128:131],a[32:35]
dt a[84:85],v22,8192
mf v[180:183],a[128:131],a[36:39]
mf v[180:183],a[88:91],a[4:7]
dt a[86:87],v22,8704
mf v[184:187],a[88:91],a[8:11]
mf v[184:187],a[128:131],a[40:43]
dt a[124:125],v22,28672
mf v[188:191],a[128:131],a[44:47]
mf v[188:191],a[88:91],a[12:15]
dt a[126:127],v22,29184
mf v[192:195],a[88:91],a[16:19]
s_add_u32 m0, s64, 0
mf v[192:195],a[128:131],a[48:51]
buffer_load_dwordx4 v10, s[32:35], s70 offen offset:0  lds
mf v[196:199],a[128:131],a[52:55]
mf v[196:199],a[88:91],a[20:23]
mf v[200:203],a[88:91],a[24:27]
s_add_u32 m0, s64, 20480
mf v[200:203],a[128:131],a[56:59]
buffer_load_dwordx4 v10, s[32:35], s4 offen offset:0  lds
mf v[204:207],a[128:131],a[60:63]
mf v[204:207],a[88:91],a[28:31]
mf v[236:239],a[92:95],a[28:31]
mf v[236:239],a[132:135],a[60:63]
dt a[88:89],v21,12288
mf v[232:235],a[132:135],a[56:59]
mf v[232:235],a[92:95],a[24:27]
dt a[90:91],v21,12800
mf v[228:231],a[92:95],a[20:23]
mf v[228:231],a[132:135],a[52:55]
dt a[128:129],v21,32768
mf v[224:227],a[132:135],a[48:51]
mf v[224:227],a[92:95],a[16:19]
dt a[130:131],v21,33280
mf v[220:223],a[92:95],a[12:15]
s_add_u32 m0, s64, 16384
mf v[220:223],a[132:135],a[44:47]
buffer_load_dwordx4 v12, s[40:43], s71 offen offset:0  lds
mf v[216:219],a[132:135],a[40:43]
mf v[216:219],a[92:95],a[8:11]
mf v[212:215],a[92:95],a[4:7]
s_add_u32 m0, s64, 36864
mf v[212:215],a[132:135],a[36:39]
buffer_load_dwordx4 v12, s[40:43], s5 offen offset:0  lds
mf v[208:211],a[132:135],a[32:35]
mf v[208:211],a[92:95],a[0:3]
s_waitcnt vmcnt(10) lgkmcnt(0)
s_barrier
mf a[144:147],a[64:67],a[0:3]
s_lshl_b32 s69, s68, 7
mf a[144:147],a[104:107],a[32:35]
dt a[92:93],v22,12288
mf a[148:151],a[104:107],a[36:39]
mf a[148:151],a[64:67],a[4:7]
dt a[94:95],v22,12800
mf a[152:155],a[64:67],a[8:11]
mf a[152:155],a[104:107],a[40:43]
dt a[132:133],v22,32768
mf a[156:159],a[104:107],a[44:47]
mf a[156:159],a[64:67],a[12:15]
dt a[134:135],v22,33280
mf a[160:163],a[64:67],a[16:19]
s_add_u32 s66, s66, 2
s_add_u32 m0, s65, 0
mf a[160:163],a[104:107],a[48:51]
buffer_load_dwordx4 v8, s[56:59], s69 offen  lds
mf a[164:167],a[104:107],a[52:55]
mf a[164:167],a[64:67],a[20:23]
mf a[168:171],a[64:67],a[24:27]
mf a[168:171],a[104:107],a[56:59]
mf a[172:175],a[104:107],a[60:63]
s_add_u32 m0, s65, 1024
mf a[172:175],a[64:67],a[28:31]
buffer_load_dwordx4 v9, s[56:59], s69 offen  lds
mf a[204:207],a[68:71],a[28:31]
s_sub_u32 s67, s66, 4
mf a[204:207],a[108:111],a[60:63]
dt a[64:65],v21,0
mf a[200:203],a[108:111],a[56:59]
mf a[200:203],a[68:71],a[24:27]
dt a[66:67],v21,512
mf a[196:199],a[68:71],a[20:23]
mf a[196:199],a[108:111],a[52:55]
dt a[104:105],v21,20480
mf a[192:195],a[108:111],a[48:51]
s_add_u32 s69, s69, 0x8000
mf a[192:195],a[68:71],a[16:19]
dt a[106:107],v21,20992
mf a[188:191],a[68:71],a[12:15]
s_add_u32 m0, s65, 2048
mf a[188:191],a[108:111],a[44:47]
buffer_load_dwordx4 v8, s[56:59], s69 offen  lds
mf a[184:187],a[108:111],a[40:43]
s_cmp_lt_u32 s66, 18
s_cselect_b64 vcc, -1, 0
mf a[184:187],a[68:71],a[8:11]
mf a[180:183],a[68:71],a[4:7]
mf a[180:183],a[108:111],a[36:39]
mf a[176:179],a[108:111],a[32:35]
s_add_u32 m0, s65, 3072
mf a[176:179],a[68:71],a[0:3]
buffer_load_dwordx4 v9, s[56:59], s69 offen  lds
mf v[240:243],a[96:99],a[0:3]
mf v[240:243],a[136:139],a[32:35]
dt a[68:69],v22,0
mf v[244:247],a[136:139],a[36:39]
mf v[244:247],a[96:99],a[4:7]
dt a[70:71],v22,512
mf a[208:211],a[96:99],a[8:11]
mf a[208:211],a[136:139],a[40:43]
dt a[108:109],v22,20480
mf a[212:215],a[136:139],a[44:47]
s_add_u32 s69, s69, 0x8000
mf a[212:215],a[96:99],a[12:15]
dt a[110:111],v22,20992
mf a[216:219],a[96:99],a[16:19]
s_add_u32 m0, s65, 4096
mf a[216:219],a[136:139],a[48:51]
buffer_load_dwordx4 v8, s[56:59], s69 offen  lds
mf a[220:223],a[136:139],a[52:55]
mf a[220:223],a[96:99],a[20:23]
mf a[224:227],a[96:99],a[24:27]
mf a[224:227],a[136:139],a[56:59]
mf a[228:231],a[136:139],a[60:63]
s_add_u32 m0, s65, 5120
mf a[228:231],a[96:99],a[28:31]
buffer_load_dwordx4 v9, s[56:59], s69 offen  lds
mf v[248:251],a[100:103],a[0:3]
dq a[0:3],v16,32768
mf v[248:251],a[140:143],a[32:35]
dq a[32:35],v17,32768
mf v[252:255],a[140:143],a[36:39]
dq a[36:39],v17,34816
mf v[252:255],a[100:103],a[4:7]
dq a[4:7],v16,34816
mf a[232:235],a[100:103],a[8:11]
dq a[8:11],v16,36864
mf a[232:235],a[140:143],a[40:43]
dq a[40:43],v17,36864
mf a[236:239],a[140:143],a[44:47]
dq a[44:47],v17,38912
mf a[236:239],a[100:103],a[12:15]
dq a[12:15],v16,38912
mf a[240:243],a[100:103],a[16:19]
dq a[16:19],v16,40960
mf a[240:243],a[140:143],a[48:51]
dq a[48:51],v17,40960
mf a[244:247],a[140:143],a[52:55]
dq a[52:55],v17,43008
mf a[244:247],a[100:103],a[20:23]
dq a[20:23],v16,43008
mf a[248:251],a[100:103],a[24:27]
dq a[24:27],v16,45056
mf a[248:251],a[140:143],a[56:59]
dq a[56:59],v17,45056
mf a[252:255],a[140:143],a[60:63]
s_add_u32 s69, s69, 0x8000
dq a[60:63],v17,47104
mf a[252:255],a[100:103],a[28:31]
s_waitcnt lgkmcnt(13)
dq a[28:31],v16,47104
mf v[48:51],a[72:75],a[0:3]
s_add_u32 m0, s65, 6144
dt a[96:97],v21,16384
mf v[48:51],a[112:115],a[32:35]
s_waitcnt lgkmcnt(13)
dt a[98:99],v21,16896
buffer_load_dwordx4 v8, s[56:59], s69 offen  lds
mf v[52:55],a[112:115],a[36:39]
dt a[136:137],v21,36864
mf v[52:55],a[72:75],a[4:7]
s_waitcnt lgkmcnt(13)
dt a[138:139],v21,37376
mf v[56:59],a[72:75],a[8:11]
dt a[100:101],v22,16384
mf v[56:59],a[112:115],a[40:43]
s_waitcnt lgkmcnt(13)
dt a[102:103],v22,16896
mf v[60:63],a[112:115],a[44:47]
dt a[140:141],v22,36864
mf v[60:63],a[72:75],a[12:15]
s_waitcnt lgkmcnt(13)
dt a[142:143],v22,37376
mf v[64:67],a[72:75],a[16:19]
s_add_u32 m0, s65, 7168
mf v[64:67],a[112:115],a[48:51]
s_waitcnt lgkmcnt(12)
buffer_load_dwordx4 v9, s[56:59], s69 offen  lds
mf v[68:71],a[112:115],a[52:55]
s_add_u32 s100, s90, L_csQ14_ret-L_base
mf v[68:71],a[72:75],a[20:23]
s_waitcnt lgkmcnt(10)
mf v[72:75],a[72:75],a[24:27]
s_addc_u32 s101, s91, 0
mf v[72:75],a[112:115],a[56:59]
s_waitcnt lgkmcnt(8)
mf v[76:79],a[112:115],a[60:63]
s_bitcmp1_b32 s79, s67
mf v[76:79],a[72:75],a[28:31]
s_waitcnt vmcnt(12) lgkmcnt(0)
s_barrier
s_cbranch_scc1 L_cs
L_csQ14_ret:
s_cbranch_vccnz L_g1loopQ
mf v[108:111],a[76:79],a[28:31]
s_lshl_b32 s3, s78, 7
v_readlane_b32 s68, v13, 18
s_add_u32 s3, s3, 23592960
mf v[108:111],a[116:119],a[60:63]
dt a[72:73],v18,4096
mf v[104:107],a[116:119],a[56:59]
s_mul_i32 s70, s68, 393216
mf v[104:107],a[76:79],a[24:27]
s_mul_i32 s71, s68, 458752
dt a[74:75],v18,4608
mf v[100:103],a[76:79],a[20:23]
s_add_u32 s5, s71, 229376
mf v[100:103],a[116:119],a[52:55]
s_add_u32 s4, s70, 196608
dt a[112:113],v18,24576
mf v[96:99],a[116:119],a[48:51]
mf v[96:99],a[76:79],a[16:19]
dt a[114:115],v18,25088
mf v[92:95],a[76:79],a[12:15]
s_add_u32 m0, s64, 45056
mf v[92:95],a[116:119],a[44:47]
buffer_load_dwordx4 v11, s[36:39], s71 offen offset:0  lds
mf v[88:91],a[116:119],a[40:43]
mf v[88:91],a[76:79],a[8:11]
s_mov_b32 m0, 147456
s_nop 0
buffer_load_dword v4, s[28:31], s3 offen sc1 lds
mf v[84:87],a[76:79],a[4:7]
s_add_u32 m0, s64, 65536
mf v[84:87],a[116:119],a[36:39]
buffer_load_dwordx4 v11, s[36:39], s5 offen offset:0  lds
mf v[80:83],a[116:119],a[32:35]
mf v[80:83],a[76:79],a[0:3]
buffer_load_dword v5, v4, s[96:99], 0 offen sc1
mf v[112:115],a[80:83],a[0:3]
mf v[112:115],a[120:123],a[32:35]
dt a[76:77],v19,4096
mf v[116:119],a[120:123],a[36:39]
mf v[116:119],a[80:83],a[4:7]
dt a[78:79],v19,4608
mf v[120:123],a[80:83],a[8:11]
mf v[120:123],a[120:123],a[40:43]
dt a[116:117],v19,24576
mf v[124:127],a[120:123],a[44:47]
mf v[124:127],a[80:83],a[12:15]
dt a[118:119],v19,25088
mf v[128:131],a[80:83],a[16:19]
s_add_u32 m0, s64, 49152
mf v[128:131],a[120:123],a[48:51]
buffer_load_dwordx4 v11, s[40:43], s71 offen offset:0  lds
mf v[132:135],a[120:123],a[52:55]
mf v[132:135],a[80:83],a[20:23]
mf v[136:139],a[80:83],a[24:27]
s_add_u32 m0, s64, 69632
mf v[136:139],a[120:123],a[56:59]
buffer_load_dwordx4 v11, s[40:43], s5 offen offset:0  lds
mf v[140:143],a[120:123],a[60:63]
mf v[140:143],a[80:83],a[28:31]
mf v[172:175],a[84:87],a[28:31]
mf v[172:175],a[124:127],a[60:63]
dt a[80:81],v18,8192
mf v[168:171],a[124:127],a[56:59]
mf v[168:171],a[84:87],a[24:27]
dt a[82:83],v18,8704
mf v[164:167],a[84:87],a[20:23]
mf v[164:167],a[124:127],a[52:55]
dt a[120:121],v18,28672
mf v[160:163],a[124:127],a[48:51]
mf v[160:163],a[84:87],a[16:19]
dt a[122:123],v18,29184
mf v[156:159],a[84:87],a[12:15]
s_add_u32 m0, s64, 53248
mf v[156:159],a[124:127],a[44:47]
buffer_load_dwordx4 v12, s[36:39], s71 offen offset:0  lds
mf v[152:155],a[124:127],a[40:43]
mf v[152:155],a[84:87],a[8:11]
mf v[148:151],a[84:87],a[4:7]
s_add_u32 m0, s64, 73728
mf v[148:151],a[124:127],a[36:39]
buffer_load_dwordx4 v12, s[36:39], s5 offen offset:0  lds
mf v[144:147],a[124:127],a[32:35]
mf v[144:147],a[84:87],a[0:3]
mf v[176:179],a[88:91],a[0:3]
mf v[176:179],a[128:131],a[32:35]
dt a[84:85],v19,8192
mf v[180:183],a[128:131],a[36:39]
mf v[180:183],a[88:91],a[4:7]
dt a[86:87],v19,8704
mf v[184:187],a[88:91],a[8:11]
mf v[184:187],a[128:131],a[40:43]
dt a[124:125],v19,28672
mf v[188:191],a[128:131],a[44:47]
mf v[188:191],a[88:91],a[12:15]
dt a[126:127],v19,29184
mf v[192:195],a[88:91],a[16:19]
s_add_u32 m0, s64, 40960
mf v[192:195],a[128:131],a[48:51]
buffer_load_dwordx4 v10, s[32:35], s70 offen offset:0  lds
mf v[196:199],a[128:131],a[52:55]
mf v[196:199],a[88:91],a[20:23]
mf v[200:203],a[88:91],a[24:27]
s_add_u32 m0, s64, 61440
mf v[200:203],a[128:131],a[56:59]
buffer_load_dwordx4 v10, s[32:35], s4 offen offset:0  lds
mf v[204:207],a[128:131],a[60:63]
mf v[204:207],a[88:91],a[28:31]
mf v[236:239],a[92:95],a[28:31]
mf v[236:239],a[132:135],a[60:63]
dt a[88:89],v18,12288
mf v[232:235],a[132:135],a[56:59]
mf v[232:235],a[92:95],a[24:27]
dt a[90:91],v18,12800
mf v[228:231],a[92:95],a[20:23]
mf v[228:231],a[132:135],a[52:55]
dt a[128:129],v18,32768
mf v[224:227],a[132:135],a[48:51]
mf v[224:227],a[92:95],a[16:19]
dt a[130:131],v18,33280
mf v[220:223],a[92:95],a[12:15]
s_add_u32 m0, s64, 57344
mf v[220:223],a[132:135],a[44:47]
buffer_load_dwordx4 v12, s[40:43], s71 offen offset:0  lds
mf v[216:219],a[132:135],a[40:43]
mf v[216:219],a[92:95],a[8:11]
mf v[212:215],a[92:95],a[4:7]
s_add_u32 m0, s64, 77824
mf v[212:215],a[132:135],a[36:39]
buffer_load_dwordx4 v12, s[40:43], s5 offen offset:0  lds
mf v[208:211],a[132:135],a[32:35]
mf v[208:211],a[92:95],a[0:3]
s_waitcnt vmcnt(12) lgkmcnt(0)
s_barrier
mf a[144:147],a[64:67],a[0:3]
s_lshl_b32 s69, s68, 7
mf a[144:147],a[104:107],a[32:35]
dt a[92:93],v19,12288
mf a[148:151],a[104:107],a[36:39]
mf a[148:151],a[64:67],a[4:7]
dt a[94:95],v19,12800
mf a[152:155],a[64:67],a[8:11]
mf a[152:155],a[104:107],a[40:43]
dt a[132:133],v19,32768
mf a[156:159],a[104:107],a[44:47]
mf a[156:159],a[64:67],a[12:15]
dt a[134:135],v19,33280
mf a[160:163],a[64:67],a[16:19]
s_add_u32 m0, s65, 32768
mf a[160:163],a[104:107],a[48:51]
buffer_load_dwordx4 v8, s[56:59], s69 offen  lds
mf a[164:167],a[104:107],a[52:55]
mf a[164:167],a[64:67],a[20:23]
s_mov_b32 m0, 147456
s_nop 0
buffer_load_dword v15, s[48:51], s89 offen lds
mf a[168:171],a[64:67],a[24:27]
s_add_u32 s89, s89, 0x100000
mf a[168:171],a[104:107],a[56:59]
s_mov_b32 m0, 147456
s_nop 0
buffer_load_dword v15, s[48:51], s89 offen lds
mf a[172:175],a[104:107],a[60:63]
s_add_u32 m0, s65, 33792
s_add_u32 s89, s89, 0x100000
v_and_b32 v6, 15, v2
mf a[172:175],a[64:67],a[28:31]
buffer_load_dwordx4 v9, s[56:59], s69 offen  lds
mf a[204:207],a[68:71],a[28:31]
v_cmp_eq_u32 vcc, 1, v6
mf a[204:207],a[108:111],a[60:63]
dt a[64:65],v18,0
v_cndmask_b32 v24, v24, v28, vcc
mf a[200:203],a[108:111],a[56:59]
v_cndmask_b32 v25, v25, v29, vcc
v_cndmask_b32 v26, v26, v30, vcc
mf a[200:203],a[68:71],a[24:27]
dt a[66:67],v18,512
v_cndmask_b32 v27, v27, v31, vcc
mf a[196:199],a[68:71],a[20:23]
v_cmp_eq_u32 vcc, 2, v6
mf a[196:199],a[108:111],a[52:55]
dt a[104:105],v18,20480
v_cndmask_b32 v24, v24, v32, vcc
mf a[192:195],a[108:111],a[48:51]
s_add_u32 s69, s69, 0x8000
v_cndmask_b32 v25, v25, v33, vcc
v_cndmask_b32 v26, v26, v34, vcc
mf a[192:195],a[68:71],a[16:19]
L_iw1Q_2:
L_stub12:
s_cbranch_execz L_stub16
dt a[106:107],v18,20992
v_cndmask_b32 v27, v27, v35, vcc
mf a[188:191],a[68:71],a[12:15]
s_add_u32 m0, s65, 34816
v_cmp_eq_u32 vcc, 3, v6
mf a[188:191],a[108:111],a[44:47]
buffer_load_dwordx4 v8, s[56:59], s69 offen  lds
mf a[184:187],a[108:111],a[40:43]
v_cndmask_b32 v24, v24, v36, vcc
v_cndmask_b32 v25, v25, v37, vcc
mf a[184:187],a[68:71],a[8:11]
v_cndmask_b32 v26, v26, v38, vcc
v_cndmask_b32 v27, v27, v39, vcc
mf a[180:183],a[68:71],a[4:7]
v_cmp_eq_u32 vcc, 4, v6
mf a[180:183],a[108:111],a[36:39]
mf a[176:179],a[108:111],a[32:35]
s_add_u32 m0, s65, 35840
v_cndmask_b32 v24, v24, v40, vcc
v_cndmask_b32 v25, v25, v41, vcc
mf a[176:179],a[68:71],a[0:3]
buffer_load_dwordx4 v9, s[56:59], s69 offen  lds
mf v[240:243],a[96:99],a[0:3]
v_cndmask_b32 v26, v26, v42, vcc
v_cndmask_b32 v27, v27, v43, vcc
mf v[240:243],a[136:139],a[32:35]
dt a[68:69],v19,0
v_cmp_gt_u32 vcc, 5, v6
mf v[244:247],a[136:139],a[36:39]
v_and_b32 v7, 48, v2
v_lshl_add_u32 v6, v6, 6, v7
mf v[244:247],a[96:99],a[4:7]
dt a[70:71],v19,512
v_mov_b32 v7, 0x7fff0000
mf a[208:211],a[96:99],a[8:11]
v_cndmask_b32 v6, v7, v6, vcc
s_lshl_b32 s82, s23, 3
mf a[208:211],a[136:139],a[40:43]
s_add_u32 s82, s82, s24
dt a[108:109],v19,20480
s_mul_i32 s82, s82, 1280
mf a[212:215],a[136:139],a[44:47]
s_add_u32 s69, s69, 0x8000
s_mul_i32 s83, s22, 640
s_add_u32 s82, s82, s83
mf a[212:215],a[96:99],a[12:15]
s_mul_i32 s83, s21, 320
dt a[110:111],v19,20992
s_add_u32 s82, s82, s83
mf a[216:219],a[96:99],a[16:19]
s_add_u32 m0, s65, 36864
s_add_u32 s82, s82, 23265280
mf a[216:219],a[136:139],a[48:51]
buffer_load_dwordx4 v8, s[56:59], s69 offen  lds
mf a[220:223],a[136:139],a[52:55]
mf a[220:223],a[96:99],a[20:23]
buffer_store_dwordx4 v[24:27], v6, s[28:31], s82 offen sc1
mf a[224:227],a[96:99],a[24:27]
mf a[224:227],a[136:139],a[56:59]
mf a[228:231],a[136:139],a[60:63]
s_add_u32 m0, s65, 37888
mf a[228:231],a[96:99],a[28:31]
buffer_load_dwordx4 v9, s[56:59], s69 offen  lds
mf v[248:251],a[100:103],a[0:3]
dq a[0:3],v16,0
mf v[248:251],a[140:143],a[32:35]
dq a[32:35],v17,0
mf v[252:255],a[140:143],a[36:39]
dq a[36:39],v17,2048
mf v[252:255],a[100:103],a[4:7]
dq a[4:7],v16,2048
mf a[232:235],a[100:103],a[8:11]
dq a[8:11],v16,4096
mf a[232:235],a[140:143],a[40:43]
dq a[40:43],v17,4096
mf a[236:239],a[140:143],a[44:47]
dq a[44:47],v17,6144
mf a[236:239],a[100:103],a[12:15]
dq a[12:15],v16,6144
mf a[240:243],a[100:103],a[16:19]
dq a[16:19],v16,8192
mf a[240:243],a[140:143],a[48:51]
dq a[48:51],v17,8192
mf a[244:247],a[140:143],a[52:55]
dq a[52:55],v17,10240
mf a[244:247],a[100:103],a[20:23]
dq a[20:23],v16,10240
mf a[248:251],a[100:103],a[24:27]
dq a[24:27],v16,12288
mf a[248:251],a[140:143],a[56:59]
dq a[56:59],v17,12288
mf a[252:255],a[140:143],a[60:63]
s_add_u32 s69, s69, 0x8000
dq a[60:63],v17,14336
mf a[252:255],a[100:103],a[28:31]
s_waitcnt lgkmcnt(13)
dq a[28:31],v16,14336
mf v[48:51],a[72:75],a[0:3]
s_add_u32 m0, s65, 38912
dt a[96:97],v18,16384
mf v[48:51],a[112:115],a[32:35]
s_waitcnt lgkmcnt(13)
dt a[98:99],v18,16896
buffer_load_dwordx4 v8, s[56:59], s69 offen  lds
mf v[52:55],a[112:115],a[36:39]
dt a[136:137],v18,36864
mf v[52:55],a[72:75],a[4:7]
s_waitcnt lgkmcnt(13)
dt a[138:139],v18,37376
mf v[56:59],a[72:75],a[8:11]
dt a[100:101],v19,16384
mf v[56:59],a[112:115],a[40:43]
s_waitcnt lgkmcnt(13)
dt a[102:103],v19,16896
mf v[60:63],a[112:115],a[44:47]
dt a[140:141],v19,36864
mf v[60:63],a[72:75],a[12:15]
s_waitcnt lgkmcnt(13)
dt a[142:143],v19,37376
mf v[64:67],a[72:75],a[16:19]
s_add_u32 m0, s65, 39936
mf v[64:67],a[112:115],a[48:51]
s_waitcnt lgkmcnt(12)
buffer_load_dwordx4 v9, s[56:59], s69 offen  lds
mf v[68:71],a[112:115],a[52:55]
mf v[68:71],a[72:75],a[20:23]
s_waitcnt lgkmcnt(10)
mf v[72:75],a[72:75],a[24:27]
mf v[72:75],a[112:115],a[56:59]
s_waitcnt lgkmcnt(8)
mf v[76:79],a[112:115],a[60:63]
mf v[76:79],a[72:75],a[28:31]
s_waitcnt vmcnt(15) lgkmcnt(0)
s_barrier
mf v[108:111],a[76:79],a[28:31]
s_lshl_b32 s82, s24, 8
v_readlane_b32 s68, v13, 20
s_lshl_b32 s83, s23, 3
mf v[108:111],a[116:119],a[60:63]
s_add_u32 s82, s82, s83
dt a[72:73],v21,4096
s_lshl_b32 s83, s20, 1
mf v[104:107],a[116:119],a[56:59]
s_mul_i32 s70, s68, 393216
s_add_u32 s82, s82, s83
s_lshl_b32 s82, s82, 11
mf v[104:107],a[76:79],a[24:27]
s_mul_i32 s71, s68, 458752
dt a[74:75],v21,4608
v_lshrrev_b32 v6, 5, v2
mf v[100:103],a[76:79],a[20:23]
s_add_u32 s5, s71, 229376
v_mul_u32_u24 v6, 1536, v6
v_add3_u32 v6, v6, v3, s82
mf v[100:103],a[116:119],a[52:55]
s_add_u32 s4, s70, 196608
dt a[112:113],v21,24576
mf v[96:99],a[116:119],a[48:51]
mf v[96:99],a[76:79],a[16:19]
dt a[114:115],v21,25088
mf v[92:95],a[76:79],a[12:15]
s_add_u32 m0, s64, 4096
mf v[92:95],a[116:119],a[44:47]
buffer_load_dwordx4 v11, s[36:39], s71 offen offset:0  lds
mf v[88:91],a[116:119],a[40:43]
mf v[88:91],a[76:79],a[8:11]
buffer_load_dwordx4 v[24:27], v6, s[56:59], 0 offen offset:0
mf v[84:87],a[76:79],a[4:7]
s_add_u32 m0, s64, 24576
mf v[84:87],a[116:119],a[36:39]
buffer_load_dwordx4 v11, s[36:39], s5 offen offset:0  lds
mf v[80:83],a[116:119],a[32:35]
mf v[80:83],a[76:79],a[0:3]
mf v[112:115],a[80:83],a[0:3]
mf v[112:115],a[120:123],a[32:35]
dt a[76:77],v22,4096
buffer_load_dwordx4 v[28:31], v6, s[56:59], 0 offen offset:512
mf v[116:119],a[120:123],a[36:39]
mf v[116:119],a[80:83],a[4:7]
dt a[78:79],v22,4608
mf v[120:123],a[80:83],a[8:11]
mf v[120:123],a[120:123],a[40:43]
dt a[116:117],v22,24576
mf v[124:127],a[120:123],a[44:47]
mf v[124:127],a[80:83],a[12:15]
dt a[118:119],v22,25088
buffer_load_dwordx4 v[32:35], v6, s[56:59], 0 offen offset:1024
mf v[128:131],a[80:83],a[16:19]
s_add_u32 m0, s64, 8192
mf v[128:131],a[120:123],a[48:51]
buffer_load_dwordx4 v11, s[40:43], s71 offen offset:0  lds
mf v[132:135],a[120:123],a[52:55]
mf v[132:135],a[80:83],a[20:23]
mf v[136:139],a[80:83],a[24:27]
s_add_u32 m0, s64, 28672
mf v[136:139],a[120:123],a[56:59]
buffer_load_dwordx4 v11, s[40:43], s5 offen offset:0  lds
mf v[140:143],a[120:123],a[60:63]
mf v[140:143],a[80:83],a[28:31]
buffer_load_dwordx4 v[36:39], v6, s[56:59], 0 offen offset:1536
mf v[172:175],a[84:87],a[28:31]
mf v[172:175],a[124:127],a[60:63]
dt a[80:81],v21,8192
mf v[168:171],a[124:127],a[56:59]
mf v[168:171],a[84:87],a[24:27]
dt a[82:83],v21,8704
mf v[164:167],a[84:87],a[20:23]
mf v[164:167],a[124:127],a[52:55]
dt a[120:121],v21,28672
mf v[160:163],a[124:127],a[48:51]
mf v[160:163],a[84:87],a[16:19]
dt a[122:123],v21,29184
mf v[156:159],a[84:87],a[12:15]
s_add_u32 m0, s64, 12288
mf v[156:159],a[124:127],a[44:47]
buffer_load_dwordx4 v12, s[36:39], s71 offen offset:0  lds
mf v[152:155],a[124:127],a[40:43]
mf v[152:155],a[84:87],a[8:11]
mf v[148:151],a[84:87],a[4:7]
s_add_u32 m0, s64, 32768
mf v[148:151],a[124:127],a[36:39]
buffer_load_dwordx4 v12, s[36:39], s5 offen offset:0  lds
mf v[144:147],a[124:127],a[32:35]
mf v[144:147],a[84:87],a[0:3]
mf v[176:179],a[88:91],a[0:3]
mf v[176:179],a[128:131],a[32:35]
dt a[84:85],v22,8192
mf v[180:183],a[128:131],a[36:39]
mf v[180:183],a[88:91],a[4:7]
dt a[86:87],v22,8704
mf v[184:187],a[88:91],a[8:11]
mf v[184:187],a[128:131],a[40:43]
dt a[124:125],v22,28672
mf v[188:191],a[128:131],a[44:47]
mf v[188:191],a[88:91],a[12:15]
dt a[126:127],v22,29184
mf v[192:195],a[88:91],a[16:19]
s_add_u32 m0, s64, 0
mf v[192:195],a[128:131],a[48:51]
buffer_load_dwordx4 v10, s[32:35], s70 offen offset:0  lds
mf v[196:199],a[128:131],a[52:55]
mf v[196:199],a[88:91],a[20:23]
mf v[200:203],a[88:91],a[24:27]
s_add_u32 m0, s64, 20480
mf v[200:203],a[128:131],a[56:59]
buffer_load_dwordx4 v10, s[32:35], s4 offen offset:0  lds
mf v[204:207],a[128:131],a[60:63]
mf v[204:207],a[88:91],a[28:31]
mf v[236:239],a[92:95],a[28:31]
mf v[236:239],a[132:135],a[60:63]
dt a[88:89],v21,12288
mf v[232:235],a[132:135],a[56:59]
mf v[232:235],a[92:95],a[24:27]
dt a[90:91],v21,12800
mf v[228:231],a[92:95],a[20:23]
mf v[228:231],a[132:135],a[52:55]
dt a[128:129],v21,32768
mf v[224:227],a[132:135],a[48:51]
mf v[224:227],a[92:95],a[16:19]
dt a[130:131],v21,33280
mf v[220:223],a[92:95],a[12:15]
s_add_u32 m0, s64, 16384
mf v[220:223],a[132:135],a[44:47]
buffer_load_dwordx4 v12, s[40:43], s71 offen offset:0  lds
mf v[216:219],a[132:135],a[40:43]
mf v[216:219],a[92:95],a[8:11]
mf v[212:215],a[92:95],a[4:7]
s_add_u32 m0, s64, 36864
mf v[212:215],a[132:135],a[36:39]
buffer_load_dwordx4 v12, s[40:43], s5 offen offset:0  lds
mf v[208:211],a[132:135],a[32:35]
mf v[208:211],a[92:95],a[0:3]
s_waitcnt vmcnt(14) lgkmcnt(0)
s_barrier
mf a[144:147],a[64:67],a[0:3]
s_lshl_b32 s69, s68, 7
mf a[144:147],a[104:107],a[32:35]
dt a[92:93],v22,12288
mf a[148:151],a[104:107],a[36:39]
mf a[148:151],a[64:67],a[4:7]
dt a[94:95],v22,12800
mf a[152:155],a[64:67],a[8:11]
mf a[152:155],a[104:107],a[40:43]
dt a[132:133],v22,32768
mf a[156:159],a[104:107],a[44:47]
mf a[156:159],a[64:67],a[12:15]
dt a[134:135],v22,33280
mf a[160:163],a[64:67],a[16:19]
s_add_u32 m0, s65, 0
mf a[160:163],a[104:107],a[48:51]
buffer_load_dwordx4 v8, s[56:59], s69 offen  lds
mf a[164:167],a[104:107],a[52:55]
mf a[164:167],a[64:67],a[20:23]
s_mov_b32 m0, 147456
s_nop 0
buffer_load_dword v15, s[48:51], s89 offen lds
mf a[168:171],a[64:67],a[24:27]
s_add_u32 s89, s89, 0x100000
mf a[168:171],a[104:107],a[56:59]
s_mov_b32 m0, 147456
s_nop 0
buffer_load_dword v15, s[48:51], s89 offen lds
mf a[172:175],a[104:107],a[60:63]
s_add_u32 m0, s65, 1024
s_add_u32 s89, s89, 0x100000
mf a[172:175],a[64:67],a[28:31]
buffer_load_dwordx4 v9, s[56:59], s69 offen  lds
mf a[204:207],a[68:71],a[28:31]
mf a[204:207],a[108:111],a[60:63]
dt a[64:65],v21,0
mf a[200:203],a[108:111],a[56:59]
mf a[200:203],a[68:71],a[24:27]
dt a[66:67],v21,512
mf a[196:199],a[68:71],a[20:23]
mf a[196:199],a[108:111],a[52:55]
dt a[104:105],v21,20480
mf a[192:195],a[108:111],a[48:51]
s_add_u32 s69, s69, 0x8000
mf a[192:195],a[68:71],a[16:19]
dt a[106:107],v21,20992
mf a[188:191],a[68:71],a[12:15]
s_add_u32 m0, s65, 2048
mf a[188:191],a[108:111],a[44:47]
buffer_load_dwordx4 v8, s[56:59], s69 offen  lds
mf a[184:187],a[108:111],a[40:43]
mf a[184:187],a[68:71],a[8:11]
mf a[180:183],a[68:71],a[4:7]
mf a[180:183],a[108:111],a[36:39]
mf a[176:179],a[108:111],a[32:35]
s_add_u32 m0, s65, 3072
mf a[176:179],a[68:71],a[0:3]
buffer_load_dwordx4 v9, s[56:59], s69 offen  lds
mf v[240:243],a[96:99],a[0:3]
mf v[240:243],a[136:139],a[32:35]
dt a[68:69],v22,0
mf v[244:247],a[136:139],a[36:39]
mf v[244:247],a[96:99],a[4:7]
dt a[70:71],v22,512
mf a[208:211],a[96:99],a[8:11]
mf a[208:211],a[136:139],a[40:43]
dt a[108:109],v22,20480
mf a[212:215],a[136:139],a[44:47]
s_add_u32 s69, s69, 0x8000
mf a[212:215],a[96:99],a[12:15]
dt a[110:111],v22,20992
mf a[216:219],a[96:99],a[16:19]
s_add_u32 m0, s65, 4096
mf a[216:219],a[136:139],a[48:51]
buffer_load_dwordx4 v8, s[56:59], s69 offen  lds
mf a[220:223],a[136:139],a[52:55]
mf a[220:223],a[96:99],a[20:23]
mf a[224:227],a[96:99],a[24:27]
mf a[224:227],a[136:139],a[56:59]
mf a[228:231],a[136:139],a[60:63]
s_add_u32 m0, s65, 5120
mf a[228:231],a[96:99],a[28:31]
buffer_load_dwordx4 v9, s[56:59], s69 offen  lds
mf v[248:251],a[100:103],a[0:3]
dq a[0:3],v16,32768
mf v[248:251],a[140:143],a[32:35]
dq a[32:35],v17,32768
mf v[252:255],a[140:143],a[36:39]
dq a[36:39],v17,34816
mf v[252:255],a[100:103],a[4:7]
dq a[4:7],v16,34816
mf a[232:235],a[100:103],a[8:11]
dq a[8:11],v16,36864
mf a[232:235],a[140:143],a[40:43]
dq a[40:43],v17,36864
mf a[236:239],a[140:143],a[44:47]
dq a[44:47],v17,38912
mf a[236:239],a[100:103],a[12:15]
dq a[12:15],v16,38912
mf a[240:243],a[100:103],a[16:19]
dq a[16:19],v16,40960
mf a[240:243],a[140:143],a[48:51]
dq a[48:51],v17,40960
mf a[244:247],a[140:143],a[52:55]
dq a[52:55],v17,43008
mf a[244:247],a[100:103],a[20:23]
dq a[20:23],v16,43008
mf a[248:251],a[100:103],a[24:27]
dq a[24:27],v16,45056
mf a[248:251],a[140:143],a[56:59]
dq a[56:59],v17,45056
mf a[252:255],a[140:143],a[60:63]
s_add_u32 s69, s69, 0x8000
dq a[60:63],v17,47104
mf a[252:255],a[100:103],a[28:31]
s_waitcnt lgkmcnt(13)
dq a[28:31],v16,47104
mf v[48:51],a[72:75],a[0:3]
s_add_u32 m0, s65, 6144
dt a[96:97],v21,16384
mf v[48:51],a[112:115],a[32:35]
s_waitcnt lgkmcnt(13)
dt a[98:99],v21,16896
buffer_load_dwordx4 v8, s[56:59], s69 offen  lds
mf v[52:55],a[112:115],a[36:39]
dt a[136:137],v21,36864
mf v[52:55],a[72:75],a[4:7]
s_waitcnt lgkmcnt(13)
dt a[138:139],v21,37376
mf v[56:59],a[72:75],a[8:11]
dt a[100:101],v22,16384
mf v[56:59],a[112:115],a[40:43]
s_waitcnt lgkmcnt(13)
dt a[102:103],v22,16896
mf v[60:63],a[112:115],a[44:47]
dt a[140:141],v22,36864
mf v[60:63],a[72:75],a[12:15]
s_waitcnt lgkmcnt(13)
dt a[142:143],v22,37376
mf v[64:67],a[72:75],a[16:19]
s_add_u32 m0, s65, 7168
mf v[64:67],a[112:115],a[48:51]
s_waitcnt lgkmcnt(12)
buffer_load_dwordx4 v9, s[56:59], s69 offen  lds
mf v[68:71],a[112:115],a[52:55]
mf v[68:71],a[72:75],a[20:23]
s_waitcnt lgkmcnt(10)
mf v[72:75],a[72:75],a[24:27]
mf v[72:75],a[112:115],a[56:59]
s_waitcnt lgkmcnt(8)
mf v[76:79],a[112:115],a[60:63]
mf v[76:79],a[72:75],a[28:31]
s_waitcnt vmcnt(14) lgkmcnt(0)
s_barrier
v_cmp_eq_u32 vcc, 0, v5
s_nop 0
s_cbranch_vccnz L_tagQ_slow
L_tagQ_back:
mf v[108:111],a[76:79],a[28:31]
v_readlane_b32 s68, v13, 22
v_readfirstlane_b32 s15, v5
mf v[108:111],a[116:119],a[60:63]
dt a[72:73],v18,4096
v_and_b32 v5, -4, v5
mf v[104:107],a[116:119],a[56:59]
s_mul_i32 s70, s68, 393216
v_lshlrev_b32 v6, 16, v24
v_and_b32 v7, 0xffff0000, v24
mf v[104:107],a[76:79],a[24:27]
s_mul_i32 s71, s68, 458752
dt a[74:75],v18,4608
v_mov_b32 v40, v6
mf v[100:103],a[76:79],a[20:23]
s_add_u32 s5, s71, 229376
v_mov_b32 v41, v7
v_lshlrev_b32 v6, 16, v25
mf v[100:103],a[116:119],a[52:55]
s_add_u32 s4, s70, 196608
dt a[112:113],v18,24576
v_and_b32 v7, 0xffff0000, v25
mf v[96:99],a[116:119],a[48:51]
v_add_f32 v40, v40, v6
v_add_f32 v41, v41, v7
mf v[96:99],a[76:79],a[16:19]
dt a[114:115],v18,25088
v_lshlrev_b32 v6, 16, v26
mf v[92:95],a[76:79],a[12:15]
s_add_u32 m0, s64, 45056
v_and_b32 v7, 0xffff0000, v26
v_add_f32 v40, v40, v6
mf v[92:95],a[116:119],a[44:47]
buffer_load_dwordx4 v11, s[36:39], s71 offen offset:0  lds
mf v[88:91],a[116:119],a[40:43]
v_add_f32 v41, v41, v7
v_lshlrev_b32 v6, 16, v27
mf v[88:91],a[76:79],a[8:11]
v_and_b32 v7, 0xffff0000, v27
v_add_f32 v40, v40, v6
mf v[84:87],a[76:79],a[4:7]
s_add_u32 m0, s64, 65536
v_add_f32 v41, v41, v7
v_lshlrev_b32 v6, 16, v28
mf v[84:87],a[116:119],a[36:39]
buffer_load_dwordx4 v11, s[36:39], s5 offen offset:0  lds
mf v[80:83],a[116:119],a[32:35]
v_and_b32 v7, 0xffff0000, v28
v_add_f32 v40, v40, v6
mf v[80:83],a[76:79],a[0:3]
v_add_f32 v41, v41, v7
v_lshlrev_b32 v6, 16, v29
mf v[112:115],a[80:83],a[0:3]
v_and_b32 v7, 0xffff0000, v29
v_add_f32 v40, v40, v6
mf v[112:115],a[120:123],a[32:35]
dt a[76:77],v19,4096
v_add_f32 v41, v41, v7
mf v[116:119],a[120:123],a[36:39]
v_lshlrev_b32 v6, 16, v30
v_and_b32 v7, 0xffff0000, v30
mf v[116:119],a[80:83],a[4:7]
dt a[78:79],v19,4608
v_add_f32 v40, v40, v6
mf v[120:123],a[80:83],a[8:11]
v_add_f32 v41, v41, v7
v_lshlrev_b32 v6, 16, v31
mf v[120:123],a[120:123],a[40:43]
dt a[116:117],v19,24576
v_and_b32 v7, 0xffff0000, v31
mf v[124:127],a[120:123],a[44:47]
v_add_f32 v40, v40, v6
v_add_f32 v41, v41, v7
mf v[124:127],a[80:83],a[12:15]
dt a[118:119],v19,25088
v_lshlrev_b32 v6, 16, v32
mf v[128:131],a[80:83],a[16:19]
s_add_u32 m0, s64, 49152
v_and_b32 v7, 0xffff0000, v32
v_add_f32 v40, v40, v6
mf v[128:131],a[120:123],a[48:51]
buffer_load_dwordx4 v11, s[40:43], s71 offen offset:0  lds
mf v[132:135],a[120:123],a[52:55]
v_add_f32 v41, v41, v7
v_lshlrev_b32 v6, 16, v33
mf v[132:135],a[80:83],a[20:23]
v_and_b32 v7, 0xffff0000, v33
v_add_f32 v40, v40, v6
mf v[136:139],a[80:83],a[24:27]
s_add_u32 m0, s64, 69632
v_add_f32 v41, v41, v7
v_lshlrev_b32 v6, 16, v34
mf v[136:139],a[120:123],a[56:59]
buffer_load_dwordx4 v11, s[40:43], s5 offen offset:0  lds
mf v[140:143],a[120:123],a[60:63]
v_and_b32 v7, 0xffff0000, v34
v_add_f32 v40, v40, v6
mf v[140:143],a[80:83],a[28:31]
v_add_f32 v41, v41, v7
v_lshlrev_b32 v6, 16, v35
mf v[172:175],a[84:87],a[28:31]
v_and_b32 v7, 0xffff0000, v35
v_add_f32 v40, v40, v6
mf v[172:175],a[124:127],a[60:63]
dt a[80:81],v18,8192
v_add_f32 v41, v41, v7
mf v[168:171],a[124:127],a[56:59]
v_lshlrev_b32 v6, 16, v36
v_and_b32 v7, 0xffff0000, v36
mf v[168:171],a[84:87],a[24:27]
dt a[82:83],v18,8704
v_add_f32 v40, v40, v6
mf v[164:167],a[84:87],a[20:23]
v_add_f32 v41, v41, v7
v_lshlrev_b32 v6, 16, v37
mf v[164:167],a[124:127],a[52:55]
dt a[120:121],v18,28672
v_and_b32 v7, 0xffff0000, v37
mf v[160:163],a[124:127],a[48:51]
v_add_f32 v40, v40, v6
v_add_f32 v41, v41, v7
mf v[160:163],a[84:87],a[16:19]
dt a[122:123],v18,29184
v_lshlrev_b32 v6, 16, v38
mf v[156:159],a[84:87],a[12:15]
s_add_u32 m0, s64, 53248
v_and_b32 v7, 0xffff0000, v38
v_add_f32 v40, v40, v6
mf v[156:159],a[124:127],a[44:47]
buffer_load_dwordx4 v12, s[36:39], s71 offen offset:0  lds
mf v[152:155],a[124:127],a[40:43]
L_iw1Q_3:
L_stub13:
s_cbranch_execz L_stub17
v_add_f32 v41, v41, v7
v_lshlrev_b32 v6, 16, v39
mf v[152:155],a[84:87],a[8:11]
v_and_b32 v7, 0xffff0000, v39
v_add_f32 v40, v40, v6
mf v[148:151],a[84:87],a[4:7]
s_add_u32 m0, s64, 73728
v_add_f32 v41, v41, v7
v_add_f32 v40, v40, v41
mf v[148:151],a[124:127],a[36:39]
buffer_load_dwordx4 v12, s[36:39], s5 offen offset:0  lds
mf v[144:147],a[124:127],a[32:35]
v_add_f32_dpp v40, v40, v40 quad_perm:[1,0,3,2] row_mask:0xf bank_mask:0xf
mf v[144:147],a[84:87],a[0:3]
mf v[176:179],a[88:91],a[0:3]
v_add_f32_dpp v40, v40, v40 quad_perm:[2,3,0,1] row_mask:0xf bank_mask:0xf
mf v[176:179],a[128:131],a[32:35]
dt a[84:85],v19,8192
v_add_f32_dpp v40, v40, v40 row_half_mirror row_mask:0xf bank_mask:0xf
mf v[180:183],a[128:131],a[36:39]
mf v[180:183],a[88:91],a[4:7]
dt a[86:87],v19,8704
v_add_f32_dpp v40, v40, v40 row_mirror row_mask:0xf bank_mask:0xf
mf v[184:187],a[88:91],a[8:11]
v_mov_b32 v41, v40
mf v[184:187],a[128:131],a[40:43]
dt a[124:125],v19,28672
v_permlane16_swap_b32 v41, v40
mf v[188:191],a[128:131],a[44:47]
mf v[188:191],a[88:91],a[12:15]
dt a[126:127],v19,29184
v_add_f32 v40, v40, v41
mf v[192:195],a[88:91],a[16:19]
s_add_u32 m0, s64, 40960
v_mul_f32 v40, 0x3a800000, v40
v_lshlrev_b32 v6, 16, v24
mf v[192:195],a[128:131],a[48:51]
buffer_load_dwordx4 v10, s[32:35], s70 offen offset:0  lds
mf v[196:199],a[128:131],a[52:55]
v_and_b32 v7, 0xffff0000, v24
v_sub_f32 v6, v6, v40
mf v[196:199],a[88:91],a[20:23]
v_sub_f32 v7, v7, v40
v_mul_f32 v42, v6, v6
mf v[200:203],a[88:91],a[24:27]
s_add_u32 m0, s64, 61440
v_mul_f32 v43, v7, v7
v_lshlrev_b32 v6, 16, v25
mf v[200:203],a[128:131],a[56:59]
buffer_load_dwordx4 v10, s[32:35], s4 offen offset:0  lds
mf v[204:207],a[128:131],a[60:63]
v_and_b32 v7, 0xffff0000, v25
v_sub_f32 v6, v6, v40
mf v[204:207],a[88:91],a[28:31]
v_sub_f32 v7, v7, v40
v_fmac_f32 v42, v6, v6
mf v[236:239],a[92:95],a[28:31]
v_fmac_f32 v43, v7, v7
v_lshlrev_b32 v6, 16, v26
mf v[236:239],a[132:135],a[60:63]
dt a[88:89],v18,12288
v_and_b32 v7, 0xffff0000, v26
mf v[232:235],a[132:135],a[56:59]
v_sub_f32 v6, v6, v40
v_sub_f32 v7, v7, v40
mf v[232:235],a[92:95],a[24:27]
dt a[90:91],v18,12800
v_fmac_f32 v42, v6, v6
mf v[228:231],a[92:95],a[20:23]
v_fmac_f32 v43, v7, v7
v_lshlrev_b32 v6, 16, v27
mf v[228:231],a[132:135],a[52:55]
dt a[128:129],v18,32768
v_and_b32 v7, 0xffff0000, v27
mf v[224:227],a[132:135],a[48:51]
v_sub_f32 v6, v6, v40
v_sub_f32 v7, v7, v40
mf v[224:227],a[92:95],a[16:19]
dt a[130:131],v18,33280
v_fmac_f32 v42, v6, v6
mf v[220:223],a[92:95],a[12:15]
s_add_u32 m0, s64, 57344
v_fmac_f32 v43, v7, v7
v_lshlrev_b32 v6, 16, v28
mf v[220:223],a[132:135],a[44:47]
buffer_load_dwordx4 v12, s[40:43], s71 offen offset:0  lds
mf v[216:219],a[132:135],a[40:43]
v_and_b32 v7, 0xffff0000, v28
v_sub_f32 v6, v6, v40
mf v[216:219],a[92:95],a[8:11]
v_sub_f32 v7, v7, v40
v_fmac_f32 v42, v6, v6
mf v[212:215],a[92:95],a[4:7]
s_add_u32 m0, s64, 77824
v_fmac_f32 v43, v7, v7
v_lshlrev_b32 v6, 16, v29
mf v[212:215],a[132:135],a[36:39]
buffer_load_dwordx4 v12, s[40:43], s5 offen offset:0  lds
mf v[208:211],a[132:135],a[32:35]
v_and_b32 v7, 0xffff0000, v29
v_sub_f32 v6, v6, v40
mf v[208:211],a[92:95],a[0:3]
s_waitcnt vmcnt(10) lgkmcnt(0)
s_barrier
mf a[144:147],a[64:67],a[0:3]
s_lshl_b32 s69, s68, 7
v_sub_f32 v7, v7, v40
v_fmac_f32 v42, v6, v6
mf a[144:147],a[104:107],a[32:35]
dt a[92:93],v19,12288
v_fmac_f32 v43, v7, v7
mf a[148:151],a[104:107],a[36:39]
v_lshlrev_b32 v6, 16, v30
v_and_b32 v7, 0xffff0000, v30
mf a[148:151],a[64:67],a[4:7]
dt a[94:95],v19,12800
v_sub_f32 v6, v6, v40
mf a[152:155],a[64:67],a[8:11]
v_sub_f32 v7, v7, v40
v_fmac_f32 v42, v6, v6
mf a[152:155],a[104:107],a[40:43]
dt a[132:133],v19,32768
v_fmac_f32 v43, v7, v7
mf a[156:159],a[104:107],a[44:47]
v_lshlrev_b32 v6, 16, v31
v_and_b32 v7, 0xffff0000, v31
mf a[156:159],a[64:67],a[12:15]
dt a[134:135],v19,33280
v_sub_f32 v6, v6, v40
mf a[160:163],a[64:67],a[16:19]
s_add_u32 m0, s65, 32768
v_sub_f32 v7, v7, v40
v_fmac_f32 v42, v6, v6
mf a[160:163],a[104:107],a[48:51]
buffer_load_dwordx4 v8, s[56:59], s69 offen  lds
mf a[164:167],a[104:107],a[52:55]
v_fmac_f32 v43, v7, v7
v_lshlrev_b32 v6, 16, v32
mf a[164:167],a[64:67],a[20:23]
v_and_b32 v7, 0xffff0000, v32
v_sub_f32 v6, v6, v40
mf a[168:171],a[64:67],a[24:27]
v_sub_f32 v7, v7, v40
v_fmac_f32 v42, v6, v6
mf a[168:171],a[104:107],a[56:59]
v_fmac_f32 v43, v7, v7
v_lshlrev_b32 v6, 16, v33
mf a[172:175],a[104:107],a[60:63]
s_add_u32 m0, s65, 33792
v_and_b32 v7, 0xffff0000, v33
v_sub_f32 v6, v6, v40
mf a[172:175],a[64:67],a[28:31]
buffer_load_dwordx4 v9, s[56:59], s69 offen  lds
mf a[204:207],a[68:71],a[28:31]
v_sub_f32 v7, v7, v40
v_fmac_f32 v42, v6, v6
mf a[204:207],a[108:111],a[60:63]
dt a[64:65],v18,0
v_fmac_f32 v43, v7, v7
mf a[200:203],a[108:111],a[56:59]
v_lshlrev_b32 v6, 16, v34
v_and_b32 v7, 0xffff0000, v34
mf a[200:203],a[68:71],a[24:27]
dt a[66:67],v18,512
v_sub_f32 v6, v6, v40
mf a[196:199],a[68:71],a[20:23]
v_sub_f32 v7, v7, v40
v_fmac_f32 v42, v6, v6
mf a[196:199],a[108:111],a[52:55]
dt a[104:105],v18,20480
v_fmac_f32 v43, v7, v7
mf a[192:195],a[108:111],a[48:51]
s_add_u32 s69, s69, 0x8000
v_lshlrev_b32 v6, 16, v35
v_and_b32 v7, 0xffff0000, v35
mf a[192:195],a[68:71],a[16:19]
dt a[106:107],v18,20992
v_sub_f32 v6, v6, v40
mf a[188:191],a[68:71],a[12:15]
s_add_u32 m0, s65, 34816
v_sub_f32 v7, v7, v40
v_fmac_f32 v42, v6, v6
mf a[188:191],a[108:111],a[44:47]
buffer_load_dwordx4 v8, s[56:59], s69 offen  lds
mf a[184:187],a[108:111],a[40:43]
v_fmac_f32 v43, v7, v7
v_lshlrev_b32 v6, 16, v36
mf a[184:187],a[68:71],a[8:11]
v_and_b32 v7, 0xffff0000, v36
v_sub_f32 v6, v6, v40
mf a[180:183],a[68:71],a[4:7]
v_sub_f32 v7, v7, v40
v_fmac_f32 v42, v6, v6
mf a[180:183],a[108:111],a[36:39]
v_fmac_f32 v43, v7, v7
v_lshlrev_b32 v6, 16, v37
mf a[176:179],a[108:111],a[32:35]
s_add_u32 m0, s65, 35840
v_and_b32 v7, 0xffff0000, v37
v_sub_f32 v6, v6, v40
mf a[176:179],a[68:71],a[0:3]
buffer_load_dwordx4 v9, s[56:59], s69 offen  lds
mf v[240:243],a[96:99],a[0:3]
v_sub_f32 v7, v7, v40
v_fmac_f32 v42, v6, v6
mf v[240:243],a[136:139],a[32:35]
dt a[68:69],v19,0
v_fmac_f32 v43, v7, v7
mf v[244:247],a[136:139],a[36:39]
v_lshlrev_b32 v6, 16, v38
v_and_b32 v7, 0xffff0000, v38
mf v[244:247],a[96:99],a[4:7]
dt a[70:71],v19,512
v_sub_f32 v6, v6, v40
mf a[208:211],a[96:99],a[8:11]
v_sub_f32 v7, v7, v40
v_fmac_f32 v42, v6, v6
mf a[208:211],a[136:139],a[40:43]
dt a[108:109],v19,20480
v_fmac_f32 v43, v7, v7
mf a[212:215],a[136:139],a[44:47]
s_add_u32 s69, s69, 0x8000
v_lshlrev_b32 v6, 16, v39
v_and_b32 v7, 0xffff0000, v39
mf a[212:215],a[96:99],a[12:15]
dt a[110:111],v19,20992
v_sub_f32 v6, v6, v40
mf a[216:219],a[96:99],a[16:19]
s_add_u32 m0, s65, 36864
v_sub_f32 v7, v7, v40
v_fmac_f32 v42, v6, v6
mf a[216:219],a[136:139],a[48:51]
buffer_load_dwordx4 v8, s[56:59], s69 offen  lds
mf a[220:223],a[136:139],a[52:55]
v_fmac_f32 v43, v7, v7
v_add_f32 v42, v42, v43
mf a[220:223],a[96:99],a[20:23]
mf a[224:227],a[96:99],a[24:27]
v_add_f32_dpp v42, v42, v42 quad_perm:[1,0,3,2] row_mask:0xf bank_mask:0xf
mf a[224:227],a[136:139],a[56:59]
mf a[228:231],a[136:139],a[60:63]
s_add_u32 m0, s65, 37888
v_add_f32_dpp v42, v42, v42 quad_perm:[2,3,0,1] row_mask:0xf bank_mask:0xf
mf a[228:231],a[96:99],a[28:31]
buffer_load_dwordx4 v9, s[56:59], s69 offen  lds
mf v[248:251],a[100:103],a[0:3]
dq a[0:3],v16,0
v_add_f32_dpp v42, v42, v42 row_half_mirror row_mask:0xf bank_mask:0xf
mf v[248:251],a[140:143],a[32:35]
dq a[32:35],v17,0
v_add_f32_dpp v42, v42, v42 row_mirror row_mask:0xf bank_mask:0xf
mf v[252:255],a[140:143],a[36:39]
dq a[36:39],v17,2048
v_mov_b32 v43, v42
mf v[252:255],a[100:103],a[4:7]
dq a[4:7],v16,2048
v_permlane16_swap_b32 v43, v42
mf a[232:235],a[100:103],a[8:11]
dq a[8:11],v16,4096
v_add_f32 v42, v42, v43
mf a[232:235],a[140:143],a[40:43]
dq a[40:43],v17,4096
v_mul_f32 v42, 0x3a800000, v42
mf a[236:239],a[140:143],a[44:47]
dq a[44:47],v17,6144
v_cvt_pk_bf16_f32 v40, v40, v40
mf a[236:239],a[100:103],a[12:15]
dq a[12:15],v16,6144
v_lshlrev_b32 v40, 16, v40
mf a[240:243],a[100:103],a[16:19]
dq a[16:19],v16,8192
v_cvt_pk_bf16_f32 v42, v42, v42
mf a[240:243],a[140:143],a[48:51]
dq a[48:51],v17,8192
v_lshlrev_b32 v42, 16, v42
mf a[244:247],a[140:143],a[52:55]
dq a[52:55],v17,10240
v_add_f32 v42, 0x3727c5ac, v42
mf a[244:247],a[100:103],a[20:23]
dq a[20:23],v16,10240
v_cvt_pk_bf16_f32 v42, v42, v42
mf a[248:251],a[100:103],a[24:27]
dq a[24:27],v16,12288
v_lshlrev_b32 v42, 16, v42
mf a[248:251],a[140:143],a[56:59]
dq a[56:59],v17,12288
mf a[252:255],a[140:143],a[60:63]
s_add_u32 s69, s69, 0x8000
dq a[60:63],v17,14336
mf a[252:255],a[100:103],a[28:31]
s_waitcnt lgkmcnt(13)
dq a[28:31],v16,14336
mf v[48:51],a[72:75],a[0:3]
s_add_u32 m0, s65, 38912
dt a[96:97],v18,16384
mf v[48:51],a[112:115],a[32:35]
s_waitcnt lgkmcnt(13)
dt a[98:99],v18,16896
buffer_load_dwordx4 v8, s[56:59], s69 offen  lds
mf v[52:55],a[112:115],a[36:39]
dt a[136:137],v18,36864
mf v[52:55],a[72:75],a[4:7]
s_waitcnt lgkmcnt(13)
dt a[138:139],v18,37376
mf v[56:59],a[72:75],a[8:11]
dt a[100:101],v19,16384
mf v[56:59],a[112:115],a[40:43]
s_waitcnt lgkmcnt(13)
dt a[102:103],v19,16896
mf v[60:63],a[112:115],a[44:47]
dt a[140:141],v19,36864
mf v[60:63],a[72:75],a[12:15]
s_waitcnt lgkmcnt(13)
dt a[142:143],v19,37376
mf v[64:67],a[72:75],a[16:19]
s_add_u32 m0, s65, 39936
v_sqrt_f32 v42, v42
mf v[64:67],a[112:115],a[48:51]
s_waitcnt lgkmcnt(12)
buffer_load_dwordx4 v9, s[56:59], s69 offen  lds
mf v[68:71],a[112:115],a[52:55]
v_cvt_pk_bf16_f32 v42, v42, v42
v_lshlrev_b32 v42, 16, v42
mf v[68:71],a[72:75],a[20:23]
s_waitcnt lgkmcnt(10)
v_rcp_f32 v6, v42
mf v[72:75],a[72:75],a[24:27]
v_sub_f32 v44, 0, v40
v_mul_f32 v47, v42, v42
mf v[72:75],a[112:115],a[56:59]
s_waitcnt lgkmcnt(8)
v_mul_f32 v45, 0xc0135761, v6
v_mul_f32 v46, v6, v6
mf v[76:79],a[112:115],a[60:63]
v_mul_f32 v46, v46, v6
v_mul_f32 v46, 0xbdd2d3e8, v46
mf v[76:79],a[72:75],a[28:31]
s_waitcnt vmcnt(12) lgkmcnt(0)
s_barrier
mf v[108:111],a[76:79],a[28:31]
s_lshl_b32 s82, s23, 3
v_readlane_b32 s68, v13, 24
s_lshl_b32 s83, s20, 1
mf v[108:111],a[116:119],a[60:63]
s_add_u32 s82, s82, s83
dt a[72:73],v21,4096
s_mul_i32 s3, s24, 6144
mf v[104:107],a[116:119],a[56:59]
s_mul_i32 s70, s68, 393216
s_add_u32 s3, s3, 23592960
s_lshl_b32 s83, s82, 4
mf v[104:107],a[76:79],a[24:27]
s_mul_i32 s71, s68, 458752
dt a[74:75],v21,4608
s_add_u32 s83, s83, s3
mf v[100:103],a[76:79],a[20:23]
s_add_u32 s5, s71, 229376
s_lshl_b32 s82, s82, 2
s_add_u32 s82, s82, s3
mf v[100:103],a[116:119],a[52:55]
s_add_u32 s4, s70, 196608
dt a[112:113],v21,24576
s_add_u32 s82, s82, 4096
mf v[96:99],a[116:119],a[48:51]
v_and_b32 v40, 31, v2
v_lshlrev_b32 v40, 26, v40
mf v[96:99],a[76:79],a[16:19]
dt a[114:115],v21,25088
v_lshrrev_b32 v7, 1, v2
mf v[92:95],a[76:79],a[12:15]
s_add_u32 m0, s64, 4096
v_or_b32 v7, v7, v40
v_lshrrev_b32 v42, 3, v2
mf v[92:95],a[116:119],a[44:47]
buffer_load_dwordx4 v11, s[36:39], s71 offen offset:0  lds
mf v[88:91],a[116:119],a[40:43]
v_or_b32 v42, v42, v40
mf v[88:91],a[76:79],a[8:11]
buffer_store_dwordx4 v[44:47], v7, s[28:31], s83 offen sc1
mf v[84:87],a[76:79],a[4:7]
s_add_u32 m0, s64, 24576
mf v[84:87],a[116:119],a[36:39]
buffer_load_dwordx4 v11, s[36:39], s5 offen offset:0  lds
mf v[80:83],a[116:119],a[32:35]
mf v[80:83],a[76:79],a[0:3]
buffer_store_dword v44, v42, s[28:31], s82 offen sc1
mf v[112:115],a[80:83],a[0:3]
mf v[112:115],a[120:123],a[32:35]
dt a[76:77],v22,4096
buffer_store_dword v6, v42, s[28:31], s82 offen offset:1024 sc1
mf v[116:119],a[120:123],a[36:39]
mf v[116:119],a[80:83],a[4:7]
dt a[78:79],v22,4608
mf v[120:123],a[80:83],a[8:11]
mf v[120:123],a[120:123],a[40:43]
dt a[116:117],v22,24576
mf v[124:127],a[120:123],a[44:47]
mf v[124:127],a[80:83],a[12:15]
dt a[118:119],v22,25088
mf v[128:131],a[80:83],a[16:19]
s_add_u32 m0, s64, 8192
mf v[128:131],a[120:123],a[48:51]
buffer_load_dwordx4 v11, s[40:43], s71 offen offset:0  lds
mf v[132:135],a[120:123],a[52:55]
mf v[132:135],a[80:83],a[20:23]
mf v[136:139],a[80:83],a[24:27]
s_add_u32 m0, s64, 28672
mf v[136:139],a[120:123],a[56:59]
buffer_load_dwordx4 v11, s[40:43], s5 offen offset:0  lds
mf v[140:143],a[120:123],a[60:63]
mf v[140:143],a[80:83],a[28:31]
mf v[172:175],a[84:87],a[28:31]
mf v[172:175],a[124:127],a[60:63]
dt a[80:81],v21,8192
mf v[168:171],a[124:127],a[56:59]
mf v[168:171],a[84:87],a[24:27]
dt a[82:83],v21,8704
mf v[164:167],a[84:87],a[20:23]
mf v[164:167],a[124:127],a[52:55]
dt a[120:121],v21,28672
mf v[160:163],a[124:127],a[48:51]
mf v[160:163],a[84:87],a[16:19]
dt a[122:123],v21,29184
mf v[156:159],a[84:87],a[12:15]
s_add_u32 m0, s64, 12288
mf v[156:159],a[124:127],a[44:47]
buffer_load_dwordx4 v12, s[36:39], s71 offen offset:0  lds
mf v[152:155],a[124:127],a[40:43]
mf v[152:155],a[84:87],a[8:11]
mf v[148:151],a[84:87],a[4:7]
s_add_u32 m0, s64, 32768
mf v[148:151],a[124:127],a[36:39]
buffer_load_dwordx4 v12, s[36:39], s5 offen offset:0  lds
mf v[144:147],a[124:127],a[32:35]
mf v[144:147],a[84:87],a[0:3]
mf v[176:179],a[88:91],a[0:3]
mf v[176:179],a[128:131],a[32:35]
dt a[84:85],v22,8192
mf v[180:183],a[128:131],a[36:39]
mf v[180:183],a[88:91],a[4:7]
dt a[86:87],v22,8704
mf v[184:187],a[88:91],a[8:11]
mf v[184:187],a[128:131],a[40:43]
dt a[124:125],v22,28672
mf v[188:191],a[128:131],a[44:47]
mf v[188:191],a[88:91],a[12:15]
dt a[126:127],v22,29184
mf v[192:195],a[88:91],a[16:19]
s_add_u32 m0, s64, 0
mf v[192:195],a[128:131],a[48:51]
buffer_load_dwordx4 v10, s[32:35], s70 offen offset:0  lds
mf v[196:199],a[128:131],a[52:55]
mf v[196:199],a[88:91],a[20:23]
mf v[200:203],a[88:91],a[24:27]
s_add_u32 m0, s64, 20480
mf v[200:203],a[128:131],a[56:59]
buffer_load_dwordx4 v10, s[32:35], s4 offen offset:0  lds
mf v[204:207],a[128:131],a[60:63]
mf v[204:207],a[88:91],a[28:31]
mf v[236:239],a[92:95],a[28:31]
mf v[236:239],a[132:135],a[60:63]
dt a[88:89],v21,12288
mf v[232:235],a[132:135],a[56:59]
mf v[232:235],a[92:95],a[24:27]
dt a[90:91],v21,12800
mf v[228:231],a[92:95],a[20:23]
mf v[228:231],a[132:135],a[52:55]
dt a[128:129],v21,32768
mf v[224:227],a[132:135],a[48:51]
mf v[224:227],a[92:95],a[16:19]
dt a[130:131],v21,33280
mf v[220:223],a[92:95],a[12:15]
s_add_u32 m0, s64, 16384
mf v[220:223],a[132:135],a[44:47]
buffer_load_dwordx4 v12, s[40:43], s71 offen offset:0  lds
mf v[216:219],a[132:135],a[40:43]
mf v[216:219],a[92:95],a[8:11]
mf v[212:215],a[92:95],a[4:7]
s_add_u32 m0, s64, 36864
mf v[212:215],a[132:135],a[36:39]
buffer_load_dwordx4 v12, s[40:43], s5 offen offset:0  lds
mf v[208:211],a[132:135],a[32:35]
mf v[208:211],a[92:95],a[0:3]
s_waitcnt vmcnt(13) lgkmcnt(0)
s_barrier
mf a[144:147],a[64:67],a[0:3]
s_lshl_b32 s69, s68, 7
s_lshl_b32 s3, s78, 11
v_lshrrev_b32 v6, 2, v2
mf a[144:147],a[104:107],a[32:35]
dt a[92:93],v22,12288
v_lshl_add_u32 v6, v6, 7, s3
mf a[148:151],a[104:107],a[36:39]
mf a[148:151],a[64:67],a[4:7]
dt a[94:95],v22,12800
mf a[152:155],a[64:67],a[8:11]
mf a[152:155],a[104:107],a[40:43]
dt a[132:133],v22,32768
mf a[156:159],a[104:107],a[44:47]
mf a[156:159],a[64:67],a[12:15]
dt a[134:135],v22,33280
mf a[160:163],a[64:67],a[16:19]
s_add_u32 m0, s65, 0
mf a[160:163],a[104:107],a[48:51]
buffer_load_dwordx4 v8, s[56:59], s69 offen  lds
mf a[164:167],a[104:107],a[52:55]
mf a[164:167],a[64:67],a[20:23]
s_mov_b32 m0, 147456
s_nop 0
buffer_load_dword v6, s[52:55], 0 offen lds
mf a[168:171],a[64:67],a[24:27]
mf a[168:171],a[104:107],a[56:59]
s_mov_b32 m0, 147456
s_nop 0
buffer_load_dword v15, s[48:51], s89 offen lds
mf a[172:175],a[104:107],a[60:63]
s_add_u32 m0, s65, 1024
s_add_u32 s89, s89, 0x100000
mf a[172:175],a[64:67],a[28:31]
buffer_load_dwordx4 v9, s[56:59], s69 offen  lds
mf a[204:207],a[68:71],a[28:31]
mf a[204:207],a[108:111],a[60:63]
dt a[64:65],v21,0
mf a[200:203],a[108:111],a[56:59]
mf a[200:203],a[68:71],a[24:27]
dt a[66:67],v21,512
mf a[196:199],a[68:71],a[20:23]
mf a[196:199],a[108:111],a[52:55]
dt a[104:105],v21,20480
mf a[192:195],a[108:111],a[48:51]
s_add_u32 s69, s69, 0x8000
mf a[192:195],a[68:71],a[16:19]
dt a[106:107],v21,20992
mf a[188:191],a[68:71],a[12:15]
s_add_u32 m0, s65, 2048
mf a[188:191],a[108:111],a[44:47]
buffer_load_dwordx4 v8, s[56:59], s69 offen  lds
mf a[184:187],a[108:111],a[40:43]
mf a[184:187],a[68:71],a[8:11]
s_mov_b32 m0, 147456
s_nop 0
buffer_load_dword v15, s[48:51], s89 offen lds
mf a[180:183],a[68:71],a[4:7]
s_add_u32 s89, s89, 0x100000
mf a[180:183],a[108:111],a[36:39]
mf a[176:179],a[108:111],a[32:35]
s_add_u32 m0, s65, 3072
mf a[176:179],a[68:71],a[0:3]
buffer_load_dwordx4 v9, s[56:59], s69 offen  lds
mf v[240:243],a[96:99],a[0:3]
mf v[240:243],a[136:139],a[32:35]
dt a[68:69],v22,0
mf v[244:247],a[136:139],a[36:39]
mf v[244:247],a[96:99],a[4:7]
dt a[70:71],v22,512
mf a[208:211],a[96:99],a[8:11]
mf a[208:211],a[136:139],a[40:43]
dt a[108:109],v22,20480
mf a[212:215],a[136:139],a[44:47]
s_add_u32 s69, s69, 0x8000
mf a[212:215],a[96:99],a[12:15]
dt a[110:111],v22,20992
mf a[216:219],a[96:99],a[16:19]
s_add_u32 m0, s65, 4096
mf a[216:219],a[136:139],a[48:51]
buffer_load_dwordx4 v8, s[56:59], s69 offen  lds
mf a[220:223],a[136:139],a[52:55]
mf a[220:223],a[96:99],a[20:23]
mf a[224:227],a[96:99],a[24:27]
mf a[224:227],a[136:139],a[56:59]
mf a[228:231],a[136:139],a[60:63]
s_add_u32 m0, s65, 5120
mf a[228:231],a[96:99],a[28:31]
buffer_load_dwordx4 v9, s[56:59], s69 offen  lds
mf v[248:251],a[100:103],a[0:3]
dq a[0:3],v16,32768
mf v[248:251],a[140:143],a[32:35]
dq a[32:35],v17,32768
mf v[252:255],a[140:143],a[36:39]
dq a[36:39],v17,34816
L_stub14:
s_cbranch_execz L_stub18
mf v[252:255],a[100:103],a[4:7]
dq a[4:7],v16,34816
mf a[232:235],a[100:103],a[8:11]
dq a[8:11],v16,36864
mf a[232:235],a[140:143],a[40:43]
dq a[40:43],v17,36864
mf a[236:239],a[140:143],a[44:47]
dq a[44:47],v17,38912
mf a[236:239],a[100:103],a[12:15]
dq a[12:15],v16,38912
mf a[240:243],a[100:103],a[16:19]
dq a[16:19],v16,40960
mf a[240:243],a[140:143],a[48:51]
dq a[48:51],v17,40960
mf a[244:247],a[140:143],a[52:55]
dq a[52:55],v17,43008
mf a[244:247],a[100:103],a[20:23]
dq a[20:23],v16,43008
mf a[248:251],a[100:103],a[24:27]
dq a[24:27],v16,45056
mf a[248:251],a[140:143],a[56:59]
dq a[56:59],v17,45056
mf a[252:255],a[140:143],a[60:63]
s_add_u32 s69, s69, 0x8000
dq a[60:63],v17,47104
mf a[252:255],a[100:103],a[28:31]
s_waitcnt lgkmcnt(13)
dq a[28:31],v16,47104
mf v[48:51],a[72:75],a[0:3]
s_add_u32 m0, s65, 6144
dt a[96:97],v21,16384
mf v[48:51],a[112:115],a[32:35]
s_waitcnt lgkmcnt(13)
dt a[98:99],v21,16896
buffer_load_dwordx4 v8, s[56:59], s69 offen  lds
mf v[52:55],a[112:115],a[36:39]
dt a[136:137],v21,36864
mf v[52:55],a[72:75],a[4:7]
s_waitcnt lgkmcnt(13)
dt a[138:139],v21,37376
mf v[56:59],a[72:75],a[8:11]
dt a[100:101],v22,16384
mf v[56:59],a[112:115],a[40:43]
s_waitcnt lgkmcnt(13)
dt a[102:103],v22,16896
mf v[60:63],a[112:115],a[44:47]
dt a[140:141],v22,36864
mf v[60:63],a[72:75],a[12:15]
s_waitcnt lgkmcnt(13)
dt a[142:143],v22,37376
mf v[64:67],a[72:75],a[16:19]
s_add_u32 m0, s65, 7168
mf v[64:67],a[112:115],a[48:51]
s_waitcnt lgkmcnt(12)
buffer_load_dwordx4 v9, s[56:59], s69 offen  lds
mf v[68:71],a[112:115],a[52:55]
mf v[68:71],a[72:75],a[20:23]
s_waitcnt lgkmcnt(10)
mf v[72:75],a[72:75],a[24:27]
mf v[72:75],a[112:115],a[56:59]
s_waitcnt lgkmcnt(8)
mf v[76:79],a[112:115],a[60:63]
mf v[76:79],a[72:75],a[28:31]
s_waitcnt vmcnt(15) lgkmcnt(0)
s_barrier
mf v[108:111],a[76:79],a[28:31]
s_lshl_b32 s82, s24, 5
v_readlane_b32 s68, v13, 26
s_add_u32 s82, s82, s23
mf v[108:111],a[116:119],a[60:63]
s_lshl_b32 s82, s82, 5
dt a[72:73],v18,4096
s_add_u32 s82, s82, 23642112
mf v[104:107],a[116:119],a[56:59]
s_mul_i32 s70, s68, 393216
v_or_b32 v7, s20, v2
v_lshlrev_b32 v7, 25, v7
mf v[104:107],a[76:79],a[24:27]
s_mul_i32 s71, s68, 458752
dt a[74:75],v18,4608
v_add_u32 v6, 1, v5
mf v[100:103],a[76:79],a[20:23]
s_add_u32 s5, s71, 229376
mf v[100:103],a[116:119],a[52:55]
s_add_u32 s4, s70, 196608
dt a[112:113],v18,24576
buffer_store_dword v6, v7, s[28:31], s82 offen sc1
mf v[96:99],a[116:119],a[48:51]
s_and_b32 s83, s23, 3
s_xor_b32 s83, s83, 1
s_mov_b32 s82, s24
mf v[96:99],a[76:79],a[16:19]
s_and_b32 s3, s2, 7
dt a[114:115],v18,25088
s_and_b32 s75, s3, 1
mf v[92:95],a[76:79],a[12:15]
s_add_u32 m0, s64, 45056
s_bfe_u32 s74, s3, 0x10001
s_lshl_b32 s74, s74, 2
mf v[92:95],a[116:119],a[44:47]
s_add_u32 s74, s74, s83
buffer_load_dwordx4 v11, s[36:39], s71 offen offset:0  lds
s_lshr_b32 s73, s3, 2
mf v[88:91],a[116:119],a[40:43]
s_lshl_b32 s73, s73, 3
s_add_u32 s73, s73, s82
s_add_u32 s72, s83, s82
mf v[88:91],a[76:79],a[8:11]
s_lshr_b32 s15, s15, 1
s_xor_b32 s15, s15, s2
s_xor_b32 s15, s15, 0
mf v[84:87],a[76:79],a[4:7]
s_add_u32 m0, s64, 65536
s_and_b32 s15, s15, 1
s_lshl_b32 s15, s15, 2
mf v[84:87],a[116:119],a[36:39]
s_sub_u32 s17, 13, s15
buffer_load_dwordx4 v11, s[36:39], s5 offen offset:0  lds
mf v[80:83],a[116:119],a[32:35]
v_subrev_u32 v47, 20, v2
v_cmp_gt_u32 vcc, 10, v47
mf v[80:83],a[76:79],a[0:3]
v_subrev_u32 v47, s15, v2
mf v[112:115],a[80:83],a[0:3]
v_cndmask_b32 v47, v2, v47, vcc
v_subrev_u32 v6, s72, v47
mf v[112:115],a[120:123],a[32:35]
dt a[76:77],v19,4096
v_add_u32 v6, 1, v6
mf v[116:119],a[120:123],a[36:39]
v_and_b32 v6, 3, v6
v_cmp_ge_u32 vcc, 1, v6
mf v[116:119],a[80:83],a[4:7]
dt a[78:79],v19,4608
v_mov_b32 v45, -1
mf v[120:123],a[80:83],a[8:11]
v_mov_b32 v46, 1
v_cndmask_b32 v7, 0, v45, vcc
mf v[120:123],a[120:123],a[40:43]
dt a[116:117],v19,24576
v_cmp_eq_u32 vcc, 0, v6
mf v[124:127],a[120:123],a[44:47]
v_sub_u32 v6, v47, v6
v_mov_b32 v45, 0
mf v[124:127],a[80:83],a[12:15]
dt a[118:119],v19,25088
v_cndmask_b32 v7, v7, v46, vcc
mf v[128:131],a[80:83],a[16:19]
s_add_u32 m0, s64, 49152
v_subrev_u32 v46, 4, v6
v_cmp_gt_u32 vcc, 11, v46
mf v[128:131],a[120:123],a[48:51]
buffer_load_dwordx4 v11, s[40:43], s71 offen offset:0  lds
mf v[132:135],a[120:123],a[52:55]
v_cndmask_b32 v45, v45, v7, vcc
v_subrev_u32 v46, 16, v6
mf v[132:135],a[80:83],a[20:23]
v_cmp_gt_u32 vcc, s17, v46
mf v[136:139],a[80:83],a[24:27]
s_add_u32 m0, s64, 69632
v_cndmask_b32 v45, v45, v7, vcc
v_subrev_u32 v46, 30, v6
mf v[136:139],a[120:123],a[56:59]
buffer_load_dwordx4 v11, s[40:43], s5 offen offset:0  lds
mf v[140:143],a[120:123],a[60:63]
v_cmp_gt_u32 vcc, 15, v46
mf v[140:143],a[80:83],a[28:31]
mf v[172:175],a[84:87],a[28:31]
v_cndmask_b32 v45, v45, v7, vcc
v_add_u32 v6, s72, v47
mf v[172:175],a[124:127],a[60:63]
dt a[80:81],v18,8192
v_and_b32 v6, 3, v6
mf v[168:171],a[124:127],a[56:59]
v_and_b32 v7, 60, v47
v_or_b32 v6, v6, v7
mf v[168:171],a[84:87],a[24:27]
dt a[82:83],v18,8704
v_add_u32 v24, v47, v45
mf v[164:167],a[84:87],a[20:23]
v_cmp_eq_u32 vcc, 0, v7
mf v[164:167],a[124:127],a[52:55]
dt a[120:121],v18,28672
v_cndmask_b32 v24, v24, v6, vcc
mf v[160:163],a[124:127],a[48:51]
v_subrev_u32 v47, 24, v24
v_bfe_u32 v6, v24, 1, 2
mf v[160:163],a[84:87],a[16:19]
dt a[122:123],v18,29184
v_mul_u32_u24 v6, 14, v6
mf v[156:159],a[84:87],a[12:15]
s_add_u32 m0, s64, 53248
v_lshrrev_b32 v7, 3, v24
v_lshlrev_b32 v7, 1, v7
mf v[156:159],a[124:127],a[44:47]
buffer_load_dwordx4 v12, s[36:39], s71 offen offset:0  lds
mf v[152:155],a[124:127],a[40:43]
v_and_b32 v45, 1, v24
v_or_b32 v7, v7, v45
mf v[152:155],a[84:87],a[8:11]
v_lshlrev_b32 v7, 2, v7
v_mov_b32 v45, 0x514260
mf v[148:151],a[84:87],a[4:7]
s_add_u32 m0, s64, 73728
v_bfe_u32 v7, v45, v7, 4
v_add_u32 v6, v6, v7
mf v[148:151],a[124:127],a[36:39]
buffer_load_dwordx4 v12, s[36:39], s5 offen offset:0  lds
mf v[144:147],a[124:127],a[32:35]
v_mad_u32_u24 v45, v47, 14, 3
v_cmp_le_u32 vcc, 24, v24
mf v[144:147],a[84:87],a[0:3]
s_mul_i32 s82, s75, 7
mf v[176:179],a[88:91],a[0:3]
v_cndmask_b32 v6, v6, v45, vcc
v_add_u32 v6, s82, v6
mf v[176:179],a[128:131],a[32:35]
s_add_u32 s82, s82, 21
dt a[84:85],v19,8192
v_cmp_le_u32 vcc, 28, v24
mf v[180:183],a[128:131],a[36:39]
v_subrev_u32 v45, s82, v45
mf v[180:183],a[88:91],a[4:7]
dt a[86:87],v19,8704
v_cndmask_b32 v6, v6, v45, vcc
mf v[184:187],a[88:91],a[8:11]
v_cmp_le_u32 vcc, 30, v24
v_subrev_u32 v45, 30, v24
mf v[184:187],a[128:131],a[40:43]
dt a[124:125],v19,28672
v_cndmask_b32 v24, v6, v45, vcc
mf v[188:191],a[128:131],a[44:47]
v_cmp_gt_u32 vcc, 6, v47
v_lshlrev_b32 v25, 17, v24
mf v[188:191],a[88:91],a[12:15]
dt a[126:127],v19,29184
v_lshlrev_b32 v24, 14, v24
mf v[192:195],a[88:91],a[16:19]
s_add_u32 m0, s64, 40960
s_lshl_b32 s82, s22, 14
v_mov_b32 v6, s82
mf v[192:195],a[128:131],a[48:51]
buffer_load_dwordx4 v10, s[32:35], s70 offen offset:0  lds
mf v[196:199],a[128:131],a[52:55]
v_mov_b32 v7, 0x4000
v_cndmask_b32 v6, 0, v6, vcc
mf v[196:199],a[88:91],a[20:23]
v_cndmask_b32 v7, 0, v7, vcc
v_sub_u32 v25, v25, v6
mf v[200:203],a[88:91],a[24:27]
s_add_u32 m0, s64, 61440
v_add_u32 v26, 0x4000, v25
v_add_u32 v26, v26, v7
mf v[200:203],a[128:131],a[56:59]
s_lshl_b32 s80, s73, 11
buffer_load_dwordx4 v10, s[32:35], s4 offen offset:0  lds
s_add_u32 s80, s80, 23658496
mf v[204:207],a[128:131],a[60:63]
s_lshl_b32 s83, s20, 9
s_add_u32 s83, s83, s80
v_lshrrev_b32 v7, 2, v2
mf v[204:207],a[88:91],a[28:31]
v_lshl_add_u32 v28, v7, 5, s83
s_lshl_b32 s83, s21, 5
mf v[236:239],a[92:95],a[28:31]
s_add_u32 s80, s80, s83
s_lshl_b32 s83, s75, 8
s_add_u32 s83, s83, s80
mf v[236:239],a[132:135],a[60:63]
dt a[88:89],v18,12288
v_lshrrev_b32 v6, 4, v2
mf v[232:235],a[132:135],a[56:59]
v_lshl_add_u32 v6, v6, 9, s83
v_and_b32 v7, 3, v7
mf v[232:235],a[92:95],a[24:27]
dt a[90:91],v18,12800
v_lshl_add_u32 v27, v7, 6, v6
mf v[228:231],a[92:95],a[20:23]
s_add_u32 s80, s80, 64
s_lshl_b32 s78, s24, 1
s_add_u32 s78, s78, s21
mf v[228:231],a[132:135],a[52:55]
s_lshl_b32 s79, s78, 6
dt a[128:129],v18,32768
s_lshl_b32 s82, s23, 1
mf v[224:227],a[132:135],a[48:51]
s_add_u32 s79, s79, s82
s_add_u32 s79, s79, s22
s_lshl_b32 s79, s79, 5
mf v[224:227],a[92:95],a[16:19]
s_add_u32 s79, s79, 23658496
dt a[130:131],v18,33280
s_mul_i32 s78, s78, 1179648
mf v[220:223],a[92:95],a[12:15]
s_add_u32 m0, s64, 57344
s_add_u32 s78, s78, 262144
s_lshl_b32 s14, s73, 3
mf v[220:223],a[132:135],a[44:47]
s_add_u32 s14, s14, s74
buffer_load_dwordx4 v12, s[40:43], s71 offen offset:0  lds
s_lshl_b32 s14, s14, 1
mf v[216:219],a[132:135],a[40:43]
s_add_u32 s14, s14, s75
s_lshl_b32 s14, s14, 2
s_add_u32 s14, s14, s20
mf v[216:219],a[92:95],a[8:11]
s_lshl_b32 s66, s20, 12
s_mul_i32 s82, s73, 1179648
s_add_u32 s82, s82, s66
mf v[212:215],a[92:95],a[4:7]
s_add_u32 m0, s64, 77824
s_add_u32 s83, s82, 262144
v_add_u32 v29, s83, v3
mf v[212:215],a[132:135],a[36:39]
s_lshl_b32 s3, s75, 11
buffer_load_dwordx4 v12, s[40:43], s5 offen offset:0  lds
s_add_u32 s83, s82, s3
mf v[208:211],a[132:135],a[32:35]
v_add_u32 v30, s83, v3
s_add_u32 s66, s66, s3
mf v[208:211],a[92:95],a[0:3]
s_waitcnt vmcnt(11) lgkmcnt(0)
s_barrier
mf a[144:147],a[64:67],a[0:3]
s_lshl_b32 s69, s68, 7
v_lshrrev_b32 v6, 3, v2
s_lshl_b32 s82, s20, 4
mf a[144:147],a[104:107],a[32:35]
dt a[92:93],v19,12288
v_add_u32 v6, s82, v6
mf a[148:151],a[104:107],a[36:39]
v_lshlrev_b32 v6, 11, v6
v_lshrrev_b32 v7, 4, v2
mf a[148:151],a[64:67],a[4:7]
dt a[94:95],v19,12800
v_lshlrev_b32 v7, 1, v7
mf a[152:155],a[64:67],a[8:11]
v_and_b32 v45, 7, v2
v_xor_b32 v7, v7, v45
mf a[152:155],a[104:107],a[40:43]
dt a[132:133],v19,32768
v_lshl_add_u32 v6, v7, 4, v6
mf a[156:159],a[104:107],a[44:47]
s_lshl_b32 s81, s74, 7
s_and_b32 s82, s81, 127
s_andn2_b32 s81, s81, 127
mf a[156:159],a[64:67],a[12:15]
s_lshl_b32 s81, s81, 1
dt a[134:135],v19,33280
s_or_b32 s81, s81, s82
mf a[160:163],a[64:67],a[16:19]
s_add_u32 m0, s65, 32768
v_add_u32 v31, s81, v6
s_lshl_b32 s67, s20, 11
mf a[160:163],a[104:107],a[48:51]
s_add_u32 s67, s67, 0x10000
buffer_load_dwordx4 v8, s[56:59], s69 offen  lds
s_lshl_b32 s82, s21, 12
mf a[164:167],a[104:107],a[52:55]
s_add_u32 s82, s82, s3
v_add_u32 v32, s82, v3
v_xor_b32 v33, 2048, v32
mf a[164:167],a[64:67],a[20:23]
v_lshrrev_b32 v6, 2, v2
v_lshlrev_b32 v6, 7, v6
mf a[168:171],a[64:67],a[24:27]
v_and_b32 v7, 3, v2
v_lshl_add_u32 v6, v7, 3, v6
mf a[168:171],a[104:107],a[56:59]
v_bfe_u32 v7, v2, 3, 2
v_lshl_add_u32 v6, v7, 5, v6
mf a[172:175],a[104:107],a[60:63]
s_add_u32 m0, s65, 33792
s_lshl_b32 s82, s22, 13
s_add_u32 s82, s82, 0x10000
mf a[172:175],a[64:67],a[28:31]
buffer_load_dwordx4 v9, s[56:59], s69 offen  lds
mf a[204:207],a[68:71],a[28:31]
v_add_u32 v34, s82, v6
v_xor_b32 v35, 32, v34
mf a[204:207],a[108:111],a[60:63]
dt a[64:65],v18,0
v_xor_b32 v36, 64, v34
mf a[200:203],a[108:111],a[56:59]
v_xor_b32 v37, 96, v34
s_lshl_b32 s82, s73, 7
mf a[200:203],a[68:71],a[24:27]
s_lshl_b32 s83, s21, 6
dt a[66:67],v18,512
s_add_u32 s82, s82, s83
mf a[196:199],a[68:71],a[20:23]
s_lshl_b32 s83, s75, 5
s_add_u32 s82, s82, s83
v_and_b32 v45, 15, v2
mf a[196:199],a[108:111],a[52:55]
dt a[104:105],v18,20480
v_lshrrev_b32 v6, 3, v2
mf a[192:195],a[108:111],a[48:51]
s_add_u32 s69, s69, 0x8000
v_add_u32 v6, s82, v6
v_lshlrev_b32 v6, 11, v6
mf a[192:195],a[68:71],a[16:19]
dt a[106:107],v18,20992
v_and_b32 v7, 7, v2
mf a[188:191],a[68:71],a[12:15]
s_add_u32 m0, s65, 34816
v_lshl_add_u32 v6, v7, 4, v6
s_mul_i32 s83, s22, 128
mf a[188:191],a[108:111],a[44:47]
s_add_u32 s82, s81, s83
buffer_load_dwordx4 v8, s[56:59], s69 offen  lds
mf a[184:187],a[108:111],a[40:43]
v_add_u32 v38, s82, v6
s_mov_b32 s18, 0x3fb8aa3b
mf a[184:187],a[68:71],a[8:11]
s_mov_b32 s19, s18
v_mov_b32 v40, 0x358637bd
s_mov_b32 s16, 32768
mf a[180:183],a[68:71],a[4:7]
s_lshl_b32 s82, s21, 11
s_add_u32 s82, s82, 157696
v_lshl_add_u32 v43, v45, 4, s82
mf a[180:183],a[108:111],a[36:39]
s_mul_i32 s82, s22, 640
s_add_u32 s82, s82, 156416
v_and_b32 v6, 48, v2
mf a[176:179],a[108:111],a[32:35]
s_add_u32 m0, s65, 35840
v_add_u32 v44, s82, v6
s_mul_i32 s82, s20, 320
mf a[176:179],a[68:71],a[0:3]
s_add_u32 s82, s82, 147456
buffer_load_dwordx4 v9, s[56:59], s69 offen  lds
mf v[240:243],a[96:99],a[0:3]
v_min_u32 v6, 39, v2
v_lshl_add_u32 v47, v6, 3, s82
mf v[240:243],a[136:139],a[32:35]
dt a[68:69],v19,0
mf v[244:247],a[136:139],a[36:39]
mf v[244:247],a[96:99],a[4:7]
dt a[70:71],v19,512
mf a[208:211],a[96:99],a[8:11]
mf a[208:211],a[136:139],a[40:43]
dt a[108:109],v19,20480
mf a[212:215],a[136:139],a[44:47]
s_add_u32 s69, s69, 0x8000
mf a[212:215],a[96:99],a[12:15]
dt a[110:111],v19,20992
mf a[216:219],a[96:99],a[16:19]
s_add_u32 m0, s65, 36864
mf a[216:219],a[136:139],a[48:51]
buffer_load_dwordx4 v8, s[56:59], s69 offen  lds
mf a[220:223],a[136:139],a[52:55]
mf a[220:223],a[96:99],a[20:23]
s_mov_b32 m0, 147456
s_nop 0
buffer_load_dword v15, s[48:51], s89 offen lds
mf a[224:227],a[96:99],a[24:27]
s_add_u32 s89, s89, 0x100000
mf a[224:227],a[136:139],a[56:59]
mf a[228:231],a[136:139],a[60:63]
s_add_u32 m0, s65, 37888
mf a[228:231],a[96:99],a[28:31]
buffer_load_dwordx4 v9, s[56:59], s69 offen  lds
mf v[248:251],a[100:103],a[0:3]
dq a[0:3],v16,0
mf v[248:251],a[140:143],a[32:35]
dq a[32:35],v17,0
mf v[252:255],a[140:143],a[36:39]
dq a[36:39],v17,2048
mf v[252:255],a[100:103],a[4:7]
dq a[4:7],v16,2048
mf a[232:235],a[100:103],a[8:11]
dq a[8:11],v16,4096
mf a[232:235],a[140:143],a[40:43]
dq a[40:43],v17,4096
mf a[236:239],a[140:143],a[44:47]
dq a[44:47],v17,6144
mf a[236:239],a[100:103],a[12:15]
dq a[12:15],v16,6144
mf a[240:243],a[100:103],a[16:19]
dq a[16:19],v16,8192
mf a[240:243],a[140:143],a[48:51]
dq a[48:51],v17,8192
mf a[244:247],a[140:143],a[52:55]
dq a[52:55],v17,10240
mf a[244:247],a[100:103],a[20:23]
dq a[20:23],v16,10240
mf a[248:251],a[100:103],a[24:27]
dq a[24:27],v16,12288
mf a[248:251],a[140:143],a[56:59]
dq a[56:59],v17,12288
mf a[252:255],a[140:143],a[60:63]
s_add_u32 s69, s69, 0x8000
dq a[60:63],v17,14336
mf a[252:255],a[100:103],a[28:31]
s_waitcnt lgkmcnt(13)
dq a[28:31],v16,14336
mf v[48:51],a[72:75],a[0:3]
s_add_u32 m0, s65, 38912
dt a[96:97],v18,16384
mf v[48:51],a[112:115],a[32:35]
s_waitcnt lgkmcnt(13)
dt a[98:99],v18,16896
buffer_load_dwordx4 v8, s[56:59], s69 offen  lds
mf v[52:55],a[112:115],a[36:39]
dt a[136:137],v18,36864
mf v[52:55],a[72:75],a[4:7]
s_waitcnt lgkmcnt(13)
dt a[138:139],v18,37376
mf v[56:59],a[72:75],a[8:11]
dt a[100:101],v19,16384
mf v[56:59],a[112:115],a[40:43]
s_waitcnt lgkmcnt(13)
dt a[102:103],v19,16896
mf v[60:63],a[112:115],a[44:47]
dt a[140:141],v19,36864
mf v[60:63],a[72:75],a[12:15]
s_waitcnt lgkmcnt(13)
dt a[142:143],v19,37376
mf v[64:67],a[72:75],a[16:19]
s_add_u32 m0, s65, 39936
mf v[64:67],a[112:115],a[48:51]
s_waitcnt lgkmcnt(12)
buffer_load_dwordx4 v9, s[56:59], s69 offen  lds
mf v[68:71],a[112:115],a[52:55]
mf v[68:71],a[72:75],a[20:23]
s_waitcnt lgkmcnt(10)
mf v[72:75],a[72:75],a[24:27]
mf v[72:75],a[112:115],a[56:59]
s_waitcnt lgkmcnt(8)
mf v[76:79],a[112:115],a[60:63]
mf v[76:79],a[72:75],a[28:31]
s_waitcnt vmcnt(13) lgkmcnt(0)
s_barrier
mf v[108:111],a[76:79],a[28:31]
v_readlane_b32 s68, v13, 28
mf v[108:111],a[116:119],a[60:63]
dt a[72:73],v21,4096
mf v[104:107],a[116:119],a[56:59]
s_mul_i32 s70, s68, 393216
mf v[104:107],a[76:79],a[24:27]
s_mul_i32 s71, s68, 458752
dt a[74:75],v21,4608
mf v[100:103],a[76:79],a[20:23]
s_add_u32 s5, s71, 229376
mf v[100:103],a[116:119],a[52:55]
s_add_u32 s4, s70, 196608
dt a[112:113],v21,24576
mf v[96:99],a[116:119],a[48:51]
mf v[96:99],a[76:79],a[16:19]
dt a[114:115],v21,25088
mf v[92:95],a[76:79],a[12:15]
s_add_u32 m0, s64, 4096
mf v[92:95],a[116:119],a[44:47]
buffer_load_dwordx4 v11, s[36:39], s71 offen offset:0  lds
mf v[88:91],a[116:119],a[40:43]
mf v[88:91],a[76:79],a[8:11]
mf v[84:87],a[76:79],a[4:7]
s_add_u32 m0, s64, 24576
mf v[84:87],a[116:119],a[36:39]
buffer_load_dwordx4 v11, s[36:39], s5 offen offset:0  lds
mf v[80:83],a[116:119],a[32:35]
mf v[80:83],a[76:79],a[0:3]
mf v[112:115],a[80:83],a[0:3]
mf v[112:115],a[120:123],a[32:35]
dt a[76:77],v22,4096
mf v[116:119],a[120:123],a[36:39]
mf v[116:119],a[80:83],a[4:7]
dt a[78:79],v22,4608
mf v[120:123],a[80:83],a[8:11]
mf v[120:123],a[120:123],a[40:43]
dt a[116:117],v22,24576
mf v[124:127],a[120:123],a[44:47]
mf v[124:127],a[80:83],a[12:15]
dt a[118:119],v22,25088
mf v[128:131],a[80:83],a[16:19]
s_add_u32 m0, s64, 8192
mf v[128:131],a[120:123],a[48:51]
buffer_load_dwordx4 v11, s[40:43], s71 offen offset:0  lds
mf v[132:135],a[120:123],a[52:55]
mf v[132:135],a[80:83],a[20:23]
mf v[136:139],a[80:83],a[24:27]
s_add_u32 m0, s64, 28672
mf v[136:139],a[120:123],a[56:59]
buffer_load_dwordx4 v11, s[40:43], s5 offen offset:0  lds
mf v[140:143],a[120:123],a[60:63]
mf v[140:143],a[80:83],a[28:31]
mf v[172:175],a[84:87],a[28:31]
mf v[172:175],a[124:127],a[60:63]
dt a[80:81],v21,8192
mf v[168:171],a[124:127],a[56:59]
mf v[168:171],a[84:87],a[24:27]
dt a[82:83],v21,8704
mf v[164:167],a[84:87],a[20:23]
mf v[164:167],a[124:127],a[52:55]
dt a[120:121],v21,28672
mf v[160:163],a[124:127],a[48:51]
mf v[160:163],a[84:87],a[16:19]
dt a[122:123],v21,29184
L_stub15:
s_cbranch_execz L_stub19
mf v[156:159],a[84:87],a[12:15]
s_add_u32 m0, s64, 12288
mf v[156:159],a[124:127],a[44:47]
buffer_load_dwordx4 v12, s[36:39], s71 offen offset:0  lds
mf v[152:155],a[124:127],a[40:43]
mf v[152:155],a[84:87],a[8:11]
mf v[148:151],a[84:87],a[4:7]
s_add_u32 m0, s64, 32768
mf v[148:151],a[124:127],a[36:39]
buffer_load_dwordx4 v12, s[36:39], s5 offen offset:0  lds
mf v[144:147],a[124:127],a[32:35]
mf v[144:147],a[84:87],a[0:3]
mf v[176:179],a[88:91],a[0:3]
mf v[176:179],a[128:131],a[32:35]
dt a[84:85],v22,8192
mf v[180:183],a[128:131],a[36:39]
mf v[180:183],a[88:91],a[4:7]
dt a[86:87],v22,8704
mf v[184:187],a[88:91],a[8:11]
mf v[184:187],a[128:131],a[40:43]
dt a[124:125],v22,28672
mf v[188:191],a[128:131],a[44:47]
mf v[188:191],a[88:91],a[12:15]
dt a[126:127],v22,29184
mf v[192:195],a[88:91],a[16:19]
s_add_u32 m0, s64, 0
mf v[192:195],a[128:131],a[48:51]
buffer_load_dwordx4 v10, s[32:35], s70 offen offset:0  lds
mf v[196:199],a[128:131],a[52:55]
mf v[196:199],a[88:91],a[20:23]
mf v[200:203],a[88:91],a[24:27]
s_add_u32 m0, s64, 20480
mf v[200:203],a[128:131],a[56:59]
buffer_load_dwordx4 v10, s[32:35], s4 offen offset:0  lds
mf v[204:207],a[128:131],a[60:63]
mf v[204:207],a[88:91],a[28:31]
mf v[236:239],a[92:95],a[28:31]
mf v[236:239],a[132:135],a[60:63]
dt a[88:89],v21,12288
mf v[232:235],a[132:135],a[56:59]
mf v[232:235],a[92:95],a[24:27]
dt a[90:91],v21,12800
mf v[228:231],a[92:95],a[20:23]
mf v[228:231],a[132:135],a[52:55]
dt a[128:129],v21,32768
mf v[224:227],a[132:135],a[48:51]
mf v[224:227],a[92:95],a[16:19]
dt a[130:131],v21,33280
mf v[220:223],a[92:95],a[12:15]
s_add_u32 m0, s64, 16384
mf v[220:223],a[132:135],a[44:47]
buffer_load_dwordx4 v12, s[40:43], s71 offen offset:0  lds
mf v[216:219],a[132:135],a[40:43]
mf v[216:219],a[92:95],a[8:11]
mf v[212:215],a[92:95],a[4:7]
s_add_u32 m0, s64, 36864
mf v[212:215],a[132:135],a[36:39]
buffer_load_dwordx4 v12, s[40:43], s5 offen offset:0  lds
mf v[208:211],a[132:135],a[32:35]
mf v[208:211],a[92:95],a[0:3]
s_waitcnt vmcnt(10) lgkmcnt(0)
s_barrier
mf a[144:147],a[64:67],a[0:3]
s_lshl_b32 s69, s68, 7
s_lshl_b32 s82, s24, 5
v_add_u32 v6, s82, v2
mf a[144:147],a[104:107],a[32:35]
dt a[92:93],v22,12288
v_and_b32 v7, 7, v2
mf a[148:151],a[104:107],a[36:39]
v_cmp_gt_u32 vcc, 32, v2
v_lshlrev_b32 v7, 5, v7
mf a[148:151],a[64:67],a[4:7]
dt a[94:95],v22,12800
v_add_u32 v7, s23, v7
mf a[152:155],a[64:67],a[8:11]
v_cndmask_b32 v6, v7, v6, vcc
v_lshlrev_b32 v6, 5, v6
mf a[152:155],a[104:107],a[40:43]
dt a[132:133],v22,32768
v_add_u32 v41, 23642112, v6
mf a[156:159],a[104:107],a[44:47]
mf a[156:159],a[64:67],a[12:15]
dt a[134:135],v22,33280
buffer_load_dword v42, v41, s[28:31], 0 offen sc1
mf a[160:163],a[64:67],a[16:19]
s_add_u32 m0, s65, 0
mf a[160:163],a[104:107],a[48:51]
buffer_load_dwordx4 v8, s[56:59], s69 offen  lds
mf a[164:167],a[104:107],a[52:55]
mf a[164:167],a[64:67],a[20:23]
mf a[168:171],a[64:67],a[24:27]
mf a[168:171],a[104:107],a[56:59]
mf a[172:175],a[104:107],a[60:63]
s_add_u32 m0, s65, 1024
mf a[172:175],a[64:67],a[28:31]
buffer_load_dwordx4 v9, s[56:59], s69 offen  lds
mf a[204:207],a[68:71],a[28:31]
mf a[204:207],a[108:111],a[60:63]
dt a[64:65],v21,0
mf a[200:203],a[108:111],a[56:59]
mf a[200:203],a[68:71],a[24:27]
dt a[66:67],v21,512
mf a[196:199],a[68:71],a[20:23]
mf a[196:199],a[108:111],a[52:55]
dt a[104:105],v21,20480
mf a[192:195],a[108:111],a[48:51]
s_add_u32 s69, s69, 0x8000
mf a[192:195],a[68:71],a[16:19]
dt a[106:107],v21,20992
mf a[188:191],a[68:71],a[12:15]
s_add_u32 m0, s65, 2048
mf a[188:191],a[108:111],a[44:47]
buffer_load_dwordx4 v8, s[56:59], s69 offen  lds
mf a[184:187],a[108:111],a[40:43]
mf a[184:187],a[68:71],a[8:11]
mf a[180:183],a[68:71],a[4:7]
mf a[180:183],a[108:111],a[36:39]
mf a[176:179],a[108:111],a[32:35]
s_add_u32 m0, s65, 3072
mf a[176:179],a[68:71],a[0:3]
buffer_load_dwordx4 v9, s[56:59], s69 offen  lds
mf v[240:243],a[96:99],a[0:3]
mf v[240:243],a[136:139],a[32:35]
dt a[68:69],v22,0
mf v[244:247],a[136:139],a[36:39]
mf v[244:247],a[96:99],a[4:7]
dt a[70:71],v22,512
mf a[208:211],a[96:99],a[8:11]
mf a[208:211],a[136:139],a[40:43]
dt a[108:109],v22,20480
mf a[212:215],a[136:139],a[44:47]
s_add_u32 s69, s69, 0x8000
mf a[212:215],a[96:99],a[12:15]
dt a[110:111],v22,20992
mf a[216:219],a[96:99],a[16:19]
s_add_u32 m0, s65, 4096
mf a[216:219],a[136:139],a[48:51]
buffer_load_dwordx4 v8, s[56:59], s69 offen  lds
mf a[220:223],a[136:139],a[52:55]
mf a[220:223],a[96:99],a[20:23]
mf a[224:227],a[96:99],a[24:27]
mf a[224:227],a[136:139],a[56:59]
mf a[228:231],a[136:139],a[60:63]
s_add_u32 m0, s65, 5120
mf a[228:231],a[96:99],a[28:31]
buffer_load_dwordx4 v9, s[56:59], s69 offen  lds
mf v[248:251],a[100:103],a[0:3]
dq a[0:3],v16,32768
mf v[248:251],a[140:143],a[32:35]
dq a[32:35],v17,32768
mf v[252:255],a[140:143],a[36:39]
dq a[36:39],v17,34816
mf v[252:255],a[100:103],a[4:7]
dq a[4:7],v16,34816
mf a[232:235],a[100:103],a[8:11]
dq a[8:11],v16,36864
mf a[232:235],a[140:143],a[40:43]
dq a[40:43],v17,36864
mf a[236:239],a[140:143],a[44:47]
dq a[44:47],v17,38912
mf a[236:239],a[100:103],a[12:15]
dq a[12:15],v16,38912
mf a[240:243],a[100:103],a[16:19]
dq a[16:19],v16,40960
mf a[240:243],a[140:143],a[48:51]
dq a[48:51],v17,40960
mf a[244:247],a[140:143],a[52:55]
dq a[52:55],v17,43008
mf a[244:247],a[100:103],a[20:23]
dq a[20:23],v16,43008
mf a[248:251],a[100:103],a[24:27]
dq a[24:27],v16,45056
mf a[248:251],a[140:143],a[56:59]
dq a[56:59],v17,45056
mf a[252:255],a[140:143],a[60:63]
s_add_u32 s69, s69, 0x8000
dq a[60:63],v17,47104
mf a[252:255],a[100:103],a[28:31]
s_waitcnt lgkmcnt(13)
dq a[28:31],v16,47104
mf v[48:51],a[72:75],a[0:3]
s_add_u32 m0, s65, 6144
dt a[96:97],v21,16384
mf v[48:51],a[112:115],a[32:35]
s_waitcnt lgkmcnt(13)
dt a[98:99],v21,16896
buffer_load_dwordx4 v8, s[56:59], s69 offen  lds
mf v[52:55],a[112:115],a[36:39]
dt a[136:137],v21,36864
mf v[52:55],a[72:75],a[4:7]
s_waitcnt lgkmcnt(13)
dt a[138:139],v21,37376
mf v[56:59],a[72:75],a[8:11]
dt a[100:101],v22,16384
mf v[56:59],a[112:115],a[40:43]
s_waitcnt lgkmcnt(13)
dt a[102:103],v22,16896
mf v[60:63],a[112:115],a[44:47]
dt a[140:141],v22,36864
mf v[60:63],a[72:75],a[12:15]
s_waitcnt lgkmcnt(13)
dt a[142:143],v22,37376
mf v[64:67],a[72:75],a[16:19]
s_add_u32 m0, s65, 7168
mf v[64:67],a[112:115],a[48:51]
s_waitcnt lgkmcnt(12)
buffer_load_dwordx4 v9, s[56:59], s69 offen  lds
mf v[68:71],a[112:115],a[52:55]
mf v[68:71],a[72:75],a[20:23]
s_waitcnt lgkmcnt(10)
mf v[72:75],a[72:75],a[24:27]
mf v[72:75],a[112:115],a[56:59]
s_waitcnt lgkmcnt(8)
mf v[76:79],a[112:115],a[60:63]
mf v[76:79],a[72:75],a[28:31]
s_waitcnt vmcnt(8) lgkmcnt(0)
s_barrier
v_sub_u32 v42, v42, v5
v_subrev_u32 v42, 1, v42
v_cmp_lt_u32 vcc, 2, v42
s_nop 0
s_cbranch_vccnz L_eQ_slow
L_eQ_back:
mf v[108:111],a[76:79],a[28:31]
s_mul_i32 s10, s23, 10240
v_readlane_b32 s68, v13, 30
s_add_u32 s10, s10, 23265280
mf v[108:111],a[116:119],a[60:63]
s_mul_i32 s11, s24, 6144
dt a[72:73],v18,4096
s_add_u32 s11, s11, 23582720
mf v[104:107],a[116:119],a[56:59]
s_mul_i32 s70, s68, 393216
s_lshl_b32 s12, s20, 12
s_add_u32 s10, s10, s12
mf v[104:107],a[76:79],a[24:27]
s_mul_i32 s71, s68, 458752
dt a[74:75],v18,4608
s_add_u32 s11, s11, s12
mf v[100:103],a[76:79],a[20:23]
s_add_u32 s5, s71, 229376
s_add_u32 s13, s12, 147456
mf v[100:103],a[116:119],a[52:55]
s_add_u32 s4, s70, 196608
dt a[112:113],v18,24576
mf v[96:99],a[116:119],a[48:51]
mf v[96:99],a[76:79],a[16:19]
dt a[114:115],v18,25088
mf v[92:95],a[76:79],a[12:15]
s_add_u32 m0, s64, 45056
mf v[92:95],a[116:119],a[44:47]
buffer_load_dwordx4 v11, s[36:39], s71 offen offset:0  lds
mf v[88:91],a[116:119],a[40:43]
mf v[88:91],a[76:79],a[8:11]
s_cmp_lt_u32 s20, 3
s_cselect_b32 s12, s10, s11
mf v[84:87],a[76:79],a[4:7]
s_add_u32 m0, s64, 65536
mf v[84:87],a[116:119],a[36:39]
buffer_load_dwordx4 v11, s[36:39], s5 offen offset:0  lds
mf v[80:83],a[116:119],a[32:35]
mf v[80:83],a[76:79],a[0:3]
s_cmp_lt_u32 s20, 2
s_cselect_b32 s11, s10, s11
mf v[112:115],a[80:83],a[0:3]
mf v[112:115],a[120:123],a[32:35]
dt a[76:77],v19,4096
mf v[116:119],a[120:123],a[36:39]
mf v[116:119],a[80:83],a[4:7]
dt a[78:79],v19,4608
mf v[120:123],a[80:83],a[8:11]
mf v[120:123],a[120:123],a[40:43]
dt a[116:117],v19,24576
mf v[124:127],a[120:123],a[44:47]
mf v[124:127],a[80:83],a[12:15]
dt a[118:119],v19,25088
mf v[128:131],a[80:83],a[16:19]
s_add_u32 m0, s64, 49152
mf v[128:131],a[120:123],a[48:51]
buffer_load_dwordx4 v11, s[40:43], s71 offen offset:0  lds
mf v[132:135],a[120:123],a[52:55]
mf v[132:135],a[80:83],a[20:23]
s_mov_b32 m0, s13
s_nop 0
buffer_load_dwordx4 v3, s[28:31], s12 offen offset:0 sc1 lds
mf v[136:139],a[80:83],a[24:27]
s_add_u32 m0, s64, 69632
mf v[136:139],a[120:123],a[56:59]
buffer_load_dwordx4 v11, s[40:43], s5 offen offset:0  lds
mf v[140:143],a[120:123],a[60:63]
mf v[140:143],a[80:83],a[28:31]
s_mov_b32 m0, s13
s_nop 0
buffer_load_dwordx4 v3, s[28:31], s12 offen offset:1024 sc1 lds
mf v[172:175],a[84:87],a[28:31]
mf v[172:175],a[124:127],a[60:63]
dt a[80:81],v18,8192
mf v[168:171],a[124:127],a[56:59]
mf v[168:171],a[84:87],a[24:27]
dt a[82:83],v18,8704
mf v[164:167],a[84:87],a[20:23]
mf v[164:167],a[124:127],a[52:55]
dt a[120:121],v18,28672
mf v[160:163],a[124:127],a[48:51]
mf v[160:163],a[84:87],a[16:19]
dt a[122:123],v18,29184
mf v[156:159],a[84:87],a[12:15]
s_add_u32 m0, s64, 53248
mf v[156:159],a[124:127],a[44:47]
buffer_load_dwordx4 v12, s[36:39], s71 offen offset:0  lds
mf v[152:155],a[124:127],a[40:43]
mf v[152:155],a[84:87],a[8:11]
s_mov_b32 m0, s13
s_nop 0
buffer_load_dwordx4 v3, s[28:31], s11 offen offset:2048 sc1 lds
mf v[148:151],a[84:87],a[4:7]
s_add_u32 m0, s64, 73728
mf v[148:151],a[124:127],a[36:39]
buffer_load_dwordx4 v12, s[36:39], s5 offen offset:0  lds
mf v[144:147],a[124:127],a[32:35]
mf v[144:147],a[84:87],a[0:3]
s_mov_b32 m0, s13
s_nop 0
buffer_load_dwordx4 v3, s[28:31], s11 offen offset:3072 sc1 lds
mf v[176:179],a[88:91],a[0:3]
mf v[176:179],a[128:131],a[32:35]
dt a[84:85],v19,8192
mf v[180:183],a[128:131],a[36:39]
mf v[180:183],a[88:91],a[4:7]
dt a[86:87],v19,8704
mf v[184:187],a[88:91],a[8:11]
mf v[184:187],a[128:131],a[40:43]
dt a[124:125],v19,28672
mf v[188:191],a[128:131],a[44:47]
mf v[188:191],a[88:91],a[12:15]
dt a[126:127],v19,29184
mf v[192:195],a[88:91],a[16:19]
s_add_u32 m0, s64, 40960
mf v[192:195],a[128:131],a[48:51]
buffer_load_dwordx4 v10, s[32:35], s70 offen offset:0  lds
mf v[196:199],a[128:131],a[52:55]
mf v[196:199],a[88:91],a[20:23]
mf v[200:203],a[88:91],a[24:27]
s_add_u32 m0, s64, 61440
mf v[200:203],a[128:131],a[56:59]
buffer_load_dwordx4 v10, s[32:35], s4 offen offset:0  lds
mf v[204:207],a[128:131],a[60:63]
mf v[204:207],a[88:91],a[28:31]
mf v[236:239],a[92:95],a[28:31]
mf v[236:239],a[132:135],a[60:63]
dt a[88:89],v18,12288
mf v[232:235],a[132:135],a[56:59]
mf v[232:235],a[92:95],a[24:27]
dt a[90:91],v18,12800
mf v[228:231],a[92:95],a[20:23]
mf v[228:231],a[132:135],a[52:55]
dt a[128:129],v18,32768
mf v[224:227],a[132:135],a[48:51]
mf v[224:227],a[92:95],a[16:19]
dt a[130:131],v18,33280
mf v[220:223],a[92:95],a[12:15]
s_add_u32 m0, s64, 57344
mf v[220:223],a[132:135],a[44:47]
buffer_load_dwordx4 v12, s[40:43], s71 offen offset:0  lds
mf v[216:219],a[132:135],a[40:43]
mf v[216:219],a[92:95],a[8:11]
mf v[212:215],a[92:95],a[4:7]
s_add_u32 m0, s64, 77824
mf v[212:215],a[132:135],a[36:39]
buffer_load_dwordx4 v12, s[40:43], s5 offen offset:0  lds
mf v[208:211],a[132:135],a[32:35]
mf v[208:211],a[92:95],a[0:3]
s_waitcnt vmcnt(14) lgkmcnt(0)
s_barrier
mf a[144:147],a[64:67],a[0:3]
s_lshl_b32 s69, s68, 7
v_mov_b32 v41, 0xb5c1a2a0
v_mov_b32 v42, v15
mf a[144:147],a[104:107],a[32:35]
dt a[92:93],v19,12288
mf a[148:151],a[104:107],a[36:39]
mf a[148:151],a[64:67],a[4:7]
dt a[94:95],v19,12800
mf a[152:155],a[64:67],a[8:11]
mf a[152:155],a[104:107],a[40:43]
dt a[132:133],v19,32768
mf a[156:159],a[104:107],a[44:47]
mf a[156:159],a[64:67],a[12:15]
dt a[134:135],v19,33280
mf a[160:163],a[64:67],a[16:19]
s_add_u32 m0, s65, 32768
mf a[160:163],a[104:107],a[48:51]
buffer_load_dwordx4 v8, s[56:59], s69 offen  lds
mf a[164:167],a[104:107],a[52:55]
s_add_u32 m0, s65, 33792
mf a[164:167],a[64:67],a[20:23]
buffer_load_dwordx4 v9, s[56:59], s69 offen  lds
mf a[168:171],a[64:67],a[24:27]
s_add_u32 s69, s69, 0x8000
mf a[168:171],a[104:107],a[56:59]
mf a[172:175],a[104:107],a[60:63]
s_add_u32 m0, s65, 34816
mf a[172:175],a[64:67],a[28:31]
buffer_load_dwordx4 v8, s[56:59], s69 offen  lds
mf a[204:207],a[68:71],a[28:31]
mf a[204:207],a[108:111],a[60:63]
dt a[64:65],v18,0
mf a[200:203],a[108:111],a[56:59]
mf a[200:203],a[68:71],a[24:27]
dt a[66:67],v18,512
mf a[196:199],a[68:71],a[20:23]
mf a[196:199],a[108:111],a[52:55]
dt a[104:105],v18,20480
mf a[192:195],a[108:111],a[48:51]
mf a[192:195],a[68:71],a[16:19]
dt a[106:107],v18,20992
mf a[188:191],a[68:71],a[12:15]
s_add_u32 m0, s65, 35840
mf a[188:191],a[108:111],a[44:47]
buffer_load_dwordx4 v9, s[56:59], s69 offen  lds
mf a[184:187],a[108:111],a[40:43]
s_add_u32 s69, s69, 0x8000
mf a[184:187],a[68:71],a[8:11]
mf a[180:183],a[68:71],a[4:7]
s_add_u32 m0, s65, 36864
mf a[180:183],a[108:111],a[36:39]
buffer_load_dwordx4 v8, s[56:59], s69 offen  lds
mf a[176:179],a[108:111],a[32:35]
s_add_u32 m0, s65, 37888
mf a[176:179],a[68:71],a[0:3]
buffer_load_dwordx4 v9, s[56:59], s69 offen  lds
mf v[240:243],a[96:99],a[0:3]
mf v[240:243],a[136:139],a[32:35]
dt a[68:69],v19,0
mf v[244:247],a[136:139],a[36:39]
mf v[244:247],a[96:99],a[4:7]
dt a[70:71],v19,512
mf a[208:211],a[96:99],a[8:11]
mf a[208:211],a[136:139],a[40:43]
dt a[108:109],v19,20480
mf a[212:215],a[136:139],a[44:47]
s_add_u32 s69, s69, 0x8000
mf a[212:215],a[96:99],a[12:15]
dt a[110:111],v19,20992
mf a[216:219],a[96:99],a[16:19]
s_add_u32 m0, s65, 38912
mf a[216:219],a[136:139],a[48:51]
buffer_load_dwordx4 v8, s[56:59], s69 offen  lds
mf a[220:223],a[136:139],a[52:55]
mf a[220:223],a[96:99],a[20:23]
mf a[224:227],a[96:99],a[24:27]
s_add_u32 m0, s65, 39936
mf a[224:227],a[136:139],a[56:59]
buffer_load_dwordx4 v9, s[56:59], s69 offen  lds
mf a[228:231],a[136:139],a[60:63]
mf a[228:231],a[96:99],a[28:31]
mf v[248:251],a[100:103],a[0:3]
dq a[0:3],v16,0
mf v[248:251],a[140:143],a[32:35]
dq a[32:35],v17,0
mf v[252:255],a[140:143],a[36:39]
dq a[36:39],v17,2048
mf v[252:255],a[100:103],a[4:7]
dq a[4:7],v16,2048
mf a[232:235],a[100:103],a[8:11]
dq a[8:11],v16,4096
mf a[232:235],a[140:143],a[40:43]
dq a[40:43],v17,4096
mf a[236:239],a[140:143],a[44:47]
dq a[44:47],v17,6144
mf a[236:239],a[100:103],a[12:15]
dq a[12:15],v16,6144
mf a[240:243],a[100:103],a[16:19]
dq a[16:19],v16,8192
mf a[240:243],a[140:143],a[48:51]
dq a[48:51],v17,8192
mf a[244:247],a[140:143],a[52:55]
dq a[52:55],v17,10240
mf a[244:247],a[100:103],a[20:23]
dq a[20:23],v16,10240
mf a[248:251],a[100:103],a[24:27]
dq a[24:27],v16,12288
mf a[248:251],a[140:143],a[56:59]
dq a[56:59],v17,12288
mf a[252:255],a[140:143],a[60:63]
dq a[60:63],v17,14336
mf a[252:255],a[100:103],a[28:31]
s_waitcnt lgkmcnt(13)
dq a[28:31],v16,14336
mf v[48:51],a[72:75],a[0:3]
dt a[96:97],v18,16384
mf v[48:51],a[112:115],a[32:35]
s_waitcnt lgkmcnt(13)
dt a[98:99],v18,16896
mf v[52:55],a[112:115],a[36:39]
dt a[136:137],v18,36864
mf v[52:55],a[72:75],a[4:7]
s_waitcnt lgkmcnt(13)
dt a[138:139],v18,37376
mf v[56:59],a[72:75],a[8:11]
dt a[100:101],v19,16384
mf v[56:59],a[112:115],a[40:43]
s_waitcnt lgkmcnt(13)
dt a[102:103],v19,16896
mf v[60:63],a[112:115],a[44:47]
dt a[140:141],v19,36864
mf v[60:63],a[72:75],a[12:15]
s_waitcnt lgkmcnt(13)
dt a[142:143],v19,37376
mf v[64:67],a[72:75],a[16:19]
mf v[64:67],a[112:115],a[48:51]
s_waitcnt lgkmcnt(12)
mf v[68:71],a[112:115],a[52:55]
mf v[68:71],a[72:75],a[20:23]
s_waitcnt lgkmcnt(10)
mf v[72:75],a[72:75],a[24:27]
mf v[72:75],a[112:115],a[56:59]
s_waitcnt lgkmcnt(8)
mf v[76:79],a[112:115],a[60:63]
mf v[76:79],a[72:75],a[28:31]
s_waitcnt vmcnt(8) lgkmcnt(0)
s_barrier
mf v[108:111],a[76:79],a[28:31]
ds_read_b64 v[8:9], v47 offset:0
mf v[108:111],a[116:119],a[60:63]
ds_read_b64 v[10:11], v47 offset:1280
mf v[104:107],a[116:119],a[56:59]
ds_read_b64 v[12:13], v47 offset:2560
mf v[104:107],a[76:79],a[24:27]
ds_read_b64 v[14:15], v47 offset:3840
mf v[100:103],a[76:79],a[20:23]
dt a[72:73],v21,4096
mf v[100:103],a[116:119],a[52:55]
dt a[74:75],v21,4608
mf v[96:99],a[116:119],a[48:51]
dt a[112:113],v21,24576
s_waitcnt lgkmcnt(3)
mf v[96:99],a[76:79],a[16:19]
dt a[114:115],v21,25088
v_add_f32 v8, v8, v10
mf v[92:95],a[76:79],a[12:15]
L_stub16:
s_cbranch_execz L_stub9
v_add_f32 v12, v12, v14
v_add_f32 v9, v9, v11
mf v[92:95],a[116:119],a[44:47]
v_add_f32 v13, v13, v15
v_add_f32 v6, v8, v12
mf v[88:91],a[116:119],a[40:43]
v_add_f32 v7, v9, v13
mf v[88:91],a[76:79],a[8:11]
ds_read_b64 v[8:9], v47 offset:5120
mf v[84:87],a[76:79],a[4:7]
ds_read_b64 v[10:11], v47 offset:6400
mf v[84:87],a[116:119],a[36:39]
ds_read_b64 v[12:13], v47 offset:7680
mf v[80:83],a[116:119],a[32:35]
ds_read_b64 v[14:15], v47 offset:8960
mf v[80:83],a[76:79],a[0:3]
mf v[112:115],a[80:83],a[0:3]
mf v[112:115],a[120:123],a[32:35]
mf v[116:119],a[120:123],a[36:39]
mf v[116:119],a[80:83],a[4:7]
mf v[120:123],a[80:83],a[8:11]
s_waitcnt lgkmcnt(0)
v_add_f32 v8, v8, v10
v_add_f32 v12, v12, v14
mf v[120:123],a[120:123],a[40:43]
v_add_f32 v9, v9, v11
v_add_f32 v13, v13, v15
mf v[124:127],a[120:123],a[44:47]
v_add_f32 v6, v6, v8
v_add_f32 v6, v6, v12
mf v[124:127],a[80:83],a[12:15]
v_add_f32 v7, v7, v9
v_add_f32 v7, v7, v13
mf v[128:131],a[80:83],a[16:19]
ds_write_b64 v47, v[6:7] offset:8960
s_lshl_b32 s65, s20, 12
mf v[128:131],a[120:123],a[48:51]
mf v[132:135],a[120:123],a[52:55]
mf v[132:135],a[80:83],a[20:23]
mf v[136:139],a[80:83],a[24:27]
mf v[136:139],a[120:123],a[56:59]
mf v[140:143],a[120:123],a[60:63]
mf v[140:143],a[80:83],a[28:31]
ds_read2st64_b32 v[8:9], v43 offset0:0 offset1:1
ds_read2st64_b32 v[10:11], v43 offset0:2 offset1:3
ds_read2st64_b32 v[12:13], v43 offset0:4 offset1:5
ds_read2st64_b32 v[14:15], v43 offset0:6 offset1:7
s_waitcnt vmcnt(0) lgkmcnt(4)
s_barrier
ds_read_b64 v[6:7], v44 offset:256
ds_read_b64 v[46:47], v44 offset:264
ds_read_b64 v[18:19], v44 offset:128
ds_read_b32 v20, v44 offset:136
ds_read_b32 v45, v44 offset:140
mf v[144:147],a[84:87],a[0:3]
dq a[0:3],v16,32768
mf v[144:147],a[124:127],a[32:35]
s_waitcnt lgkmcnt(4)
dq a[32:35],v17,32768
v_fmac_f32 v112, v8, v6
mf v[148:151],a[124:127],a[36:39]
dq a[36:39],v17,34816
v_fmac_f32 v113, v8, v7
mf v[148:151],a[84:87],a[4:7]
dq a[4:7],v16,34816
v_fmac_f32 v114, v8, v46
mf v[152:155],a[84:87],a[8:11]
dq a[8:11],v16,36864
v_fmac_f32 v115, v8, v47
mf v[152:155],a[124:127],a[40:43]
dq a[40:43],v17,36864
v_fmac_f32 v116, v9, v6
mf v[156:159],a[124:127],a[44:47]
dq a[44:47],v17,38912
v_fmac_f32 v117, v9, v7
mf v[156:159],a[84:87],a[12:15]
dq a[12:15],v16,38912
v_fmac_f32 v118, v9, v46
mf v[160:163],a[84:87],a[16:19]
dq a[16:19],v16,40960
v_fmac_f32 v119, v9, v47
mf v[160:163],a[124:127],a[48:51]
dq a[48:51],v17,40960
v_fmac_f32 v120, v10, v6
mf v[164:167],a[124:127],a[52:55]
dq a[52:55],v17,43008
v_fmac_f32 v121, v10, v7
mf v[164:167],a[84:87],a[20:23]
dq a[20:23],v16,43008
v_fmac_f32 v122, v10, v46
mf v[168:171],a[84:87],a[24:27]
dq a[24:27],v16,45056
v_fmac_f32 v123, v10, v47
mf v[168:171],a[124:127],a[56:59]
dq a[56:59],v17,45056
v_fmac_f32 v124, v11, v6
mf v[172:175],a[124:127],a[60:63]
dq a[60:63],v17,47104
v_fmac_f32 v125, v11, v7
mf v[172:175],a[84:87],a[28:31]
s_waitcnt lgkmcnt(13)
dq a[28:31],v16,47104
v_fmac_f32 v126, v11, v46
mf v[48:51],a[72:75],a[0:3]
dt a[76:77],v22,4096
v_fmac_f32 v127, v11, v47
mf v[48:51],a[112:115],a[32:35]
s_waitcnt lgkmcnt(13)
dt a[78:79],v22,4608
v_fmac_f32 v128, v12, v6
mf v[52:55],a[112:115],a[36:39]
dt a[116:117],v22,24576
v_fmac_f32 v129, v12, v7
mf v[52:55],a[72:75],a[4:7]
s_waitcnt lgkmcnt(13)
dt a[118:119],v22,25088
v_fmac_f32 v130, v12, v46
mf v[56:59],a[72:75],a[8:11]
dt a[80:81],v21,8192
v_fmac_f32 v131, v12, v47
mf v[56:59],a[112:115],a[40:43]
s_waitcnt lgkmcnt(13)
dt a[82:83],v21,8704
v_fmac_f32 v132, v13, v6
mf v[60:63],a[112:115],a[44:47]
dt a[120:121],v21,28672
v_fmac_f32 v133, v13, v7
mf v[60:63],a[72:75],a[12:15]
s_waitcnt lgkmcnt(13)
dt a[122:123],v21,29184
v_fmac_f32 v134, v13, v46
mf v[64:67],a[72:75],a[16:19]
v_fmac_f32 v135, v13, v47
v_fmac_f32 v136, v14, v6
mf v[64:67],a[112:115],a[48:51]
s_waitcnt lgkmcnt(12)
v_fmac_f32 v137, v14, v7
v_fmac_f32 v138, v14, v46
mf v[68:71],a[112:115],a[52:55]
v_fmac_f32 v139, v14, v47
v_fmac_f32 v140, v15, v6
mf v[68:71],a[72:75],a[20:23]
s_waitcnt lgkmcnt(10)
v_fmac_f32 v141, v15, v7
v_fmac_f32 v142, v15, v46
mf v[72:75],a[72:75],a[24:27]
v_fmac_f32 v143, v15, v47
mf v[72:75],a[112:115],a[56:59]
s_waitcnt lgkmcnt(8)
ds_read_b64 v[6:7], v44 offset:192
mf v[76:79],a[112:115],a[60:63]
ds_read_b64 v[46:47], v44 offset:200
mf v[76:79],a[72:75],a[28:31]
s_waitcnt lgkmcnt(6)
mf v[108:111],a[76:79],a[28:31]
s_waitcnt lgkmcnt(15)
v_fmac_f32 v48, v8, v18
v_fmac_f32 v49, v8, v19
mf v[108:111],a[116:119],a[60:63]
dt a[84:85],v22,8192
v_fmac_f32 v50, v8, v20
mf v[104:107],a[116:119],a[56:59]
v_fmac_f32 v51, v8, v45
v_fmac_f32 v52, v9, v18
mf v[104:107],a[76:79],a[24:27]
dt a[86:87],v22,8704
v_fmac_f32 v53, v9, v19
mf v[100:103],a[76:79],a[20:23]
v_fmac_f32 v54, v9, v20
v_fmac_f32 v55, v9, v45
mf v[100:103],a[116:119],a[52:55]
dt a[124:125],v22,28672
v_fmac_f32 v56, v10, v18
mf v[96:99],a[116:119],a[48:51]
v_fmac_f32 v57, v10, v19
v_fmac_f32 v58, v10, v20
mf v[96:99],a[76:79],a[16:19]
dt a[126:127],v22,29184
v_fmac_f32 v59, v10, v45
mf v[92:95],a[76:79],a[12:15]
v_fmac_f32 v60, v11, v18
v_fmac_f32 v61, v11, v19
mf v[92:95],a[116:119],a[44:47]
v_fmac_f32 v62, v11, v20
v_fmac_f32 v63, v11, v45
mf v[88:91],a[116:119],a[40:43]
v_fmac_f32 v64, v12, v18
v_fmac_f32 v65, v12, v19
mf v[88:91],a[76:79],a[8:11]
v_fmac_f32 v66, v12, v20
v_fmac_f32 v67, v12, v45
mf v[84:87],a[76:79],a[4:7]
v_fmac_f32 v68, v13, v18
v_fmac_f32 v69, v13, v19
mf v[84:87],a[116:119],a[36:39]
v_fmac_f32 v70, v13, v20
v_fmac_f32 v71, v13, v45
mf v[80:83],a[116:119],a[32:35]
v_fmac_f32 v72, v14, v18
v_fmac_f32 v73, v14, v19
mf v[80:83],a[76:79],a[0:3]
s_waitcnt lgkmcnt(6)
v_fmac_f32 v74, v14, v20
v_fmac_f32 v75, v14, v45
mf v[112:115],a[80:83],a[0:3]
v_fmac_f32 v76, v15, v18
v_fmac_f32 v77, v15, v19
mf v[112:115],a[120:123],a[32:35]
v_fmac_f32 v78, v15, v20
v_fmac_f32 v79, v15, v45
mf v[116:119],a[120:123],a[36:39]
ds_read_b64 v[18:19], v44 offset:320
mf v[116:119],a[80:83],a[4:7]
ds_read_b32 v20, v44 offset:328
mf v[120:123],a[80:83],a[8:11]
ds_read_b32 v45, v44 offset:332
s_waitcnt lgkmcnt(7)
mf v[120:123],a[120:123],a[40:43]
v_fmac_f32 v80, v8, v6
v_fmac_f32 v81, v8, v7
mf v[124:127],a[120:123],a[44:47]
v_fmac_f32 v82, v8, v46
v_fmac_f32 v83, v8, v47
mf v[124:127],a[80:83],a[12:15]
v_fmac_f32 v84, v9, v6
v_fmac_f32 v85, v9, v7
mf v[128:131],a[80:83],a[16:19]
v_fmac_f32 v86, v9, v46
v_fmac_f32 v87, v9, v47
mf v[128:131],a[120:123],a[48:51]
v_fmac_f32 v88, v10, v6
v_fmac_f32 v89, v10, v7
mf v[132:135],a[120:123],a[52:55]
v_fmac_f32 v90, v10, v46
v_fmac_f32 v91, v10, v47
mf v[132:135],a[80:83],a[20:23]
v_fmac_f32 v92, v11, v6
v_fmac_f32 v93, v11, v7
mf v[136:139],a[80:83],a[24:27]
v_fmac_f32 v94, v11, v46
v_fmac_f32 v95, v11, v47
mf v[136:139],a[120:123],a[56:59]
v_fmac_f32 v96, v12, v6
v_fmac_f32 v97, v12, v7
mf v[140:143],a[120:123],a[60:63]
v_fmac_f32 v98, v12, v46
v_fmac_f32 v99, v12, v47
mf v[140:143],a[80:83],a[28:31]
s_waitcnt lgkmcnt(3)
v_fmac_f32 v100, v13, v6
v_fmac_f32 v101, v13, v7
mf v[144:147],a[84:87],a[0:3]
dq a[0:3],v16,0
v_fmac_f32 v102, v13, v46
mf v[144:147],a[124:127],a[32:35]
dq a[32:35],v17,0
v_fmac_f32 v103, v13, v47
mf v[148:151],a[124:127],a[36:39]
dq a[36:39],v17,2048
v_fmac_f32 v104, v14, v6
mf v[148:151],a[84:87],a[4:7]
dq a[4:7],v16,2048
v_fmac_f32 v105, v14, v7
mf v[152:155],a[84:87],a[8:11]
dq a[8:11],v16,4096
v_fmac_f32 v106, v14, v46
mf v[152:155],a[124:127],a[40:43]
dq a[40:43],v17,4096
v_fmac_f32 v107, v14, v47
mf v[156:159],a[124:127],a[44:47]
dq a[44:47],v17,6144
v_fmac_f32 v108, v15, v6
mf v[156:159],a[84:87],a[12:15]
dq a[12:15],v16,6144
v_fmac_f32 v109, v15, v7
mf v[160:163],a[84:87],a[16:19]
dq a[16:19],v16,8192
v_fmac_f32 v110, v15, v46
mf v[160:163],a[124:127],a[48:51]
dq a[48:51],v17,8192
v_fmac_f32 v111, v15, v47
mf v[164:167],a[124:127],a[52:55]
dq a[52:55],v17,10240
mf v[164:167],a[84:87],a[20:23]
dq a[20:23],v16,10240
mf v[168:171],a[84:87],a[24:27]
dq a[24:27],v16,12288
mf v[168:171],a[124:127],a[56:59]
dq a[56:59],v17,12288
mf v[172:175],a[124:127],a[60:63]
dq a[60:63],v17,14336
mf v[172:175],a[84:87],a[28:31]
s_waitcnt lgkmcnt(13)
dq a[28:31],v16,14336
mf v[176:179],a[88:91],a[0:3]
ds_read_b64 v[6:7], v43 offset:8
mf v[176:179],a[128:131],a[32:35]
s_waitcnt lgkmcnt(13)
ds_read_b32 v46, v43 offset:4
s_waitcnt lgkmcnt(15)
mf v[180:183],a[128:131],a[36:39]
v_fmac_f32 v144, v8, v18
v_fmac_f32 v145, v8, v19
mf v[180:183],a[88:91],a[4:7]
s_waitcnt lgkmcnt(12)
v_fmac_f32 v146, v8, v20
v_fmac_f32 v147, v8, v45
mf v[184:187],a[88:91],a[8:11]
v_fmac_f32 v148, v9, v18
v_fmac_f32 v149, v9, v19
mf v[184:187],a[128:131],a[40:43]
s_waitcnt lgkmcnt(10)
v_fmac_f32 v150, v9, v20
v_fmac_f32 v151, v9, v45
mf v[188:191],a[128:131],a[44:47]
v_fmac_f32 v152, v10, v18
v_fmac_f32 v153, v10, v19
mf v[188:191],a[88:91],a[12:15]
s_waitcnt lgkmcnt(8)
v_fmac_f32 v154, v10, v20
v_fmac_f32 v155, v10, v45
mf v[192:195],a[88:91],a[16:19]
v_fmac_f32 v156, v11, v18
v_fmac_f32 v157, v11, v19
mf v[192:195],a[128:131],a[48:51]
s_waitcnt lgkmcnt(6)
v_fmac_f32 v158, v11, v20
v_fmac_f32 v159, v11, v45
mf v[196:199],a[128:131],a[52:55]
v_fmac_f32 v160, v12, v18
v_fmac_f32 v161, v12, v19
mf v[196:199],a[88:91],a[20:23]
s_waitcnt lgkmcnt(4)
v_fmac_f32 v162, v12, v20
v_fmac_f32 v163, v12, v45
mf v[200:203],a[88:91],a[24:27]
v_fmac_f32 v164, v13, v18
v_fmac_f32 v165, v13, v19
mf v[200:203],a[128:131],a[56:59]
s_waitcnt lgkmcnt(2)
v_fmac_f32 v166, v13, v20
v_fmac_f32 v167, v13, v45
mf v[204:207],a[128:131],a[60:63]
v_fmac_f32 v168, v14, v18
v_fmac_f32 v169, v14, v19
mf v[204:207],a[88:91],a[28:31]
v_fmac_f32 v170, v14, v20
v_fmac_f32 v171, v14, v45
mf v[236:239],a[92:95],a[28:31]
v_fmac_f32 v172, v15, v18
v_fmac_f32 v173, v15, v19
mf v[236:239],a[132:135],a[60:63]
dt a[88:89],v21,12288
v_fmac_f32 v174, v15, v20
mf v[232:235],a[132:135],a[56:59]
v_fmac_f32 v175, v15, v45
s_lshr_b32 s10, s76, 6
mf v[232:235],a[92:95],a[24:27]
s_add_u32 s10, s10, s22
dt a[90:91],v21,12800
s_lshl_b32 s10, s10, 13
mf v[228:231],a[92:95],a[20:23]
s_add_u32 s10, s10, s78
v_mul_f32 v8, v48, v48
v_mul_f32 v9, v49, v49
mf v[228:231],a[132:135],a[52:55]
dt a[128:129],v21,32768
v_mul_f32 v10, v50, v50
mf v[224:227],a[132:135],a[48:51]
v_mul_f32 v11, v51, v51
v_mul_f32 v12, v80, v80
mf v[224:227],a[92:95],a[16:19]
dt a[130:131],v21,33280
v_mul_f32 v13, v81, v81
mf v[220:223],a[92:95],a[12:15]
v_mul_f32 v14, v82, v82
v_mul_f32 v15, v83, v83
mf v[220:223],a[132:135],a[44:47]
s_waitcnt lgkmcnt(4)
v_fma_f32 v8, v8, v6, v46
v_fma_f32 v9, v9, v6, v46
mf v[216:219],a[132:135],a[40:43]
v_fma_f32 v10, v10, v6, v46
v_fma_f32 v11, v11, v6, v46
mf v[216:219],a[92:95],a[8:11]
v_fma_f32 v12, v12, v6, v46
v_fma_f32 v13, v13, v6, v46
mf v[212:215],a[92:95],a[4:7]
v_fma_f32 v14, v14, v6, v46
v_fma_f32 v15, v15, v6, v46
mf v[212:215],a[132:135],a[36:39]
v_mul_f32 v8, v8, v48
v_mul_f32 v9, v9, v49
mf v[208:211],a[132:135],a[32:35]
v_mul_f32 v10, v10, v50
v_mul_f32 v11, v11, v51
mf v[208:211],a[92:95],a[0:3]
v_mul_f32 v12, v12, v80
v_mul_f32 v13, v13, v81
mf a[144:147],a[64:67],a[0:3]
v_readlane_b32 s70, v25, 0
v_readlane_b32 s71, v26, 0
mf a[144:147],a[104:107],a[32:35]
dt a[92:93],v22,12288
v_mul_f32 v14, v14, v82
mf a[148:151],a[104:107],a[36:39]
v_mul_f32 v15, v15, v83
v_mul_f32 v112, v48, v112
mf a[148:151],a[64:67],a[4:7]
dt a[94:95],v22,12800
v_mul_f32 v113, v49, v113
mf a[152:155],a[64:67],a[8:11]
s_add_u32 m0, s67, 0
v_mul_f32 v114, v50, v114
v_mul_f32 v115, v51, v115
mf a[152:155],a[104:107],a[40:43]
dt a[132:133],v22,32768
buffer_load_dwordx4 v31, s[48:51], s70 offen offset:0 sc1 lds
mf a[156:159],a[104:107],a[44:47]
v_mul_f32 v144, v80, v144
v_mul_f32 v145, v81, v145
mf a[156:159],a[64:67],a[12:15]
dt a[134:135],v22,33280
v_mul_f32 v146, v82, v146
mf a[160:163],a[64:67],a[16:19]
s_add_u32 m0, s67, 8064
v_mul_f32 v147, v83, v147
mf a[160:163],a[104:107],a[48:51]
buffer_load_dwordx4 v31, s[48:51], s70 offen offset:128 sc1 lds
dq v[80:83],v43,256
mf a[164:167],a[104:107],a[52:55]
s_add_u32 m0, s67, 1024
v_exp_f32 v8, v8
mf a[164:167],a[64:67],a[20:23]
buffer_load_dwordx4 v31, s[48:51], s71 offen offset:0 sc1 lds
mf a[168:171],a[64:67],a[24:27]
v_exp_f32 v9, v9
mf a[168:171],a[104:107],a[56:59]
v_exp_f32 v10, v10
mf a[172:175],a[104:107],a[60:63]
s_add_u32 m0, s67, 9088
v_exp_f32 v11, v11
mf a[172:175],a[64:67],a[28:31]
buffer_load_dwordx4 v31, s[48:51], s71 offen offset:128 sc1 lds
mf a[204:207],a[68:71],a[28:31]
v_readlane_b32 s70, v25, 1
v_readlane_b32 s71, v26, 1
mf a[204:207],a[108:111],a[60:63]
dt a[64:65],v21,0
mf a[200:203],a[108:111],a[56:59]
v_exp_f32 v12, v12
mf a[200:203],a[68:71],a[24:27]
dt a[66:67],v21,512
mf a[196:199],a[68:71],a[20:23]
s_add_u32 m0, s67, 16384
v_exp_f32 v13, v13
mf a[196:199],a[108:111],a[52:55]
dt a[104:105],v21,20480
buffer_load_dwordx4 v31, s[48:51], s70 offen offset:0 sc1 lds
mf a[192:195],a[108:111],a[48:51]
v_exp_f32 v14, v14
mf a[192:195],a[68:71],a[16:19]
dt a[106:107],v21,20992
mf a[188:191],a[68:71],a[12:15]
s_add_u32 m0, s67, 24448
v_exp_f32 v15, v15
mf a[188:191],a[108:111],a[44:47]
buffer_load_dwordx4 v31, s[48:51], s70 offen offset:128 sc1 lds
v_fma_f32 v8, v8, v7, v7
mf a[184:187],a[108:111],a[40:43]
s_add_u32 m0, s67, 17408
v_fma_f32 v9, v9, v7, v7
v_fma_f32 v10, v10, v7, v7
mf a[184:187],a[68:71],a[8:11]
buffer_load_dwordx4 v31, s[48:51], s71 offen offset:0 sc1 lds
v_fma_f32 v11, v11, v7, v7
mf a[180:183],a[68:71],a[4:7]
v_fma_f32 v12, v12, v7, v7
v_fma_f32 v13, v13, v7, v7
mf a[180:183],a[108:111],a[36:39]
v_fma_f32 v14, v14, v7, v7
v_fma_f32 v15, v15, v7, v7
mf a[176:179],a[108:111],a[32:35]
s_add_u32 m0, s67, 25472
v_rcp_f32 v8, v8
mf a[176:179],a[68:71],a[0:3]
buffer_load_dwordx4 v31, s[48:51], s71 offen offset:128 sc1 lds
mf v[240:243],a[96:99],a[0:3]
v_rcp_f32 v9, v9
mf v[240:243],a[136:139],a[32:35]
dt a[68:69],v22,0
mf v[244:247],a[136:139],a[36:39]
v_rcp_f32 v10, v10
mf v[244:247],a[96:99],a[4:7]
dt a[70:71],v22,512
mf a[208:211],a[96:99],a[8:11]
v_rcp_f32 v11, v11
mf a[208:211],a[136:139],a[40:43]
dt a[108:109],v22,20480
mf a[212:215],a[136:139],a[44:47]
v_rcp_f32 v12, v12
mf a[212:215],a[96:99],a[12:15]
dt a[110:111],v22,20992
mf a[216:219],a[96:99],a[16:19]
v_rcp_f32 v13, v13
mf a[216:219],a[136:139],a[48:51]
v_rcp_f32 v14, v14
mf a[220:223],a[136:139],a[52:55]
v_rcp_f32 v15, v15
mf a[220:223],a[96:99],a[20:23]
v_mul_f32 v8, v8, v112
v_mul_f32 v9, v9, v113
mf a[224:227],a[96:99],a[24:27]
v_mul_f32 v10, v10, v114
v_mul_f32 v11, v11, v115
mf a[224:227],a[136:139],a[56:59]
v_mul_f32 v12, v12, v144
v_mul_f32 v13, v13, v145
mf a[228:231],a[136:139],a[60:63]
v_mul_f32 v14, v14, v146
v_mul_f32 v15, v15, v147
mf a[228:231],a[96:99],a[28:31]
v_cvt_pk_bf16_f32 v48, v8, v9
v_cvt_pk_bf16_f32 v49, v10, v11
mf v[248:251],a[100:103],a[0:3]
dq a[0:3],v16,32768
v_cvt_pk_bf16_f32 v50, v12, v13
mf v[248:251],a[140:143],a[32:35]
dq a[32:35],v17,32768
v_cvt_pk_bf16_f32 v51, v14, v15
mf v[252:255],a[140:143],a[36:39]
dq a[36:39],v17,34816
mf v[252:255],a[100:103],a[4:7]
dq a[4:7],v16,34816
buffer_store_dwordx4 v[48:51], v3, s[28:31], s10 offen offset:0 sc1
mf a[232:235],a[100:103],a[8:11]
dq a[8:11],v16,36864
v_mul_f32 v8, v52, v52
mf a[232:235],a[140:143],a[40:43]
dq a[40:43],v17,36864
v_mul_f32 v9, v53, v53
mf a[236:239],a[140:143],a[44:47]
dq a[44:47],v17,38912
v_mul_f32 v10, v54, v54
mf a[236:239],a[100:103],a[12:15]
dq a[12:15],v16,38912
v_mul_f32 v11, v55, v55
mf a[240:243],a[100:103],a[16:19]
dq a[16:19],v16,40960
v_mul_f32 v12, v84, v84
mf a[240:243],a[140:143],a[48:51]
dq a[48:51],v17,40960
v_mul_f32 v13, v85, v85
mf a[244:247],a[140:143],a[52:55]
dq a[52:55],v17,43008
v_mul_f32 v14, v86, v86
mf a[244:247],a[100:103],a[20:23]
dq a[20:23],v16,43008
v_mul_f32 v15, v87, v87
mf a[248:251],a[100:103],a[24:27]
s_waitcnt lgkmcnt(15)
dq a[24:27],v16,45056
v_fma_f32 v8, v8, v82, v81
mf a[248:251],a[140:143],a[56:59]
dq a[56:59],v17,45056
v_fma_f32 v9, v9, v82, v81
mf a[252:255],a[140:143],a[60:63]
dq a[60:63],v17,47104
v_fma_f32 v10, v10, v82, v81
mf a[252:255],a[100:103],a[28:31]
s_waitcnt lgkmcnt(13)
dq a[28:31],v16,47104
v_fma_f32 v11, v11, v82, v81
mf v[176:179],a[88:91],a[0:3]
dt a[96:97],v21,16384
v_fma_f32 v12, v12, v82, v81
mf v[176:179],a[128:131],a[32:35]
s_waitcnt lgkmcnt(13)
dt a[98:99],v21,16896
v_fma_f32 v13, v13, v82, v81
mf v[180:183],a[128:131],a[36:39]
dt a[136:137],v21,36864
v_fma_f32 v14, v14, v82, v81
mf v[180:183],a[88:91],a[4:7]
s_waitcnt lgkmcnt(13)
dt a[138:139],v21,37376
v_fma_f32 v15, v15, v82, v81
mf v[184:187],a[88:91],a[8:11]
dt a[100:101],v22,16384
v_mul_f32 v8, v8, v52
mf v[184:187],a[128:131],a[40:43]
s_waitcnt lgkmcnt(13)
dt a[102:103],v22,16896
v_mul_f32 v9, v9, v53
mf v[188:191],a[128:131],a[44:47]
dt a[140:141],v22,36864
v_mul_f32 v10, v10, v54
mf v[188:191],a[88:91],a[12:15]
s_waitcnt lgkmcnt(13)
dt a[142:143],v22,37376
v_mul_f32 v11, v11, v55
mf v[192:195],a[88:91],a[16:19]
v_mul_f32 v12, v12, v84
v_mul_f32 v13, v13, v85
mf v[192:195],a[128:131],a[48:51]
s_waitcnt lgkmcnt(12)
v_mul_f32 v14, v14, v86
v_mul_f32 v15, v15, v87
mf v[196:199],a[128:131],a[52:55]
v_mul_f32 v116, v52, v116
v_mul_f32 v117, v53, v117
mf v[196:199],a[88:91],a[20:23]
s_waitcnt lgkmcnt(10)
v_mul_f32 v118, v54, v118
v_mul_f32 v119, v55, v119
mf v[200:203],a[88:91],a[24:27]
v_mul_f32 v148, v84, v148
v_mul_f32 v149, v85, v149
mf v[200:203],a[128:131],a[56:59]
s_waitcnt lgkmcnt(8)
v_mul_f32 v150, v86, v150
v_mul_f32 v151, v87, v151
mf v[204:207],a[128:131],a[60:63]
dq v[84:87],v43,512
mf v[204:207],a[88:91],a[28:31]
s_waitcnt lgkmcnt(1)
s_barrier
mf v[236:239],a[92:95],a[28:31]
v_readlane_b32 s70, v25, 2
v_readlane_b32 s71, v26, 2
mf v[236:239],a[132:135],a[60:63]
v_exp_f32 v8, v8
mf v[232:235],a[132:135],a[56:59]
v_exp_f32 v9, v9
mf v[232:235],a[92:95],a[24:27]
v_exp_f32 v10, v10
mf v[228:231],a[92:95],a[20:23]
s_add_u32 m0, s67, 32768
v_exp_f32 v11, v11
mf v[228:231],a[132:135],a[52:55]
buffer_load_dwordx4 v31, s[48:51], s70 offen offset:0 sc1 lds
mf v[224:227],a[132:135],a[48:51]
L_stub17:
s_cbranch_execz L_stub20
v_exp_f32 v12, v12
mf v[224:227],a[92:95],a[16:19]
v_exp_f32 v13, v13
mf v[220:223],a[92:95],a[12:15]
s_add_u32 m0, s67, 40832
v_exp_f32 v14, v14
mf v[220:223],a[132:135],a[44:47]
buffer_load_dwordx4 v31, s[48:51], s70 offen offset:128 sc1 lds
mf v[216:219],a[132:135],a[40:43]
s_add_u32 m0, s67, 33792
v_exp_f32 v15, v15
mf v[216:219],a[92:95],a[8:11]
buffer_load_dwordx4 v31, s[48:51], s71 offen offset:0 sc1 lds
v_fma_f32 v8, v8, v83, v83
mf v[212:215],a[92:95],a[4:7]
v_fma_f32 v9, v9, v83, v83
v_fma_f32 v10, v10, v83, v83
mf v[212:215],a[132:135],a[36:39]
v_fma_f32 v11, v11, v83, v83
v_fma_f32 v12, v12, v83, v83
mf v[208:211],a[132:135],a[32:35]
s_add_u32 m0, s67, 41856
v_fma_f32 v13, v13, v83, v83
v_fma_f32 v14, v14, v83, v83
mf v[208:211],a[92:95],a[0:3]
buffer_load_dwordx4 v31, s[48:51], s71 offen offset:128 sc1 lds
v_fma_f32 v15, v15, v83, v83
mf a[144:147],a[64:67],a[0:3]
v_readlane_b32 s70, v25, 3
v_readlane_b32 s71, v26, 3
mf a[144:147],a[104:107],a[32:35]
v_rcp_f32 v8, v8
mf a[148:151],a[104:107],a[36:39]
v_rcp_f32 v9, v9
mf a[148:151],a[64:67],a[4:7]
v_rcp_f32 v10, v10
mf a[152:155],a[64:67],a[8:11]
s_add_u32 m0, s67, 49152
v_rcp_f32 v11, v11
mf a[152:155],a[104:107],a[40:43]
buffer_load_dwordx4 v31, s[48:51], s70 offen offset:0 sc1 lds
mf a[156:159],a[104:107],a[44:47]
v_rcp_f32 v12, v12
mf a[156:159],a[64:67],a[12:15]
v_rcp_f32 v13, v13
mf a[160:163],a[64:67],a[16:19]
s_add_u32 m0, s67, 57216
v_rcp_f32 v14, v14
mf a[160:163],a[104:107],a[48:51]
buffer_load_dwordx4 v31, s[48:51], s70 offen offset:128 sc1 lds
mf a[164:167],a[104:107],a[52:55]
s_add_u32 m0, s67, 50176
v_rcp_f32 v15, v15
mf a[164:167],a[64:67],a[20:23]
buffer_load_dwordx4 v31, s[48:51], s71 offen offset:0 sc1 lds
v_mul_f32 v8, v8, v116
mf a[168:171],a[64:67],a[24:27]
v_mul_f32 v9, v9, v117
v_mul_f32 v10, v10, v118
mf a[168:171],a[104:107],a[56:59]
v_mul_f32 v11, v11, v119
v_mul_f32 v12, v12, v148
mf a[172:175],a[104:107],a[60:63]
s_add_u32 m0, s67, 58240
v_mul_f32 v13, v13, v149
v_mul_f32 v14, v14, v150
mf a[172:175],a[64:67],a[28:31]
buffer_load_dwordx4 v31, s[48:51], s71 offen offset:128 sc1 lds
v_mul_f32 v15, v15, v151
mf a[204:207],a[68:71],a[28:31]
v_lshrrev_b32 v39, 3, v2
v_lshlrev_b32 v39, 4, v39
mf a[204:207],a[108:111],a[60:63]
s_mov_b32 s3, 0
v_xor_b32 v39, v39, v38
v_cvt_pk_bf16_f32 v52, v8, v9
mf a[200:203],a[108:111],a[56:59]
s_add_u32 m0, s65, 16384
v_cvt_pk_bf16_f32 v53, v10, v11
v_cvt_pk_bf16_f32 v54, v12, v13
mf a[200:203],a[68:71],a[24:27]
buffer_load_dwordx4 v39, s[56:59], s3 offen lds
v_cvt_pk_bf16_f32 v55, v14, v15
mf a[196:199],a[68:71],a[20:23]
v_mul_f32 v8, v56, v56
v_mul_f32 v9, v57, v57
mf a[196:199],a[108:111],a[52:55]
s_mov_b32 s3, 16384
v_mul_f32 v10, v58, v58
v_mul_f32 v11, v59, v59
mf a[192:195],a[108:111],a[48:51]
s_add_u32 m0, s65, 17408
v_mul_f32 v12, v88, v88
v_mul_f32 v13, v89, v89
mf a[192:195],a[68:71],a[16:19]
buffer_load_dwordx4 v39, s[56:59], s3 offen lds
v_mul_f32 v14, v90, v90
mf a[188:191],a[68:71],a[12:15]
v_mul_f32 v15, v91, v91
s_waitcnt lgkmcnt(0)
mf a[188:191],a[108:111],a[44:47]
s_mov_b32 s3, 32768
v_fma_f32 v8, v8, v86, v85
v_fma_f32 v9, v9, v86, v85
mf a[184:187],a[108:111],a[40:43]
s_add_u32 m0, s65, 18432
v_fma_f32 v10, v10, v86, v85
v_fma_f32 v11, v11, v86, v85
mf a[184:187],a[68:71],a[8:11]
buffer_load_dwordx4 v39, s[56:59], s3 offen lds
v_fma_f32 v12, v12, v86, v85
mf a[180:183],a[68:71],a[4:7]
v_fma_f32 v13, v13, v86, v85
v_fma_f32 v14, v14, v86, v85
mf a[180:183],a[108:111],a[36:39]
s_mov_b32 s3, 49152
v_fma_f32 v15, v15, v86, v85
v_mul_f32 v8, v8, v56
mf a[176:179],a[108:111],a[32:35]
s_add_u32 m0, s65, 19456
v_mul_f32 v9, v9, v57
v_mul_f32 v10, v10, v58
mf a[176:179],a[68:71],a[0:3]
buffer_load_dwordx4 v39, s[56:59], s3 offen lds
v_mul_f32 v11, v11, v59
mf v[240:243],a[96:99],a[0:3]
dq v[20:23],v43,768
v_mul_f32 v12, v12, v88
mf v[240:243],a[136:139],a[32:35]
v_mul_f32 v13, v13, v89
v_mul_f32 v14, v14, v90
mf v[244:247],a[136:139],a[36:39]
v_mul_f32 v15, v15, v91
v_mul_f32 v120, v56, v120
mf v[244:247],a[96:99],a[4:7]
v_mul_f32 v121, v57, v121
v_mul_f32 v122, v58, v122
mf a[208:211],a[96:99],a[8:11]
v_mul_f32 v123, v59, v123
v_mul_f32 v152, v88, v152
mf a[208:211],a[136:139],a[40:43]
v_mul_f32 v153, v89, v153
v_mul_f32 v154, v90, v154
mf a[212:215],a[136:139],a[44:47]
v_mul_f32 v155, v91, v155
mf a[212:215],a[96:99],a[12:15]
v_exp_f32 v8, v8
mf a[216:219],a[96:99],a[16:19]
v_exp_f32 v9, v9
mf a[216:219],a[136:139],a[48:51]
v_exp_f32 v10, v10
mf a[220:223],a[136:139],a[52:55]
v_exp_f32 v11, v11
mf a[220:223],a[96:99],a[20:23]
v_exp_f32 v12, v12
mf a[224:227],a[96:99],a[24:27]
v_exp_f32 v13, v13
mf a[224:227],a[136:139],a[56:59]
v_exp_f32 v14, v14
mf a[228:231],a[136:139],a[60:63]
v_exp_f32 v15, v15
mf a[228:231],a[96:99],a[28:31]
v_fma_f32 v8, v8, v87, v87
v_fma_f32 v9, v9, v87, v87
mf v[248:251],a[100:103],a[0:3]
v_fma_f32 v10, v10, v87, v87
v_fma_f32 v11, v11, v87, v87
mf v[248:251],a[140:143],a[32:35]
v_fma_f32 v12, v12, v87, v87
v_fma_f32 v13, v13, v87, v87
mf v[252:255],a[140:143],a[36:39]
v_fma_f32 v14, v14, v87, v87
v_fma_f32 v15, v15, v87, v87
mf v[252:255],a[100:103],a[4:7]
v_rcp_f32 v8, v8
mf a[232:235],a[100:103],a[8:11]
v_rcp_f32 v9, v9
mf a[232:235],a[140:143],a[40:43]
v_rcp_f32 v10, v10
mf a[236:239],a[140:143],a[44:47]
v_rcp_f32 v11, v11
mf a[236:239],a[100:103],a[12:15]
v_rcp_f32 v12, v12
mf a[240:243],a[100:103],a[16:19]
v_rcp_f32 v13, v13
mf a[240:243],a[140:143],a[48:51]
v_rcp_f32 v14, v14
mf a[244:247],a[140:143],a[52:55]
v_rcp_f32 v15, v15
mf a[244:247],a[100:103],a[20:23]
v_mul_f32 v8, v8, v120
v_mul_f32 v9, v9, v121
mf a[248:251],a[100:103],a[24:27]
v_mul_f32 v10, v10, v122
v_mul_f32 v11, v11, v123
mf a[248:251],a[140:143],a[56:59]
v_mul_f32 v12, v12, v152
v_mul_f32 v13, v13, v153
mf a[252:255],a[140:143],a[60:63]
v_mul_f32 v14, v14, v154
v_mul_f32 v15, v15, v155
mf a[252:255],a[100:103],a[28:31]
v_cvt_pk_bf16_f32 v56, v8, v9
v_cvt_pk_bf16_f32 v57, v10, v11
v_cvt_pk_bf16_f32 v58, v12, v13
v_cvt_pk_bf16_f32 v59, v14, v15
buffer_store_dwordx4 v[52:55], v3, s[28:31], s10 offen offset:1024 sc1
buffer_store_dwordx4 v[56:59], v3, s[28:31], s10 offen offset:2048 sc1
L_epiQ:
s_lshr_b32 s70, s76, 6
s_add_u32 s70, s70, s22
s_lshl_b32 s70, s70, 13
s_add_u32 s70, s70, s78
s_add_u32 s71, s70, 4096
s_waitcnt lgkmcnt(0)
s_nop 0
dq v[16:19],v43,1024
v_pk_mul_f32 v[8:9], v[60:61], v[60:61]
v_pk_mul_f32 v[10:11], v[62:63], v[62:63]
v_pk_mul_f32 v[12:13], v[92:93], v[92:93]
v_pk_mul_f32 v[14:15], v[94:95], v[94:95]
v_pk_fma_f32 v[8:9], v[8:9], v[22:23], v[20:21] op_sel:[0,0,1] op_sel_hi:[1,0,1]
v_pk_fma_f32 v[10:11], v[10:11], v[22:23], v[20:21] op_sel:[0,0,1] op_sel_hi:[1,0,1]
v_pk_fma_f32 v[12:13], v[12:13], v[22:23], v[20:21] op_sel:[0,0,1] op_sel_hi:[1,0,1]
v_pk_fma_f32 v[14:15], v[14:15], v[22:23], v[20:21] op_sel:[0,0,1] op_sel_hi:[1,0,1]
v_pk_mul_f32 v[8:9], v[8:9], v[60:61]
v_pk_mul_f32 v[10:11], v[10:11], v[62:63]
v_pk_mul_f32 v[12:13], v[12:13], v[92:93]
v_pk_mul_f32 v[14:15], v[14:15], v[94:95]
v_exp_f32 v8, v8
v_exp_f32 v9, v9
v_exp_f32 v10, v10
v_exp_f32 v11, v11
v_exp_f32 v12, v12
v_exp_f32 v13, v13
v_exp_f32 v14, v14
v_exp_f32 v15, v15
v_pk_mul_f32 v[124:125], v[60:61], v[124:125]
v_pk_mul_f32 v[126:127], v[62:63], v[126:127]
v_pk_mul_f32 v[156:157], v[92:93], v[156:157]
v_pk_mul_f32 v[158:159], v[94:95], v[158:159]
v_pk_fma_f32 v[8:9], v[8:9], v[22:23], v[22:23] op_sel:[0,1,1] op_sel_hi:[1,1,1]
v_pk_fma_f32 v[10:11], v[10:11], v[22:23], v[22:23] op_sel:[0,1,1] op_sel_hi:[1,1,1]
v_pk_fma_f32 v[12:13], v[12:13], v[22:23], v[22:23] op_sel:[0,1,1] op_sel_hi:[1,1,1]
v_pk_fma_f32 v[14:15], v[14:15], v[22:23], v[22:23] op_sel:[0,1,1] op_sel_hi:[1,1,1]
v_rcp_f32 v8, v8
v_rcp_f32 v9, v9
v_rcp_f32 v10, v10
v_rcp_f32 v11, v11
v_rcp_f32 v12, v12
v_rcp_f32 v13, v13
v_rcp_f32 v14, v14
v_rcp_f32 v15, v15
v_pk_mul_f32 v[8:9], v[8:9], v[124:125]
v_pk_mul_f32 v[10:11], v[10:11], v[126:127]
v_pk_mul_f32 v[12:13], v[12:13], v[156:157]
v_pk_mul_f32 v[14:15], v[14:15], v[158:159]
v_cvt_pk_bf16_f32 v60, v8, v9
v_cvt_pk_bf16_f32 v61, v10, v11
v_cvt_pk_bf16_f32 v62, v12, v13
v_cvt_pk_bf16_f32 v63, v14, v15
buffer_store_dwordx4 v[60:63], v3, s[28:31], s70 offen offset:3072 sc1
s_waitcnt lgkmcnt(0)
s_nop 0
dq v[20:23],v43,1280
v_pk_mul_f32 v[8:9], v[64:65], v[64:65]
v_pk_mul_f32 v[10:11], v[66:67], v[66:67]
v_pk_mul_f32 v[12:13], v[96:97], v[96:97]
v_pk_mul_f32 v[14:15], v[98:99], v[98:99]
v_pk_fma_f32 v[8:9], v[8:9], v[18:19], v[16:17] op_sel:[0,0,1] op_sel_hi:[1,0,1]
v_pk_fma_f32 v[10:11], v[10:11], v[18:19], v[16:17] op_sel:[0,0,1] op_sel_hi:[1,0,1]
v_pk_fma_f32 v[12:13], v[12:13], v[18:19], v[16:17] op_sel:[0,0,1] op_sel_hi:[1,0,1]
v_pk_fma_f32 v[14:15], v[14:15], v[18:19], v[16:17] op_sel:[0,0,1] op_sel_hi:[1,0,1]
v_pk_mul_f32 v[8:9], v[8:9], v[64:65]
v_pk_mul_f32 v[10:11], v[10:11], v[66:67]
v_pk_mul_f32 v[12:13], v[12:13], v[96:97]
v_pk_mul_f32 v[14:15], v[14:15], v[98:99]
v_exp_f32 v8, v8
v_exp_f32 v9, v9
v_exp_f32 v10, v10
v_exp_f32 v11, v11
v_exp_f32 v12, v12
v_exp_f32 v13, v13
v_exp_f32 v14, v14
v_exp_f32 v15, v15
v_pk_mul_f32 v[128:129], v[64:65], v[128:129]
v_pk_mul_f32 v[130:131], v[66:67], v[130:131]
v_pk_mul_f32 v[160:161], v[96:97], v[160:161]
v_pk_mul_f32 v[162:163], v[98:99], v[162:163]
v_pk_fma_f32 v[8:9], v[8:9], v[18:19], v[18:19] op_sel:[0,1,1] op_sel_hi:[1,1,1]
v_pk_fma_f32 v[10:11], v[10:11], v[18:19], v[18:19] op_sel:[0,1,1] op_sel_hi:[1,1,1]
v_pk_fma_f32 v[12:13], v[12:13], v[18:19], v[18:19] op_sel:[0,1,1] op_sel_hi:[1,1,1]
v_pk_fma_f32 v[14:15], v[14:15], v[18:19], v[18:19] op_sel:[0,1,1] op_sel_hi:[1,1,1]
v_rcp_f32 v8, v8
v_rcp_f32 v9, v9
v_rcp_f32 v10, v10
v_rcp_f32 v11, v11
v_rcp_f32 v12, v12
v_rcp_f32 v13, v13
v_rcp_f32 v14, v14
v_rcp_f32 v15, v15
v_pk_mul_f32 v[8:9], v[8:9], v[128:129]
v_pk_mul_f32 v[10:11], v[10:11], v[130:131]
v_pk_mul_f32 v[12:13], v[12:13], v[160:161]
v_pk_mul_f32 v[14:15], v[14:15], v[162:163]
v_cvt_pk_bf16_f32 v64, v8, v9
v_cvt_pk_bf16_f32 v65, v10, v11
v_cvt_pk_bf16_f32 v66, v12, v13
v_cvt_pk_bf16_f32 v67, v14, v15
buffer_store_dwordx4 v[64:67], v3, s[28:31], s71 offen offset:0 sc1
s_waitcnt lgkmcnt(0)
s_nop 0
dq v[16:19],v43,1536
v_pk_mul_f32 v[8:9], v[68:69], v[68:69]
v_pk_mul_f32 v[10:11], v[70:71], v[70:71]
v_pk_mul_f32 v[12:13], v[100:101], v[100:101]
v_pk_mul_f32 v[14:15], v[102:103], v[102:103]
v_pk_fma_f32 v[8:9], v[8:9], v[22:23], v[20:21] op_sel:[0,0,1] op_sel_hi:[1,0,1]
v_pk_fma_f32 v[10:11], v[10:11], v[22:23], v[20:21] op_sel:[0,0,1] op_sel_hi:[1,0,1]
v_pk_fma_f32 v[12:13], v[12:13], v[22:23], v[20:21] op_sel:[0,0,1] op_sel_hi:[1,0,1]
v_pk_fma_f32 v[14:15], v[14:15], v[22:23], v[20:21] op_sel:[0,0,1] op_sel_hi:[1,0,1]
v_pk_mul_f32 v[8:9], v[8:9], v[68:69]
v_pk_mul_f32 v[10:11], v[10:11], v[70:71]
v_pk_mul_f32 v[12:13], v[12:13], v[100:101]
v_pk_mul_f32 v[14:15], v[14:15], v[102:103]
v_exp_f32 v8, v8
v_exp_f32 v9, v9
v_exp_f32 v10, v10
v_exp_f32 v11, v11
v_exp_f32 v12, v12
v_exp_f32 v13, v13
v_exp_f32 v14, v14
v_exp_f32 v15, v15
v_pk_mul_f32 v[132:133], v[68:69], v[132:133]
v_pk_mul_f32 v[134:135], v[70:71], v[134:135]
v_pk_mul_f32 v[164:165], v[100:101], v[164:165]
v_pk_mul_f32 v[166:167], v[102:103], v[166:167]
v_pk_fma_f32 v[8:9], v[8:9], v[22:23], v[22:23] op_sel:[0,1,1] op_sel_hi:[1,1,1]
v_pk_fma_f32 v[10:11], v[10:11], v[22:23], v[22:23] op_sel:[0,1,1] op_sel_hi:[1,1,1]
v_pk_fma_f32 v[12:13], v[12:13], v[22:23], v[22:23] op_sel:[0,1,1] op_sel_hi:[1,1,1]
v_pk_fma_f32 v[14:15], v[14:15], v[22:23], v[22:23] op_sel:[0,1,1] op_sel_hi:[1,1,1]
v_rcp_f32 v8, v8
v_rcp_f32 v9, v9
v_rcp_f32 v10, v10
v_rcp_f32 v11, v11
v_rcp_f32 v12, v12
v_rcp_f32 v13, v13
v_rcp_f32 v14, v14
v_rcp_f32 v15, v15
v_pk_mul_f32 v[8:9], v[8:9], v[132:133]
v_pk_mul_f32 v[10:11], v[10:11], v[134:135]
v_pk_mul_f32 v[12:13], v[12:13], v[164:165]
v_pk_mul_f32 v[14:15], v[14:15], v[166:167]
v_cvt_pk_bf16_f32 v68, v8, v9
v_cvt_pk_bf16_f32 v69, v10, v11
v_cvt_pk_bf16_f32 v70, v12, v13
v_cvt_pk_bf16_f32 v71, v14, v15
buffer_store_dwordx4 v[68:71], v3, s[28:31], s71 offen offset:1024 sc1
s_waitcnt lgkmcnt(0)
s_nop 0
dq v[20:23],v43,1792
v_pk_mul_f32 v[8:9], v[72:73], v[72:73]
v_pk_mul_f32 v[10:11], v[74:75], v[74:75]
v_pk_mul_f32 v[12:13], v[104:105], v[104:105]
v_pk_mul_f32 v[14:15], v[106:107], v[106:107]
v_pk_fma_f32 v[8:9], v[8:9], v[18:19], v[16:17] op_sel:[0,0,1] op_sel_hi:[1,0,1]
v_pk_fma_f32 v[10:11], v[10:11], v[18:19], v[16:17] op_sel:[0,0,1] op_sel_hi:[1,0,1]
v_pk_fma_f32 v[12:13], v[12:13], v[18:19], v[16:17] op_sel:[0,0,1] op_sel_hi:[1,0,1]
v_pk_fma_f32 v[14:15], v[14:15], v[18:19], v[16:17] op_sel:[0,0,1] op_sel_hi:[1,0,1]
v_pk_mul_f32 v[8:9], v[8:9], v[72:73]
v_pk_mul_f32 v[10:11], v[10:11], v[74:75]
v_pk_mul_f32 v[12:13], v[12:13], v[104:105]
v_pk_mul_f32 v[14:15], v[14:15], v[106:107]
v_exp_f32 v8, v8
v_exp_f32 v9, v9
v_exp_f32 v10, v10
v_exp_f32 v11, v11
v_exp_f32 v12, v12
v_exp_f32 v13, v13
v_exp_f32 v14, v14
v_exp_f32 v15, v15
v_pk_mul_f32 v[136:137], v[72:73], v[136:137]
v_pk_mul_f32 v[138:139], v[74:75], v[138:139]
v_pk_mul_f32 v[168:169], v[104:105], v[168:169]
v_pk_mul_f32 v[170:171], v[106:107], v[170:171]
v_pk_fma_f32 v[8:9], v[8:9], v[18:19], v[18:19] op_sel:[0,1,1] op_sel_hi:[1,1,1]
v_pk_fma_f32 v[10:11], v[10:11], v[18:19], v[18:19] op_sel:[0,1,1] op_sel_hi:[1,1,1]
v_pk_fma_f32 v[12:13], v[12:13], v[18:19], v[18:19] op_sel:[0,1,1] op_sel_hi:[1,1,1]
v_pk_fma_f32 v[14:15], v[14:15], v[18:19], v[18:19] op_sel:[0,1,1] op_sel_hi:[1,1,1]
v_rcp_f32 v8, v8
v_rcp_f32 v9, v9
v_rcp_f32 v10, v10
v_rcp_f32 v11, v11
v_rcp_f32 v12, v12
v_rcp_f32 v13, v13
v_rcp_f32 v14, v14
v_rcp_f32 v15, v15
v_pk_mul_f32 v[8:9], v[8:9], v[136:137]
v_pk_mul_f32 v[10:11], v[10:11], v[138:139]
v_pk_mul_f32 v[12:13], v[12:13], v[168:169]
v_pk_mul_f32 v[14:15], v[14:15], v[170:171]
v_cvt_pk_bf16_f32 v72, v8, v9
v_cvt_pk_bf16_f32 v73, v10, v11
v_cvt_pk_bf16_f32 v74, v12, v13
v_cvt_pk_bf16_f32 v75, v14, v15
buffer_store_dwordx4 v[72:75], v3, s[28:31], s71 offen offset:2048 sc1
dq v[144:147],v44,0
dq v[148:151],v44,64
dq v[152:155],v44,384
dq v[156:159],v44,448
dq v[160:163],v44,512
dq v[164:167],v44,576
s_waitcnt lgkmcnt(6)
s_nop 0
dq v[16:19],v43,0
v_pk_mul_f32 v[8:9], v[76:77], v[76:77]
v_pk_mul_f32 v[10:11], v[78:79], v[78:79]
v_pk_mul_f32 v[12:13], v[108:109], v[108:109]
v_pk_mul_f32 v[14:15], v[110:111], v[110:111]
v_pk_fma_f32 v[8:9], v[8:9], v[22:23], v[20:21] op_sel:[0,0,1] op_sel_hi:[1,0,1]
v_pk_fma_f32 v[10:11], v[10:11], v[22:23], v[20:21] op_sel:[0,0,1] op_sel_hi:[1,0,1]
v_pk_fma_f32 v[12:13], v[12:13], v[22:23], v[20:21] op_sel:[0,0,1] op_sel_hi:[1,0,1]
v_pk_fma_f32 v[14:15], v[14:15], v[22:23], v[20:21] op_sel:[0,0,1] op_sel_hi:[1,0,1]
v_pk_mul_f32 v[8:9], v[8:9], v[76:77]
v_pk_mul_f32 v[10:11], v[10:11], v[78:79]
v_pk_mul_f32 v[12:13], v[12:13], v[108:109]
v_pk_mul_f32 v[14:15], v[14:15], v[110:111]
v_exp_f32 v8, v8
v_exp_f32 v9, v9
v_exp_f32 v10, v10
v_exp_f32 v11, v11
v_exp_f32 v12, v12
v_exp_f32 v13, v13
v_exp_f32 v14, v14
v_exp_f32 v15, v15
v_pk_mul_f32 v[140:141], v[76:77], v[140:141]
v_pk_mul_f32 v[142:143], v[78:79], v[142:143]
v_pk_mul_f32 v[172:173], v[108:109], v[172:173]
v_pk_mul_f32 v[174:175], v[110:111], v[174:175]
v_pk_fma_f32 v[8:9], v[8:9], v[22:23], v[22:23] op_sel:[0,1,1] op_sel_hi:[1,1,1]
v_pk_fma_f32 v[10:11], v[10:11], v[22:23], v[22:23] op_sel:[0,1,1] op_sel_hi:[1,1,1]
v_pk_fma_f32 v[12:13], v[12:13], v[22:23], v[22:23] op_sel:[0,1,1] op_sel_hi:[1,1,1]
v_pk_fma_f32 v[14:15], v[14:15], v[22:23], v[22:23] op_sel:[0,1,1] op_sel_hi:[1,1,1]
v_rcp_f32 v8, v8
v_rcp_f32 v9, v9
v_rcp_f32 v10, v10
v_rcp_f32 v11, v11
v_rcp_f32 v12, v12
v_rcp_f32 v13, v13
v_rcp_f32 v14, v14
v_rcp_f32 v15, v15
v_pk_mul_f32 v[8:9], v[8:9], v[140:141]
v_pk_mul_f32 v[10:11], v[10:11], v[142:143]
v_pk_mul_f32 v[12:13], v[12:13], v[172:173]
v_pk_mul_f32 v[14:15], v[14:15], v[174:175]
v_cvt_pk_bf16_f32 v76, v8, v9
v_cvt_pk_bf16_f32 v77, v10, v11
v_cvt_pk_bf16_f32 v78, v12, v13
v_cvt_pk_bf16_f32 v79, v14, v15
buffer_store_dwordx4 v[76:79], v3, s[28:31], s71 offen offset:3072 sc1
s_waitcnt lgkmcnt(0)
s_nop 0
dq v[20:23],v43,256
v_accvgpr_read_b32 v112, a144
v_accvgpr_read_b32 v113, a145
v_accvgpr_read_b32 v114, a146
v_accvgpr_read_b32 v115, a147
v_accvgpr_read_b32 v116, a176
v_accvgpr_read_b32 v117, a177
v_accvgpr_read_b32 v118, a178
v_accvgpr_read_b32 v119, a179
v_mul_f32 v6, 0xbede652a, v17
v_pk_fma_f32 v[112:113], v[144:145], v[16:17], v[112:113] op_sel_hi:[1,0,1]
v_pk_fma_f32 v[114:115], v[146:147], v[16:17], v[114:115] op_sel_hi:[1,0,1]
v_pk_fma_f32 v[116:117], v[148:149], v[16:17], v[116:117] op_sel_hi:[1,0,1]
v_pk_fma_f32 v[118:119], v[150:151], v[16:17], v[118:119] op_sel_hi:[1,0,1]
v_pk_fma_f32 v[112:113], v[112:113], v[6:7], v[40:41] op_sel_hi:[1,0,0]
v_pk_fma_f32 v[114:115], v[114:115], v[6:7], v[40:41] op_sel_hi:[1,0,0]
v_pk_fma_f32 v[116:117], v[116:117], v[6:7], v[40:41] op_sel_hi:[1,0,0]
v_pk_fma_f32 v[118:119], v[118:119], v[6:7], v[40:41] op_sel_hi:[1,0,0]
v_pk_fma_f32 v[8:9], v[112:113], s[18:19], v[40:41] op_sel:[0,0,1] op_sel_hi:[1,1,1]
v_pk_fma_f32 v[10:11], v[114:115], s[18:19], v[40:41] op_sel:[0,0,1] op_sel_hi:[1,1,1]
v_pk_fma_f32 v[12:13], v[116:117], s[18:19], v[40:41] op_sel:[0,0,1] op_sel_hi:[1,1,1]
v_pk_fma_f32 v[14:15], v[118:119], s[18:19], v[40:41] op_sel:[0,0,1] op_sel_hi:[1,1,1]
v_exp_f32_e64 v8, v8 clamp
v_exp_f32_e64 v9, v9 clamp
v_exp_f32_e64 v10, v10 clamp
v_exp_f32_e64 v11, v11 clamp
v_exp_f32_e64 v12, v12 clamp
v_exp_f32_e64 v13, v13 clamp
v_exp_f32_e64 v14, v14 clamp
v_exp_f32_e64 v15, v15 clamp
v_max_f32 v112, v40, v112
v_max_f32 v113, v40, v113
v_max_f32 v114, v40, v114
v_max_f32 v115, v40, v115
v_max_f32 v116, v40, v116
v_max_f32 v117, v40, v117
v_max_f32 v118, v40, v118
v_max_f32 v119, v40, v119
v_pk_add_f32 v[8:9], v[8:9], v[112:113]
v_pk_add_f32 v[10:11], v[10:11], v[114:115]
v_pk_add_f32 v[12:13], v[12:13], v[116:117]
v_pk_add_f32 v[14:15], v[14:15], v[118:119]
v_cvt_pk_bf16_f32 v80, v8, v9
v_cvt_pk_bf16_f32 v81, v10, v11
v_cvt_pk_bf16_f32 v82, v12, v13
v_cvt_pk_bf16_f32 v83, v14, v15
s_waitcnt lgkmcnt(0)
s_nop 0
dq v[16:19],v43,512
v_accvgpr_read_b32 v112, a148
v_accvgpr_read_b32 v113, a149
v_accvgpr_read_b32 v114, a150
v_accvgpr_read_b32 v115, a151
v_accvgpr_read_b32 v116, a180
v_accvgpr_read_b32 v117, a181
v_accvgpr_read_b32 v118, a182
v_accvgpr_read_b32 v119, a183
v_mul_f32 v6, 0xbede652a, v21
v_pk_fma_f32 v[112:113], v[144:145], v[20:21], v[112:113] op_sel_hi:[1,0,1]
v_pk_fma_f32 v[114:115], v[146:147], v[20:21], v[114:115] op_sel_hi:[1,0,1]
v_pk_fma_f32 v[116:117], v[148:149], v[20:21], v[116:117] op_sel_hi:[1,0,1]
v_pk_fma_f32 v[118:119], v[150:151], v[20:21], v[118:119] op_sel_hi:[1,0,1]
v_pk_fma_f32 v[112:113], v[112:113], v[6:7], v[40:41] op_sel_hi:[1,0,0]
v_pk_fma_f32 v[114:115], v[114:115], v[6:7], v[40:41] op_sel_hi:[1,0,0]
v_pk_fma_f32 v[116:117], v[116:117], v[6:7], v[40:41] op_sel_hi:[1,0,0]
v_pk_fma_f32 v[118:119], v[118:119], v[6:7], v[40:41] op_sel_hi:[1,0,0]
v_pk_fma_f32 v[8:9], v[112:113], s[18:19], v[40:41] op_sel:[0,0,1] op_sel_hi:[1,1,1]
v_pk_fma_f32 v[10:11], v[114:115], s[18:19], v[40:41] op_sel:[0,0,1] op_sel_hi:[1,1,1]
v_pk_fma_f32 v[12:13], v[116:117], s[18:19], v[40:41] op_sel:[0,0,1] op_sel_hi:[1,1,1]
v_pk_fma_f32 v[14:15], v[118:119], s[18:19], v[40:41] op_sel:[0,0,1] op_sel_hi:[1,1,1]
v_exp_f32_e64 v8, v8 clamp
v_exp_f32_e64 v9, v9 clamp
v_exp_f32_e64 v10, v10 clamp
v_exp_f32_e64 v11, v11 clamp
v_exp_f32_e64 v12, v12 clamp
v_exp_f32_e64 v13, v13 clamp
v_exp_f32_e64 v14, v14 clamp
v_exp_f32_e64 v15, v15 clamp
v_max_f32 v112, v40, v112
v_max_f32 v113, v40, v113
v_max_f32 v114, v40, v114
v_max_f32 v115, v40, v115
v_max_f32 v116, v40, v116
v_max_f32 v117, v40, v117
v_max_f32 v118, v40, v118
v_max_f32 v119, v40, v119
v_pk_add_f32 v[8:9], v[8:9], v[112:113]
v_pk_add_f32 v[10:11], v[10:11], v[114:115]
v_pk_add_f32 v[12:13], v[12:13], v[116:117]
v_pk_add_f32 v[14:15], v[14:15], v[118:119]
v_cvt_pk_bf16_f32 v84, v8, v9
v_cvt_pk_bf16_f32 v85, v10, v11
v_cvt_pk_bf16_f32 v86, v12, v13
v_cvt_pk_bf16_f32 v87, v14, v15
s_waitcnt lgkmcnt(0)
s_nop 0
dq v[20:23],v43,768
v_accvgpr_read_b32 v112, a152
v_accvgpr_read_b32 v113, a153
v_accvgpr_read_b32 v114, a154
v_accvgpr_read_b32 v115, a155
v_accvgpr_read_b32 v116, a184
v_accvgpr_read_b32 v117, a185
v_accvgpr_read_b32 v118, a186
v_accvgpr_read_b32 v119, a187
v_mul_f32 v6, 0xbede652a, v17
v_pk_fma_f32 v[112:113], v[144:145], v[16:17], v[112:113] op_sel_hi:[1,0,1]
v_pk_fma_f32 v[114:115], v[146:147], v[16:17], v[114:115] op_sel_hi:[1,0,1]
v_pk_fma_f32 v[116:117], v[148:149], v[16:17], v[116:117] op_sel_hi:[1,0,1]
v_pk_fma_f32 v[118:119], v[150:151], v[16:17], v[118:119] op_sel_hi:[1,0,1]
v_pk_fma_f32 v[112:113], v[112:113], v[6:7], v[40:41] op_sel_hi:[1,0,0]
v_pk_fma_f32 v[114:115], v[114:115], v[6:7], v[40:41] op_sel_hi:[1,0,0]
v_pk_fma_f32 v[116:117], v[116:117], v[6:7], v[40:41] op_sel_hi:[1,0,0]
v_pk_fma_f32 v[118:119], v[118:119], v[6:7], v[40:41] op_sel_hi:[1,0,0]
v_pk_fma_f32 v[8:9], v[112:113], s[18:19], v[40:41] op_sel:[0,0,1] op_sel_hi:[1,1,1]
v_pk_fma_f32 v[10:11], v[114:115], s[18:19], v[40:41] op_sel:[0,0,1] op_sel_hi:[1,1,1]
v_pk_fma_f32 v[12:13], v[116:117], s[18:19], v[40:41] op_sel:[0,0,1] op_sel_hi:[1,1,1]
v_pk_fma_f32 v[14:15], v[118:119], s[18:19], v[40:41] op_sel:[0,0,1] op_sel_hi:[1,1,1]
v_exp_f32_e64 v8, v8 clamp
v_exp_f32_e64 v9, v9 clamp
v_exp_f32_e64 v10, v10 clamp
v_exp_f32_e64 v11, v11 clamp
v_exp_f32_e64 v12, v12 clamp
v_exp_f32_e64 v13, v13 clamp
v_exp_f32_e64 v14, v14 clamp
v_exp_f32_e64 v15, v15 clamp
v_max_f32 v112, v40, v112
v_max_f32 v113, v40, v113
v_max_f32 v114, v40, v114
v_max_f32 v115, v40, v115
v_max_f32 v116, v40, v116
v_max_f32 v117, v40, v117
v_max_f32 v118, v40, v118
v_max_f32 v119, v40, v119
v_pk_add_f32 v[8:9], v[8:9], v[112:113]
v_pk_add_f32 v[10:11], v[10:11], v[114:115]
v_pk_add_f32 v[12:13], v[12:13], v[116:117]
v_pk_add_f32 v[14:15], v[14:15], v[118:119]
v_cvt_pk_bf16_f32 v88, v8, v9
v_cvt_pk_bf16_f32 v89, v10, v11
v_cvt_pk_bf16_f32 v90, v12, v13
v_cvt_pk_bf16_f32 v91, v14, v15
s_waitcnt vmcnt(0)
v_add_u32 v6, 1, v5
s_mov_b64 exec, 1
buffer_store_dword v6, v4, s[28:31], s79 offen sc1
s_mov_b64 exec, -1
s_waitcnt lgkmcnt(0)
s_nop 0
dq v[16:19],v43,1024
v_accvgpr_read_b32 v112, a156
v_accvgpr_read_b32 v113, a157
L_stub18:
s_cbranch_execz L_stub21
s_nop 0
v_accvgpr_read_b32 v114, a158
v_accvgpr_read_b32 v115, a159
v_accvgpr_read_b32 v116, a188
v_accvgpr_read_b32 v117, a189
v_accvgpr_read_b32 v118, a190
v_accvgpr_read_b32 v119, a191
v_mul_f32 v6, 0xbede652a, v21
v_pk_fma_f32 v[112:113], v[144:145], v[20:21], v[112:113] op_sel_hi:[1,0,1]
v_pk_fma_f32 v[114:115], v[146:147], v[20:21], v[114:115] op_sel_hi:[1,0,1]
v_pk_fma_f32 v[116:117], v[148:149], v[20:21], v[116:117] op_sel_hi:[1,0,1]
v_pk_fma_f32 v[118:119], v[150:151], v[20:21], v[118:119] op_sel_hi:[1,0,1]
v_pk_fma_f32 v[112:113], v[112:113], v[6:7], v[40:41] op_sel_hi:[1,0,0]
v_pk_fma_f32 v[114:115], v[114:115], v[6:7], v[40:41] op_sel_hi:[1,0,0]
v_pk_fma_f32 v[116:117], v[116:117], v[6:7], v[40:41] op_sel_hi:[1,0,0]
v_pk_fma_f32 v[118:119], v[118:119], v[6:7], v[40:41] op_sel_hi:[1,0,0]
v_pk_fma_f32 v[8:9], v[112:113], s[18:19], v[40:41] op_sel:[0,0,1] op_sel_hi:[1,1,1]
v_pk_fma_f32 v[10:11], v[114:115], s[18:19], v[40:41] op_sel:[0,0,1] op_sel_hi:[1,1,1]
v_pk_fma_f32 v[12:13], v[116:117], s[18:19], v[40:41] op_sel:[0,0,1] op_sel_hi:[1,1,1]
v_pk_fma_f32 v[14:15], v[118:119], s[18:19], v[40:41] op_sel:[0,0,1] op_sel_hi:[1,1,1]
v_exp_f32_e64 v8, v8 clamp
v_exp_f32_e64 v9, v9 clamp
v_exp_f32_e64 v10, v10 clamp
v_exp_f32_e64 v11, v11 clamp
v_exp_f32_e64 v12, v12 clamp
v_exp_f32_e64 v13, v13 clamp
v_exp_f32_e64 v14, v14 clamp
v_exp_f32_e64 v15, v15 clamp
v_max_f32 v112, v40, v112
v_max_f32 v113, v40, v113
v_max_f32 v114, v40, v114
v_max_f32 v115, v40, v115
v_max_f32 v116, v40, v116
v_max_f32 v117, v40, v117
v_max_f32 v118, v40, v118
v_max_f32 v119, v40, v119
v_pk_add_f32 v[8:9], v[8:9], v[112:113]
v_pk_add_f32 v[10:11], v[10:11], v[114:115]
v_pk_add_f32 v[12:13], v[12:13], v[116:117]
v_pk_add_f32 v[14:15], v[14:15], v[118:119]
v_cvt_pk_bf16_f32 v92, v8, v9
v_cvt_pk_bf16_f32 v93, v10, v11
v_cvt_pk_bf16_f32 v94, v12, v13
v_cvt_pk_bf16_f32 v95, v14, v15
s_waitcnt lgkmcnt(0)
s_nop 0
dq v[20:23],v43,1280
v_accvgpr_read_b32 v112, a160
v_accvgpr_read_b32 v113, a161
v_accvgpr_read_b32 v114, a162
v_accvgpr_read_b32 v115, a163
v_accvgpr_read_b32 v116, a192
v_accvgpr_read_b32 v117, a193
v_accvgpr_read_b32 v118, a194
v_accvgpr_read_b32 v119, a195
v_mul_f32 v6, 0xbede652a, v17
v_pk_fma_f32 v[112:113], v[144:145], v[16:17], v[112:113] op_sel_hi:[1,0,1]
v_pk_fma_f32 v[114:115], v[146:147], v[16:17], v[114:115] op_sel_hi:[1,0,1]
v_pk_fma_f32 v[116:117], v[148:149], v[16:17], v[116:117] op_sel_hi:[1,0,1]
v_pk_fma_f32 v[118:119], v[150:151], v[16:17], v[118:119] op_sel_hi:[1,0,1]
v_pk_fma_f32 v[112:113], v[112:113], v[6:7], v[40:41] op_sel_hi:[1,0,0]
v_pk_fma_f32 v[114:115], v[114:115], v[6:7], v[40:41] op_sel_hi:[1,0,0]
v_pk_fma_f32 v[116:117], v[116:117], v[6:7], v[40:41] op_sel_hi:[1,0,0]
v_pk_fma_f32 v[118:119], v[118:119], v[6:7], v[40:41] op_sel_hi:[1,0,0]
v_pk_fma_f32 v[8:9], v[112:113], s[18:19], v[40:41] op_sel:[0,0,1] op_sel_hi:[1,1,1]
v_pk_fma_f32 v[10:11], v[114:115], s[18:19], v[40:41] op_sel:[0,0,1] op_sel_hi:[1,1,1]
v_pk_fma_f32 v[12:13], v[116:117], s[18:19], v[40:41] op_sel:[0,0,1] op_sel_hi:[1,1,1]
v_pk_fma_f32 v[14:15], v[118:119], s[18:19], v[40:41] op_sel:[0,0,1] op_sel_hi:[1,1,1]
v_exp_f32_e64 v8, v8 clamp
v_exp_f32_e64 v9, v9 clamp
v_exp_f32_e64 v10, v10 clamp
v_exp_f32_e64 v11, v11 clamp
v_exp_f32_e64 v12, v12 clamp
v_exp_f32_e64 v13, v13 clamp
v_exp_f32_e64 v14, v14 clamp
v_exp_f32_e64 v15, v15 clamp
v_max_f32 v112, v40, v112
v_max_f32 v113, v40, v113
v_max_f32 v114, v40, v114
v_max_f32 v115, v40, v115
v_max_f32 v116, v40, v116
v_max_f32 v117, v40, v117
v_max_f32 v118, v40, v118
v_max_f32 v119, v40, v119
v_pk_add_f32 v[8:9], v[8:9], v[112:113]
v_pk_add_f32 v[10:11], v[10:11], v[114:115]
v_pk_add_f32 v[12:13], v[12:13], v[116:117]
v_pk_add_f32 v[14:15], v[14:15], v[118:119]
v_cvt_pk_bf16_f32 v96, v8, v9
v_cvt_pk_bf16_f32 v97, v10, v11
v_cvt_pk_bf16_f32 v98, v12, v13
v_cvt_pk_bf16_f32 v99, v14, v15
s_waitcnt lgkmcnt(0)
s_nop 0
dq v[16:19],v43,1536
v_accvgpr_read_b32 v112, a164
v_accvgpr_read_b32 v113, a165
v_accvgpr_read_b32 v114, a166
v_accvgpr_read_b32 v115, a167
v_accvgpr_read_b32 v116, a196
v_accvgpr_read_b32 v117, a197
v_accvgpr_read_b32 v118, a198
v_accvgpr_read_b32 v119, a199
v_mul_f32 v6, 0xbede652a, v21
v_pk_fma_f32 v[112:113], v[144:145], v[20:21], v[112:113] op_sel_hi:[1,0,1]
v_pk_fma_f32 v[114:115], v[146:147], v[20:21], v[114:115] op_sel_hi:[1,0,1]
v_pk_fma_f32 v[116:117], v[148:149], v[20:21], v[116:117] op_sel_hi:[1,0,1]
v_pk_fma_f32 v[118:119], v[150:151], v[20:21], v[118:119] op_sel_hi:[1,0,1]
v_pk_fma_f32 v[112:113], v[112:113], v[6:7], v[40:41] op_sel_hi:[1,0,0]
v_pk_fma_f32 v[114:115], v[114:115], v[6:7], v[40:41] op_sel_hi:[1,0,0]
v_pk_fma_f32 v[116:117], v[116:117], v[6:7], v[40:41] op_sel_hi:[1,0,0]
v_pk_fma_f32 v[118:119], v[118:119], v[6:7], v[40:41] op_sel_hi:[1,0,0]
v_pk_fma_f32 v[8:9], v[112:113], s[18:19], v[40:41] op_sel:[0,0,1] op_sel_hi:[1,1,1]
v_pk_fma_f32 v[10:11], v[114:115], s[18:19], v[40:41] op_sel:[0,0,1] op_sel_hi:[1,1,1]
v_pk_fma_f32 v[12:13], v[116:117], s[18:19], v[40:41] op_sel:[0,0,1] op_sel_hi:[1,1,1]
v_pk_fma_f32 v[14:15], v[118:119], s[18:19], v[40:41] op_sel:[0,0,1] op_sel_hi:[1,1,1]
v_exp_f32_e64 v8, v8 clamp
v_exp_f32_e64 v9, v9 clamp
v_exp_f32_e64 v10, v10 clamp
v_exp_f32_e64 v11, v11 clamp
v_exp_f32_e64 v12, v12 clamp
v_exp_f32_e64 v13, v13 clamp
v_exp_f32_e64 v14, v14 clamp
v_exp_f32_e64 v15, v15 clamp
v_max_f32 v112, v40, v112
v_max_f32 v113, v40, v113
v_max_f32 v114, v40, v114
v_max_f32 v115, v40, v115
v_max_f32 v116, v40, v116
v_max_f32 v117, v40, v117
v_max_f32 v118, v40, v118
v_max_f32 v119, v40, v119
v_pk_add_f32 v[8:9], v[8:9], v[112:113]
v_pk_add_f32 v[10:11], v[10:11], v[114:115]
v_pk_add_f32 v[12:13], v[12:13], v[116:117]
v_pk_add_f32 v[14:15], v[14:15], v[118:119]
v_cvt_pk_bf16_f32 v100, v8, v9
v_cvt_pk_bf16_f32 v101, v10, v11
v_cvt_pk_bf16_f32 v102, v12, v13
v_cvt_pk_bf16_f32 v103, v14, v15
s_waitcnt lgkmcnt(0)
s_nop 0
dq v[20:23],v43,1792
v_accvgpr_read_b32 v112, a168
v_accvgpr_read_b32 v113, a169
v_accvgpr_read_b32 v114, a170
v_accvgpr_read_b32 v115, a171
v_accvgpr_read_b32 v116, a200
v_accvgpr_read_b32 v117, a201
v_accvgpr_read_b32 v118, a202
v_accvgpr_read_b32 v119, a203
v_mul_f32 v6, 0xbede652a, v17
v_pk_fma_f32 v[112:113], v[144:145], v[16:17], v[112:113] op_sel_hi:[1,0,1]
v_pk_fma_f32 v[114:115], v[146:147], v[16:17], v[114:115] op_sel_hi:[1,0,1]
v_pk_fma_f32 v[116:117], v[148:149], v[16:17], v[116:117] op_sel_hi:[1,0,1]
v_pk_fma_f32 v[118:119], v[150:151], v[16:17], v[118:119] op_sel_hi:[1,0,1]
v_pk_fma_f32 v[112:113], v[112:113], v[6:7], v[40:41] op_sel_hi:[1,0,0]
v_pk_fma_f32 v[114:115], v[114:115], v[6:7], v[40:41] op_sel_hi:[1,0,0]
v_pk_fma_f32 v[116:117], v[116:117], v[6:7], v[40:41] op_sel_hi:[1,0,0]
v_pk_fma_f32 v[118:119], v[118:119], v[6:7], v[40:41] op_sel_hi:[1,0,0]
v_pk_fma_f32 v[8:9], v[112:113], s[18:19], v[40:41] op_sel:[0,0,1] op_sel_hi:[1,1,1]
v_pk_fma_f32 v[10:11], v[114:115], s[18:19], v[40:41] op_sel:[0,0,1] op_sel_hi:[1,1,1]
v_pk_fma_f32 v[12:13], v[116:117], s[18:19], v[40:41] op_sel:[0,0,1] op_sel_hi:[1,1,1]
v_pk_fma_f32 v[14:15], v[118:119], s[18:19], v[40:41] op_sel:[0,0,1] op_sel_hi:[1,1,1]
v_exp_f32_e64 v8, v8 clamp
v_exp_f32_e64 v9, v9 clamp
v_exp_f32_e64 v10, v10 clamp
v_exp_f32_e64 v11, v11 clamp
v_exp_f32_e64 v12, v12 clamp
v_exp_f32_e64 v13, v13 clamp
v_exp_f32_e64 v14, v14 clamp
v_exp_f32_e64 v15, v15 clamp
v_max_f32 v112, v40, v112
v_max_f32 v113, v40, v113
v_max_f32 v114, v40, v114
v_max_f32 v115, v40, v115
v_max_f32 v116, v40, v116
v_max_f32 v117, v40, v117
v_max_f32 v118, v40, v118
v_max_f32 v119, v40, v119
v_pk_add_f32 v[8:9], v[8:9], v[112:113]
v_pk_add_f32 v[10:11], v[10:11], v[114:115]
v_pk_add_f32 v[12:13], v[12:13], v[116:117]
v_pk_add_f32 v[14:15], v[14:15], v[118:119]
v_cvt_pk_bf16_f32 v104, v8, v9
v_cvt_pk_bf16_f32 v105, v10, v11
v_cvt_pk_bf16_f32 v106, v12, v13
v_cvt_pk_bf16_f32 v107, v14, v15
v_and_b32 v64, 15, v2
v_lshrrev_b32 v65, 5, v2
v_and_b32 v66, 7, v2
v_xor_b32 v65, v65, v66
v_lshlrev_b32_e64 v65, 4, v65
v_lshl_add_u32 v64, v64, 7, v65
v_bfe_u32 v65, v2, 4, 1
v_lshl_add_u32 v64, v65, 3, v64
v_add_u32 v64, s65, v64
v_xor_b32 v65, 32, v64
v_xor_b32_e64 v66, 64, v64
v_xor_b32 v67, 96, v64
ds_read_b64 v[48:49], v64 offset:16384
ds_read_b64 v[50:51], v65 offset:16384
ds_read_b64 v[52:53], v66 offset:16384
ds_read_b64 v[54:55], v67 offset:16384
ds_read_b64 v[56:57], v64 offset:18432
ds_read_b64 v[58:59], v65 offset:18432
ds_read_b64 v[60:61], v66 offset:18432
ds_read_b64 v[62:63], v67 offset:18432
s_waitcnt lgkmcnt(0)
s_nop 0
dq v[16:19],v43,0
v_accvgpr_read_b32 v112, a172
v_accvgpr_read_b32 v113, a173
v_accvgpr_read_b32 v114, a174
v_accvgpr_read_b32 v115, a175
v_accvgpr_read_b32 v116, a204
v_accvgpr_read_b32 v117, a205
v_accvgpr_read_b32 v118, a206
v_accvgpr_read_b32 v119, a207
v_mul_f32 v6, 0xbede652a, v21
v_pk_fma_f32 v[112:113], v[144:145], v[20:21], v[112:113] op_sel_hi:[1,0,1]
v_pk_fma_f32 v[114:115], v[146:147], v[20:21], v[114:115] op_sel_hi:[1,0,1]
v_pk_fma_f32 v[116:117], v[148:149], v[20:21], v[116:117] op_sel_hi:[1,0,1]
v_pk_fma_f32 v[118:119], v[150:151], v[20:21], v[118:119] op_sel_hi:[1,0,1]
v_pk_fma_f32 v[112:113], v[112:113], v[6:7], v[40:41] op_sel_hi:[1,0,0]
v_pk_fma_f32 v[114:115], v[114:115], v[6:7], v[40:41] op_sel_hi:[1,0,0]
v_pk_fma_f32 v[116:117], v[116:117], v[6:7], v[40:41] op_sel_hi:[1,0,0]
v_pk_fma_f32 v[118:119], v[118:119], v[6:7], v[40:41] op_sel_hi:[1,0,0]
v_pk_fma_f32 v[8:9], v[112:113], s[18:19], v[40:41] op_sel:[0,0,1] op_sel_hi:[1,1,1]
v_pk_fma_f32 v[10:11], v[114:115], s[18:19], v[40:41] op_sel:[0,0,1] op_sel_hi:[1,1,1]
v_pk_fma_f32 v[12:13], v[116:117], s[18:19], v[40:41] op_sel:[0,0,1] op_sel_hi:[1,1,1]
v_pk_fma_f32 v[14:15], v[118:119], s[18:19], v[40:41] op_sel:[0,0,1] op_sel_hi:[1,1,1]
v_exp_f32_e64 v8, v8 clamp
v_exp_f32_e64 v9, v9 clamp
v_exp_f32_e64 v10, v10 clamp
v_exp_f32_e64 v11, v11 clamp
v_exp_f32_e64 v12, v12 clamp
v_exp_f32_e64 v13, v13 clamp
v_exp_f32_e64 v14, v14 clamp
v_exp_f32_e64 v15, v15 clamp
v_max_f32 v112, v40, v112
v_max_f32 v113, v40, v113
v_max_f32 v114, v40, v114
v_max_f32 v115, v40, v115
v_max_f32 v116, v40, v116
v_max_f32 v117, v40, v117
v_max_f32 v118, v40, v118
v_max_f32 v119, v40, v119
v_pk_add_f32 v[8:9], v[8:9], v[112:113]
v_pk_add_f32 v[10:11], v[10:11], v[114:115]
v_pk_add_f32 v[12:13], v[12:13], v[116:117]
v_pk_add_f32 v[14:15], v[14:15], v[118:119]
v_cvt_pk_bf16_f32 v108, v8, v9
v_cvt_pk_bf16_f32 v109, v10, v11
v_cvt_pk_bf16_f32 v110, v12, v13
v_cvt_pk_bf16_f32 v111, v14, v15
s_lshr_b32 s70, s77, 6
s_add_u32 s70, s70, s22
s_lshl_b32 s70, s70, 13
s_add_u32 s70, s70, s78
s_add_u32 s71, s70, 4096
s_waitcnt lgkmcnt(0)
s_nop 0
dq v[20:23],v43,256
v_pk_fma_f32 v[176:177], v[152:153], v[16:17], v[176:177] op_sel_hi:[1,0,1]
v_pk_fma_f32 v[178:179], v[154:155], v[16:17], v[178:179] op_sel_hi:[1,0,1]
v_pk_fma_f32 v[208:209], v[156:157], v[16:17], v[208:209] op_sel_hi:[1,0,1]
v_pk_fma_f32 v[210:211], v[158:159], v[16:17], v[210:211] op_sel_hi:[1,0,1]
v_pk_fma_f32 v[240:241], v[160:161], v[16:17], v[240:241] op_sel_hi:[1,0,1]
v_pk_fma_f32 v[242:243], v[162:163], v[16:17], v[242:243] op_sel_hi:[1,0,1]
v_pk_fma_f32 v[248:249], v[164:165], v[16:17], v[248:249] op_sel_hi:[1,0,1]
v_pk_fma_f32 v[250:251], v[166:167], v[16:17], v[250:251] op_sel_hi:[1,0,1]
v_pk_mul_f32 v[8:9], v[176:177], v[176:177]
v_pk_mul_f32 v[10:11], v[178:179], v[178:179]
v_pk_mul_f32 v[12:13], v[208:209], v[208:209]
v_pk_mul_f32 v[14:15], v[210:211], v[210:211]
v_pk_fma_f32 v[8:9], v[8:9], v[18:19], v[16:17] op_sel:[0,0,1] op_sel_hi:[1,0,1]
v_pk_fma_f32 v[10:11], v[10:11], v[18:19], v[16:17] op_sel:[0,0,1] op_sel_hi:[1,0,1]
v_pk_fma_f32 v[12:13], v[12:13], v[18:19], v[16:17] op_sel:[0,0,1] op_sel_hi:[1,0,1]
v_pk_fma_f32 v[14:15], v[14:15], v[18:19], v[16:17] op_sel:[0,0,1] op_sel_hi:[1,0,1]
v_pk_mul_f32 v[8:9], v[8:9], v[176:177]
v_pk_mul_f32 v[10:11], v[10:11], v[178:179]
v_pk_mul_f32 v[12:13], v[12:13], v[208:209]
v_pk_mul_f32 v[14:15], v[14:15], v[210:211]
v_exp_f32 v8, v8
v_exp_f32 v9, v9
v_exp_f32 v10, v10
v_exp_f32 v11, v11
v_exp_f32 v12, v12
v_exp_f32 v13, v13
v_exp_f32 v14, v14
v_exp_f32 v15, v15
v_pk_mul_f32 v[240:241], v[176:177], v[240:241]
v_pk_mul_f32 v[242:243], v[178:179], v[242:243]
v_pk_mul_f32 v[248:249], v[208:209], v[248:249]
v_pk_mul_f32 v[250:251], v[210:211], v[250:251]
v_pk_fma_f32 v[8:9], v[8:9], v[18:19], v[18:19] op_sel:[0,1,1] op_sel_hi:[1,1,1]
v_pk_fma_f32 v[10:11], v[10:11], v[18:19], v[18:19] op_sel:[0,1,1] op_sel_hi:[1,1,1]
v_pk_fma_f32 v[12:13], v[12:13], v[18:19], v[18:19] op_sel:[0,1,1] op_sel_hi:[1,1,1]
v_pk_fma_f32 v[14:15], v[14:15], v[18:19], v[18:19] op_sel:[0,1,1] op_sel_hi:[1,1,1]
v_rcp_f32 v8, v8
v_rcp_f32 v9, v9
v_rcp_f32 v10, v10
v_rcp_f32 v11, v11
v_rcp_f32 v12, v12
v_rcp_f32 v13, v13
v_rcp_f32 v14, v14
v_rcp_f32 v15, v15
v_pk_mul_f32 v[8:9], v[8:9], v[240:241]
v_pk_mul_f32 v[10:11], v[10:11], v[242:243]
v_pk_mul_f32 v[12:13], v[12:13], v[248:249]
v_pk_mul_f32 v[14:15], v[14:15], v[250:251]
v_cvt_pk_bf16_f32 v176, v8, v9
v_cvt_pk_bf16_f32 v177, v10, v11
v_cvt_pk_bf16_f32 v178, v12, v13
v_cvt_pk_bf16_f32 v179, v14, v15
buffer_store_dwordx4 v[176:179], v3, s[28:31], s70 offen offset:0 sc1
s_waitcnt lgkmcnt(0)
s_nop 0
dq v[16:19],v43,512
v_pk_fma_f32 v[180:181], v[152:153], v[20:21], v[180:181] op_sel_hi:[1,0,1]
v_pk_fma_f32 v[182:183], v[154:155], v[20:21], v[182:183] op_sel_hi:[1,0,1]
v_pk_fma_f32 v[212:213], v[156:157], v[20:21], v[212:213] op_sel_hi:[1,0,1]
v_pk_fma_f32 v[214:215], v[158:159], v[20:21], v[214:215] op_sel_hi:[1,0,1]
v_pk_fma_f32 v[244:245], v[160:161], v[20:21], v[244:245] op_sel_hi:[1,0,1]
v_pk_fma_f32 v[246:247], v[162:163], v[20:21], v[246:247] op_sel_hi:[1,0,1]
v_pk_fma_f32 v[252:253], v[164:165], v[20:21], v[252:253] op_sel_hi:[1,0,1]
v_pk_fma_f32 v[254:255], v[166:167], v[20:21], v[254:255] op_sel_hi:[1,0,1]
v_pk_mul_f32 v[8:9], v[180:181], v[180:181]
v_pk_mul_f32 v[10:11], v[182:183], v[182:183]
v_pk_mul_f32 v[12:13], v[212:213], v[212:213]
v_pk_mul_f32 v[14:15], v[214:215], v[214:215]
v_pk_fma_f32 v[8:9], v[8:9], v[22:23], v[20:21] op_sel:[0,0,1] op_sel_hi:[1,0,1]
v_pk_fma_f32 v[10:11], v[10:11], v[22:23], v[20:21] op_sel:[0,0,1] op_sel_hi:[1,0,1]
v_pk_fma_f32 v[12:13], v[12:13], v[22:23], v[20:21] op_sel:[0,0,1] op_sel_hi:[1,0,1]
v_pk_fma_f32 v[14:15], v[14:15], v[22:23], v[20:21] op_sel:[0,0,1] op_sel_hi:[1,0,1]
v_pk_mul_f32 v[8:9], v[8:9], v[180:181]
v_pk_mul_f32 v[10:11], v[10:11], v[182:183]
v_pk_mul_f32 v[12:13], v[12:13], v[212:213]
v_pk_mul_f32 v[14:15], v[14:15], v[214:215]
v_exp_f32 v8, v8
v_exp_f32 v9, v9
v_exp_f32 v10, v10
v_exp_f32 v11, v11
v_exp_f32 v12, v12
v_exp_f32 v13, v13
v_exp_f32 v14, v14
v_exp_f32 v15, v15
v_pk_mul_f32 v[244:245], v[180:181], v[244:245]
v_pk_mul_f32 v[246:247], v[182:183], v[246:247]
v_pk_mul_f32 v[252:253], v[212:213], v[252:253]
v_pk_mul_f32 v[254:255], v[214:215], v[254:255]
v_pk_fma_f32 v[8:9], v[8:9], v[22:23], v[22:23] op_sel:[0,1,1] op_sel_hi:[1,1,1]
v_pk_fma_f32 v[10:11], v[10:11], v[22:23], v[22:23] op_sel:[0,1,1] op_sel_hi:[1,1,1]
v_pk_fma_f32 v[12:13], v[12:13], v[22:23], v[22:23] op_sel:[0,1,1] op_sel_hi:[1,1,1]
v_pk_fma_f32 v[14:15], v[14:15], v[22:23], v[22:23] op_sel:[0,1,1] op_sel_hi:[1,1,1]
v_rcp_f32 v8, v8
v_rcp_f32 v9, v9
v_rcp_f32 v10, v10
v_rcp_f32 v11, v11
v_rcp_f32 v12, v12
v_rcp_f32 v13, v13
v_rcp_f32 v14, v14
v_rcp_f32 v15, v15
v_pk_mul_f32 v[8:9], v[8:9], v[244:245]
v_pk_mul_f32 v[10:11], v[10:11], v[246:247]
v_pk_mul_f32 v[12:13], v[12:13], v[252:253]
v_pk_mul_f32 v[14:15], v[14:15], v[254:255]
v_cvt_pk_bf16_f32 v180, v8, v9
v_cvt_pk_bf16_f32 v181, v10, v11
v_cvt_pk_bf16_f32 v182, v12, v13
v_cvt_pk_bf16_f32 v183, v14, v15
buffer_store_dwordx4 v[180:183], v3, s[28:31], s70 offen offset:1024 sc1
buffer_load_dword v39, v27, s[28:31], 0 offen sc1
s_mov_b32 s9, 0
s_waitcnt lgkmcnt(0)
dq v[20:23],v43,768
v_accvgpr_read_b32 v116, a208
v_accvgpr_read_b32 v117, a209
v_accvgpr_read_b32 v118, a210
v_accvgpr_read_b32 v119, a211
v_accvgpr_read_b32 v112, a232
v_accvgpr_read_b32 v113, a233
v_accvgpr_read_b32 v114, a234
v_accvgpr_read_b32 v115, a235
v_pk_fma_f32 v[184:185], v[152:153], v[16:17], v[184:185] op_sel_hi:[1,0,1]
v_pk_fma_f32 v[186:187], v[154:155], v[16:17], v[186:187] op_sel_hi:[1,0,1]
v_pk_fma_f32 v[216:217], v[156:157], v[16:17], v[216:217] op_sel_hi:[1,0,1]
v_pk_fma_f32 v[218:219], v[158:159], v[16:17], v[218:219] op_sel_hi:[1,0,1]
v_pk_fma_f32 v[116:117], v[160:161], v[16:17], v[116:117] op_sel_hi:[1,0,1]
v_pk_fma_f32 v[118:119], v[162:163], v[16:17], v[118:119] op_sel_hi:[1,0,1]
v_pk_fma_f32 v[112:113], v[164:165], v[16:17], v[112:113] op_sel_hi:[1,0,1]
v_pk_fma_f32 v[114:115], v[166:167], v[16:17], v[114:115] op_sel_hi:[1,0,1]
v_pk_mul_f32 v[8:9], v[184:185], v[184:185]
v_pk_mul_f32 v[10:11], v[186:187], v[186:187]
v_pk_mul_f32 v[12:13], v[216:217], v[216:217]
v_pk_mul_f32 v[14:15], v[218:219], v[218:219]
v_pk_fma_f32 v[8:9], v[8:9], v[18:19], v[16:17] op_sel:[0,0,1] op_sel_hi:[1,0,1]
v_pk_fma_f32 v[10:11], v[10:11], v[18:19], v[16:17] op_sel:[0,0,1] op_sel_hi:[1,0,1]
v_pk_fma_f32 v[12:13], v[12:13], v[18:19], v[16:17] op_sel:[0,0,1] op_sel_hi:[1,0,1]
v_pk_fma_f32 v[14:15], v[14:15], v[18:19], v[16:17] op_sel:[0,0,1] op_sel_hi:[1,0,1]
v_pk_mul_f32 v[8:9], v[8:9], v[184:185]
v_pk_mul_f32 v[10:11], v[10:11], v[186:187]
v_pk_mul_f32 v[12:13], v[12:13], v[216:217]
v_pk_mul_f32 v[14:15], v[14:15], v[218:219]
v_exp_f32 v8, v8
v_exp_f32 v9, v9
v_exp_f32 v10, v10
v_exp_f32 v11, v11
v_exp_f32 v12, v12
v_exp_f32 v13, v13
v_exp_f32 v14, v14
v_exp_f32 v15, v15
v_pk_mul_f32 v[116:117], v[184:185], v[116:117]
v_pk_mul_f32 v[118:119], v[186:187], v[118:119]
v_pk_mul_f32 v[112:113], v[216:217], v[112:113]
v_pk_mul_f32 v[114:115], v[218:219], v[114:115]
v_pk_fma_f32 v[8:9], v[8:9], v[18:19], v[18:19] op_sel:[0,1,1] op_sel_hi:[1,1,1]
v_pk_fma_f32 v[10:11], v[10:11], v[18:19], v[18:19] op_sel:[0,1,1] op_sel_hi:[1,1,1]
v_pk_fma_f32 v[12:13], v[12:13], v[18:19], v[18:19] op_sel:[0,1,1] op_sel_hi:[1,1,1]
v_pk_fma_f32 v[14:15], v[14:15], v[18:19], v[18:19] op_sel:[0,1,1] op_sel_hi:[1,1,1]
v_rcp_f32 v8, v8
v_rcp_f32 v9, v9
v_rcp_f32 v10, v10
v_rcp_f32 v11, v11
v_rcp_f32 v12, v12
v_rcp_f32 v13, v13
v_rcp_f32 v14, v14
v_rcp_f32 v15, v15
v_pk_mul_f32 v[8:9], v[8:9], v[116:117]
v_pk_mul_f32 v[10:11], v[10:11], v[118:119]
v_pk_mul_f32 v[12:13], v[12:13], v[112:113]
v_pk_mul_f32 v[14:15], v[14:15], v[114:115]
v_cvt_pk_bf16_f32 v184, v8, v9
v_cvt_pk_bf16_f32 v185, v10, v11
v_cvt_pk_bf16_f32 v186, v12, v13
v_cvt_pk_bf16_f32 v187, v14, v15
buffer_store_dwordx4 v[184:187], v3, s[28:31], s70 offen offset:2048 sc1
s_waitcnt lgkmcnt(0)
s_nop 0
dq v[16:19],v43,1024
v_accvgpr_read_b32 v116, a212
v_accvgpr_read_b32 v117, a213
v_accvgpr_read_b32 v118, a214
v_accvgpr_read_b32 v119, a215
v_accvgpr_read_b32 v112, a236
v_accvgpr_read_b32 v113, a237
v_accvgpr_read_b32 v114, a238
v_accvgpr_read_b32 v115, a239
v_pk_fma_f32 v[188:189], v[152:153], v[20:21], v[188:189] op_sel_hi:[1,0,1]
v_pk_fma_f32 v[190:191], v[154:155], v[20:21], v[190:191] op_sel_hi:[1,0,1]
v_pk_fma_f32 v[220:221], v[156:157], v[20:21], v[220:221] op_sel_hi:[1,0,1]
v_pk_fma_f32 v[222:223], v[158:159], v[20:21], v[222:223] op_sel_hi:[1,0,1]
v_pk_fma_f32 v[116:117], v[160:161], v[20:21], v[116:117] op_sel_hi:[1,0,1]
v_pk_fma_f32 v[118:119], v[162:163], v[20:21], v[118:119] op_sel_hi:[1,0,1]
v_pk_fma_f32 v[112:113], v[164:165], v[20:21], v[112:113] op_sel_hi:[1,0,1]
v_pk_fma_f32 v[114:115], v[166:167], v[20:21], v[114:115] op_sel_hi:[1,0,1]
v_pk_mul_f32 v[8:9], v[188:189], v[188:189]
v_pk_mul_f32 v[10:11], v[190:191], v[190:191]
v_pk_mul_f32 v[12:13], v[220:221], v[220:221]
v_pk_mul_f32 v[14:15], v[222:223], v[222:223]
v_pk_fma_f32 v[8:9], v[8:9], v[22:23], v[20:21] op_sel:[0,0,1] op_sel_hi:[1,0,1]
v_pk_fma_f32 v[10:11], v[10:11], v[22:23], v[20:21] op_sel:[0,0,1] op_sel_hi:[1,0,1]
v_pk_fma_f32 v[12:13], v[12:13], v[22:23], v[20:21] op_sel:[0,0,1] op_sel_hi:[1,0,1]
v_pk_fma_f32 v[14:15], v[14:15], v[22:23], v[20:21] op_sel:[0,0,1] op_sel_hi:[1,0,1]
v_pk_mul_f32 v[8:9], v[8:9], v[188:189]
v_pk_mul_f32 v[10:11], v[10:11], v[190:191]
v_pk_mul_f32 v[12:13], v[12:13], v[220:221]
v_pk_mul_f32 v[14:15], v[14:15], v[222:223]
v_exp_f32 v8, v8
v_exp_f32 v9, v9
v_exp_f32 v10, v10
v_exp_f32 v11, v11
v_exp_f32 v12, v12
v_exp_f32 v13, v13
v_exp_f32 v14, v14
v_exp_f32 v15, v15
v_pk_mul_f32 v[116:117], v[188:189], v[116:117]
v_pk_mul_f32 v[118:119], v[190:191], v[118:119]
v_pk_mul_f32 v[112:113], v[220:221], v[112:113]
v_pk_mul_f32 v[114:115], v[222:223], v[114:115]
v_pk_fma_f32 v[8:9], v[8:9], v[22:23], v[22:23] op_sel:[0,1,1] op_sel_hi:[1,1,1]
v_pk_fma_f32 v[10:11], v[10:11], v[22:23], v[22:23] op_sel:[0,1,1] op_sel_hi:[1,1,1]
v_pk_fma_f32 v[12:13], v[12:13], v[22:23], v[22:23] op_sel:[0,1,1] op_sel_hi:[1,1,1]
v_pk_fma_f32 v[14:15], v[14:15], v[22:23], v[22:23] op_sel:[0,1,1] op_sel_hi:[1,1,1]
v_rcp_f32 v8, v8
v_rcp_f32 v9, v9
v_rcp_f32 v10, v10
v_rcp_f32 v11, v11
v_rcp_f32 v12, v12
v_rcp_f32 v13, v13
v_rcp_f32 v14, v14
v_rcp_f32 v15, v15
v_pk_mul_f32 v[8:9], v[8:9], v[116:117]
v_pk_mul_f32 v[10:11], v[10:11], v[118:119]
v_pk_mul_f32 v[12:13], v[12:13], v[112:113]
v_pk_mul_f32 v[14:15], v[14:15], v[114:115]
v_cvt_pk_bf16_f32 v188, v8, v9
v_cvt_pk_bf16_f32 v189, v10, v11
v_cvt_pk_bf16_f32 v190, v12, v13
v_cvt_pk_bf16_f32 v191, v14, v15
buffer_store_dwordx4 v[188:191], v3, s[28:31], s70 offen offset:3072 sc1
s_waitcnt lgkmcnt(0)
s_nop 0
dq v[20:23],v43,1280
v_accvgpr_read_b32 v116, a216
v_accvgpr_read_b32 v117, a217
v_accvgpr_read_b32 v118, a218
v_accvgpr_read_b32 v119, a219
v_accvgpr_read_b32 v112, a240
v_accvgpr_read_b32 v113, a241
v_accvgpr_read_b32 v114, a242
v_accvgpr_read_b32 v115, a243
v_pk_fma_f32 v[192:193], v[152:153], v[16:17], v[192:193] op_sel_hi:[1,0,1]
v_pk_fma_f32 v[194:195], v[154:155], v[16:17], v[194:195] op_sel_hi:[1,0,1]
v_pk_fma_f32 v[224:225], v[156:157], v[16:17], v[224:225] op_sel_hi:[1,0,1]
v_pk_fma_f32 v[226:227], v[158:159], v[16:17], v[226:227] op_sel_hi:[1,0,1]
v_pk_fma_f32 v[116:117], v[160:161], v[16:17], v[116:117] op_sel_hi:[1,0,1]
v_pk_fma_f32 v[118:119], v[162:163], v[16:17], v[118:119] op_sel_hi:[1,0,1]
v_pk_fma_f32 v[112:113], v[164:165], v[16:17], v[112:113] op_sel_hi:[1,0,1]
v_pk_fma_f32 v[114:115], v[166:167], v[16:17], v[114:115] op_sel_hi:[1,0,1]
v_pk_mul_f32 v[8:9], v[192:193], v[192:193]
v_pk_mul_f32 v[10:11], v[194:195], v[194:195]
v_pk_mul_f32 v[12:13], v[224:225], v[224:225]
v_pk_mul_f32 v[14:15], v[226:227], v[226:227]
v_pk_fma_f32 v[8:9], v[8:9], v[18:19], v[16:17] op_sel:[0,0,1] op_sel_hi:[1,0,1]
v_pk_fma_f32 v[10:11], v[10:11], v[18:19], v[16:17] op_sel:[0,0,1] op_sel_hi:[1,0,1]
v_pk_fma_f32 v[12:13], v[12:13], v[18:19], v[16:17] op_sel:[0,0,1] op_sel_hi:[1,0,1]
v_pk_fma_f32 v[14:15], v[14:15], v[18:19], v[16:17] op_sel:[0,0,1] op_sel_hi:[1,0,1]
v_pk_mul_f32 v[8:9], v[8:9], v[192:193]
v_pk_mul_f32 v[10:11], v[10:11], v[194:195]
v_pk_mul_f32 v[12:13], v[12:13], v[224:225]
v_pk_mul_f32 v[14:15], v[14:15], v[226:227]
v_exp_f32 v8, v8
v_exp_f32 v9, v9
v_exp_f32 v10, v10
v_exp_f32 v11, v11
v_exp_f32 v12, v12
v_exp_f32 v13, v13
v_exp_f32 v14, v14
v_exp_f32 v15, v15
v_pk_mul_f32 v[116:117], v[192:193], v[116:117]
v_pk_mul_f32 v[118:119], v[194:195], v[118:119]
v_pk_mul_f32 v[112:113], v[224:225], v[112:113]
v_pk_mul_f32 v[114:115], v[226:227], v[114:115]
v_pk_fma_f32 v[8:9], v[8:9], v[18:19], v[18:19] op_sel:[0,1,1] op_sel_hi:[1,1,1]
v_pk_fma_f32 v[10:11], v[10:11], v[18:19], v[18:19] op_sel:[0,1,1] op_sel_hi:[1,1,1]
v_pk_fma_f32 v[12:13], v[12:13], v[18:19], v[18:19] op_sel:[0,1,1] op_sel_hi:[1,1,1]
v_pk_fma_f32 v[14:15], v[14:15], v[18:19], v[18:19] op_sel:[0,1,1] op_sel_hi:[1,1,1]
v_rcp_f32 v8, v8
v_rcp_f32 v9, v9
v_rcp_f32 v10, v10
v_rcp_f32 v11, v11
v_rcp_f32 v12, v12
v_rcp_f32 v13, v13
v_rcp_f32 v14, v14
v_rcp_f32 v15, v15
v_pk_mul_f32 v[8:9], v[8:9], v[116:117]
v_pk_mul_f32 v[10:11], v[10:11], v[118:119]
v_pk_mul_f32 v[12:13], v[12:13], v[112:113]
v_pk_mul_f32 v[14:15], v[14:15], v[114:115]
v_cvt_pk_bf16_f32 v192, v8, v9
v_cvt_pk_bf16_f32 v193, v10, v11
v_cvt_pk_bf16_f32 v194, v12, v13
v_cvt_pk_bf16_f32 v195, v14, v15
buffer_store_dwordx4 v[192:195], v3, s[28:31], s71 offen offset:0 sc1
s_waitcnt lgkmcnt(0)
s_waitcnt vmcnt(3)
v_sub_u32 v39, v39, v5
v_subrev_u32 v39, 1, v39
v_cmp_lt_u32 vcc, 2, v39
s_nop 0
s_cbranch_vccz L_ckQ0_a
buffer_load_dword v39, v27, s[28:31], 0 offen sc1
s_branch L_ckQ0_e
L_ckQ0_a:
s_mov_b32 s9, 1
v_readlane_b32 s69, v24, 0
s_nop 2
s_add_u32 m0, s65, 0
s_nop 0
buffer_load_dwordx4 v29, s[28:31], s69 offen offset:0 sc1 lds
buffer_load_dwordx4 v29, s[28:31], s69 offen offset:1024 sc1 lds
buffer_load_dwordx4 v29, s[28:31], s69 offen offset:2048 sc1 lds
buffer_load_dwordx4 v29, s[28:31], s69 offen offset:3072 sc1 lds
v_readlane_b32 s69, v24, 1
s_nop 2
s_add_u32 m0, s65, 16384
s_nop 0
buffer_load_dwordx4 v29, s[28:31], s69 offen offset:0 sc1 lds
buffer_load_dwordx4 v29, s[28:31], s69 offen offset:1024 sc1 lds
buffer_load_dwordx4 v29, s[28:31], s69 offen offset:2048 sc1 lds
buffer_load_dwordx4 v29, s[28:31], s69 offen offset:3072 sc1 lds
L_ckQ0_e:
s_waitcnt lgkmcnt(0)
s_nop 0
dq v[16:19],v43,1536
L_stub19:
s_cbranch_execz L_stub22
s_nop 0
v_accvgpr_read_b32 v116, a220
v_accvgpr_read_b32 v117, a221
v_accvgpr_read_b32 v118, a222
v_accvgpr_read_b32 v119, a223
v_accvgpr_read_b32 v112, a244
v_accvgpr_read_b32 v113, a245
v_accvgpr_read_b32 v114, a246
v_accvgpr_read_b32 v115, a247
v_pk_fma_f32 v[196:197], v[152:153], v[20:21], v[196:197] op_sel_hi:[1,0,1]
v_pk_fma_f32 v[198:199], v[154:155], v[20:21], v[198:199] op_sel_hi:[1,0,1]
v_pk_fma_f32 v[228:229], v[156:157], v[20:21], v[228:229] op_sel_hi:[1,0,1]
v_pk_fma_f32 v[230:231], v[158:159], v[20:21], v[230:231] op_sel_hi:[1,0,1]
v_pk_fma_f32 v[116:117], v[160:161], v[20:21], v[116:117] op_sel_hi:[1,0,1]
v_pk_fma_f32 v[118:119], v[162:163], v[20:21], v[118:119] op_sel_hi:[1,0,1]
v_pk_fma_f32 v[112:113], v[164:165], v[20:21], v[112:113] op_sel_hi:[1,0,1]
v_pk_fma_f32 v[114:115], v[166:167], v[20:21], v[114:115] op_sel_hi:[1,0,1]
v_pk_mul_f32 v[8:9], v[196:197], v[196:197]
v_pk_mul_f32 v[10:11], v[198:199], v[198:199]
v_pk_mul_f32 v[12:13], v[228:229], v[228:229]
v_pk_mul_f32 v[14:15], v[230:231], v[230:231]
v_pk_fma_f32 v[8:9], v[8:9], v[22:23], v[20:21] op_sel:[0,0,1] op_sel_hi:[1,0,1]
v_pk_fma_f32 v[10:11], v[10:11], v[22:23], v[20:21] op_sel:[0,0,1] op_sel_hi:[1,0,1]
v_pk_fma_f32 v[12:13], v[12:13], v[22:23], v[20:21] op_sel:[0,0,1] op_sel_hi:[1,0,1]
v_pk_fma_f32 v[14:15], v[14:15], v[22:23], v[20:21] op_sel:[0,0,1] op_sel_hi:[1,0,1]
v_pk_mul_f32 v[8:9], v[8:9], v[196:197]
v_pk_mul_f32 v[10:11], v[10:11], v[198:199]
v_pk_mul_f32 v[12:13], v[12:13], v[228:229]
v_pk_mul_f32 v[14:15], v[14:15], v[230:231]
v_exp_f32 v8, v8
v_exp_f32 v9, v9
v_exp_f32 v10, v10
v_exp_f32 v11, v11
v_exp_f32 v12, v12
v_exp_f32 v13, v13
v_exp_f32 v14, v14
v_exp_f32 v15, v15
v_pk_mul_f32 v[116:117], v[196:197], v[116:117]
v_pk_mul_f32 v[118:119], v[198:199], v[118:119]
v_pk_mul_f32 v[112:113], v[228:229], v[112:113]
v_pk_mul_f32 v[114:115], v[230:231], v[114:115]
v_pk_fma_f32 v[8:9], v[8:9], v[22:23], v[22:23] op_sel:[0,1,1] op_sel_hi:[1,1,1]
v_pk_fma_f32 v[10:11], v[10:11], v[22:23], v[22:23] op_sel:[0,1,1] op_sel_hi:[1,1,1]
v_pk_fma_f32 v[12:13], v[12:13], v[22:23], v[22:23] op_sel:[0,1,1] op_sel_hi:[1,1,1]
v_pk_fma_f32 v[14:15], v[14:15], v[22:23], v[22:23] op_sel:[0,1,1] op_sel_hi:[1,1,1]
v_rcp_f32 v8, v8
v_rcp_f32 v9, v9
v_rcp_f32 v10, v10
v_rcp_f32 v11, v11
v_rcp_f32 v12, v12
v_rcp_f32 v13, v13
v_rcp_f32 v14, v14
v_rcp_f32 v15, v15
v_pk_mul_f32 v[8:9], v[8:9], v[116:117]
v_pk_mul_f32 v[10:11], v[10:11], v[118:119]
v_pk_mul_f32 v[12:13], v[12:13], v[112:113]
v_pk_mul_f32 v[14:15], v[14:15], v[114:115]
v_cvt_pk_bf16_f32 v196, v8, v9
v_cvt_pk_bf16_f32 v197, v10, v11
v_cvt_pk_bf16_f32 v198, v12, v13
v_cvt_pk_bf16_f32 v199, v14, v15
buffer_store_dwordx4 v[196:199], v3, s[28:31], s71 offen offset:1024 sc1
s_waitcnt lgkmcnt(0)
s_nop 0
dq v[20:23],v43,1792
v_accvgpr_read_b32 v116, a224
v_accvgpr_read_b32 v117, a225
v_accvgpr_read_b32 v118, a226
v_accvgpr_read_b32 v119, a227
v_accvgpr_read_b32 v112, a248
v_accvgpr_read_b32 v113, a249
v_accvgpr_read_b32 v114, a250
v_accvgpr_read_b32 v115, a251
v_pk_fma_f32 v[200:201], v[152:153], v[16:17], v[200:201] op_sel_hi:[1,0,1]
v_pk_fma_f32 v[202:203], v[154:155], v[16:17], v[202:203] op_sel_hi:[1,0,1]
v_pk_fma_f32 v[232:233], v[156:157], v[16:17], v[232:233] op_sel_hi:[1,0,1]
v_pk_fma_f32 v[234:235], v[158:159], v[16:17], v[234:235] op_sel_hi:[1,0,1]
v_pk_fma_f32 v[116:117], v[160:161], v[16:17], v[116:117] op_sel_hi:[1,0,1]
v_pk_fma_f32 v[118:119], v[162:163], v[16:17], v[118:119] op_sel_hi:[1,0,1]
v_pk_fma_f32 v[112:113], v[164:165], v[16:17], v[112:113] op_sel_hi:[1,0,1]
v_pk_fma_f32 v[114:115], v[166:167], v[16:17], v[114:115] op_sel_hi:[1,0,1]
v_pk_mul_f32 v[8:9], v[200:201], v[200:201]
v_pk_mul_f32 v[10:11], v[202:203], v[202:203]
v_pk_mul_f32 v[12:13], v[232:233], v[232:233]
v_pk_mul_f32 v[14:15], v[234:235], v[234:235]
v_pk_fma_f32 v[8:9], v[8:9], v[18:19], v[16:17] op_sel:[0,0,1] op_sel_hi:[1,0,1]
v_pk_fma_f32 v[10:11], v[10:11], v[18:19], v[16:17] op_sel:[0,0,1] op_sel_hi:[1,0,1]
v_pk_fma_f32 v[12:13], v[12:13], v[18:19], v[16:17] op_sel:[0,0,1] op_sel_hi:[1,0,1]
v_pk_fma_f32 v[14:15], v[14:15], v[18:19], v[16:17] op_sel:[0,0,1] op_sel_hi:[1,0,1]
v_pk_mul_f32 v[8:9], v[8:9], v[200:201]
v_pk_mul_f32 v[10:11], v[10:11], v[202:203]
v_pk_mul_f32 v[12:13], v[12:13], v[232:233]
v_pk_mul_f32 v[14:15], v[14:15], v[234:235]
v_exp_f32 v8, v8
v_exp_f32 v9, v9
v_exp_f32 v10, v10
v_exp_f32 v11, v11
v_exp_f32 v12, v12
v_exp_f32 v13, v13
v_exp_f32 v14, v14
v_exp_f32 v15, v15
v_pk_mul_f32 v[116:117], v[200:201], v[116:117]
v_pk_mul_f32 v[118:119], v[202:203], v[118:119]
v_pk_mul_f32 v[112:113], v[232:233], v[112:113]
v_pk_mul_f32 v[114:115], v[234:235], v[114:115]
v_pk_fma_f32 v[8:9], v[8:9], v[18:19], v[18:19] op_sel:[0,1,1] op_sel_hi:[1,1,1]
v_pk_fma_f32 v[10:11], v[10:11], v[18:19], v[18:19] op_sel:[0,1,1] op_sel_hi:[1,1,1]
v_pk_fma_f32 v[12:13], v[12:13], v[18:19], v[18:19] op_sel:[0,1,1] op_sel_hi:[1,1,1]
v_pk_fma_f32 v[14:15], v[14:15], v[18:19], v[18:19] op_sel:[0,1,1] op_sel_hi:[1,1,1]
v_rcp_f32 v8, v8
v_rcp_f32 v9, v9
v_rcp_f32 v10, v10
v_rcp_f32 v11, v11
v_rcp_f32 v12, v12
v_rcp_f32 v13, v13
v_rcp_f32 v14, v14
v_rcp_f32 v15, v15
v_pk_mul_f32 v[8:9], v[8:9], v[116:117]
v_pk_mul_f32 v[10:11], v[10:11], v[118:119]
v_pk_mul_f32 v[12:13], v[12:13], v[112:113]
v_pk_mul_f32 v[14:15], v[14:15], v[114:115]
v_cvt_pk_bf16_f32 v200, v8, v9
v_cvt_pk_bf16_f32 v201, v10, v11
v_cvt_pk_bf16_f32 v202, v12, v13
v_cvt_pk_bf16_f32 v203, v14, v15
buffer_store_dwordx4 v[200:203], v3, s[28:31], s71 offen offset:2048 sc1
s_waitcnt lgkmcnt(0)
s_nop 0
v_accvgpr_read_b32 v116, a228
v_accvgpr_read_b32 v117, a229
v_accvgpr_read_b32 v118, a230
v_accvgpr_read_b32 v119, a231
v_accvgpr_read_b32 v112, a252
v_accvgpr_read_b32 v113, a253
v_accvgpr_read_b32 v114, a254
v_accvgpr_read_b32 v115, a255
v_pk_fma_f32 v[204:205], v[152:153], v[20:21], v[204:205] op_sel_hi:[1,0,1]
v_pk_fma_f32 v[206:207], v[154:155], v[20:21], v[206:207] op_sel_hi:[1,0,1]
v_pk_fma_f32 v[236:237], v[156:157], v[20:21], v[236:237] op_sel_hi:[1,0,1]
v_pk_fma_f32 v[238:239], v[158:159], v[20:21], v[238:239] op_sel_hi:[1,0,1]
v_pk_fma_f32 v[116:117], v[160:161], v[20:21], v[116:117] op_sel_hi:[1,0,1]
v_pk_fma_f32 v[118:119], v[162:163], v[20:21], v[118:119] op_sel_hi:[1,0,1]
v_pk_fma_f32 v[112:113], v[164:165], v[20:21], v[112:113] op_sel_hi:[1,0,1]
v_pk_fma_f32 v[114:115], v[166:167], v[20:21], v[114:115] op_sel_hi:[1,0,1]
v_pk_mul_f32 v[8:9], v[204:205], v[204:205]
v_pk_mul_f32 v[10:11], v[206:207], v[206:207]
v_pk_mul_f32 v[12:13], v[236:237], v[236:237]
v_pk_mul_f32 v[14:15], v[238:239], v[238:239]
v_pk_fma_f32 v[8:9], v[8:9], v[22:23], v[20:21] op_sel:[0,0,1] op_sel_hi:[1,0,1]
v_pk_fma_f32 v[10:11], v[10:11], v[22:23], v[20:21] op_sel:[0,0,1] op_sel_hi:[1,0,1]
v_pk_fma_f32 v[12:13], v[12:13], v[22:23], v[20:21] op_sel:[0,0,1] op_sel_hi:[1,0,1]
v_pk_fma_f32 v[14:15], v[14:15], v[22:23], v[20:21] op_sel:[0,0,1] op_sel_hi:[1,0,1]
v_pk_mul_f32 v[8:9], v[8:9], v[204:205]
v_pk_mul_f32 v[10:11], v[10:11], v[206:207]
v_pk_mul_f32 v[12:13], v[12:13], v[236:237]
v_pk_mul_f32 v[14:15], v[14:15], v[238:239]
v_exp_f32 v8, v8
v_exp_f32 v9, v9
v_exp_f32 v10, v10
v_exp_f32 v11, v11
v_exp_f32 v12, v12
v_exp_f32 v13, v13
v_exp_f32 v14, v14
v_exp_f32 v15, v15
v_pk_mul_f32 v[116:117], v[204:205], v[116:117]
v_pk_mul_f32 v[118:119], v[206:207], v[118:119]
v_pk_mul_f32 v[112:113], v[236:237], v[112:113]
v_pk_mul_f32 v[114:115], v[238:239], v[114:115]
v_pk_fma_f32 v[8:9], v[8:9], v[22:23], v[22:23] op_sel:[0,1,1] op_sel_hi:[1,1,1]
v_pk_fma_f32 v[10:11], v[10:11], v[22:23], v[22:23] op_sel:[0,1,1] op_sel_hi:[1,1,1]
v_pk_fma_f32 v[12:13], v[12:13], v[22:23], v[22:23] op_sel:[0,1,1] op_sel_hi:[1,1,1]
v_pk_fma_f32 v[14:15], v[14:15], v[22:23], v[22:23] op_sel:[0,1,1] op_sel_hi:[1,1,1]
v_rcp_f32 v8, v8
v_rcp_f32 v9, v9
v_rcp_f32 v10, v10
v_rcp_f32 v11, v11
v_rcp_f32 v12, v12
v_rcp_f32 v13, v13
v_rcp_f32 v14, v14
v_rcp_f32 v15, v15
v_pk_mul_f32 v[8:9], v[8:9], v[116:117]
v_pk_mul_f32 v[10:11], v[10:11], v[118:119]
v_pk_mul_f32 v[12:13], v[12:13], v[112:113]
v_pk_mul_f32 v[14:15], v[14:15], v[114:115]
v_cvt_pk_bf16_f32 v204, v8, v9
v_cvt_pk_bf16_f32 v205, v10, v11
v_cvt_pk_bf16_f32 v206, v12, v13
v_cvt_pk_bf16_f32 v207, v14, v15
buffer_store_dwordx4 v[204:207], v3, s[28:31], s71 offen offset:3072 sc1
v_readlane_b32 s4, v24, 2
v_readlane_b32 s5, v24, 3
s_waitcnt vmcnt(3)
s_cmp_eq_u32 s9, 1
s_cbranch_scc0 L_lateQ
L_lateQ_ret:
s_barrier
L_g2:
L_stub20:
s_cbranch_execz L_stub24
s_nop 0
s_add_u32 m0, s65, 32768
dq a[0:3],v32,0
buffer_load_dwordx4 v29, s[28:31], s4 offen offset:0 sc1 lds
dq a[4:7],v32,1024
dq a[8:11],v33,0
dq a[12:15],v33,1024
buffer_load_dwordx4 v29, s[28:31], s4 offen offset:1024 sc1 lds
dt a[64:65],v34,0
dt a[66:67],v34,2048
dt a[68:69],v35,0
buffer_load_dwordx4 v29, s[28:31], s4 offen offset:2048 sc1 lds
dt a[70:71],v35,2048
dt a[72:73],v36,0
dt a[74:75],v36,2048
buffer_load_dwordx4 v29, s[28:31], s4 offen offset:3072 sc1 lds
dt a[76:77],v37,0
dt a[78:79],v37,2048
s_add_u32 m0, s65, 49152
dq a[16:19],v32,8192
buffer_load_dwordx4 v29, s[28:31], s5 offen offset:0 sc1 lds
dq a[20:23],v32,9216
dq a[24:27],v33,8192
dq a[28:31],v33,9216
buffer_load_dwordx4 v29, s[28:31], s5 offen offset:1024 sc1 lds
dt a[80:81],v34,4096
dt a[82:83],v34,6144
dt a[84:85],v35,4096
buffer_load_dwordx4 v29, s[28:31], s5 offen offset:2048 sc1 lds
dt a[86:87],v35,6144
dt a[88:89],v36,4096
dt a[90:91],v36,6144
buffer_load_dwordx4 v29, s[28:31], s5 offen offset:3072 sc1 lds
dt a[92:93],v37,4096
dt a[94:95],v37,6144
v_add_u32 v64, 131072, v32
v_add_u32 v65, 131072, v33
v_add_u32 v66, 81920, v34
v_add_u32 v67, 81920, v35
v_add_u32 v68, 81920, v36
v_add_u32 v69, 81920, v37
v_readlane_b32 s69, v24, 4
s_cmp_eq_u32 s9, 1
s_cbranch_scc1 L_a1ok
s_waitcnt vmcnt(8)
L_a1ok:
s_waitcnt lgkmcnt(0)
s_barrier
v_mfma_f32_16x16x32_bf16 v[208:211], a[64:67], a[8:11], 0
v_readlane_b32 s70, v25, 4
v_readlane_b32 s71, v26, 4
mf v[208:211],a[80:83],a[24:27]
dq a[32:35],v32,16384
v_mfma_f32_16x16x32_bf16 v[212:215], a[68:71], a[8:11], 0
s_add_u32 m0, s65, 0
dq a[36:39],v32,17408
mf v[212:215],a[84:87],a[24:27]
dq a[40:43],v33,16384
buffer_load_dwordx4 v29, s[28:31], s69 offen offset:0 sc1 lds
v_mfma_f32_16x16x32_bf16 v[216:219], a[72:75], a[8:11], 0
dq a[44:47],v33,17408
mf v[216:219],a[88:91],a[24:27]
dt a[96:97],v34,16384
v_mfma_f32_16x16x32_bf16 v[220:223], a[76:79], a[8:11], 0
dt a[98:99],v34,18432
mf v[220:223],a[92:95],a[24:27]
dt a[100:101],v35,16384
buffer_load_dwordx4 v29, s[28:31], s69 offen offset:1024 sc1 lds
v_mfma_f32_16x16x32_bf16 v[236:239], a[76:79], a[12:15], 0
dt a[102:103],v35,18432
mf v[236:239],a[92:95],a[28:31]
dt a[104:105],v36,16384
v_mfma_f32_16x16x32_bf16 v[232:235], a[72:75], a[12:15], 0
dt a[106:107],v36,18432
mf v[232:235],a[88:91],a[28:31]
dt a[108:109],v37,16384
buffer_load_dwordx4 v29, s[28:31], s69 offen offset:2048 sc1 lds
v_mfma_f32_16x16x32_bf16 v[228:231], a[68:71], a[12:15], 0
dt a[110:111],v37,18432
mf v[228:231],a[84:87],a[28:31]
dq a[48:51],v32,24576
v_mfma_f32_16x16x32_bf16 v[224:227], a[64:67], a[12:15], 0
dq a[52:55],v32,25600
mf v[224:227],a[80:83],a[28:31]
dq a[56:59],v33,24576
buffer_load_dwordx4 v29, s[28:31], s69 offen offset:3072 sc1 lds
v_mfma_f32_16x16x32_bf16 v[160:163], a[64:67], a[0:3], 0
dq a[60:63],v33,25600
mf v[160:163],a[80:83],a[16:19]
dt a[112:113],v34,20480
v_mfma_f32_16x16x32_bf16 v[164:167], a[68:71], a[0:3], 0
s_add_u32 m0, s67, 0
dt a[114:115],v34,22528
mf v[164:167],a[84:87],a[16:19]
dt a[116:117],v35,20480
buffer_load_dwordx4 v31, s[48:51], s70 offen offset:0 sc1 lds
v_mfma_f32_16x16x32_bf16 v[168:171], a[72:75], a[0:3], 0
dt a[118:119],v35,22528
mf v[168:171],a[88:91],a[16:19]
dt a[120:121],v36,20480
v_mfma_f32_16x16x32_bf16 v[172:175], a[76:79], a[0:3], 0
s_add_u32 m0, s67, 8064
dt a[122:123],v36,22528
mf v[172:175],a[92:95],a[16:19]
dt a[124:125],v37,20480
buffer_load_dwordx4 v31, s[48:51], s70 offen offset:128 sc1 lds
v_mfma_f32_16x16x32_bf16 v[188:191], a[76:79], a[4:7], 0
dt a[126:127],v37,22528
mf v[188:191],a[92:95],a[20:23]
v_mfma_f32_16x16x32_bf16 v[184:187], a[72:75], a[4:7], 0
s_add_u32 m0, s67, 1024
v_readlane_b32 s69, v24, 5
mf v[184:187],a[88:91],a[20:23]
buffer_load_dwordx4 v31, s[48:51], s71 offen offset:0 sc1 lds
v_mfma_f32_16x16x32_bf16 v[180:183], a[68:71], a[4:7], 0
mf v[180:183],a[84:87],a[20:23]
v_mfma_f32_16x16x32_bf16 v[176:179], a[64:67], a[4:7], 0
s_add_u32 m0, s67, 9088
mf v[176:179],a[80:83],a[20:23]
buffer_load_dwordx4 v31, s[48:51], s71 offen offset:128 sc1 lds
s_waitcnt vmcnt(12) lgkmcnt(0)
s_barrier
v_add_u32 v6, 2, v5
s_mov_b64 exec, 1
buffer_store_dword v6, v4, s[28:31], s79 offen sc1
s_mov_b64 exec, -1
s_cmp_eq_u32 s26, 0
s_cbranch_scc1 L_kvflag
L_kvflag_ret:
mf v[208:211],a[96:99],a[40:43]
v_readlane_b32 s70, v25, 5
v_readlane_b32 s71, v26, 5
mf v[208:211],a[112:115],a[56:59]
dq a[0:3],v32,32768
mf v[212:215],a[100:103],a[40:43]
s_add_u32 m0, s65, 16384
dq a[4:7],v32,33792
mf v[212:215],a[116:119],a[56:59]
dq a[8:11],v33,32768
buffer_load_dwordx4 v29, s[28:31], s69 offen offset:0 sc1 lds
mf v[216:219],a[104:107],a[40:43]
dq a[12:15],v33,33792
mf v[216:219],a[120:123],a[56:59]
dt a[64:65],v34,32768
mf v[220:223],a[108:111],a[40:43]
dt a[66:67],v34,34816
mf v[220:223],a[124:127],a[56:59]
dt a[68:69],v35,32768
buffer_load_dwordx4 v29, s[28:31], s69 offen offset:1024 sc1 lds
mf v[236:239],a[108:111],a[44:47]
dt a[70:71],v35,34816
mf v[236:239],a[124:127],a[60:63]
dt a[72:73],v36,32768
mf v[232:235],a[104:107],a[44:47]
dt a[74:75],v36,34816
mf v[232:235],a[120:123],a[60:63]
dt a[76:77],v37,32768
buffer_load_dwordx4 v29, s[28:31], s69 offen offset:2048 sc1 lds
mf v[228:231],a[100:103],a[44:47]
dt a[78:79],v37,34816
mf v[228:231],a[116:119],a[60:63]
dq a[16:19],v32,40960
mf v[224:227],a[96:99],a[44:47]
dq a[20:23],v32,41984
mf v[224:227],a[112:115],a[60:63]
dq a[24:27],v33,40960
buffer_load_dwordx4 v29, s[28:31], s69 offen offset:3072 sc1 lds
mf v[160:163],a[96:99],a[32:35]
dq a[28:31],v33,41984
mf v[160:163],a[112:115],a[48:51]
dt a[80:81],v34,36864
mf v[164:167],a[100:103],a[32:35]
s_add_u32 m0, s67, 16384
dt a[82:83],v34,38912
mf v[164:167],a[116:119],a[48:51]
dt a[84:85],v35,36864
buffer_load_dwordx4 v31, s[48:51], s70 offen offset:0 sc1 lds
mf v[168:171],a[104:107],a[32:35]
dt a[86:87],v35,38912
mf v[168:171],a[120:123],a[48:51]
dt a[88:89],v36,36864
mf v[172:175],a[108:111],a[32:35]
s_add_u32 m0, s67, 24448
dt a[90:91],v36,38912
mf v[172:175],a[124:127],a[48:51]
dt a[92:93],v37,36864
buffer_load_dwordx4 v31, s[48:51], s70 offen offset:128 sc1 lds
mf v[188:191],a[108:111],a[36:39]
dt a[94:95],v37,38912
mf v[188:191],a[124:127],a[52:55]
mf v[184:187],a[104:107],a[36:39]
s_add_u32 m0, s67, 17408
v_readlane_b32 s69, v24, 6
mf v[184:187],a[120:123],a[52:55]
buffer_load_dwordx4 v31, s[48:51], s71 offen offset:0 sc1 lds
mf v[180:183],a[100:103],a[36:39]
mf v[180:183],a[116:119],a[52:55]
mf v[176:179],a[96:99],a[36:39]
s_add_u32 m0, s67, 25472
mf v[176:179],a[112:115],a[52:55]
buffer_load_dwordx4 v31, s[48:51], s71 offen offset:128 sc1 lds
s_waitcnt vmcnt(17) lgkmcnt(0)
s_barrier
mf v[208:211],a[64:67],a[8:11]
v_readlane_b32 s70, v25, 6
v_readlane_b32 s71, v26, 6
mf v[208:211],a[80:83],a[24:27]
dq a[32:35],v32,49152
mf v[212:215],a[68:71],a[8:11]
s_add_u32 m0, s65, 32768
dq a[36:39],v32,50176
mf v[212:215],a[84:87],a[24:27]
dq a[40:43],v33,49152
buffer_load_dwordx4 v29, s[28:31], s69 offen offset:0 sc1 lds
mf v[216:219],a[72:75],a[8:11]
dq a[44:47],v33,50176
mf v[216:219],a[88:91],a[24:27]
dt a[96:97],v34,49152
mf v[220:223],a[76:79],a[8:11]
dt a[98:99],v34,51200
mf v[220:223],a[92:95],a[24:27]
dt a[100:101],v35,49152
buffer_load_dwordx4 v29, s[28:31], s69 offen offset:1024 sc1 lds
mf v[236:239],a[76:79],a[12:15]
dt a[102:103],v35,51200
mf v[236:239],a[92:95],a[28:31]
dt a[104:105],v36,49152
mf v[232:235],a[72:75],a[12:15]
dt a[106:107],v36,51200
mf v[232:235],a[88:91],a[28:31]
dt a[108:109],v37,49152
buffer_load_dwordx4 v29, s[28:31], s69 offen offset:2048 sc1 lds
mf v[228:231],a[68:71],a[12:15]
dt a[110:111],v37,51200
mf v[228:231],a[84:87],a[28:31]
dq a[48:51],v32,57344
mf v[224:227],a[64:67],a[12:15]
dq a[52:55],v32,58368
mf v[224:227],a[80:83],a[28:31]
dq a[56:59],v33,57344
buffer_load_dwordx4 v29, s[28:31], s69 offen offset:3072 sc1 lds
mf v[160:163],a[64:67],a[0:3]
dq a[60:63],v33,58368
mf v[160:163],a[80:83],a[16:19]
dt a[112:113],v34,53248
mf v[164:167],a[68:71],a[0:3]
s_add_u32 m0, s67, 32768
dt a[114:115],v34,55296
mf v[164:167],a[84:87],a[16:19]
dt a[116:117],v35,53248
buffer_load_dwordx4 v31, s[48:51], s70 offen offset:0 sc1 lds
mf v[168:171],a[72:75],a[0:3]
dt a[118:119],v35,55296
mf v[168:171],a[88:91],a[16:19]
dt a[120:121],v36,53248
mf v[172:175],a[76:79],a[0:3]
s_add_u32 m0, s67, 40832
dt a[122:123],v36,55296
mf v[172:175],a[92:95],a[16:19]
dt a[124:125],v37,53248
buffer_load_dwordx4 v31, s[48:51], s70 offen offset:128 sc1 lds
mf v[188:191],a[76:79],a[4:7]
dt a[126:127],v37,55296
mf v[188:191],a[92:95],a[20:23]
mf v[184:187],a[72:75],a[4:7]
s_add_u32 m0, s67, 33792
v_readlane_b32 s69, v24, 7
mf v[184:187],a[88:91],a[20:23]
buffer_load_dwordx4 v31, s[48:51], s71 offen offset:0 sc1 lds
mf v[180:183],a[68:71],a[4:7]
mf v[180:183],a[84:87],a[20:23]
mf v[176:179],a[64:67],a[4:7]
s_add_u32 m0, s67, 41856
mf v[176:179],a[80:83],a[20:23]
buffer_load_dwordx4 v31, s[48:51], s71 offen offset:128 sc1 lds
s_waitcnt vmcnt(17) lgkmcnt(0)
s_barrier
mf v[208:211],a[96:99],a[40:43]
v_readlane_b32 s70, v25, 7
v_readlane_b32 s71, v26, 7
mf v[208:211],a[112:115],a[56:59]
dq a[0:3],v32,0
mf v[212:215],a[100:103],a[40:43]
s_add_u32 m0, s65, 49152
dq a[4:7],v32,1024
mf v[212:215],a[116:119],a[56:59]
dq a[8:11],v33,0
buffer_load_dwordx4 v29, s[28:31], s69 offen offset:0 sc1 lds
mf v[216:219],a[104:107],a[40:43]
dq a[12:15],v33,1024
mf v[216:219],a[120:123],a[56:59]
dt a[64:65],v34,0
mf v[220:223],a[108:111],a[40:43]
dt a[66:67],v34,2048
mf v[220:223],a[124:127],a[56:59]
dt a[68:69],v35,0
buffer_load_dwordx4 v29, s[28:31], s69 offen offset:1024 sc1 lds
mf v[236:239],a[108:111],a[44:47]
dt a[70:71],v35,2048
mf v[236:239],a[124:127],a[60:63]
dt a[72:73],v36,0
mf v[232:235],a[104:107],a[44:47]
dt a[74:75],v36,2048
mf v[232:235],a[120:123],a[60:63]
dt a[76:77],v37,0
buffer_load_dwordx4 v29, s[28:31], s69 offen offset:2048 sc1 lds
mf v[228:231],a[100:103],a[44:47]
dt a[78:79],v37,2048
mf v[228:231],a[116:119],a[60:63]
dq a[16:19],v32,8192
mf v[224:227],a[96:99],a[44:47]
dq a[20:23],v32,9216
mf v[224:227],a[112:115],a[60:63]
dq a[24:27],v33,8192
buffer_load_dwordx4 v29, s[28:31], s69 offen offset:3072 sc1 lds
mf v[160:163],a[96:99],a[32:35]
dq a[28:31],v33,9216
mf v[160:163],a[112:115],a[48:51]
dt a[80:81],v34,4096
mf v[164:167],a[100:103],a[32:35]
s_add_u32 m0, s67, 49152
dt a[82:83],v34,6144
mf v[164:167],a[116:119],a[48:51]
dt a[84:85],v35,4096
buffer_load_dwordx4 v31, s[48:51], s70 offen offset:0 sc1 lds
mf v[168:171],a[104:107],a[32:35]
dt a[86:87],v35,6144
mf v[168:171],a[120:123],a[48:51]
dt a[88:89],v36,4096
mf v[172:175],a[108:111],a[32:35]
s_add_u32 m0, s67, 57216
dt a[90:91],v36,6144
mf v[172:175],a[124:127],a[48:51]
dt a[92:93],v37,4096
buffer_load_dwordx4 v31, s[48:51], s70 offen offset:128 sc1 lds
mf v[188:191],a[108:111],a[36:39]
dt a[94:95],v37,6144
mf v[188:191],a[124:127],a[52:55]
mf v[184:187],a[104:107],a[36:39]
s_add_u32 m0, s67, 50176
v_readlane_b32 s69, v24, 8
mf v[184:187],a[120:123],a[52:55]
buffer_load_dwordx4 v31, s[48:51], s71 offen offset:0 sc1 lds
mf v[180:183],a[100:103],a[36:39]
mf v[180:183],a[116:119],a[52:55]
mf v[176:179],a[96:99],a[36:39]
s_add_u32 m0, s67, 58240
mf v[176:179],a[112:115],a[52:55]
buffer_load_dwordx4 v31, s[48:51], s71 offen offset:128 sc1 lds
s_waitcnt vmcnt(16) lgkmcnt(0)
s_barrier
mf v[208:211],a[64:67],a[8:11]
v_readlane_b32 s70, v25, 8
v_readlane_b32 s71, v26, 8
mf v[208:211],a[80:83],a[24:27]
dq a[32:35],v32,16384
L_stub21:
s_cbranch_execz L_stub25
mf v[212:215],a[68:71],a[8:11]
s_add_u32 m0, s65, 0
dq a[36:39],v32,17408
mf v[212:215],a[84:87],a[24:27]
dq a[40:43],v33,16384
buffer_load_dwordx4 v29, s[28:31], s69 offen offset:0 sc1 lds
mf v[216:219],a[72:75],a[8:11]
dq a[44:47],v33,17408
mf v[216:219],a[88:91],a[24:27]
dt a[96:97],v34,16384
mf v[220:223],a[76:79],a[8:11]
dt a[98:99],v34,18432
mf v[220:223],a[92:95],a[24:27]
dt a[100:101],v35,16384
buffer_load_dwordx4 v29, s[28:31], s69 offen offset:1024 sc1 lds
mf v[236:239],a[76:79],a[12:15]
dt a[102:103],v35,18432
mf v[236:239],a[92:95],a[28:31]
dt a[104:105],v36,16384
mf v[232:235],a[72:75],a[12:15]
dt a[106:107],v36,18432
mf v[232:235],a[88:91],a[28:31]
dt a[108:109],v37,16384
buffer_load_dwordx4 v29, s[28:31], s69 offen offset:2048 sc1 lds
mf v[228:231],a[68:71],a[12:15]
dt a[110:111],v37,18432
mf v[228:231],a[84:87],a[28:31]
dq a[48:51],v32,24576
mf v[224:227],a[64:67],a[12:15]
dq a[52:55],v32,25600
mf v[224:227],a[80:83],a[28:31]
dq a[56:59],v33,24576
buffer_load_dwordx4 v29, s[28:31], s69 offen offset:3072 sc1 lds
mf v[160:163],a[64:67],a[0:3]
dq a[60:63],v33,25600
mf v[160:163],a[80:83],a[16:19]
dt a[112:113],v34,20480
mf v[164:167],a[68:71],a[0:3]
s_add_u32 m0, s67, 0
dt a[114:115],v34,22528
mf v[164:167],a[84:87],a[16:19]
dt a[116:117],v35,20480
buffer_load_dwordx4 v31, s[48:51], s70 offen offset:0 sc1 lds
mf v[168:171],a[72:75],a[0:3]
dt a[118:119],v35,22528
mf v[168:171],a[88:91],a[16:19]
dt a[120:121],v36,20480
mf v[172:175],a[76:79],a[0:3]
s_add_u32 m0, s67, 8064
dt a[122:123],v36,22528
mf v[172:175],a[92:95],a[16:19]
dt a[124:125],v37,20480
buffer_load_dwordx4 v31, s[48:51], s70 offen offset:128 sc1 lds
mf v[188:191],a[76:79],a[4:7]
dt a[126:127],v37,22528
mf v[188:191],a[92:95],a[20:23]
mf v[184:187],a[72:75],a[4:7]
s_add_u32 m0, s67, 1024
v_readlane_b32 s69, v24, 9
mf v[184:187],a[88:91],a[20:23]
buffer_load_dwordx4 v31, s[48:51], s71 offen offset:0 sc1 lds
mf v[180:183],a[68:71],a[4:7]
mf v[180:183],a[84:87],a[20:23]
mf v[176:179],a[64:67],a[4:7]
s_add_u32 m0, s67, 9088
mf v[176:179],a[80:83],a[20:23]
buffer_load_dwordx4 v31, s[48:51], s71 offen offset:128 sc1 lds
s_waitcnt vmcnt(16) lgkmcnt(0)
s_barrier
s_cmp_eq_u32 s26, 1
s_cbranch_scc1 L_kvload
L_kvload_ret:
mf v[208:211],a[96:99],a[40:43]
v_readlane_b32 s70, v25, 9
v_readlane_b32 s71, v26, 9
mf v[208:211],a[112:115],a[56:59]
dq a[0:3],v32,32768
mf v[212:215],a[100:103],a[40:43]
s_add_u32 m0, s65, 16384
dq a[4:7],v32,33792
mf v[212:215],a[116:119],a[56:59]
dq a[8:11],v33,32768
buffer_load_dwordx4 v29, s[28:31], s69 offen offset:0 sc1 lds
mf v[216:219],a[104:107],a[40:43]
dq a[12:15],v33,33792
mf v[216:219],a[120:123],a[56:59]
dt a[64:65],v34,32768
mf v[220:223],a[108:111],a[40:43]
dt a[66:67],v34,34816
mf v[220:223],a[124:127],a[56:59]
dt a[68:69],v35,32768
buffer_load_dwordx4 v29, s[28:31], s69 offen offset:1024 sc1 lds
mf v[236:239],a[108:111],a[44:47]
dt a[70:71],v35,34816
mf v[236:239],a[124:127],a[60:63]
dt a[72:73],v36,32768
mf v[232:235],a[104:107],a[44:47]
dt a[74:75],v36,34816
mf v[232:235],a[120:123],a[60:63]
dt a[76:77],v37,32768
buffer_load_dwordx4 v29, s[28:31], s69 offen offset:2048 sc1 lds
mf v[228:231],a[100:103],a[44:47]
dt a[78:79],v37,34816
mf v[228:231],a[116:119],a[60:63]
dq a[16:19],v32,40960
mf v[224:227],a[96:99],a[44:47]
dq a[20:23],v32,41984
mf v[224:227],a[112:115],a[60:63]
dq a[24:27],v33,40960
buffer_load_dwordx4 v29, s[28:31], s69 offen offset:3072 sc1 lds
mf v[160:163],a[96:99],a[32:35]
dq a[28:31],v33,41984
mf v[160:163],a[112:115],a[48:51]
dt a[80:81],v34,36864
mf v[164:167],a[100:103],a[32:35]
s_add_u32 m0, s67, 16384
dt a[82:83],v34,38912
mf v[164:167],a[116:119],a[48:51]
dt a[84:85],v35,36864
buffer_load_dwordx4 v31, s[48:51], s70 offen offset:0 sc1 lds
mf v[168:171],a[104:107],a[32:35]
dt a[86:87],v35,38912
mf v[168:171],a[120:123],a[48:51]
dt a[88:89],v36,36864
mf v[172:175],a[108:111],a[32:35]
s_add_u32 m0, s67, 24448
dt a[90:91],v36,38912
mf v[172:175],a[124:127],a[48:51]
dt a[92:93],v37,36864
buffer_load_dwordx4 v31, s[48:51], s70 offen offset:128 sc1 lds
mf v[188:191],a[108:111],a[36:39]
dt a[94:95],v37,38912
mf v[188:191],a[124:127],a[52:55]
mf v[184:187],a[104:107],a[36:39]
s_add_u32 m0, s67, 17408
v_readlane_b32 s69, v24, 10
mf v[184:187],a[120:123],a[52:55]
buffer_load_dwordx4 v31, s[48:51], s71 offen offset:0 sc1 lds
mf v[180:183],a[100:103],a[36:39]
mf v[180:183],a[116:119],a[52:55]
mf v[176:179],a[96:99],a[36:39]
s_add_u32 m0, s67, 25472
mf v[176:179],a[112:115],a[52:55]
buffer_load_dwordx4 v31, s[48:51], s71 offen offset:128 sc1 lds
s_waitcnt vmcnt(16) lgkmcnt(0)
s_barrier
mf v[208:211],a[64:67],a[8:11]
v_readlane_b32 s70, v25, 10
v_readlane_b32 s71, v26, 10
mf v[208:211],a[80:83],a[24:27]
dq a[32:35],v32,49152
mf v[212:215],a[68:71],a[8:11]
s_add_u32 m0, s65, 32768
dq a[36:39],v32,50176
mf v[212:215],a[84:87],a[24:27]
dq a[40:43],v33,49152
buffer_load_dwordx4 v29, s[28:31], s69 offen offset:0 sc1 lds
mf v[216:219],a[72:75],a[8:11]
dq a[44:47],v33,50176
mf v[216:219],a[88:91],a[24:27]
dt a[96:97],v34,49152
mf v[220:223],a[76:79],a[8:11]
dt a[98:99],v34,51200
mf v[220:223],a[92:95],a[24:27]
dt a[100:101],v35,49152
buffer_load_dwordx4 v29, s[28:31], s69 offen offset:1024 sc1 lds
mf v[236:239],a[76:79],a[12:15]
dt a[102:103],v35,51200
mf v[236:239],a[92:95],a[28:31]
dt a[104:105],v36,49152
mf v[232:235],a[72:75],a[12:15]
dt a[106:107],v36,51200
mf v[232:235],a[88:91],a[28:31]
dt a[108:109],v37,49152
buffer_load_dwordx4 v29, s[28:31], s69 offen offset:2048 sc1 lds
mf v[228:231],a[68:71],a[12:15]
dt a[110:111],v37,51200
mf v[228:231],a[84:87],a[28:31]
dq a[48:51],v32,57344
mf v[224:227],a[64:67],a[12:15]
dq a[52:55],v32,58368
mf v[224:227],a[80:83],a[28:31]
dq a[56:59],v33,57344
buffer_load_dwordx4 v29, s[28:31], s69 offen offset:3072 sc1 lds
mf v[160:163],a[64:67],a[0:3]
dq a[60:63],v33,58368
mf v[160:163],a[80:83],a[16:19]
dt a[112:113],v34,53248
mf v[164:167],a[68:71],a[0:3]
s_add_u32 m0, s67, 32768
dt a[114:115],v34,55296
mf v[164:167],a[84:87],a[16:19]
dt a[116:117],v35,53248
buffer_load_dwordx4 v31, s[48:51], s70 offen offset:0 sc1 lds
mf v[168:171],a[72:75],a[0:3]
dt a[118:119],v35,55296
mf v[168:171],a[88:91],a[16:19]
dt a[120:121],v36,53248
mf v[172:175],a[76:79],a[0:3]
s_add_u32 m0, s67, 40832
dt a[122:123],v36,55296
mf v[172:175],a[92:95],a[16:19]
dt a[124:125],v37,53248
buffer_load_dwordx4 v31, s[48:51], s70 offen offset:128 sc1 lds
mf v[188:191],a[76:79],a[4:7]
dt a[126:127],v37,55296
mf v[188:191],a[92:95],a[20:23]
mf v[184:187],a[72:75],a[4:7]
s_add_u32 m0, s67, 33792
v_readlane_b32 s69, v24, 11
mf v[184:187],a[88:91],a[20:23]
buffer_load_dwordx4 v31, s[48:51], s71 offen offset:0 sc1 lds
mf v[180:183],a[68:71],a[4:7]
mf v[180:183],a[84:87],a[20:23]
mf v[176:179],a[64:67],a[4:7]
s_add_u32 m0, s67, 41856
mf v[176:179],a[80:83],a[20:23]
buffer_load_dwordx4 v31, s[48:51], s71 offen offset:128 sc1 lds
s_waitcnt vmcnt(16) lgkmcnt(0)
s_barrier
mf v[208:211],a[96:99],a[40:43]
v_readlane_b32 s70, v25, 11
v_readlane_b32 s71, v26, 11
mf v[208:211],a[112:115],a[56:59]
dq a[0:3],v32,0
mf v[212:215],a[100:103],a[40:43]
s_add_u32 m0, s65, 49152
dq a[4:7],v32,1024
mf v[212:215],a[116:119],a[56:59]
dq a[8:11],v33,0
buffer_load_dwordx4 v29, s[28:31], s69 offen offset:0 sc1 lds
mf v[216:219],a[104:107],a[40:43]
dq a[12:15],v33,1024
mf v[216:219],a[120:123],a[56:59]
dt a[64:65],v34,0
mf v[220:223],a[108:111],a[40:43]
dt a[66:67],v34,2048
mf v[220:223],a[124:127],a[56:59]
dt a[68:69],v35,0
buffer_load_dwordx4 v29, s[28:31], s69 offen offset:1024 sc1 lds
mf v[236:239],a[108:111],a[44:47]
dt a[70:71],v35,2048
mf v[236:239],a[124:127],a[60:63]
dt a[72:73],v36,0
mf v[232:235],a[104:107],a[44:47]
dt a[74:75],v36,2048
mf v[232:235],a[120:123],a[60:63]
dt a[76:77],v37,0
buffer_load_dwordx4 v29, s[28:31], s69 offen offset:2048 sc1 lds
mf v[228:231],a[100:103],a[44:47]
dt a[78:79],v37,2048
mf v[228:231],a[116:119],a[60:63]
dq a[16:19],v32,8192
mf v[224:227],a[96:99],a[44:47]
dq a[20:23],v32,9216
mf v[224:227],a[112:115],a[60:63]
dq a[24:27],v33,8192
buffer_load_dwordx4 v29, s[28:31], s69 offen offset:3072 sc1 lds
mf v[160:163],a[96:99],a[32:35]
dq a[28:31],v33,9216
mf v[160:163],a[112:115],a[48:51]
dt a[80:81],v34,4096
mf v[164:167],a[100:103],a[32:35]
s_add_u32 m0, s67, 49152
dt a[82:83],v34,6144
mf v[164:167],a[116:119],a[48:51]
dt a[84:85],v35,4096
buffer_load_dwordx4 v31, s[48:51], s70 offen offset:0 sc1 lds
mf v[168:171],a[104:107],a[32:35]
dt a[86:87],v35,6144
mf v[168:171],a[120:123],a[48:51]
dt a[88:89],v36,4096
mf v[172:175],a[108:111],a[32:35]
s_add_u32 m0, s67, 57216
dt a[90:91],v36,6144
mf v[172:175],a[124:127],a[48:51]
dt a[92:93],v37,4096
buffer_load_dwordx4 v31, s[48:51], s70 offen offset:128 sc1 lds
mf v[188:191],a[108:111],a[36:39]
dt a[94:95],v37,6144
mf v[188:191],a[124:127],a[52:55]
mf v[184:187],a[104:107],a[36:39]
s_add_u32 m0, s67, 50176
v_readlane_b32 s69, v24, 12
mf v[184:187],a[120:123],a[52:55]
buffer_load_dwordx4 v31, s[48:51], s71 offen offset:0 sc1 lds
mf v[180:183],a[100:103],a[36:39]
mf v[180:183],a[116:119],a[52:55]
mf v[176:179],a[96:99],a[36:39]
s_add_u32 m0, s67, 58240
mf v[176:179],a[112:115],a[52:55]
buffer_load_dwordx4 v31, s[48:51], s71 offen offset:128 sc1 lds
s_waitcnt vmcnt(16) lgkmcnt(0)
s_barrier
s_cmp_eq_u32 s26, 1
s_cbranch_scc1 L_kvfetch
L_kvfetch_ret:
mf v[208:211],a[64:67],a[8:11]
v_readlane_b32 s70, v25, 12
v_readlane_b32 s71, v26, 12
mf v[208:211],a[80:83],a[24:27]
dq a[32:35],v32,16384
mf v[212:215],a[68:71],a[8:11]
s_add_u32 m0, s65, 0
dq a[36:39],v32,17408
mf v[212:215],a[84:87],a[24:27]
dq a[40:43],v33,16384
buffer_load_dwordx4 v29, s[28:31], s69 offen offset:0 sc1 lds
mf v[216:219],a[72:75],a[8:11]
dq a[44:47],v33,17408
mf v[216:219],a[88:91],a[24:27]
dt a[96:97],v34,16384
mf v[220:223],a[76:79],a[8:11]
dt a[98:99],v34,18432
mf v[220:223],a[92:95],a[24:27]
dt a[100:101],v35,16384
buffer_load_dwordx4 v29, s[28:31], s69 offen offset:1024 sc1 lds
mf v[236:239],a[76:79],a[12:15]
dt a[102:103],v35,18432
mf v[236:239],a[92:95],a[28:31]
dt a[104:105],v36,16384
mf v[232:235],a[72:75],a[12:15]
dt a[106:107],v36,18432
mf v[232:235],a[88:91],a[28:31]
dt a[108:109],v37,16384
buffer_load_dwordx4 v29, s[28:31], s69 offen offset:2048 sc1 lds
mf v[228:231],a[68:71],a[12:15]
dt a[110:111],v37,18432
mf v[228:231],a[84:87],a[28:31]
dq a[48:51],v32,24576
mf v[224:227],a[64:67],a[12:15]
dq a[52:55],v32,25600
mf v[224:227],a[80:83],a[28:31]
dq a[56:59],v33,24576
buffer_load_dwordx4 v29, s[28:31], s69 offen offset:3072 sc1 lds
mf v[160:163],a[64:67],a[0:3]
dq a[60:63],v33,25600
mf v[160:163],a[80:83],a[16:19]
dt a[112:113],v34,20480
mf v[164:167],a[68:71],a[0:3]
s_add_u32 m0, s67, 0
dt a[114:115],v34,22528
mf v[164:167],a[84:87],a[16:19]
dt a[116:117],v35,20480
buffer_load_dwordx4 v31, s[48:51], s70 offen offset:0 sc1 lds
mf v[168:171],a[72:75],a[0:3]
dt a[118:119],v35,22528
mf v[168:171],a[88:91],a[16:19]
dt a[120:121],v36,20480
mf v[172:175],a[76:79],a[0:3]
s_add_u32 m0, s67, 8064
dt a[122:123],v36,22528
mf v[172:175],a[92:95],a[16:19]
dt a[124:125],v37,20480
buffer_load_dwordx4 v31, s[48:51], s70 offen offset:128 sc1 lds
mf v[188:191],a[76:79],a[4:7]
dt a[126:127],v37,22528
mf v[188:191],a[92:95],a[20:23]
mf v[184:187],a[72:75],a[4:7]
s_add_u32 m0, s67, 1024
v_readlane_b32 s69, v24, 13
mf v[184:187],a[88:91],a[20:23]
buffer_load_dwordx4 v31, s[48:51], s71 offen offset:0 sc1 lds
mf v[180:183],a[68:71],a[4:7]
mf v[180:183],a[84:87],a[20:23]
mf v[176:179],a[64:67],a[4:7]
s_add_u32 m0, s67, 9088
mf v[176:179],a[80:83],a[20:23]
buffer_load_dwordx4 v31, s[48:51], s71 offen offset:128 sc1 lds
s_waitcnt vmcnt(16) lgkmcnt(0)
s_barrier
mf v[208:211],a[96:99],a[40:43]
v_readlane_b32 s70, v25, 13
v_readlane_b32 s71, v26, 13
mf v[208:211],a[112:115],a[56:59]
dq a[0:3],v32,32768
mf v[212:215],a[100:103],a[40:43]
s_add_u32 m0, s65, 16384
dq a[4:7],v32,33792
mf v[212:215],a[116:119],a[56:59]
dq a[8:11],v33,32768
buffer_load_dwordx4 v29, s[28:31], s69 offen offset:0 sc1 lds
mf v[216:219],a[104:107],a[40:43]
dq a[12:15],v33,33792
mf v[216:219],a[120:123],a[56:59]
dt a[64:65],v34,32768
buffer_load_dword v39, v28, s[28:31], 0 offen sc1
mf v[220:223],a[108:111],a[40:43]
dt a[66:67],v34,34816
mf v[220:223],a[124:127],a[56:59]
dt a[68:69],v35,32768
buffer_load_dwordx4 v29, s[28:31], s69 offen offset:1024 sc1 lds
mf v[236:239],a[108:111],a[44:47]
dt a[70:71],v35,34816
mf v[236:239],a[124:127],a[60:63]
dt a[72:73],v36,32768
mf v[232:235],a[104:107],a[44:47]
dt a[74:75],v36,34816
mf v[232:235],a[120:123],a[60:63]
dt a[76:77],v37,32768
buffer_load_dwordx4 v29, s[28:31], s69 offen offset:2048 sc1 lds
mf v[228:231],a[100:103],a[44:47]
dt a[78:79],v37,34816
mf v[228:231],a[116:119],a[60:63]
dq a[16:19],v32,40960
mf v[224:227],a[96:99],a[44:47]
dq a[20:23],v32,41984
mf v[224:227],a[112:115],a[60:63]
dq a[24:27],v33,40960
buffer_load_dwordx4 v29, s[28:31], s69 offen offset:3072 sc1 lds
mf v[160:163],a[96:99],a[32:35]
dq a[28:31],v33,41984
mf v[160:163],a[112:115],a[48:51]
dt a[80:81],v34,36864
mf v[164:167],a[100:103],a[32:35]
s_add_u32 m0, s67, 16384
dt a[82:83],v34,38912
mf v[164:167],a[116:119],a[48:51]
dt a[84:85],v35,36864
buffer_load_dwordx4 v31, s[48:51], s70 offen offset:0 sc1 lds
mf v[168:171],a[104:107],a[32:35]
dt a[86:87],v35,38912
mf v[168:171],a[120:123],a[48:51]
dt a[88:89],v36,36864
mf v[172:175],a[108:111],a[32:35]
s_add_u32 m0, s67, 24448
dt a[90:91],v36,38912
mf v[172:175],a[124:127],a[48:51]
dt a[92:93],v37,36864
buffer_load_dwordx4 v31, s[48:51], s70 offen offset:128 sc1 lds
mf v[188:191],a[108:111],a[36:39]
dt a[94:95],v37,38912
mf v[188:191],a[124:127],a[52:55]
mf v[184:187],a[104:107],a[36:39]
s_add_u32 m0, s67, 17408
v_readlane_b32 s69, v24, 14
mf v[184:187],a[120:123],a[52:55]
buffer_load_dwordx4 v31, s[48:51], s71 offen offset:0 sc1 lds
mf v[180:183],a[100:103],a[36:39]
mf v[180:183],a[116:119],a[52:55]
mf v[176:179],a[96:99],a[36:39]
s_add_u32 m0, s67, 25472
mf v[176:179],a[112:115],a[52:55]
buffer_load_dwordx4 v31, s[48:51], s71 offen offset:128 sc1 lds
s_waitcnt vmcnt(17) lgkmcnt(0)
s_barrier
mf v[208:211],a[64:67],a[8:11]
v_readlane_b32 s70, v25, 14
v_readlane_b32 s71, v26, 14
mf v[208:211],a[80:83],a[24:27]
dq a[32:35],v32,49152
mf v[212:215],a[68:71],a[8:11]
s_add_u32 m0, s65, 32768
dq a[36:39],v32,50176
mf v[212:215],a[84:87],a[24:27]
dq a[40:43],v33,49152
buffer_load_dwordx4 v29, s[28:31], s69 offen offset:0 sc1 lds
mf v[216:219],a[72:75],a[8:11]
dq a[44:47],v33,50176
mf v[216:219],a[88:91],a[24:27]
dt a[96:97],v34,49152
mf v[220:223],a[76:79],a[8:11]
dt a[98:99],v34,51200
mf v[220:223],a[92:95],a[24:27]
dt a[100:101],v35,49152
buffer_load_dwordx4 v29, s[28:31], s69 offen offset:1024 sc1 lds
mf v[236:239],a[76:79],a[12:15]
dt a[102:103],v35,51200
mf v[236:239],a[92:95],a[28:31]
dt a[104:105],v36,49152
mf v[232:235],a[72:75],a[12:15]
dt a[106:107],v36,51200
mf v[232:235],a[88:91],a[28:31]
dt a[108:109],v37,49152
buffer_load_dwordx4 v29, s[28:31], s69 offen offset:2048 sc1 lds
mf v[228:231],a[68:71],a[12:15]
dt a[110:111],v37,51200
mf v[228:231],a[84:87],a[28:31]
dq a[48:51],v32,57344
mf v[224:227],a[64:67],a[12:15]
dq a[52:55],v32,58368
mf v[224:227],a[80:83],a[28:31]
dq a[56:59],v33,57344
buffer_load_dwordx4 v29, s[28:31], s69 offen offset:3072 sc1 lds
mf v[160:163],a[64:67],a[0:3]
dq a[60:63],v33,58368
mf v[160:163],a[80:83],a[16:19]
dt a[112:113],v34,53248
mf v[164:167],a[68:71],a[0:3]
s_add_u32 m0, s67, 32768
dt a[114:115],v34,55296
mf v[164:167],a[84:87],a[16:19]
dt a[116:117],v35,53248
buffer_load_dwordx4 v31, s[48:51], s70 offen offset:0 sc1 lds
mf v[168:171],a[72:75],a[0:3]
dt a[118:119],v35,55296
mf v[168:171],a[88:91],a[16:19]
dt a[120:121],v36,53248
mf v[172:175],a[76:79],a[0:3]
s_add_u32 m0, s67, 40832
dt a[122:123],v36,55296
mf v[172:175],a[92:95],a[16:19]
dt a[124:125],v37,53248
buffer_load_dwordx4 v31, s[48:51], s70 offen offset:128 sc1 lds
mf v[188:191],a[76:79],a[4:7]
dt a[126:127],v37,55296
mf v[188:191],a[92:95],a[20:23]
mf v[184:187],a[72:75],a[4:7]
s_add_u32 m0, s67, 33792
v_readlane_b32 s69, v24, 15
mf v[184:187],a[88:91],a[20:23]
buffer_load_dwordx4 v31, s[48:51], s71 offen offset:0 sc1 lds
mf v[180:183],a[68:71],a[4:7]
mf v[180:183],a[84:87],a[20:23]
mf v[176:179],a[64:67],a[4:7]
s_add_u32 m0, s67, 41856
mf v[176:179],a[80:83],a[20:23]
buffer_load_dwordx4 v31, s[48:51], s71 offen offset:128 sc1 lds
s_waitcnt vmcnt(17) lgkmcnt(0)
s_barrier
s_cmp_eq_u32 s26, 1
s_cbranch_scc1 L_ocomp
L_ocomp_ret:
mf v[208:211],a[96:99],a[40:43]
v_readlane_b32 s70, v25, 15
v_readlane_b32 s71, v26, 15
mf v[208:211],a[112:115],a[56:59]
L_stub22:
s_cbranch_execz L_stub26
dq a[0:3],v32,0
mf v[212:215],a[100:103],a[40:43]
s_add_u32 m0, s65, 49152
dq a[4:7],v32,1024
mf v[212:215],a[116:119],a[56:59]
dq a[8:11],v33,0
buffer_load_dwordx4 v29, s[28:31], s69 offen offset:0 sc1 lds
mf v[216:219],a[104:107],a[40:43]
dq a[12:15],v33,1024
mf v[216:219],a[120:123],a[56:59]
dt a[64:65],v34,0
mf v[220:223],a[108:111],a[40:43]
dt a[66:67],v34,2048
mf v[220:223],a[124:127],a[56:59]
dt a[68:69],v35,0
buffer_load_dwordx4 v29, s[28:31], s69 offen offset:1024 sc1 lds
mf v[236:239],a[108:111],a[44:47]
dt a[70:71],v35,2048
mf v[236:239],a[124:127],a[60:63]
dt a[72:73],v36,0
mf v[232:235],a[104:107],a[44:47]
dt a[74:75],v36,2048
mf v[232:235],a[120:123],a[60:63]
dt a[76:77],v37,0
buffer_load_dwordx4 v29, s[28:31], s69 offen offset:2048 sc1 lds
mf v[228:231],a[100:103],a[44:47]
dt a[78:79],v37,2048
mf v[228:231],a[116:119],a[60:63]
dq a[16:19],v32,8192
mf v[224:227],a[96:99],a[44:47]
dq a[20:23],v32,9216
mf v[224:227],a[112:115],a[60:63]
dq a[24:27],v33,8192
buffer_load_dwordx4 v29, s[28:31], s69 offen offset:3072 sc1 lds
mf v[160:163],a[96:99],a[32:35]
dq a[28:31],v33,9216
mf v[160:163],a[112:115],a[48:51]
dt a[80:81],v34,4096
mf v[164:167],a[100:103],a[32:35]
s_add_u32 m0, s67, 49152
dt a[82:83],v34,6144
mf v[164:167],a[116:119],a[48:51]
dt a[84:85],v35,4096
buffer_load_dwordx4 v31, s[48:51], s70 offen offset:0 sc1 lds
mf v[168:171],a[104:107],a[32:35]
dt a[86:87],v35,6144
mf v[168:171],a[120:123],a[48:51]
dt a[88:89],v36,4096
mf v[172:175],a[108:111],a[32:35]
s_add_u32 m0, s67, 57216
dt a[90:91],v36,6144
mf v[172:175],a[124:127],a[48:51]
dt a[92:93],v37,4096
buffer_load_dwordx4 v31, s[48:51], s70 offen offset:128 sc1 lds
mf v[188:191],a[108:111],a[36:39]
dt a[94:95],v37,6144
mf v[188:191],a[124:127],a[52:55]
mf v[184:187],a[104:107],a[36:39]
s_add_u32 m0, s67, 50176
v_readlane_b32 s69, v24, 16
mf v[184:187],a[120:123],a[52:55]
buffer_load_dwordx4 v31, s[48:51], s71 offen offset:0 sc1 lds
mf v[180:183],a[100:103],a[36:39]
mf v[180:183],a[116:119],a[52:55]
mf v[176:179],a[96:99],a[36:39]
s_add_u32 m0, s67, 58240
mf v[176:179],a[112:115],a[52:55]
buffer_load_dwordx4 v31, s[48:51], s71 offen offset:128 sc1 lds
s_waitcnt vmcnt(16) lgkmcnt(0)
v_sub_u32 v39, v39, v5
v_subrev_u32 v39, 2, v39
v_cmp_lt_u32 vcc, 1, v39
s_nop 0
s_cbranch_vccnz L_b_slow
L_b_back:
s_barrier
mf v[208:211],a[64:67],a[8:11]
v_readlane_b32 s70, v25, 16
v_readlane_b32 s71, v26, 16
mf v[208:211],a[80:83],a[24:27]
dq a[32:35],v32,16384
mf v[212:215],a[68:71],a[8:11]
s_add_u32 m0, s65, 0
dq a[36:39],v32,17408
mf v[212:215],a[84:87],a[24:27]
dq a[40:43],v33,16384
buffer_load_dwordx4 v29, s[28:31], s69 offen offset:0 sc1 lds
mf v[216:219],a[72:75],a[8:11]
dq a[44:47],v33,17408
mf v[216:219],a[88:91],a[24:27]
dt a[96:97],v34,16384
mf v[220:223],a[76:79],a[8:11]
dt a[98:99],v34,18432
mf v[220:223],a[92:95],a[24:27]
dt a[100:101],v35,16384
buffer_load_dwordx4 v29, s[28:31], s69 offen offset:1024 sc1 lds
mf v[236:239],a[76:79],a[12:15]
dt a[102:103],v35,18432
mf v[236:239],a[92:95],a[28:31]
dt a[104:105],v36,16384
mf v[232:235],a[72:75],a[12:15]
dt a[106:107],v36,18432
mf v[232:235],a[88:91],a[28:31]
dt a[108:109],v37,16384
buffer_load_dwordx4 v29, s[28:31], s69 offen offset:2048 sc1 lds
mf v[228:231],a[68:71],a[12:15]
dt a[110:111],v37,18432
mf v[228:231],a[84:87],a[28:31]
dq a[48:51],v32,24576
mf v[224:227],a[64:67],a[12:15]
dq a[52:55],v32,25600
mf v[224:227],a[80:83],a[28:31]
dq a[56:59],v33,24576
buffer_load_dwordx4 v29, s[28:31], s69 offen offset:3072 sc1 lds
mf v[160:163],a[64:67],a[0:3]
dq a[60:63],v33,25600
mf v[160:163],a[80:83],a[16:19]
dt a[112:113],v34,20480
mf v[164:167],a[68:71],a[0:3]
s_add_u32 m0, s67, 0
dt a[114:115],v34,22528
mf v[164:167],a[84:87],a[16:19]
dt a[116:117],v35,20480
buffer_load_dwordx4 v31, s[48:51], s70 offen offset:0 sc1 lds
mf v[168:171],a[72:75],a[0:3]
dt a[118:119],v35,22528
mf v[168:171],a[88:91],a[16:19]
dt a[120:121],v36,20480
mf v[172:175],a[76:79],a[0:3]
s_add_u32 m0, s67, 8064
dt a[122:123],v36,22528
mf v[172:175],a[92:95],a[16:19]
dt a[124:125],v37,20480
buffer_load_dwordx4 v31, s[48:51], s70 offen offset:128 sc1 lds
mf v[188:191],a[76:79],a[4:7]
dt a[126:127],v37,22528
mf v[188:191],a[92:95],a[20:23]
mf v[184:187],a[72:75],a[4:7]
s_add_u32 m0, s67, 1024
v_readlane_b32 s69, v24, 17
mf v[184:187],a[88:91],a[20:23]
buffer_load_dwordx4 v31, s[48:51], s71 offen offset:0 sc1 lds
mf v[180:183],a[68:71],a[4:7]
mf v[180:183],a[84:87],a[20:23]
mf v[176:179],a[64:67],a[4:7]
s_add_u32 m0, s67, 9088
mf v[176:179],a[80:83],a[20:23]
buffer_load_dwordx4 v31, s[48:51], s71 offen offset:128 sc1 lds
s_waitcnt vmcnt(16) lgkmcnt(0)
s_barrier
mf v[208:211],a[96:99],a[40:43]
v_readlane_b32 s70, v25, 17
v_readlane_b32 s71, v26, 17
mf v[208:211],a[112:115],a[56:59]
dq a[0:3],v32,32768
mf v[212:215],a[100:103],a[40:43]
s_add_u32 m0, s65, 16384
dq a[4:7],v32,33792
mf v[212:215],a[116:119],a[56:59]
dq a[8:11],v33,32768
buffer_load_dwordx4 v29, s[28:31], s69 offen offset:0 sc1 lds
mf v[216:219],a[104:107],a[40:43]
dq a[12:15],v33,33792
mf v[216:219],a[120:123],a[56:59]
dt a[64:65],v34,32768
mf v[220:223],a[108:111],a[40:43]
dt a[66:67],v34,34816
mf v[220:223],a[124:127],a[56:59]
dt a[68:69],v35,32768
buffer_load_dwordx4 v29, s[28:31], s69 offen offset:1024 sc1 lds
mf v[236:239],a[108:111],a[44:47]
dt a[70:71],v35,34816
mf v[236:239],a[124:127],a[60:63]
dt a[72:73],v36,32768
mf v[232:235],a[104:107],a[44:47]
dt a[74:75],v36,34816
mf v[232:235],a[120:123],a[60:63]
dt a[76:77],v37,32768
buffer_load_dwordx4 v29, s[28:31], s69 offen offset:2048 sc1 lds
mf v[228:231],a[100:103],a[44:47]
dt a[78:79],v37,34816
mf v[228:231],a[116:119],a[60:63]
dq a[16:19],v32,40960
mf v[224:227],a[96:99],a[44:47]
dq a[20:23],v32,41984
mf v[224:227],a[112:115],a[60:63]
dq a[24:27],v33,40960
buffer_load_dwordx4 v29, s[28:31], s69 offen offset:3072 sc1 lds
mf v[160:163],a[96:99],a[32:35]
dq a[28:31],v33,41984
mf v[160:163],a[112:115],a[48:51]
dt a[80:81],v34,36864
mf v[164:167],a[100:103],a[32:35]
s_add_u32 m0, s67, 16384
dt a[82:83],v34,38912
mf v[164:167],a[116:119],a[48:51]
dt a[84:85],v35,36864
buffer_load_dwordx4 v31, s[48:51], s70 offen offset:0 sc1 lds
mf v[168:171],a[104:107],a[32:35]
dt a[86:87],v35,38912
mf v[168:171],a[120:123],a[48:51]
dt a[88:89],v36,36864
mf v[172:175],a[108:111],a[32:35]
s_add_u32 m0, s67, 24448
dt a[90:91],v36,38912
mf v[172:175],a[124:127],a[48:51]
dt a[92:93],v37,36864
buffer_load_dwordx4 v31, s[48:51], s70 offen offset:128 sc1 lds
mf v[188:191],a[108:111],a[36:39]
dt a[94:95],v37,38912
mf v[188:191],a[124:127],a[52:55]
mf v[184:187],a[104:107],a[36:39]
s_add_u32 m0, s67, 17408
v_readlane_b32 s69, v24, 18
mf v[184:187],a[120:123],a[52:55]
buffer_load_dwordx4 v31, s[48:51], s71 offen offset:0 sc1 lds
mf v[180:183],a[100:103],a[36:39]
mf v[180:183],a[116:119],a[52:55]
mf v[176:179],a[96:99],a[36:39]
s_add_u32 m0, s67, 25472
mf v[176:179],a[112:115],a[52:55]
buffer_load_dwordx4 v31, s[48:51], s71 offen offset:128 sc1 lds
s_waitcnt vmcnt(16) lgkmcnt(0)
s_barrier
mf v[208:211],a[64:67],a[8:11]
v_readlane_b32 s70, v25, 18
v_readlane_b32 s71, v26, 18
mf v[208:211],a[80:83],a[24:27]
dq a[32:35],v32,49152
mf v[212:215],a[68:71],a[8:11]
s_add_u32 m0, s65, 32768
dq a[36:39],v32,50176
mf v[212:215],a[84:87],a[24:27]
dq a[40:43],v33,49152
buffer_load_dwordx4 v29, s[28:31], s69 offen offset:0 sc1 lds
mf v[216:219],a[72:75],a[8:11]
dq a[44:47],v33,50176
mf v[216:219],a[88:91],a[24:27]
dt a[96:97],v34,49152
mf v[220:223],a[76:79],a[8:11]
dt a[98:99],v34,51200
mf v[220:223],a[92:95],a[24:27]
dt a[100:101],v35,49152
buffer_load_dwordx4 v29, s[28:31], s69 offen offset:1024 sc1 lds
mf v[236:239],a[76:79],a[12:15]
dt a[102:103],v35,51200
mf v[236:239],a[92:95],a[28:31]
dt a[104:105],v36,49152
mf v[232:235],a[72:75],a[12:15]
dt a[106:107],v36,51200
mf v[232:235],a[88:91],a[28:31]
dt a[108:109],v37,49152
buffer_load_dwordx4 v29, s[28:31], s69 offen offset:2048 sc1 lds
mf v[228:231],a[68:71],a[12:15]
dt a[110:111],v37,51200
mf v[228:231],a[84:87],a[28:31]
dq a[48:51],v32,57344
mf v[224:227],a[64:67],a[12:15]
dq a[52:55],v32,58368
mf v[224:227],a[80:83],a[28:31]
dq a[56:59],v33,57344
buffer_load_dwordx4 v29, s[28:31], s69 offen offset:3072 sc1 lds
mf v[160:163],a[64:67],a[0:3]
dq a[60:63],v33,58368
mf v[160:163],a[80:83],a[16:19]
dt a[112:113],v34,53248
mf v[164:167],a[68:71],a[0:3]
s_add_u32 m0, s67, 32768
dt a[114:115],v34,55296
mf v[164:167],a[84:87],a[16:19]
dt a[116:117],v35,53248
buffer_load_dwordx4 v31, s[48:51], s70 offen offset:0 sc1 lds
mf v[168:171],a[72:75],a[0:3]
dt a[118:119],v35,55296
mf v[168:171],a[88:91],a[16:19]
dt a[120:121],v36,53248
mf v[172:175],a[76:79],a[0:3]
s_add_u32 m0, s67, 40832
dt a[122:123],v36,55296
mf v[172:175],a[92:95],a[16:19]
dt a[124:125],v37,53248
buffer_load_dwordx4 v31, s[48:51], s70 offen offset:128 sc1 lds
mf v[188:191],a[76:79],a[4:7]
dt a[126:127],v37,55296
mf v[188:191],a[92:95],a[20:23]
mf v[184:187],a[72:75],a[4:7]
s_add_u32 m0, s67, 33792
v_readlane_b32 s69, v24, 19
mf v[184:187],a[88:91],a[20:23]
buffer_load_dwordx4 v31, s[48:51], s71 offen offset:0 sc1 lds
mf v[180:183],a[68:71],a[4:7]
mf v[180:183],a[84:87],a[20:23]
mf v[176:179],a[64:67],a[4:7]
s_add_u32 m0, s67, 41856
mf v[176:179],a[80:83],a[20:23]
buffer_load_dwordx4 v31, s[48:51], s71 offen offset:128 sc1 lds
s_waitcnt vmcnt(16) lgkmcnt(0)
s_barrier
s_cmp_eq_u32 s26, 1
s_cbranch_scc1 L_oflag
L_oflag_ret:
mf v[208:211],a[96:99],a[40:43]
v_readlane_b32 s70, v25, 19
v_readlane_b32 s71, v26, 19
mf v[208:211],a[112:115],a[56:59]
dq a[0:3],v32,0
mf v[212:215],a[100:103],a[40:43]
s_add_u32 m0, s65, 49152
dq a[4:7],v32,1024
mf v[212:215],a[116:119],a[56:59]
dq a[8:11],v33,0
buffer_load_dwordx4 v29, s[28:31], s69 offen offset:0 sc1 lds
mf v[216:219],a[104:107],a[40:43]
dq a[12:15],v33,1024
mf v[216:219],a[120:123],a[56:59]
dt a[64:65],v34,0
mf v[220:223],a[108:111],a[40:43]
dt a[66:67],v34,2048
mf v[220:223],a[124:127],a[56:59]
dt a[68:69],v35,0
buffer_load_dwordx4 v29, s[28:31], s69 offen offset:1024 sc1 lds
mf v[236:239],a[108:111],a[44:47]
dt a[70:71],v35,2048
mf v[236:239],a[124:127],a[60:63]
dt a[72:73],v36,0
mf v[232:235],a[104:107],a[44:47]
dt a[74:75],v36,2048
mf v[232:235],a[120:123],a[60:63]
dt a[76:77],v37,0
buffer_load_dwordx4 v29, s[28:31], s69 offen offset:2048 sc1 lds
mf v[228:231],a[100:103],a[44:47]
dt a[78:79],v37,2048
mf v[228:231],a[116:119],a[60:63]
dq a[16:19],v32,8192
mf v[224:227],a[96:99],a[44:47]
dq a[20:23],v32,9216
mf v[224:227],a[112:115],a[60:63]
dq a[24:27],v33,8192
buffer_load_dwordx4 v29, s[28:31], s69 offen offset:3072 sc1 lds
mf v[160:163],a[96:99],a[32:35]
dq a[28:31],v33,9216
mf v[160:163],a[112:115],a[48:51]
dt a[80:81],v34,4096
mf v[164:167],a[100:103],a[32:35]
s_add_u32 m0, s67, 49152
dt a[82:83],v34,6144
mf v[164:167],a[116:119],a[48:51]
dt a[84:85],v35,4096
buffer_load_dwordx4 v31, s[48:51], s70 offen offset:0 sc1 lds
mf v[168:171],a[104:107],a[32:35]
dt a[86:87],v35,6144
mf v[168:171],a[120:123],a[48:51]
dt a[88:89],v36,4096
mf v[172:175],a[108:111],a[32:35]
s_add_u32 m0, s67, 57216
dt a[90:91],v36,6144
mf v[172:175],a[124:127],a[48:51]
dt a[92:93],v37,4096
buffer_load_dwordx4 v31, s[48:51], s70 offen offset:128 sc1 lds
mf v[188:191],a[108:111],a[36:39]
dt a[94:95],v37,6144
mf v[188:191],a[124:127],a[52:55]
mf v[184:187],a[104:107],a[36:39]
s_add_u32 m0, s67, 50176
v_readlane_b32 s69, v24, 20
mf v[184:187],a[120:123],a[52:55]
buffer_load_dwordx4 v31, s[48:51], s71 offen offset:0 sc1 lds
mf v[180:183],a[100:103],a[36:39]
mf v[180:183],a[116:119],a[52:55]
mf v[176:179],a[96:99],a[36:39]
s_add_u32 m0, s67, 58240
mf v[176:179],a[112:115],a[52:55]
buffer_load_dwordx4 v31, s[48:51], s71 offen offset:128 sc1 lds
s_waitcnt vmcnt(16) lgkmcnt(0)
s_barrier
s_cmp_lg_u32 s15, 0
s_cbranch_scc1 L_skipF
mf v[208:211],a[64:67],a[8:11]
v_readlane_b32 s70, v25, 20
v_readlane_b32 s71, v26, 20
mf v[208:211],a[80:83],a[24:27]
dq a[32:35],v32,16384
mf v[212:215],a[68:71],a[8:11]
s_add_u32 m0, s65, 0
dq a[36:39],v32,17408
mf v[212:215],a[84:87],a[24:27]
dq a[40:43],v33,16384
buffer_load_dwordx4 v29, s[28:31], s69 offen offset:0 sc1 lds
mf v[216:219],a[72:75],a[8:11]
dq a[44:47],v33,17408
mf v[216:219],a[88:91],a[24:27]
dt a[96:97],v34,16384
mf v[220:223],a[76:79],a[8:11]
dt a[98:99],v34,18432
mf v[220:223],a[92:95],a[24:27]
dt a[100:101],v35,16384
buffer_load_dwordx4 v29, s[28:31], s69 offen offset:1024 sc1 lds
mf v[236:239],a[76:79],a[12:15]
dt a[102:103],v35,18432
mf v[236:239],a[92:95],a[28:31]
dt a[104:105],v36,16384
mf v[232:235],a[72:75],a[12:15]
dt a[106:107],v36,18432
mf v[232:235],a[88:91],a[28:31]
dt a[108:109],v37,16384
buffer_load_dwordx4 v29, s[28:31], s69 offen offset:2048 sc1 lds
mf v[228:231],a[68:71],a[12:15]
dt a[110:111],v37,18432
mf v[228:231],a[84:87],a[28:31]
dq a[48:51],v32,24576
mf v[224:227],a[64:67],a[12:15]
dq a[52:55],v32,25600
mf v[224:227],a[80:83],a[28:31]
dq a[56:59],v33,24576
buffer_load_dwordx4 v29, s[28:31], s69 offen offset:3072 sc1 lds
mf v[160:163],a[64:67],a[0:3]
dq a[60:63],v33,25600
mf v[160:163],a[80:83],a[16:19]
dt a[112:113],v34,20480
mf v[164:167],a[68:71],a[0:3]
s_add_u32 m0, s67, 0
dt a[114:115],v34,22528
mf v[164:167],a[84:87],a[16:19]
dt a[116:117],v35,20480
buffer_load_dwordx4 v31, s[48:51], s70 offen offset:0 sc1 lds
mf v[168:171],a[72:75],a[0:3]
dt a[118:119],v35,22528
mf v[168:171],a[88:91],a[16:19]
dt a[120:121],v36,20480
mf v[172:175],a[76:79],a[0:3]
s_add_u32 m0, s67, 8064
dt a[122:123],v36,22528
mf v[172:175],a[92:95],a[16:19]
dt a[124:125],v37,20480
buffer_load_dwordx4 v31, s[48:51], s70 offen offset:128 sc1 lds
mf v[188:191],a[76:79],a[4:7]
dt a[126:127],v37,22528
mf v[188:191],a[92:95],a[20:23]
mf v[184:187],a[72:75],a[4:7]
s_add_u32 m0, s67, 1024
v_readlane_b32 s69, v24, 21
mf v[184:187],a[88:91],a[20:23]
buffer_load_dwordx4 v31, s[48:51], s71 offen offset:0 sc1 lds
mf v[180:183],a[68:71],a[4:7]
mf v[180:183],a[84:87],a[20:23]
mf v[176:179],a[64:67],a[4:7]
s_add_u32 m0, s67, 9088
mf v[176:179],a[80:83],a[20:23]
buffer_load_dwordx4 v31, s[48:51], s71 offen offset:128 sc1 lds
s_waitcnt vmcnt(16) lgkmcnt(0)
s_barrier
mf v[208:211],a[96:99],a[40:43]
v_readlane_b32 s70, v25, 21
v_readlane_b32 s71, v26, 21
mf v[208:211],a[112:115],a[56:59]
dq a[0:3],v32,32768
mf v[212:215],a[100:103],a[40:43]
s_add_u32 m0, s65, 16384
dq a[4:7],v32,33792
mf v[212:215],a[116:119],a[56:59]
dq a[8:11],v33,32768
buffer_load_dwordx4 v29, s[28:31], s69 offen offset:0 sc1 lds
mf v[216:219],a[104:107],a[40:43]
dq a[12:15],v33,33792
mf v[216:219],a[120:123],a[56:59]
dt a[64:65],v34,32768
mf v[220:223],a[108:111],a[40:43]
dt a[66:67],v34,34816
mf v[220:223],a[124:127],a[56:59]
dt a[68:69],v35,32768
buffer_load_dwordx4 v29, s[28:31], s69 offen offset:1024 sc1 lds
mf v[236:239],a[108:111],a[44:47]
dt a[70:71],v35,34816
mf v[236:239],a[124:127],a[60:63]
dt a[72:73],v36,32768
mf v[232:235],a[104:107],a[44:47]
dt a[74:75],v36,34816
mf v[232:235],a[120:123],a[60:63]
dt a[76:77],v37,32768
buffer_load_dwordx4 v29, s[28:31], s69 offen offset:2048 sc1 lds
mf v[228:231],a[100:103],a[44:47]
dt a[78:79],v37,34816
mf v[228:231],a[116:119],a[60:63]
dq a[16:19],v32,40960
mf v[224:227],a[96:99],a[44:47]
dq a[20:23],v32,41984
mf v[224:227],a[112:115],a[60:63]
dq a[24:27],v33,40960
buffer_load_dwordx4 v29, s[28:31], s69 offen offset:3072 sc1 lds
mf v[160:163],a[96:99],a[32:35]
dq a[28:31],v33,41984
mf v[160:163],a[112:115],a[48:51]
dt a[80:81],v34,36864
mf v[164:167],a[100:103],a[32:35]
s_add_u32 m0, s67, 16384
dt a[82:83],v34,38912
mf v[164:167],a[116:119],a[48:51]
dt a[84:85],v35,36864
buffer_load_dwordx4 v31, s[48:51], s70 offen offset:0 sc1 lds
mf v[168:171],a[104:107],a[32:35]
dt a[86:87],v35,38912
mf v[168:171],a[120:123],a[48:51]
dt a[88:89],v36,36864
mf v[172:175],a[108:111],a[32:35]
s_add_u32 m0, s67, 24448
dt a[90:91],v36,38912
mf v[172:175],a[124:127],a[48:51]
dt a[92:93],v37,36864
buffer_load_dwordx4 v31, s[48:51], s70 offen offset:128 sc1 lds
mf v[188:191],a[108:111],a[36:39]
dt a[94:95],v37,38912
mf v[188:191],a[124:127],a[52:55]
mf v[184:187],a[104:107],a[36:39]
s_add_u32 m0, s67, 17408
v_readlane_b32 s69, v24, 22
mf v[184:187],a[120:123],a[52:55]
buffer_load_dwordx4 v31, s[48:51], s71 offen offset:0 sc1 lds
mf v[180:183],a[100:103],a[36:39]
mf v[180:183],a[116:119],a[52:55]
mf v[176:179],a[96:99],a[36:39]
s_add_u32 m0, s67, 25472
mf v[176:179],a[112:115],a[52:55]
buffer_load_dwordx4 v31, s[48:51], s71 offen offset:128 sc1 lds
s_waitcnt vmcnt(16) lgkmcnt(0)
s_barrier
mf v[208:211],a[64:67],a[8:11]
v_readlane_b32 s70, v25, 22
L_stub23:
s_cbranch_execz L_stub27
v_readlane_b32 s71, v26, 22
mf v[208:211],a[80:83],a[24:27]
dq a[32:35],v32,49152
mf v[212:215],a[68:71],a[8:11]
s_add_u32 m0, s65, 32768
dq a[36:39],v32,50176
mf v[212:215],a[84:87],a[24:27]
dq a[40:43],v33,49152
buffer_load_dwordx4 v29, s[28:31], s69 offen offset:0 sc1 lds
mf v[216:219],a[72:75],a[8:11]
dq a[44:47],v33,50176
mf v[216:219],a[88:91],a[24:27]
dt a[96:97],v34,49152
mf v[220:223],a[76:79],a[8:11]
dt a[98:99],v34,51200
mf v[220:223],a[92:95],a[24:27]
dt a[100:101],v35,49152
buffer_load_dwordx4 v29, s[28:31], s69 offen offset:1024 sc1 lds
mf v[236:239],a[76:79],a[12:15]
dt a[102:103],v35,51200
mf v[236:239],a[92:95],a[28:31]
dt a[104:105],v36,49152
mf v[232:235],a[72:75],a[12:15]
dt a[106:107],v36,51200
mf v[232:235],a[88:91],a[28:31]
dt a[108:109],v37,49152
buffer_load_dwordx4 v29, s[28:31], s69 offen offset:2048 sc1 lds
mf v[228:231],a[68:71],a[12:15]
dt a[110:111],v37,51200
mf v[228:231],a[84:87],a[28:31]
dq a[48:51],v32,57344
mf v[224:227],a[64:67],a[12:15]
dq a[52:55],v32,58368
mf v[224:227],a[80:83],a[28:31]
dq a[56:59],v33,57344
buffer_load_dwordx4 v29, s[28:31], s69 offen offset:3072 sc1 lds
mf v[160:163],a[64:67],a[0:3]
dq a[60:63],v33,58368
mf v[160:163],a[80:83],a[16:19]
dt a[112:113],v34,53248
mf v[164:167],a[68:71],a[0:3]
s_add_u32 m0, s67, 32768
dt a[114:115],v34,55296
mf v[164:167],a[84:87],a[16:19]
dt a[116:117],v35,53248
buffer_load_dwordx4 v31, s[48:51], s70 offen offset:0 sc1 lds
mf v[168:171],a[72:75],a[0:3]
dt a[118:119],v35,55296
mf v[168:171],a[88:91],a[16:19]
dt a[120:121],v36,53248
mf v[172:175],a[76:79],a[0:3]
s_add_u32 m0, s67, 40832
dt a[122:123],v36,55296
mf v[172:175],a[92:95],a[16:19]
dt a[124:125],v37,53248
buffer_load_dwordx4 v31, s[48:51], s70 offen offset:128 sc1 lds
mf v[188:191],a[76:79],a[4:7]
dt a[126:127],v37,55296
mf v[188:191],a[92:95],a[20:23]
mf v[184:187],a[72:75],a[4:7]
s_add_u32 m0, s67, 33792
v_readlane_b32 s69, v24, 23
mf v[184:187],a[88:91],a[20:23]
buffer_load_dwordx4 v31, s[48:51], s71 offen offset:0 sc1 lds
mf v[180:183],a[68:71],a[4:7]
mf v[180:183],a[84:87],a[20:23]
mf v[176:179],a[64:67],a[4:7]
s_add_u32 m0, s67, 41856
mf v[176:179],a[80:83],a[20:23]
buffer_load_dwordx4 v31, s[48:51], s71 offen offset:128 sc1 lds
s_waitcnt vmcnt(16) lgkmcnt(0)
s_barrier
mf v[208:211],a[96:99],a[40:43]
v_readlane_b32 s70, v25, 23
v_readlane_b32 s71, v26, 23
mf v[208:211],a[112:115],a[56:59]
dq a[0:3],v32,0
mf v[212:215],a[100:103],a[40:43]
s_add_u32 m0, s65, 49152
dq a[4:7],v32,1024
mf v[212:215],a[116:119],a[56:59]
dq a[8:11],v33,0
buffer_load_dwordx4 v29, s[28:31], s69 offen offset:0 sc1 lds
mf v[216:219],a[104:107],a[40:43]
dq a[12:15],v33,1024
mf v[216:219],a[120:123],a[56:59]
dt a[64:65],v34,0
mf v[220:223],a[108:111],a[40:43]
dt a[66:67],v34,2048
mf v[220:223],a[124:127],a[56:59]
dt a[68:69],v35,0
buffer_load_dwordx4 v29, s[28:31], s69 offen offset:1024 sc1 lds
mf v[236:239],a[108:111],a[44:47]
dt a[70:71],v35,2048
mf v[236:239],a[124:127],a[60:63]
dt a[72:73],v36,0
mf v[232:235],a[104:107],a[44:47]
dt a[74:75],v36,2048
mf v[232:235],a[120:123],a[60:63]
dt a[76:77],v37,0
buffer_load_dwordx4 v29, s[28:31], s69 offen offset:2048 sc1 lds
mf v[228:231],a[100:103],a[44:47]
dt a[78:79],v37,2048
mf v[228:231],a[116:119],a[60:63]
dq a[16:19],v32,8192
mf v[224:227],a[96:99],a[44:47]
dq a[20:23],v32,9216
mf v[224:227],a[112:115],a[60:63]
dq a[24:27],v33,8192
buffer_load_dwordx4 v29, s[28:31], s69 offen offset:3072 sc1 lds
mf v[160:163],a[96:99],a[32:35]
dq a[28:31],v33,9216
mf v[160:163],a[112:115],a[48:51]
dt a[80:81],v34,4096
mf v[164:167],a[100:103],a[32:35]
s_add_u32 m0, s67, 49152
dt a[82:83],v34,6144
mf v[164:167],a[116:119],a[48:51]
dt a[84:85],v35,4096
buffer_load_dwordx4 v31, s[48:51], s70 offen offset:0 sc1 lds
mf v[168:171],a[104:107],a[32:35]
dt a[86:87],v35,6144
mf v[168:171],a[120:123],a[48:51]
dt a[88:89],v36,4096
mf v[172:175],a[108:111],a[32:35]
s_add_u32 m0, s67, 57216
dt a[90:91],v36,6144
mf v[172:175],a[124:127],a[48:51]
dt a[92:93],v37,4096
buffer_load_dwordx4 v31, s[48:51], s70 offen offset:128 sc1 lds
mf v[188:191],a[108:111],a[36:39]
dt a[94:95],v37,6144
mf v[188:191],a[124:127],a[52:55]
mf v[184:187],a[104:107],a[36:39]
s_add_u32 m0, s67, 50176
v_readlane_b32 s69, v24, 24
mf v[184:187],a[120:123],a[52:55]
buffer_load_dwordx4 v31, s[48:51], s71 offen offset:0 sc1 lds
mf v[180:183],a[100:103],a[36:39]
mf v[180:183],a[116:119],a[52:55]
mf v[176:179],a[96:99],a[36:39]
s_add_u32 m0, s67, 58240
mf v[176:179],a[112:115],a[52:55]
buffer_load_dwordx4 v31, s[48:51], s71 offen offset:128 sc1 lds
s_waitcnt vmcnt(16) lgkmcnt(0)
s_barrier
L_skipF:
L_stub24:
s_cbranch_execz L_stub28
v_readlane_b32 s69, v24, 24
mf v[208:211],a[64:67],a[8:11]
v_readlane_b32 s70, v25, 24
v_readlane_b32 s71, v26, 24
mf v[208:211],a[80:83],a[24:27]
dq a[32:35],v32,16384
mf v[212:215],a[68:71],a[8:11]
s_add_u32 m0, s65, 0
dq a[36:39],v32,17408
mf v[212:215],a[84:87],a[24:27]
dq a[40:43],v33,16384
buffer_load_dwordx4 v29, s[28:31], s69 offen offset:0 sc1 lds
mf v[216:219],a[72:75],a[8:11]
dq a[44:47],v33,17408
mf v[216:219],a[88:91],a[24:27]
dt a[96:97],v34,16384
mf v[220:223],a[76:79],a[8:11]
dt a[98:99],v34,18432
mf v[220:223],a[92:95],a[24:27]
dt a[100:101],v35,16384
buffer_load_dwordx4 v29, s[28:31], s69 offen offset:1024 sc1 lds
mf v[236:239],a[76:79],a[12:15]
dt a[102:103],v35,18432
mf v[236:239],a[92:95],a[28:31]
dt a[104:105],v36,16384
mf v[232:235],a[72:75],a[12:15]
dt a[106:107],v36,18432
mf v[232:235],a[88:91],a[28:31]
dt a[108:109],v37,16384
buffer_load_dwordx4 v29, s[28:31], s69 offen offset:2048 sc1 lds
mf v[228:231],a[68:71],a[12:15]
dt a[110:111],v37,18432
mf v[228:231],a[84:87],a[28:31]
dq a[48:51],v32,24576
mf v[224:227],a[64:67],a[12:15]
dq a[52:55],v32,25600
mf v[224:227],a[80:83],a[28:31]
dq a[56:59],v33,24576
buffer_load_dwordx4 v29, s[28:31], s69 offen offset:3072 sc1 lds
mf v[160:163],a[64:67],a[0:3]
dq a[60:63],v33,25600
mf v[160:163],a[80:83],a[16:19]
dt a[112:113],v34,20480
mf v[164:167],a[68:71],a[0:3]
s_add_u32 m0, s67, 0
dt a[114:115],v34,22528
mf v[164:167],a[84:87],a[16:19]
dt a[116:117],v35,20480
buffer_load_dwordx4 v31, s[48:51], s70 offen offset:0 sc1 lds
mf v[168:171],a[72:75],a[0:3]
dt a[118:119],v35,22528
mf v[168:171],a[88:91],a[16:19]
dt a[120:121],v36,20480
mf v[172:175],a[76:79],a[0:3]
s_add_u32 m0, s67, 8064
dt a[122:123],v36,22528
mf v[172:175],a[92:95],a[16:19]
dt a[124:125],v37,20480
buffer_load_dwordx4 v31, s[48:51], s70 offen offset:128 sc1 lds
mf v[188:191],a[76:79],a[4:7]
dt a[126:127],v37,22528
mf v[188:191],a[92:95],a[20:23]
mf v[184:187],a[72:75],a[4:7]
s_add_u32 m0, s67, 1024
v_readlane_b32 s69, v24, 25
mf v[184:187],a[88:91],a[20:23]
buffer_load_dwordx4 v31, s[48:51], s71 offen offset:0 sc1 lds
mf v[180:183],a[68:71],a[4:7]
mf v[180:183],a[84:87],a[20:23]
mf v[176:179],a[64:67],a[4:7]
s_add_u32 m0, s67, 9088
mf v[176:179],a[80:83],a[20:23]
buffer_load_dwordx4 v31, s[48:51], s71 offen offset:128 sc1 lds
s_waitcnt vmcnt(16) lgkmcnt(0)
s_barrier
mf v[208:211],a[96:99],a[40:43]
v_readlane_b32 s70, v25, 25
v_readlane_b32 s71, v26, 25
mf v[208:211],a[112:115],a[56:59]
dq a[0:3],v32,32768
mf v[212:215],a[100:103],a[40:43]
s_add_u32 m0, s65, 16384
dq a[4:7],v32,33792
mf v[212:215],a[116:119],a[56:59]
dq a[8:11],v33,32768
buffer_load_dwordx4 v29, s[28:31], s69 offen offset:0 sc1 lds
mf v[216:219],a[104:107],a[40:43]
dq a[12:15],v33,33792
mf v[216:219],a[120:123],a[56:59]
dt a[64:65],v34,32768
mf v[220:223],a[108:111],a[40:43]
dt a[66:67],v34,34816
mf v[220:223],a[124:127],a[56:59]
dt a[68:69],v35,32768
buffer_load_dwordx4 v29, s[28:31], s69 offen offset:1024 sc1 lds
mf v[236:239],a[108:111],a[44:47]
dt a[70:71],v35,34816
mf v[236:239],a[124:127],a[60:63]
dt a[72:73],v36,32768
mf v[232:235],a[104:107],a[44:47]
dt a[74:75],v36,34816
mf v[232:235],a[120:123],a[60:63]
dt a[76:77],v37,32768
buffer_load_dwordx4 v29, s[28:31], s69 offen offset:2048 sc1 lds
mf v[228:231],a[100:103],a[44:47]
dt a[78:79],v37,34816
mf v[228:231],a[116:119],a[60:63]
dq a[16:19],v32,40960
mf v[224:227],a[96:99],a[44:47]
dq a[20:23],v32,41984
mf v[224:227],a[112:115],a[60:63]
dq a[24:27],v33,40960
buffer_load_dwordx4 v29, s[28:31], s69 offen offset:3072 sc1 lds
mf v[160:163],a[96:99],a[32:35]
dq a[28:31],v33,41984
mf v[160:163],a[112:115],a[48:51]
dt a[80:81],v34,36864
mf v[164:167],a[100:103],a[32:35]
s_add_u32 m0, s67, 16384
dt a[82:83],v34,38912
mf v[164:167],a[116:119],a[48:51]
dt a[84:85],v35,36864
buffer_load_dwordx4 v31, s[48:51], s70 offen offset:0 sc1 lds
mf v[168:171],a[104:107],a[32:35]
dt a[86:87],v35,38912
mf v[168:171],a[120:123],a[48:51]
dt a[88:89],v36,36864
mf v[172:175],a[108:111],a[32:35]
s_add_u32 m0, s67, 24448
dt a[90:91],v36,38912
mf v[172:175],a[124:127],a[48:51]
dt a[92:93],v37,36864
buffer_load_dwordx4 v31, s[48:51], s70 offen offset:128 sc1 lds
mf v[188:191],a[108:111],a[36:39]
dt a[94:95],v37,38912
mf v[188:191],a[124:127],a[52:55]
mf v[184:187],a[104:107],a[36:39]
s_add_u32 m0, s67, 17408
v_readlane_b32 s69, v24, 26
mf v[184:187],a[120:123],a[52:55]
buffer_load_dwordx4 v31, s[48:51], s71 offen offset:0 sc1 lds
mf v[180:183],a[100:103],a[36:39]
mf v[180:183],a[116:119],a[52:55]
mf v[176:179],a[96:99],a[36:39]
s_add_u32 m0, s67, 25472
mf v[176:179],a[112:115],a[52:55]
buffer_load_dwordx4 v31, s[48:51], s71 offen offset:128 sc1 lds
s_waitcnt vmcnt(16) lgkmcnt(0)
s_barrier
mf v[208:211],a[64:67],a[8:11]
v_readlane_b32 s70, v25, 26
v_readlane_b32 s71, v26, 26
mf v[208:211],a[80:83],a[24:27]
dq a[32:35],v32,49152
mf v[212:215],a[68:71],a[8:11]
s_add_u32 m0, s65, 32768
dq a[36:39],v32,50176
mf v[212:215],a[84:87],a[24:27]
dq a[40:43],v33,49152
buffer_load_dwordx4 v29, s[28:31], s69 offen offset:0 sc1 lds
mf v[216:219],a[72:75],a[8:11]
dq a[44:47],v33,50176
mf v[216:219],a[88:91],a[24:27]
dt a[96:97],v34,49152
mf v[220:223],a[76:79],a[8:11]
dt a[98:99],v34,51200
mf v[220:223],a[92:95],a[24:27]
dt a[100:101],v35,49152
buffer_load_dwordx4 v29, s[28:31], s69 offen offset:1024 sc1 lds
mf v[236:239],a[76:79],a[12:15]
dt a[102:103],v35,51200
mf v[236:239],a[92:95],a[28:31]
dt a[104:105],v36,49152
mf v[232:235],a[72:75],a[12:15]
dt a[106:107],v36,51200
mf v[232:235],a[88:91],a[28:31]
dt a[108:109],v37,49152
buffer_load_dwordx4 v29, s[28:31], s69 offen offset:2048 sc1 lds
mf v[228:231],a[68:71],a[12:15]
dt a[110:111],v37,51200
mf v[228:231],a[84:87],a[28:31]
dq a[48:51],v32,57344
mf v[224:227],a[64:67],a[12:15]
dq a[52:55],v32,58368
mf v[224:227],a[80:83],a[28:31]
dq a[56:59],v33,57344
buffer_load_dwordx4 v29, s[28:31], s69 offen offset:3072 sc1 lds
mf v[160:163],a[64:67],a[0:3]
dq a[60:63],v33,58368
mf v[160:163],a[80:83],a[16:19]
dt a[112:113],v34,53248
mf v[164:167],a[68:71],a[0:3]
s_add_u32 m0, s67, 32768
dt a[114:115],v34,55296
mf v[164:167],a[84:87],a[16:19]
dt a[116:117],v35,53248
buffer_load_dwordx4 v31, s[48:51], s70 offen offset:0 sc1 lds
mf v[168:171],a[72:75],a[0:3]
dt a[118:119],v35,55296
mf v[168:171],a[88:91],a[16:19]
dt a[120:121],v36,53248
mf v[172:175],a[76:79],a[0:3]
s_add_u32 m0, s67, 40832
dt a[122:123],v36,55296
mf v[172:175],a[92:95],a[16:19]
dt a[124:125],v37,53248
buffer_load_dwordx4 v31, s[48:51], s70 offen offset:128 sc1 lds
mf v[188:191],a[76:79],a[4:7]
dt a[126:127],v37,55296
mf v[188:191],a[92:95],a[20:23]
mf v[184:187],a[72:75],a[4:7]
s_add_u32 m0, s67, 33792
v_readlane_b32 s69, v24, 27
mf v[184:187],a[88:91],a[20:23]
buffer_load_dwordx4 v31, s[48:51], s71 offen offset:0 sc1 lds
mf v[180:183],a[68:71],a[4:7]
v_lshrrev_b32 v28, 2, v2
mf v[180:183],a[84:87],a[20:23]
v_lshl_add_u32 v28, v28, 7, s80
mf v[176:179],a[64:67],a[4:7]
s_add_u32 m0, s67, 41856
mf v[176:179],a[80:83],a[20:23]
buffer_load_dwordx4 v31, s[48:51], s71 offen offset:128 sc1 lds
s_waitcnt vmcnt(16) lgkmcnt(0)
s_barrier
mf v[208:211],a[96:99],a[40:43]
v_readlane_b32 s70, v25, 27
v_readlane_b32 s71, v26, 27
mf v[208:211],a[112:115],a[56:59]
dq a[0:3],v32,0
mf v[212:215],a[100:103],a[40:43]
s_add_u32 m0, s65, 49152
dq a[4:7],v32,1024
mf v[212:215],a[116:119],a[56:59]
dq a[8:11],v33,0
buffer_load_dwordx4 v29, s[28:31], s69 offen offset:0 sc1 lds
mf v[216:219],a[104:107],a[40:43]
dq a[12:15],v33,1024
mf v[216:219],a[120:123],a[56:59]
dt a[64:65],v34,0
buffer_load_dword v39, v28, s[28:31], 0 offen sc1
mf v[220:223],a[108:111],a[40:43]
dt a[66:67],v34,2048
mf v[220:223],a[124:127],a[56:59]
dt a[68:69],v35,0
buffer_load_dwordx4 v29, s[28:31], s69 offen offset:1024 sc1 lds
mf v[236:239],a[108:111],a[44:47]
dt a[70:71],v35,2048
mf v[236:239],a[124:127],a[60:63]
dt a[72:73],v36,0
mf v[232:235],a[104:107],a[44:47]
dt a[74:75],v36,2048
mf v[232:235],a[120:123],a[60:63]
dt a[76:77],v37,0
buffer_load_dwordx4 v29, s[28:31], s69 offen offset:2048 sc1 lds
mf v[228:231],a[100:103],a[44:47]
dt a[78:79],v37,2048
mf v[228:231],a[116:119],a[60:63]
dq a[16:19],v32,8192
mf v[224:227],a[96:99],a[44:47]
dq a[20:23],v32,9216
mf v[224:227],a[112:115],a[60:63]
dq a[24:27],v33,8192
buffer_load_dwordx4 v29, s[28:31], s69 offen offset:3072 sc1 lds
mf v[160:163],a[96:99],a[32:35]
dq a[28:31],v33,9216
mf v[160:163],a[112:115],a[48:51]
dt a[80:81],v34,4096
mf v[164:167],a[100:103],a[32:35]
s_add_u32 m0, s67, 49152
dt a[82:83],v34,6144
mf v[164:167],a[116:119],a[48:51]
dt a[84:85],v35,4096
buffer_load_dwordx4 v31, s[48:51], s70 offen offset:0 sc1 lds
mf v[168:171],a[104:107],a[32:35]
dt a[86:87],v35,6144
mf v[168:171],a[120:123],a[48:51]
dt a[88:89],v36,4096
mf v[172:175],a[108:111],a[32:35]
s_add_u32 m0, s67, 57216
dt a[90:91],v36,6144
mf v[172:175],a[124:127],a[48:51]
dt a[92:93],v37,4096
buffer_load_dwordx4 v31, s[48:51], s70 offen offset:128 sc1 lds
mf v[188:191],a[108:111],a[36:39]
dt a[94:95],v37,6144
mf v[188:191],a[124:127],a[52:55]
mf v[184:187],a[104:107],a[36:39]
s_add_u32 m0, s67, 50176
v_readlane_b32 s69, v24, 28
mf v[184:187],a[120:123],a[52:55]
buffer_load_dwordx4 v31, s[48:51], s71 offen offset:0 sc1 lds
mf v[180:183],a[100:103],a[36:39]
mf v[180:183],a[116:119],a[52:55]
mf v[176:179],a[96:99],a[36:39]
s_add_u32 m0, s67, 58240
mf v[176:179],a[112:115],a[52:55]
buffer_load_dwordx4 v31, s[48:51], s71 offen offset:128 sc1 lds
s_waitcnt vmcnt(17) lgkmcnt(0)
s_barrier
mf v[208:211],a[64:67],a[8:11]
v_readlane_b32 s70, v25, 28
v_readlane_b32 s71, v26, 28
mf v[208:211],a[80:83],a[24:27]
dq a[32:35],v32,16384
mf v[212:215],a[68:71],a[8:11]
s_add_u32 m0, s65, 0
dq a[36:39],v32,17408
mf v[212:215],a[84:87],a[24:27]
dq a[40:43],v33,16384
buffer_load_dwordx4 v29, s[28:31], s69 offen offset:0 sc1 lds
mf v[216:219],a[72:75],a[8:11]
dq a[44:47],v33,17408
mf v[216:219],a[88:91],a[24:27]
dt a[96:97],v34,16384
mf v[220:223],a[76:79],a[8:11]
dt a[98:99],v34,18432
mf v[220:223],a[92:95],a[24:27]
dt a[100:101],v35,16384
buffer_load_dwordx4 v29, s[28:31], s69 offen offset:1024 sc1 lds
mf v[236:239],a[76:79],a[12:15]
dt a[102:103],v35,18432
mf v[236:239],a[92:95],a[28:31]
dt a[104:105],v36,16384
mf v[232:235],a[72:75],a[12:15]
dt a[106:107],v36,18432
mf v[232:235],a[88:91],a[28:31]
dt a[108:109],v37,16384
buffer_load_dwordx4 v29, s[28:31], s69 offen offset:2048 sc1 lds
mf v[228:231],a[68:71],a[12:15]
dt a[110:111],v37,18432
mf v[228:231],a[84:87],a[28:31]
dq a[48:51],v32,24576
mf v[224:227],a[64:67],a[12:15]
dq a[52:55],v32,25600
mf v[224:227],a[80:83],a[28:31]
dq a[56:59],v33,24576
buffer_load_dwordx4 v29, s[28:31], s69 offen offset:3072 sc1 lds
mf v[160:163],a[64:67],a[0:3]
dq a[60:63],v33,25600
mf v[160:163],a[80:83],a[16:19]
dt a[112:113],v34,20480
mf v[164:167],a[68:71],a[0:3]
s_add_u32 m0, s67, 0
dt a[114:115],v34,22528
mf v[164:167],a[84:87],a[16:19]
dt a[116:117],v35,20480
buffer_load_dwordx4 v31, s[48:51], s70 offen offset:0 sc1 lds
mf v[168:171],a[72:75],a[0:3]
dt a[118:119],v35,22528
mf v[168:171],a[88:91],a[16:19]
dt a[120:121],v36,20480
mf v[172:175],a[76:79],a[0:3]
s_add_u32 m0, s67, 8064
dt a[122:123],v36,22528
mf v[172:175],a[92:95],a[16:19]
dt a[124:125],v37,20480
buffer_load_dwordx4 v31, s[48:51], s70 offen offset:128 sc1 lds
mf v[188:191],a[76:79],a[4:7]
dt a[126:127],v37,22528
mf v[188:191],a[92:95],a[20:23]
mf v[184:187],a[72:75],a[4:7]
s_add_u32 m0, s67, 1024
v_readlane_b32 s69, v24, 29
mf v[184:187],a[88:91],a[20:23]
buffer_load_dwordx4 v31, s[48:51], s71 offen offset:0 sc1 lds
mf v[180:183],a[68:71],a[4:7]
mf v[180:183],a[84:87],a[20:23]
mf v[176:179],a[64:67],a[4:7]
s_add_u32 m0, s67, 9088
mf v[176:179],a[80:83],a[20:23]
buffer_load_dwordx4 v31, s[48:51], s71 offen offset:128 sc1 lds
s_waitcnt vmcnt(17) lgkmcnt(0)
s_barrier
L_stub25:
s_cbranch_execz L_stub29
mf v[208:211],a[96:99],a[40:43]
v_readlane_b32 s70, v25, 29
v_readlane_b32 s71, v26, 29
mf v[208:211],a[112:115],a[56:59]
dq a[0:3],v32,32768
mf v[212:215],a[100:103],a[40:43]
s_add_u32 m0, s65, 16384
dq a[4:7],v32,33792
mf v[212:215],a[116:119],a[56:59]
dq a[8:11],v33,32768
buffer_load_dwordx4 v29, s[28:31], s69 offen offset:0 sc1 lds
mf v[216:219],a[104:107],a[40:43]
dq a[12:15],v33,33792
mf v[216:219],a[120:123],a[56:59]
dt a[64:65],v34,32768
mf v[220:223],a[108:111],a[40:43]
dt a[66:67],v34,34816
mf v[220:223],a[124:127],a[56:59]
dt a[68:69],v35,32768
buffer_load_dwordx4 v29, s[28:31], s69 offen offset:1024 sc1 lds
mf v[236:239],a[108:111],a[44:47]
dt a[70:71],v35,34816
mf v[236:239],a[124:127],a[60:63]
dt a[72:73],v36,32768
mf v[232:235],a[104:107],a[44:47]
dt a[74:75],v36,34816
mf v[232:235],a[120:123],a[60:63]
dt a[76:77],v37,32768
buffer_load_dwordx4 v29, s[28:31], s69 offen offset:2048 sc1 lds
mf v[228:231],a[100:103],a[44:47]
dt a[78:79],v37,34816
mf v[228:231],a[116:119],a[60:63]
dq a[16:19],v32,40960
mf v[224:227],a[96:99],a[44:47]
dq a[20:23],v32,41984
mf v[224:227],a[112:115],a[60:63]
dq a[24:27],v33,40960
buffer_load_dwordx4 v29, s[28:31], s69 offen offset:3072 sc1 lds
mf v[160:163],a[96:99],a[32:35]
dq a[28:31],v33,41984
mf v[160:163],a[112:115],a[48:51]
dt a[80:81],v34,36864
mf v[164:167],a[100:103],a[32:35]
s_add_u32 m0, s67, 16384
dt a[82:83],v34,38912
mf v[164:167],a[116:119],a[48:51]
dt a[84:85],v35,36864
buffer_load_dwordx4 v31, s[48:51], s70 offen offset:0 sc1 lds
mf v[168:171],a[104:107],a[32:35]
dt a[86:87],v35,38912
mf v[168:171],a[120:123],a[48:51]
dt a[88:89],v36,36864
mf v[172:175],a[108:111],a[32:35]
s_add_u32 m0, s67, 24448
dt a[90:91],v36,38912
mf v[172:175],a[124:127],a[48:51]
dt a[92:93],v37,36864
buffer_load_dwordx4 v31, s[48:51], s70 offen offset:128 sc1 lds
mf v[188:191],a[108:111],a[36:39]
dt a[94:95],v37,38912
mf v[188:191],a[124:127],a[52:55]
mf v[184:187],a[104:107],a[36:39]
s_add_u32 m0, s67, 17408
v_readlane_b32 s69, v24, 30
mf v[184:187],a[120:123],a[52:55]
buffer_load_dwordx4 v31, s[48:51], s71 offen offset:0 sc1 lds
mf v[180:183],a[100:103],a[36:39]
mf v[180:183],a[116:119],a[52:55]
mf v[176:179],a[96:99],a[36:39]
s_add_u32 m0, s67, 25472
mf v[176:179],a[112:115],a[52:55]
buffer_load_dwordx4 v31, s[48:51], s71 offen offset:128 sc1 lds
s_waitcnt vmcnt(16) lgkmcnt(0)
s_barrier
v_sub_u32 v39, v39, v5
v_subrev_u32 v39, 3, v39
v_cmp_lt_u32 vcc, 0, v39
s_nop 0
s_cbranch_vccnz L_s_slow
L_s_back:
mf v[208:211],a[64:67],a[8:11]
v_readlane_b32 s70, v25, 30
v_readlane_b32 s71, v26, 30
mf v[208:211],a[80:83],a[24:27]
dq a[32:35],v32,49152
mf v[212:215],a[68:71],a[8:11]
s_add_u32 m0, s66, 32768
dq a[36:39],v32,50176
mf v[212:215],a[84:87],a[24:27]
dq a[40:43],v33,49152
buffer_load_dwordx4 v30, s[28:31], s69 offen offset:0 sc1 lds
mf v[216:219],a[72:75],a[8:11]
dq a[44:47],v33,50176
mf v[216:219],a[88:91],a[24:27]
dt a[96:97],v34,49152
mf v[220:223],a[76:79],a[8:11]
dt a[98:99],v34,51200
mf v[220:223],a[92:95],a[24:27]
dt a[100:101],v35,49152
buffer_load_dwordx4 v30, s[28:31], s69 offen offset:1024 sc1 lds
mf v[236:239],a[76:79],a[12:15]
dt a[102:103],v35,51200
mf v[236:239],a[92:95],a[28:31]
dt a[104:105],v36,49152
mf v[232:235],a[72:75],a[12:15]
s_add_u32 m0, s67, 32768
dt a[106:107],v36,51200
mf v[232:235],a[88:91],a[28:31]
dt a[108:109],v37,49152
buffer_load_dwordx4 v31, s[52:55], s70 offen offset:0 sc1 lds
mf v[228:231],a[68:71],a[12:15]
dt a[110:111],v37,51200
mf v[228:231],a[84:87],a[28:31]
dq a[48:51],v32,57344
mf v[224:227],a[64:67],a[12:15]
s_add_u32 m0, s67, 40832
dq a[52:55],v32,58368
mf v[224:227],a[80:83],a[28:31]
dq a[56:59],v33,57344
buffer_load_dwordx4 v31, s[52:55], s70 offen offset:128 sc1 lds
mf v[160:163],a[64:67],a[0:3]
dq a[60:63],v33,58368
mf v[160:163],a[80:83],a[16:19]
dt a[112:113],v34,53248
mf v[164:167],a[68:71],a[0:3]
s_add_u32 m0, s67, 33792
dt a[114:115],v34,55296
mf v[164:167],a[84:87],a[16:19]
dt a[116:117],v35,53248
buffer_load_dwordx4 v31, s[52:55], s71 offen offset:0 sc1 lds
mf v[168:171],a[72:75],a[0:3]
dt a[118:119],v35,55296
mf v[168:171],a[88:91],a[16:19]
dt a[120:121],v36,53248
mf v[172:175],a[76:79],a[0:3]
s_add_u32 m0, s67, 41856
dt a[122:123],v36,55296
mf v[172:175],a[92:95],a[16:19]
dt a[124:125],v37,53248
buffer_load_dwordx4 v31, s[52:55], s71 offen offset:128 sc1 lds
mf v[188:191],a[76:79],a[4:7]
dt a[126:127],v37,55296
mf v[188:191],a[92:95],a[20:23]
mf v[184:187],a[72:75],a[4:7]
s_xor_b32 s12, s14, 4
v_readlane_b32 s69, v24, 31
mf v[184:187],a[88:91],a[20:23]
s_lshl_b32 s13, s12, 5
mf v[180:183],a[68:71],a[4:7]
s_add_u32 s13, s13, 23691264
mf v[180:183],a[84:87],a[20:23]
s_mov_b32 s18, 0xbfb8aa3b
mf v[176:179],a[64:67],a[4:7]
s_mov_b32 s19, s18
mf v[176:179],a[80:83],a[20:23]
s_waitcnt vmcnt(14) lgkmcnt(0)
s_barrier
mf v[208:211],a[96:99],a[40:43]
v_readlane_b32 s70, v25, 31
v_readlane_b32 s71, v26, 31
mf v[208:211],a[112:115],a[56:59]
dq a[0:3],v32,0
mf v[212:215],a[100:103],a[40:43]
s_add_u32 m0, s66, 49152
dq a[4:7],v32,1024
mf v[212:215],a[116:119],a[56:59]
dq a[8:11],v33,0
buffer_load_dwordx4 v30, s[28:31], s69 offen offset:0 sc1 lds
mf v[216:219],a[104:107],a[40:43]
dq a[12:15],v33,1024
mf v[216:219],a[120:123],a[56:59]
dt a[64:65],v34,0
mf v[220:223],a[108:111],a[40:43]
dt a[66:67],v34,2048
mf v[220:223],a[124:127],a[56:59]
dt a[68:69],v35,0
buffer_load_dwordx4 v30, s[28:31], s69 offen offset:1024 sc1 lds
mf v[236:239],a[108:111],a[44:47]
dt a[70:71],v35,2048
mf v[236:239],a[124:127],a[60:63]
dt a[72:73],v36,0
mf v[232:235],a[104:107],a[44:47]
s_add_u32 m0, s67, 49152
dt a[74:75],v36,2048
mf v[232:235],a[120:123],a[60:63]
dt a[76:77],v37,0
buffer_load_dwordx4 v31, s[52:55], s70 offen offset:0 sc1 lds
mf v[228:231],a[100:103],a[44:47]
dt a[78:79],v37,2048
mf v[228:231],a[116:119],a[60:63]
dq a[16:19],v32,8192
mf v[224:227],a[96:99],a[44:47]
s_add_u32 m0, s67, 57216
dq a[20:23],v32,9216
mf v[224:227],a[112:115],a[60:63]
dq a[24:27],v33,8192
buffer_load_dwordx4 v31, s[52:55], s70 offen offset:128 sc1 lds
mf v[160:163],a[96:99],a[32:35]
dq a[28:31],v33,9216
mf v[160:163],a[112:115],a[48:51]
dt a[80:81],v34,4096
mf v[164:167],a[100:103],a[32:35]
s_add_u32 m0, s67, 50176
dt a[82:83],v34,6144
mf v[164:167],a[116:119],a[48:51]
dt a[84:85],v35,4096
buffer_load_dwordx4 v31, s[52:55], s71 offen offset:0 sc1 lds
mf v[168:171],a[104:107],a[32:35]
dt a[86:87],v35,6144
mf v[168:171],a[120:123],a[48:51]
dt a[88:89],v36,4096
mf v[172:175],a[108:111],a[32:35]
s_add_u32 m0, s67, 58240
dt a[90:91],v36,6144
mf v[172:175],a[124:127],a[48:51]
dt a[92:93],v37,4096
buffer_load_dwordx4 v31, s[52:55], s71 offen offset:128 sc1 lds
mf v[188:191],a[108:111],a[36:39]
dt a[94:95],v37,6144
mf v[188:191],a[124:127],a[52:55]
mf v[184:187],a[104:107],a[36:39]
v_readlane_b32 s69, v24, 32
mf v[184:187],a[120:123],a[52:55]
mf v[180:183],a[100:103],a[36:39]
mf v[180:183],a[116:119],a[52:55]
mf v[176:179],a[96:99],a[36:39]
mf v[176:179],a[112:115],a[52:55]
s_waitcnt vmcnt(12) lgkmcnt(0)
s_barrier
mf v[208:211],a[64:67],a[8:11]
v_readlane_b32 s70, v25, 32
v_readlane_b32 s71, v26, 32
mf v[208:211],a[80:83],a[24:27]
dq a[32:35],v32,16384
mf v[212:215],a[68:71],a[8:11]
s_add_u32 m0, s66, 0
dq a[36:39],v32,17408
mf v[212:215],a[84:87],a[24:27]
dq a[40:43],v33,16384
buffer_load_dwordx4 v30, s[28:31], s69 offen offset:0 sc1 lds
mf v[216:219],a[72:75],a[8:11]
dq a[44:47],v33,17408
mf v[216:219],a[88:91],a[24:27]
dt a[96:97],v34,16384
mf v[220:223],a[76:79],a[8:11]
dt a[98:99],v34,18432
mf v[220:223],a[92:95],a[24:27]
dt a[100:101],v35,16384
buffer_load_dwordx4 v30, s[28:31], s69 offen offset:1024 sc1 lds
mf v[236:239],a[76:79],a[12:15]
dt a[102:103],v35,18432
mf v[236:239],a[92:95],a[28:31]
dt a[104:105],v36,16384
mf v[232:235],a[72:75],a[12:15]
s_add_u32 m0, s67, 0
dt a[106:107],v36,18432
mf v[232:235],a[88:91],a[28:31]
dt a[108:109],v37,16384
buffer_load_dwordx4 v31, s[52:55], s70 offen offset:0 sc1 lds
mf v[228:231],a[68:71],a[12:15]
dt a[110:111],v37,18432
mf v[228:231],a[84:87],a[28:31]
dq a[48:51],v32,24576
mf v[224:227],a[64:67],a[12:15]
s_add_u32 m0, s67, 8064
dq a[52:55],v32,25600
mf v[224:227],a[80:83],a[28:31]
dq a[56:59],v33,24576
buffer_load_dwordx4 v31, s[52:55], s70 offen offset:128 sc1 lds
mf v[160:163],a[64:67],a[0:3]
dq a[60:63],v33,25600
mf v[160:163],a[80:83],a[16:19]
dt a[112:113],v34,20480
mf v[164:167],a[68:71],a[0:3]
s_add_u32 m0, s67, 1024
dt a[114:115],v34,22528
mf v[164:167],a[84:87],a[16:19]
dt a[116:117],v35,20480
buffer_load_dwordx4 v31, s[52:55], s71 offen offset:0 sc1 lds
mf v[168:171],a[72:75],a[0:3]
dt a[118:119],v35,22528
mf v[168:171],a[88:91],a[16:19]
dt a[120:121],v36,20480
mf v[172:175],a[76:79],a[0:3]
s_add_u32 m0, s67, 9088
dt a[122:123],v36,22528
mf v[172:175],a[92:95],a[16:19]
dt a[124:125],v37,20480
buffer_load_dwordx4 v31, s[52:55], s71 offen offset:128 sc1 lds
mf v[188:191],a[76:79],a[4:7]
dt a[126:127],v37,22528
mf v[188:191],a[92:95],a[20:23]
mf v[184:187],a[72:75],a[4:7]
v_readlane_b32 s69, v24, 33
mf v[184:187],a[88:91],a[20:23]
mf v[180:183],a[68:71],a[4:7]
mf v[180:183],a[84:87],a[20:23]
mf v[176:179],a[64:67],a[4:7]
mf v[176:179],a[80:83],a[20:23]
s_waitcnt vmcnt(12) lgkmcnt(0)
s_barrier
mf v[208:211],a[96:99],a[40:43]
v_readlane_b32 s70, v25, 33
v_readlane_b32 s71, v26, 33
mf v[208:211],a[112:115],a[56:59]
dq a[0:3],v32,32768
mf v[212:215],a[100:103],a[40:43]
s_add_u32 m0, s66, 16384
dq a[4:7],v32,33792
mf v[212:215],a[116:119],a[56:59]
dt a[64:65],v34,32768
buffer_load_dwordx4 v30, s[28:31], s69 offen offset:0 sc1 lds
mf v[216:219],a[104:107],a[40:43]
dt a[66:67],v34,34816
mf v[216:219],a[120:123],a[56:59]
dt a[68:69],v35,32768
mf v[220:223],a[108:111],a[40:43]
mf v[220:223],a[124:127],a[56:59]
dt a[70:71],v35,34816
buffer_load_dwordx4 v30, s[28:31], s69 offen offset:1024 sc1 lds
mf v[236:239],a[108:111],a[44:47]
dt a[72:73],v36,32768
mf v[236:239],a[124:127],a[60:63]
dt a[74:75],v36,34816
mf v[232:235],a[104:107],a[44:47]
s_add_u32 m0, s67, 16384
dt a[76:77],v37,32768
mf v[232:235],a[120:123],a[60:63]
dt a[78:79],v37,34816
buffer_load_dwordx4 v31, s[52:55], s70 offen offset:0 sc1 lds
mf v[228:231],a[100:103],a[44:47]
mf v[228:231],a[116:119],a[60:63]
dq a[16:19],v32,40960
mf v[224:227],a[96:99],a[44:47]
s_add_u32 m0, s67, 24448
dq a[20:23],v32,41984
mf v[224:227],a[112:115],a[60:63]
dt a[80:81],v34,36864
buffer_load_dwordx4 v31, s[52:55], s70 offen offset:128 sc1 lds
mf v[160:163],a[96:99],a[32:35]
dt a[82:83],v34,38912
mf v[160:163],a[112:115],a[48:51]
dt a[84:85],v35,36864
mf v[164:167],a[100:103],a[32:35]
s_add_u32 m0, s67, 17408
mf v[164:167],a[116:119],a[48:51]
dt a[86:87],v35,38912
buffer_load_dwordx4 v31, s[52:55], s71 offen offset:0 sc1 lds
mf v[168:171],a[104:107],a[32:35]
dt a[88:89],v36,36864
mf v[168:171],a[120:123],a[48:51]
dt a[90:91],v36,38912
mf v[172:175],a[108:111],a[32:35]
s_add_u32 m0, s67, 25472
dt a[92:93],v37,36864
mf v[172:175],a[124:127],a[48:51]
dt a[94:95],v37,38912
buffer_load_dwordx4 v31, s[52:55], s71 offen offset:128 sc1 lds
mf v[188:191],a[108:111],a[36:39]
mf v[188:191],a[124:127],a[52:55]
mf v[184:187],a[104:107],a[36:39]
mf v[184:187],a[120:123],a[52:55]
mf v[180:183],a[100:103],a[36:39]
mf v[180:183],a[116:119],a[52:55]
mf v[176:179],a[96:99],a[36:39]
mf v[176:179],a[112:115],a[52:55]
s_lshl_b32 s82, s14, 12
s_add_u32 s82, s82, 18874368
v_cvt_pk_bf16_f32 v240, v208, v209
v_cvt_pk_bf16_f32 v241, v210, v211
v_cvt_pk_bf16_f32 v242, v212, v213
v_cvt_pk_bf16_f32 v243, v214, v215
buffer_store_dwordx4 v[240:243], v3, s[28:31], s82 offen offset:0 sc1
v_cvt_pk_bf16_f32 v244, v216, v217
v_cvt_pk_bf16_f32 v245, v218, v219
v_cvt_pk_bf16_f32 v246, v220, v221
v_cvt_pk_bf16_f32 v247, v222, v223
buffer_store_dwordx4 v[244:247], v3, s[28:31], s82 offen offset:1024 sc1
v_cvt_pk_bf16_f32 v252, v232, v233
v_cvt_pk_bf16_f32 v253, v234, v235
v_cvt_pk_bf16_f32 v254, v236, v237
v_cvt_pk_bf16_f32 v255, v238, v239
buffer_store_dwordx4 v[252:255], v3, s[28:31], s82 offen offset:3072 sc1
v_cvt_pk_bf16_f32 v248, v224, v225
v_cvt_pk_bf16_f32 v249, v226, v227
v_cvt_pk_bf16_f32 v250, v228, v229
v_cvt_pk_bf16_f32 v251, v230, v231
buffer_store_dwordx4 v[248:251], v3, s[28:31], s82 offen offset:2048 sc1
s_waitcnt vmcnt(16) lgkmcnt(0)
s_barrier
v_mfma_f32_16x16x32_bf16 v[80:83], a[64:67], a[0:3], 0
dq a[32:35],v32,49152
v_readlane_b32 s69, v24, 34
mf v[80:83],a[80:83],a[16:19]
dq a[48:51],v32,57344
dq a[36:39],v32,50176
v_mfma_f32_16x16x32_bf16 v[96:99], a[64:67], a[4:7], 0
dq a[52:55],v32,58368
v_readlane_b32 s70, v25, 34
mf v[96:99],a[80:83],a[20:23]
dt a[96:97],v34,49152
dt a[98:99],v34,51200
v_mfma_f32_16x16x32_bf16 v[100:103], a[68:71], a[4:7], 0
s_add_u32 m0, s66, 131072
dt a[112:113],v34,53248
v_readlane_b32 s71, v26, 34
mf v[100:103],a[84:87],a[20:23]
dt a[114:115],v34,55296
buffer_load_dwordx4 v30, s[28:31], s69 offen offset:0 sc1 lds
v_mfma_f32_16x16x32_bf16 v[84:87], a[68:71], a[0:3], 0
dt a[100:101],v35,49152
mf v[84:87],a[84:87],a[16:19]
dt a[102:103],v35,51200
buffer_load_dwordx4 v30, s[28:31], s69 offen offset:1024 sc1 lds
v_mfma_f32_16x16x32_bf16 v[88:91], a[72:75], a[0:3], 0
dt a[116:117],v35,53248
mf v[88:91],a[88:91],a[16:19]
dt a[118:119],v35,55296
dt a[104:105],v36,49152
v_mfma_f32_16x16x32_bf16 v[104:107], a[72:75], a[4:7], 0
dt a[106:107],v36,51200
mf v[104:107],a[88:91],a[20:23]
dt a[120:121],v36,53248
dt a[122:123],v36,55296
v_mfma_f32_16x16x32_bf16 v[108:111], a[76:79], a[4:7], 0
s_add_u32 m0, s67, 81920
dt a[108:109],v37,49152
mf v[108:111],a[92:95],a[20:23]
dt a[110:111],v37,51200
buffer_load_dwordx4 v31, s[52:55], s70 offen offset:0 sc1 lds
v_mfma_f32_16x16x32_bf16 v[92:95], a[76:79], a[0:3], 0
s_add_u32 m0, s67, 89984
dt a[124:125],v37,53248
mf v[92:95],a[92:95],a[16:19]
dt a[126:127],v37,55296
buffer_load_dwordx4 v31, s[52:55], s70 offen offset:128 sc1 lds
v_lshlrev_b32 v192, 16, v48
v_and_b32 v193, 0xffff0000, v48
v_lshlrev_b32 v194, 16, v49
v_and_b32 v195, 0xffff0000, v49
v_lshlrev_b32_e64 v196, 16, v50
s_add_u32 m0, s67, 82944
v_and_b32 v197, 0xffff0000, v50
buffer_load_dwordx4 v31, s[52:55], s71 offen offset:0 sc1 lds
v_lshlrev_b32 v198, 16, v51
v_and_b32 v199, 0xffff0000, v51
v_lshlrev_b32 v200, 16, v52
v_and_b32 v201, 0xffff0000, v52
v_lshlrev_b32 v202, 16, v53
v_and_b32 v203, 0xffff0000, v53
s_add_u32 m0, s67, 91008
v_lshlrev_b32 v204, 16, v54
buffer_load_dwordx4 v31, s[52:55], s71 offen offset:128 sc1 lds
v_and_b32 v205, 0xffff0000, v54
v_lshlrev_b32 v206, 16, v55
v_and_b32 v207, 0xffff0000, v55
v_lshlrev_b32 v208, 16, v56
v_and_b32 v209, 0xffff0000, v56
v_lshlrev_b32 v210, 16, v57
v_and_b32 v211, 0xffff0000, v57
s_waitcnt vmcnt(16) lgkmcnt(8)
s_barrier
mf v[80:83],a[96:99],a[32:35]
dq a[0:3],v32,0
v_readlane_b32 s69, v24, 35
mf v[80:83],a[112:115],a[48:51]
dq a[16:19],v32,8192
dq a[4:7],v32,1024
mf v[96:99],a[96:99],a[36:39]
dq a[20:23],v32,9216
v_readlane_b32 s70, v25, 35
mf v[96:99],a[112:115],a[52:55]
dt a[64:65],v34,0
dt a[66:67],v34,2048
mf v[100:103],a[100:103],a[36:39]
s_add_u32 m0, s66, 32768
dt a[80:81],v34,4096
v_readlane_b32 s71, v26, 35
mf v[100:103],a[116:119],a[52:55]
dt a[82:83],v34,6144
buffer_load_dwordx4 v30, s[28:31], s69 offen offset:0 sc1 lds
mf v[84:87],a[100:103],a[32:35]
dt a[68:69],v35,0
mf v[84:87],a[116:119],a[48:51]
s_waitcnt lgkmcnt(9)
dt a[70:71],v35,2048
buffer_load_dwordx4 v30, s[28:31], s69 offen offset:1024 sc1 lds
mf v[88:91],a[104:107],a[32:35]
dt a[84:85],v35,4096
mf v[88:91],a[120:123],a[48:51]
dt a[86:87],v35,6144
dt a[72:73],v36,0
mf v[104:107],a[104:107],a[36:39]
dt a[74:75],v36,2048
mf v[104:107],a[120:123],a[52:55]
dt a[88:89],v36,4096
dt a[90:91],v36,6144
mf v[108:111],a[108:111],a[36:39]
s_add_u32 m0, s67, 32768
dt a[76:77],v37,0
mf v[108:111],a[124:127],a[52:55]
dt a[78:79],v37,2048
buffer_load_dwordx4 v31, s[52:55], s70 offen offset:0 sc1 lds
mf v[92:95],a[108:111],a[32:35]
s_add_u32 m0, s67, 40832
dt a[92:93],v37,4096
mf v[92:95],a[124:127],a[48:51]
dt a[94:95],v37,6144
buffer_load_dwordx4 v31, s[52:55], s70 offen offset:128 sc1 lds
v_lshlrev_b32 v212, 16, v58
v_and_b32 v213, 0xffff0000, v58
v_lshlrev_b32 v214, 16, v59
v_and_b32 v215, 0xffff0000, v59
v_lshlrev_b32_e64 v216, 16, v60
s_add_u32 m0, s67, 33792
v_and_b32 v217, 0xffff0000, v60
buffer_load_dwordx4 v31, s[52:55], s71 offen offset:0 sc1 lds
v_lshlrev_b32 v218, 16, v61
v_and_b32 v219, 0xffff0000, v61
v_lshlrev_b32 v220, 16, v62
v_and_b32 v221, 0xffff0000, v62
v_lshlrev_b32_e64 v222, 16, v63
v_and_b32 v223, 0xffff0000, v63
s_add_u32 m0, s67, 41856
s_mul_i32 s4, s20, 4608
buffer_load_dwordx4 v31, s[52:55], s71 offen offset:128 sc1 lds
v_and_b32 v45, 15, v2
v_mul_u32_u24 v45, 144, v45
v_lshrrev_b32 v46, 4, v2
v_lshl_add_u32 v45, v46, 3, v45
v_add_u32 v45, s4, v45
v_lshrrev_b32 v47, 3, v2
v_and_b32 v7, 7, v2
s_waitcnt vmcnt(16) lgkmcnt(8)
L_stub26:
s_cbranch_execz L_iwret
s_barrier
mf v[80:83],a[64:67],a[0:3]
dq a[32:35],v32,16384
v_readlane_b32 s69, v24, 36
mf v[80:83],a[80:83],a[16:19]
dq a[48:51],v32,24576
dq a[36:39],v32,17408
mf v[96:99],a[64:67],a[4:7]
dq a[52:55],v32,25600
v_readlane_b32 s70, v25, 36
mf v[96:99],a[80:83],a[20:23]
dt a[96:97],v34,16384
dt a[98:99],v34,18432
mf v[100:103],a[68:71],a[4:7]
s_add_u32 m0, s66, 49152
dt a[112:113],v34,20480
v_readlane_b32 s71, v26, 36
mf v[100:103],a[84:87],a[20:23]
dt a[114:115],v34,22528
buffer_load_dwordx4 v30, s[28:31], s69 offen offset:0 sc1 lds
mf v[84:87],a[68:71],a[0:3]
dt a[100:101],v35,16384
mf v[84:87],a[84:87],a[16:19]
s_waitcnt lgkmcnt(9)
dt a[102:103],v35,18432
buffer_load_dwordx4 v30, s[28:31], s69 offen offset:1024 sc1 lds
mf v[88:91],a[72:75],a[0:3]
dt a[116:117],v35,20480
mf v[88:91],a[88:91],a[16:19]
dt a[118:119],v35,22528
dt a[104:105],v36,16384
mf v[104:107],a[72:75],a[4:7]
dt a[106:107],v36,18432
mf v[104:107],a[88:91],a[20:23]
dt a[120:121],v36,20480
dt a[122:123],v36,22528
mf v[108:111],a[76:79],a[4:7]
s_add_u32 m0, s67, 49152
dt a[108:109],v37,16384
mf v[108:111],a[92:95],a[20:23]
dt a[110:111],v37,18432
buffer_load_dwordx4 v31, s[52:55], s70 offen offset:0 sc1 lds
mf v[92:95],a[76:79],a[0:3]
s_add_u32 m0, s67, 57216
dt a[124:125],v37,20480
mf v[92:95],a[92:95],a[16:19]
dt a[126:127],v37,22528
buffer_load_dwordx4 v31, s[52:55], s70 offen offset:128 sc1 lds
s_add_u32 m0, s67, 50176
v_lshlrev_b32 v7, 4, v7
buffer_load_dwordx4 v31, s[52:55], s71 offen offset:0 sc1 lds
s_add_u32 m0, s67, 58240
v_mul_u32_u24 v46, 144, v47
buffer_load_dwordx4 v31, s[52:55], s71 offen offset:128 sc1 lds
v_add3_u32 v46, v46, v7, s4
s_waitcnt vmcnt(12) lgkmcnt(8)
s_barrier
s_lshl_b32 s82, s14, 5
s_add_u32 s82, s82, 23691264
v_add_u32 v6, 1, v5
s_mov_b64 exec, 1
buffer_store_dword v6, v4, s[28:31], s82 offen sc1
s_mov_b64 exec, -1
mf v[80:83],a[96:99],a[32:35]
dq a[0:3],v64,0
v_readlane_b32 s69, v24, 37
mf v[80:83],a[112:115],a[48:51]
dq a[16:19],v64,8192
dq a[4:7],v64,1024
mf v[96:99],a[96:99],a[36:39]
dq a[20:23],v64,9216
v_readlane_b32 s70, v25, 37
mf v[96:99],a[112:115],a[52:55]
dt a[64:65],v66,0
dt a[66:67],v66,2048
mf v[100:103],a[100:103],a[36:39]
s_add_u32 m0, s66, 0
dt a[80:81],v66,4096
v_readlane_b32 s71, v26, 37
mf v[100:103],a[116:119],a[52:55]
dt a[82:83],v66,6144
buffer_load_dwordx4 v30, s[28:31], s69 offen offset:0 sc1 lds
mf v[84:87],a[100:103],a[32:35]
dt a[68:69],v67,0
mf v[84:87],a[116:119],a[48:51]
s_waitcnt lgkmcnt(9)
dt a[70:71],v67,2048
buffer_load_dwordx4 v30, s[28:31], s69 offen offset:1024 sc1 lds
mf v[88:91],a[104:107],a[32:35]
s_add_u32 m0, s67, 0
dt a[84:85],v67,4096
mf v[88:91],a[120:123],a[48:51]
dt a[86:87],v67,6144
dt a[72:73],v68,0
buffer_load_dwordx4 v31, s[52:55], s70 offen offset:0 sc1 lds
mf v[104:107],a[104:107],a[36:39]
s_add_u32 m0, s67, 8064
dt a[74:75],v68,2048
mf v[104:107],a[120:123],a[52:55]
dt a[88:89],v68,4096
dt a[90:91],v68,6144
buffer_load_dwordx4 v31, s[52:55], s70 offen offset:128 sc1 lds
mf v[108:111],a[108:111],a[36:39]
s_add_u32 m0, s67, 1024
dt a[76:77],v69,0
mf v[108:111],a[124:127],a[52:55]
dt a[78:79],v69,2048
buffer_load_dwordx4 v31, s[52:55], s71 offen offset:0 sc1 lds
mf v[92:95],a[108:111],a[32:35]
s_add_u32 m0, s67, 9088
dt a[92:93],v69,4096
mf v[92:95],a[124:127],a[48:51]
dt a[94:95],v69,6144
buffer_load_dwordx4 v31, s[52:55], s71 offen offset:128 sc1 lds
s_waitcnt vmcnt(13) lgkmcnt(8)
s_barrier
buffer_load_dword v39, v4, s[28:31], s13 offen sc1
mf v[80:83],a[64:67],a[0:3]
dq a[32:35],v32,32768
v_readlane_b32 s69, v24, 38
mf v[80:83],a[80:83],a[16:19]
dq a[48:51],v32,40960
dq a[36:39],v32,33792
mf v[96:99],a[64:67],a[4:7]
dq a[52:55],v32,41984
v_readlane_b32 s70, v25, 38
mf v[96:99],a[80:83],a[20:23]
dt a[96:97],v34,32768
dt a[98:99],v34,34816
mf v[100:103],a[68:71],a[4:7]
s_add_u32 m0, s66, 16384
dt a[112:113],v34,36864
v_readlane_b32 s71, v26, 38
mf v[100:103],a[84:87],a[20:23]
dt a[114:115],v34,38912
buffer_load_dwordx4 v30, s[28:31], s69 offen offset:0 sc1 lds
mf v[84:87],a[68:71],a[0:3]
dt a[100:101],v35,32768
mf v[84:87],a[84:87],a[16:19]
s_waitcnt lgkmcnt(9)
dt a[102:103],v35,34816
buffer_load_dwordx4 v30, s[28:31], s69 offen offset:1024 sc1 lds
mf v[88:91],a[72:75],a[0:3]
s_add_u32 m0, s67, 16384
dt a[116:117],v35,36864
mf v[88:91],a[88:91],a[16:19]
dt a[118:119],v35,38912
dt a[104:105],v36,32768
buffer_load_dwordx4 v31, s[52:55], s70 offen offset:0 sc1 lds
mf v[104:107],a[72:75],a[4:7]
s_add_u32 m0, s67, 24448
dt a[106:107],v36,34816
mf v[104:107],a[88:91],a[20:23]
dt a[120:121],v36,36864
dt a[122:123],v36,38912
buffer_load_dwordx4 v31, s[52:55], s70 offen offset:128 sc1 lds
mf v[108:111],a[76:79],a[4:7]
s_add_u32 m0, s67, 17408
dt a[108:109],v37,32768
mf v[108:111],a[92:95],a[20:23]
dt a[110:111],v37,34816
buffer_load_dwordx4 v31, s[52:55], s71 offen offset:0 sc1 lds
mf v[92:95],a[76:79],a[0:3]
s_add_u32 m0, s67, 25472
dt a[124:125],v37,36864
mf v[92:95],a[92:95],a[16:19]
dt a[126:127],v37,38912
buffer_load_dwordx4 v31, s[52:55], s71 offen offset:128 sc1 lds
s_waitcnt vmcnt(14) lgkmcnt(8)
s_barrier
mf v[80:83],a[96:99],a[32:35]
dq a[0:3],v32,49152
v_readlane_b32 s69, v24, 39
mf v[80:83],a[112:115],a[48:51]
dq a[16:19],v32,57344
dq a[4:7],v32,50176
mf v[96:99],a[96:99],a[36:39]
dq a[20:23],v32,58368
v_readlane_b32 s70, v25, 39
mf v[96:99],a[112:115],a[52:55]
dt a[64:65],v34,49152
dt a[66:67],v34,51200
mf v[100:103],a[100:103],a[36:39]
s_add_u32 m0, s66, 131072
dt a[80:81],v34,53248
v_readlane_b32 s71, v26, 39
mf v[100:103],a[116:119],a[52:55]
dt a[82:83],v34,55296
buffer_load_dwordx4 v30, s[28:31], s69 offen offset:0 sc1 lds
mf v[84:87],a[100:103],a[32:35]
dt a[68:69],v35,49152
mf v[84:87],a[116:119],a[48:51]
s_waitcnt lgkmcnt(9)
dt a[70:71],v35,51200
buffer_load_dwordx4 v30, s[28:31], s69 offen offset:1024 sc1 lds
mf v[88:91],a[104:107],a[32:35]
s_add_u32 m0, s67, 81920
dt a[84:85],v35,53248
mf v[88:91],a[120:123],a[48:51]
dt a[86:87],v35,55296
dt a[72:73],v36,49152
buffer_load_dwordx4 v31, s[52:55], s70 offen offset:0 sc1 lds
mf v[104:107],a[104:107],a[36:39]
s_add_u32 m0, s67, 89984
dt a[74:75],v36,51200
mf v[104:107],a[120:123],a[52:55]
dt a[88:89],v36,53248
dt a[90:91],v36,55296
buffer_load_dwordx4 v31, s[52:55], s70 offen offset:128 sc1 lds
mf v[108:111],a[108:111],a[36:39]
s_add_u32 m0, s67, 82944
dt a[76:77],v37,49152
mf v[108:111],a[124:127],a[52:55]
dt a[78:79],v37,51200
buffer_load_dwordx4 v31, s[52:55], s71 offen offset:0 sc1 lds
mf v[92:95],a[108:111],a[32:35]
s_add_u32 m0, s67, 91008
dt a[92:93],v37,53248
mf v[92:95],a[124:127],a[48:51]
dt a[94:95],v37,55296
buffer_load_dwordx4 v31, s[52:55], s71 offen offset:128 sc1 lds
s_waitcnt vmcnt(12) lgkmcnt(8)
s_barrier
v_sub_u32_e64 v39, v39, v5
v_subrev_u32 v39, 1, v39
v_cmp_lt_u32 vcc, 2, v39
s_nop 0
s_cbranch_vccnz L_p_slow
L_p_back:
s_lshl_b32 s82, s12, 12
s_add_u32 s82, s82, 18874368
buffer_load_dwordx4 v[128:131], v3, s[28:31], s82 offen offset:0 sc1
buffer_load_dwordx4 v[132:135], v3, s[28:31], s82 offen offset:1024 sc1
buffer_load_dwordx4 v[136:139], v3, s[28:31], s82 offen offset:2048 sc1
buffer_load_dwordx4 v[140:143], v3, s[28:31], s82 offen offset:3072 sc1
mf v[80:83],a[64:67],a[0:3]
dq a[32:35],v32,0
v_readlane_b32 s69, v24, 40
mf v[80:83],a[80:83],a[16:19]
dq a[48:51],v32,8192
dq a[36:39],v32,1024
mf v[96:99],a[64:67],a[4:7]
dq a[52:55],v32,9216
v_readlane_b32 s70, v25, 40
mf v[96:99],a[80:83],a[20:23]
dt a[96:97],v34,0
dt a[98:99],v34,2048
mf v[100:103],a[68:71],a[4:7]
s_add_u32 m0, s66, 32768
dt a[112:113],v34,4096
v_readlane_b32 s71, v26, 40
mf v[100:103],a[84:87],a[20:23]
dt a[114:115],v34,6144
buffer_load_dwordx4 v30, s[28:31], s69 offen offset:0 sc1 lds
mf v[84:87],a[68:71],a[0:3]
dt a[100:101],v35,0
mf v[84:87],a[84:87],a[16:19]
s_waitcnt lgkmcnt(9)
dt a[102:103],v35,2048
buffer_load_dwordx4 v30, s[28:31], s69 offen offset:1024 sc1 lds
mf v[88:91],a[72:75],a[0:3]
s_add_u32 m0, s67, 32768
dt a[116:117],v35,4096
mf v[88:91],a[88:91],a[16:19]
dt a[118:119],v35,6144
dt a[104:105],v36,0
buffer_load_dwordx4 v31, s[52:55], s70 offen offset:0 sc1 lds
mf v[104:107],a[72:75],a[4:7]
s_add_u32 m0, s67, 40832
dt a[106:107],v36,2048
mf v[104:107],a[88:91],a[20:23]
dt a[120:121],v36,4096
dt a[122:123],v36,6144
buffer_load_dwordx4 v31, s[52:55], s70 offen offset:128 sc1 lds
mf v[108:111],a[76:79],a[4:7]
s_add_u32 m0, s67, 33792
dt a[108:109],v37,0
mf v[108:111],a[92:95],a[20:23]
dt a[110:111],v37,2048
buffer_load_dwordx4 v31, s[52:55], s71 offen offset:0 sc1 lds
mf v[92:95],a[76:79],a[0:3]
s_add_u32 m0, s67, 41856
dt a[124:125],v37,4096
mf v[92:95],a[92:95],a[16:19]
dt a[126:127],v37,6144
buffer_load_dwordx4 v31, s[52:55], s71 offen offset:128 sc1 lds
s_waitcnt vmcnt(16) lgkmcnt(8)
s_barrier
mf v[80:83],a[96:99],a[32:35]
dq a[0:3],v32,16384
v_readlane_b32 s69, v24, 41
mf v[80:83],a[112:115],a[48:51]
dq a[16:19],v32,24576
dq a[4:7],v32,17408
mf v[96:99],a[96:99],a[36:39]
dq a[20:23],v32,25600
v_readlane_b32 s70, v25, 41
mf v[96:99],a[112:115],a[52:55]
dt a[64:65],v34,16384
dt a[66:67],v34,18432
mf v[100:103],a[100:103],a[36:39]
s_add_u32 m0, s66, 49152
dt a[80:81],v34,20480
v_readlane_b32 s71, v26, 41
mf v[100:103],a[116:119],a[52:55]
dt a[82:83],v34,22528
buffer_load_dwordx4 v30, s[28:31], s69 offen offset:0 sc1 lds
mf v[84:87],a[100:103],a[32:35]
dt a[68:69],v35,16384
mf v[84:87],a[116:119],a[48:51]
s_waitcnt lgkmcnt(9)
dt a[70:71],v35,18432
buffer_load_dwordx4 v30, s[28:31], s69 offen offset:1024 sc1 lds
mf v[88:91],a[104:107],a[32:35]
s_add_u32 m0, s67, 49152
dt a[84:85],v35,20480
mf v[88:91],a[120:123],a[48:51]
dt a[86:87],v35,22528
dt a[72:73],v36,16384
buffer_load_dwordx4 v31, s[52:55], s70 offen offset:0 sc1 lds
mf v[104:107],a[104:107],a[36:39]
s_add_u32 m0, s67, 57216
dt a[74:75],v36,18432
mf v[104:107],a[120:123],a[52:55]
dt a[88:89],v36,20480
dt a[90:91],v36,22528
buffer_load_dwordx4 v31, s[52:55], s70 offen offset:128 sc1 lds
mf v[108:111],a[108:111],a[36:39]
s_add_u32 m0, s67, 50176
dt a[76:77],v37,16384
mf v[108:111],a[124:127],a[52:55]
dt a[78:79],v37,18432
buffer_load_dwordx4 v31, s[52:55], s71 offen offset:0 sc1 lds
mf v[92:95],a[108:111],a[32:35]
s_add_u32 m0, s67, 58240
dt a[92:93],v37,20480
mf v[92:95],a[124:127],a[48:51]
dt a[94:95],v37,22528
buffer_load_dwordx4 v31, s[52:55], s71 offen offset:128 sc1 lds
s_waitcnt vmcnt(12) lgkmcnt(8)
s_barrier
mf v[80:83],a[64:67],a[0:3]
dq a[32:35],v64,0
v_readlane_b32 s69, v24, 42
mf v[80:83],a[80:83],a[16:19]
dq a[48:51],v64,8192
dq a[36:39],v64,1024
mf v[96:99],a[64:67],a[4:7]
dq a[52:55],v64,9216
v_readlane_b32 s70, v25, 42
mf v[96:99],a[80:83],a[20:23]
dt a[96:97],v66,0
dt a[98:99],v66,2048
mf v[100:103],a[68:71],a[4:7]
s_add_u32 m0, s66, 0
dt a[112:113],v66,4096
v_readlane_b32 s71, v26, 42
mf v[100:103],a[84:87],a[20:23]
dt a[114:115],v66,6144
buffer_load_dwordx4 v30, s[28:31], s69 offen offset:0 sc1 lds
mf v[84:87],a[68:71],a[0:3]
dt a[100:101],v67,0
mf v[84:87],a[84:87],a[16:19]
s_waitcnt lgkmcnt(9)
dt a[102:103],v67,2048
buffer_load_dwordx4 v30, s[28:31], s69 offen offset:1024 sc1 lds
mf v[88:91],a[72:75],a[0:3]
dt a[116:117],v67,4096
mf v[88:91],a[88:91],a[16:19]
dt a[118:119],v67,6144
dt a[104:105],v68,0
mf v[104:107],a[72:75],a[4:7]
dt a[106:107],v68,2048
mf v[104:107],a[88:91],a[20:23]
dt a[120:121],v68,4096
dt a[122:123],v68,6144
mf v[108:111],a[76:79],a[4:7]
s_add_u32 m0, s67, 0
dt a[108:109],v69,0
mf v[108:111],a[92:95],a[20:23]
dt a[110:111],v69,2048
buffer_load_dwordx4 v31, s[52:55], s70 offen offset:0 sc1 lds
mf v[92:95],a[76:79],a[0:3]
s_add_u32 m0, s67, 8064
dt a[124:125],v69,4096
mf v[92:95],a[92:95],a[16:19]
dt a[126:127],v69,6144
buffer_load_dwordx4 v31, s[52:55], s70 offen offset:128 sc1 lds
v_lshlrev_b32 v224, 16, v128
v_and_b32 v225, 0xffff0000, v128
v_lshlrev_b32 v226, 16, v129
v_and_b32 v227, 0xffff0000, v129
v_lshlrev_b32 v228, 16, v130
v_and_b32 v229, 0xffff0000, v130
v_lshlrev_b32 v230, 16, v131
v_and_b32 v231, 0xffff0000, v131
v_lshlrev_b32 v232, 16, v132
v_and_b32 v233, 0xffff0000, v132
v_lshlrev_b32 v234, 16, v133
v_and_b32 v235, 0xffff0000, v133
v_lshlrev_b32 v236, 16, v134
s_add_u32 m0, s67, 1024
v_and_b32 v237, 0xffff0000, v134
buffer_load_dwordx4 v31, s[52:55], s71 offen offset:0 sc1 lds
v_lshlrev_b32_e64 v238, 16, v135
v_and_b32 v239, 0xffff0000, v135
v_pk_add_f32 v[160:161], v[160:161], v[224:225]
v_pk_add_f32 v[162:163], v[162:163], v[226:227]
v_pk_add_f32 v[164:165], v[164:165], v[228:229]
v_pk_add_f32 v[166:167], v[166:167], v[230:231]
v_pk_add_f32 v[168:169], v[168:169], v[232:233]
v_pk_add_f32 v[170:171], v[170:171], v[234:235]
v_pk_add_f32 v[172:173], v[172:173], v[236:237]
v_pk_add_f32 v[174:175], v[174:175], v[238:239]
v_pk_mul_f32 v[224:225], v[160:161], s[18:19]
v_pk_mul_f32 v[226:227], v[162:163], s[18:19]
v_pk_mul_f32 v[228:229], v[164:165], s[18:19]
v_pk_mul_f32 v[230:231], v[166:167], s[18:19]
s_add_u32 m0, s67, 9088
v_pk_mul_f32 v[232:233], v[168:169], s[18:19]
buffer_load_dwordx4 v31, s[52:55], s71 offen offset:128 sc1 lds
v_pk_mul_f32 v[234:235], v[170:171], s[18:19]
v_pk_mul_f32 v[236:237], v[172:173], s[18:19]
v_pk_mul_f32 v[238:239], v[174:175], s[18:19]
v_exp_f32 v224, v224
v_exp_f32 v225, v225
v_exp_f32 v226, v226
v_exp_f32 v227, v227
v_exp_f32 v228, v228
v_exp_f32 v229, v229
v_exp_f32 v230, v230
v_exp_f32 v231, v231
v_exp_f32 v232, v232
v_exp_f32 v233, v233
v_exp_f32 v234, v234
v_exp_f32 v235, v235
s_waitcnt vmcnt(12) lgkmcnt(8)
s_barrier
mf v[80:83],a[96:99],a[32:35]
dq a[0:3],v32,32768
v_readlane_b32 s69, v24, 43
mf v[80:83],a[112:115],a[48:51]
dq a[16:19],v32,40960
dq a[4:7],v32,33792
mf v[96:99],a[96:99],a[36:39]
dq a[20:23],v32,41984
v_readlane_b32 s70, v25, 43
mf v[96:99],a[112:115],a[52:55]
dt a[64:65],v34,32768
dt a[66:67],v34,34816
mf v[100:103],a[100:103],a[36:39]
s_add_u32 m0, s66, 16384
dt a[80:81],v34,36864
v_readlane_b32 s71, v26, 43
mf v[100:103],a[116:119],a[52:55]
dt a[82:83],v34,38912
buffer_load_dwordx4 v30, s[28:31], s69 offen offset:0 sc1 lds
mf v[84:87],a[100:103],a[32:35]
dt a[68:69],v35,32768
mf v[84:87],a[116:119],a[48:51]
s_waitcnt lgkmcnt(9)
dt a[70:71],v35,34816
buffer_load_dwordx4 v30, s[28:31], s69 offen offset:1024 sc1 lds
mf v[88:91],a[104:107],a[32:35]
dt a[84:85],v35,36864
mf v[88:91],a[120:123],a[48:51]
dt a[86:87],v35,38912
dt a[72:73],v36,32768
mf v[104:107],a[104:107],a[36:39]
dt a[74:75],v36,34816
mf v[104:107],a[120:123],a[52:55]
dt a[88:89],v36,36864
dt a[90:91],v36,38912
mf v[108:111],a[108:111],a[36:39]
s_add_u32 m0, s67, 16384
dt a[76:77],v37,32768
mf v[108:111],a[124:127],a[52:55]
dt a[78:79],v37,34816
buffer_load_dwordx4 v31, s[52:55], s70 offen offset:0 sc1 lds
mf v[92:95],a[108:111],a[32:35]
s_add_u32 m0, s67, 24448
dt a[92:93],v37,36864
mf v[92:95],a[124:127],a[48:51]
dt a[94:95],v37,38912
buffer_load_dwordx4 v31, s[52:55], s70 offen offset:128 sc1 lds
v_exp_f32 v236, v236
v_exp_f32 v237, v237
v_exp_f32 v238, v238
v_exp_f32_e64 v239, v239
v_pk_add_f32 v[224:225], v[224:225], 1.0 op_sel_hi:[1,0]
v_pk_add_f32 v[226:227], v[226:227], 1.0 op_sel_hi:[1,0]
v_pk_add_f32 v[228:229], v[228:229], 1.0 op_sel_hi:[1,0]
v_pk_add_f32 v[230:231], v[230:231], 1.0 op_sel_hi:[1,0]
v_pk_add_f32 v[232:233], v[232:233], 1.0 op_sel_hi:[1,0]
v_pk_add_f32 v[234:235], v[234:235], 1.0 op_sel_hi:[1,0]
v_pk_add_f32 v[236:237], v[236:237], 1.0 op_sel_hi:[1,0]
s_add_u32 m0, s67, 17408
v_pk_add_f32 v[238:239], v[238:239], 1.0 op_sel_hi:[1,0]
buffer_load_dwordx4 v31, s[52:55], s71 offen offset:0 sc1 lds
v_rcp_f32 v224, v224
v_rcp_f32 v225, v225
v_rcp_f32 v226, v226
v_rcp_f32 v227, v227
v_rcp_f32 v228, v228
v_rcp_f32 v229, v229
v_rcp_f32 v230, v230
v_rcp_f32 v231, v231
v_rcp_f32 v232, v232
v_rcp_f32 v233, v233
v_rcp_f32 v234, v234
s_add_u32 m0, s67, 25472
v_rcp_f32 v235, v235
buffer_load_dwordx4 v31, s[52:55], s71 offen offset:128 sc1 lds
v_rcp_f32 v236, v236
v_rcp_f32 v237, v237
v_rcp_f32 v238, v238
v_rcp_f32 v239, v239
v_pk_mul_f32 v[160:161], v[160:161], v[224:225]
v_pk_mul_f32 v[162:163], v[162:163], v[226:227]
v_pk_mul_f32 v[164:165], v[164:165], v[228:229]
v_pk_mul_f32 v[166:167], v[166:167], v[230:231]
v_pk_mul_f32 v[168:169], v[168:169], v[232:233]
v_pk_mul_f32 v[170:171], v[170:171], v[234:235]
v_pk_mul_f32 v[172:173], v[172:173], v[236:237]
v_pk_mul_f32 v[174:175], v[174:175], v[238:239]
s_waitcnt vmcnt(12) lgkmcnt(8)
s_barrier
mf v[80:83],a[64:67],a[0:3]
dq a[32:35],v32,49152
v_readlane_b32 s69, v24, 44
mf v[80:83],a[80:83],a[16:19]
dq a[48:51],v32,57344
dq a[36:39],v32,50176
mf v[96:99],a[64:67],a[4:7]
dq a[52:55],v32,58368
v_readlane_b32 s70, v25, 44
mf v[96:99],a[80:83],a[20:23]
dt a[96:97],v34,49152
dt a[98:99],v34,51200
mf v[100:103],a[68:71],a[4:7]
s_add_u32 m0, s66, 131072
dt a[112:113],v34,53248
v_readlane_b32 s71, v26, 44
mf v[100:103],a[84:87],a[20:23]
dt a[114:115],v34,55296
buffer_load_dwordx4 v30, s[28:31], s69 offen offset:0 sc1 lds
mf v[84:87],a[68:71],a[0:3]
dt a[100:101],v35,49152
mf v[84:87],a[84:87],a[16:19]
s_waitcnt lgkmcnt(9)
dt a[102:103],v35,51200
buffer_load_dwordx4 v30, s[28:31], s69 offen offset:1024 sc1 lds
L_stub27:
s_cbranch_execz L_iwret
mf v[88:91],a[72:75],a[0:3]
dt a[116:117],v35,53248
mf v[88:91],a[88:91],a[16:19]
dt a[118:119],v35,55296
dt a[104:105],v36,49152
mf v[104:107],a[72:75],a[4:7]
dt a[106:107],v36,51200
mf v[104:107],a[88:91],a[20:23]
dt a[120:121],v36,53248
dt a[122:123],v36,55296
mf v[108:111],a[76:79],a[4:7]
s_add_u32 m0, s67, 81920
dt a[108:109],v37,49152
mf v[108:111],a[92:95],a[20:23]
dt a[110:111],v37,51200
buffer_load_dwordx4 v31, s[52:55], s70 offen offset:0 sc1 lds
mf v[92:95],a[76:79],a[0:3]
s_add_u32 m0, s67, 89984
dt a[124:125],v37,53248
mf v[92:95],a[92:95],a[16:19]
dt a[126:127],v37,55296
buffer_load_dwordx4 v31, s[52:55], s70 offen offset:128 sc1 lds
v_lshlrev_b32 v224, 16, v136
v_and_b32 v225, 0xffff0000, v136
v_lshlrev_b32 v226, 16, v137
v_and_b32 v227, 0xffff0000, v137
v_lshlrev_b32 v228, 16, v138
v_and_b32 v229, 0xffff0000, v138
v_lshlrev_b32 v230, 16, v139
v_and_b32 v231, 0xffff0000, v139
v_lshlrev_b32 v232, 16, v140
v_and_b32 v233, 0xffff0000, v140
v_lshlrev_b32 v234, 16, v141
v_and_b32 v235, 0xffff0000, v141
v_lshlrev_b32_e64 v236, 16, v142
s_add_u32 m0, s67, 82944
v_and_b32 v237, 0xffff0000, v142
buffer_load_dwordx4 v31, s[52:55], s71 offen offset:0 sc1 lds
v_lshlrev_b32_e64 v238, 16, v143
v_and_b32 v239, 0xffff0000, v143
v_pk_add_f32 v[176:177], v[176:177], v[224:225]
v_pk_add_f32 v[178:179], v[178:179], v[226:227]
v_pk_add_f32 v[180:181], v[180:181], v[228:229]
v_pk_add_f32 v[182:183], v[182:183], v[230:231]
v_pk_add_f32 v[184:185], v[184:185], v[232:233]
v_pk_add_f32 v[186:187], v[186:187], v[234:235]
v_pk_add_f32 v[188:189], v[188:189], v[236:237]
v_pk_add_f32 v[190:191], v[190:191], v[238:239]
v_pk_mul_f32 v[224:225], v[176:177], s[18:19]
v_pk_mul_f32 v[226:227], v[178:179], s[18:19]
v_pk_mul_f32 v[228:229], v[180:181], s[18:19]
v_pk_mul_f32 v[230:231], v[182:183], s[18:19]
s_add_u32 m0, s67, 91008
v_pk_mul_f32 v[232:233], v[184:185], s[18:19]
buffer_load_dwordx4 v31, s[52:55], s71 offen offset:128 sc1 lds
v_pk_mul_f32 v[234:235], v[186:187], s[18:19]
v_pk_mul_f32 v[236:237], v[188:189], s[18:19]
v_pk_mul_f32 v[238:239], v[190:191], s[18:19]
v_exp_f32 v224, v224
v_exp_f32 v225, v225
v_exp_f32 v226, v226
v_exp_f32 v227, v227
v_exp_f32 v228, v228
v_exp_f32 v229, v229
v_exp_f32 v230, v230
v_exp_f32 v231, v231
v_exp_f32 v232, v232
v_exp_f32 v233, v233
v_exp_f32 v234, v234
v_exp_f32 v235, v235
s_waitcnt vmcnt(12) lgkmcnt(8)
s_barrier
mf v[80:83],a[96:99],a[32:35]
dq a[0:3],v32,0
v_readlane_b32 s69, v24, 45
mf v[80:83],a[112:115],a[48:51]
dq a[16:19],v32,8192
dq a[4:7],v32,1024
mf v[96:99],a[96:99],a[36:39]
dq a[20:23],v32,9216
v_readlane_b32 s70, v25, 45
mf v[96:99],a[112:115],a[52:55]
dt a[64:65],v34,0
dt a[66:67],v34,2048
mf v[100:103],a[100:103],a[36:39]
s_add_u32 m0, s66, 32768
dt a[80:81],v34,4096
v_readlane_b32 s71, v26, 45
mf v[100:103],a[116:119],a[52:55]
dt a[82:83],v34,6144
buffer_load_dwordx4 v30, s[28:31], s69 offen offset:0 sc1 lds
mf v[84:87],a[100:103],a[32:35]
dt a[68:69],v35,0
mf v[84:87],a[116:119],a[48:51]
s_waitcnt lgkmcnt(9)
dt a[70:71],v35,2048
buffer_load_dwordx4 v30, s[28:31], s69 offen offset:1024 sc1 lds
mf v[88:91],a[104:107],a[32:35]
dt a[84:85],v35,4096
mf v[88:91],a[120:123],a[48:51]
dt a[86:87],v35,6144
dt a[72:73],v36,0
mf v[104:107],a[104:107],a[36:39]
dt a[74:75],v36,2048
mf v[104:107],a[120:123],a[52:55]
dt a[88:89],v36,4096
dt a[90:91],v36,6144
mf v[108:111],a[108:111],a[36:39]
s_add_u32 m0, s67, 32768
dt a[76:77],v37,0
mf v[108:111],a[124:127],a[52:55]
dt a[78:79],v37,2048
buffer_load_dwordx4 v31, s[52:55], s70 offen offset:0 sc1 lds
mf v[92:95],a[108:111],a[32:35]
s_add_u32 m0, s67, 40832
dt a[92:93],v37,4096
mf v[92:95],a[124:127],a[48:51]
dt a[94:95],v37,6144
buffer_load_dwordx4 v31, s[52:55], s70 offen offset:128 sc1 lds
v_exp_f32 v236, v236
v_exp_f32 v237, v237
v_exp_f32 v238, v238
v_exp_f32_e64 v239, v239
v_pk_add_f32 v[224:225], v[224:225], 1.0 op_sel_hi:[1,0]
v_pk_add_f32 v[226:227], v[226:227], 1.0 op_sel_hi:[1,0]
v_pk_add_f32 v[228:229], v[228:229], 1.0 op_sel_hi:[1,0]
v_pk_add_f32 v[230:231], v[230:231], 1.0 op_sel_hi:[1,0]
v_pk_add_f32 v[232:233], v[232:233], 1.0 op_sel_hi:[1,0]
v_pk_add_f32 v[234:235], v[234:235], 1.0 op_sel_hi:[1,0]
v_pk_add_f32 v[236:237], v[236:237], 1.0 op_sel_hi:[1,0]
s_add_u32 m0, s67, 33792
v_pk_add_f32 v[238:239], v[238:239], 1.0 op_sel_hi:[1,0]
buffer_load_dwordx4 v31, s[52:55], s71 offen offset:0 sc1 lds
v_rcp_f32 v224, v224
v_rcp_f32 v225, v225
v_rcp_f32 v226, v226
v_rcp_f32 v227, v227
v_rcp_f32 v228, v228
v_rcp_f32 v229, v229
v_rcp_f32 v230, v230
v_rcp_f32 v231, v231
v_rcp_f32 v232, v232
v_rcp_f32 v233, v233
v_rcp_f32 v234, v234
s_add_u32 m0, s67, 41856
v_rcp_f32 v235, v235
buffer_load_dwordx4 v31, s[52:55], s71 offen offset:128 sc1 lds
v_rcp_f32 v236, v236
v_rcp_f32 v237, v237
v_rcp_f32 v238, v238
v_rcp_f32 v239, v239
v_pk_mul_f32 v[176:177], v[176:177], v[224:225]
v_pk_mul_f32 v[178:179], v[178:179], v[226:227]
v_pk_mul_f32 v[180:181], v[180:181], v[228:229]
v_pk_mul_f32 v[182:183], v[182:183], v[230:231]
v_pk_mul_f32 v[184:185], v[184:185], v[232:233]
v_pk_mul_f32 v[186:187], v[186:187], v[234:235]
v_pk_mul_f32 v[188:189], v[188:189], v[236:237]
v_pk_mul_f32 v[190:191], v[190:191], v[238:239]
s_waitcnt vmcnt(12) lgkmcnt(8)
s_barrier
mf v[80:83],a[64:67],a[0:3]
dq a[32:35],v32,16384
mf v[80:83],a[80:83],a[16:19]
dq a[48:51],v32,24576
dq a[36:39],v32,17408
mf v[96:99],a[64:67],a[4:7]
dq a[52:55],v32,25600
mf v[96:99],a[80:83],a[20:23]
dt a[96:97],v34,16384
dt a[98:99],v34,18432
mf v[100:103],a[68:71],a[4:7]
dt a[112:113],v34,20480
mf v[100:103],a[84:87],a[20:23]
dt a[114:115],v34,22528
mf v[84:87],a[68:71],a[0:3]
dt a[100:101],v35,16384
mf v[84:87],a[84:87],a[16:19]
s_waitcnt lgkmcnt(9)
dt a[102:103],v35,18432
mf v[88:91],a[72:75],a[0:3]
dt a[116:117],v35,20480
mf v[88:91],a[88:91],a[16:19]
dt a[118:119],v35,22528
dt a[104:105],v36,16384
mf v[104:107],a[72:75],a[4:7]
dt a[106:107],v36,18432
mf v[104:107],a[88:91],a[20:23]
dt a[120:121],v36,20480
dt a[122:123],v36,22528
mf v[108:111],a[76:79],a[4:7]
dt a[108:109],v37,16384
mf v[108:111],a[92:95],a[20:23]
dt a[110:111],v37,18432
mf v[92:95],a[76:79],a[0:3]
dt a[124:125],v37,20480
mf v[92:95],a[92:95],a[16:19]
dt a[126:127],v37,22528
s_waitcnt vmcnt(6) lgkmcnt(8)
s_barrier
mf v[80:83],a[96:99],a[32:35]
dq a[0:3],v64,0
mf v[80:83],a[112:115],a[48:51]
dq a[16:19],v64,8192
dq a[4:7],v64,1024
mf v[96:99],a[96:99],a[36:39]
dq a[20:23],v64,9216
mf v[96:99],a[112:115],a[52:55]
dt a[64:65],v66,0
dt a[66:67],v66,2048
mf v[100:103],a[100:103],a[36:39]
dt a[80:81],v66,4096
mf v[100:103],a[116:119],a[52:55]
dt a[82:83],v66,6144
mf v[84:87],a[100:103],a[32:35]
dt a[68:69],v67,0
mf v[84:87],a[116:119],a[48:51]
s_waitcnt lgkmcnt(9)
dt a[70:71],v67,2048
mf v[88:91],a[104:107],a[32:35]
dt a[84:85],v67,4096
mf v[88:91],a[120:123],a[48:51]
dt a[86:87],v67,6144
dt a[72:73],v68,0
mf v[104:107],a[104:107],a[36:39]
dt a[74:75],v68,2048
mf v[104:107],a[120:123],a[52:55]
dt a[88:89],v68,4096
dt a[90:91],v68,6144
mf v[108:111],a[108:111],a[36:39]
dt a[76:77],v69,0
mf v[108:111],a[124:127],a[52:55]
dt a[78:79],v69,2048
mf v[92:95],a[108:111],a[32:35]
dt a[92:93],v69,4096
mf v[92:95],a[124:127],a[48:51]
dt a[94:95],v69,6144
s_waitcnt vmcnt(0) lgkmcnt(8)
s_barrier
mf v[80:83],a[64:67],a[0:3]
dq a[32:35],v32,32768
dq a[48:51],v32,40960
mf v[80:83],a[80:83],a[16:19]
dq a[36:39],v32,33792
dq a[52:55],v32,41984
mf v[96:99],a[64:67],a[4:7]
dt a[96:97],v34,32768
dt a[98:99],v34,34816
mf v[96:99],a[80:83],a[20:23]
dt a[112:113],v34,36864
dt a[114:115],v34,38912
mf v[100:103],a[68:71],a[4:7]
dt a[100:101],v35,32768
dt a[102:103],v35,34816
mf v[100:103],a[84:87],a[20:23]
dt a[116:117],v35,36864
dt a[118:119],v35,38912
mf v[84:87],a[68:71],a[0:3]
dt a[104:105],v36,32768
dt a[106:107],v36,34816
mf v[84:87],a[84:87],a[16:19]
s_waitcnt lgkmcnt(14)
dt a[120:121],v36,36864
dt a[122:123],v36,38912
mf v[88:91],a[72:75],a[0:3]
dt a[108:109],v37,32768
dt a[110:111],v37,34816
mf v[88:91],a[88:91],a[16:19]
dt a[124:125],v37,36864
dt a[126:127],v37,38912
mf v[104:107],a[72:75],a[4:7]
mf v[104:107],a[88:91],a[20:23]
mf v[108:111],a[76:79],a[4:7]
mf v[108:111],a[92:95],a[20:23]
mf v[92:95],a[76:79],a[0:3]
mf v[92:95],a[92:95],a[16:19]
s_waitcnt lgkmcnt(8)
mf v[80:83],a[96:99],a[32:35]
mf v[80:83],a[112:115],a[48:51]
mf v[96:99],a[96:99],a[36:39]
mf v[96:99],a[112:115],a[52:55]
mf v[100:103],a[100:103],a[36:39]
mf v[100:103],a[116:119],a[52:55]
mf v[84:87],a[100:103],a[32:35]
mf v[84:87],a[116:119],a[48:51]
s_waitcnt lgkmcnt(0)
mf v[88:91],a[104:107],a[32:35]
mf v[88:91],a[120:123],a[48:51]
mf v[104:107],a[104:107],a[36:39]
mf v[104:107],a[120:123],a[52:55]
mf v[108:111],a[108:111],a[36:39]
mf v[108:111],a[124:127],a[52:55]
mf v[92:95],a[108:111],a[32:35]
mf v[92:95],a[124:127],a[48:51]
s_nop 4
v_pk_fma_f32 v[160:161], v[160:161], v[80:81], v[192:193]
v_pk_fma_f32 v[162:163], v[162:163], v[82:83], v[194:195]
v_pk_fma_f32 v[164:165], v[164:165], v[84:85], v[196:197]
v_pk_fma_f32 v[166:167], v[166:167], v[86:87], v[198:199]
v_pk_fma_f32 v[168:169], v[168:169], v[88:89], v[200:201]
v_pk_fma_f32 v[170:171], v[170:171], v[90:91], v[202:203]
v_pk_fma_f32 v[172:173], v[172:173], v[92:93], v[204:205]
v_pk_fma_f32 v[174:175], v[174:175], v[94:95], v[206:207]
v_cvt_pk_bf16_f32 v224, v160, v161
v_cvt_pk_bf16_f32 v225, v162, v163
v_cvt_pk_bf16_f32 v226, v164, v165
v_cvt_pk_bf16_f32 v227, v166, v167
v_cvt_pk_bf16_f32 v228, v168, v169
v_cvt_pk_bf16_f32 v229, v170, v171
v_cvt_pk_bf16_f32 v230, v172, v173
v_cvt_pk_bf16_f32 v231, v174, v175
ds_write_b64 v45, v[224:225] offset:0
ds_write_b64 v45, v[226:227] offset:32
ds_write_b64 v45, v[228:229] offset:64
ds_write_b64 v45, v[230:231] offset:96
dq v[240:243],v46,0
dq v[244:247],v46,1152
v_pk_fma_f32 v[176:177], v[176:177], v[96:97], v[208:209]
v_pk_fma_f32 v[178:179], v[178:179], v[98:99], v[210:211]
v_pk_fma_f32 v[180:181], v[180:181], v[100:101], v[212:213]
v_pk_fma_f32 v[182:183], v[182:183], v[102:103], v[214:215]
v_pk_fma_f32 v[184:185], v[184:185], v[104:105], v[216:217]
v_pk_fma_f32 v[186:187], v[186:187], v[106:107], v[218:219]
v_pk_fma_f32 v[188:189], v[188:189], v[108:109], v[220:221]
v_pk_fma_f32 v[190:191], v[190:191], v[110:111], v[222:223]
v_cvt_pk_bf16_f32 v232, v176, v177
v_cvt_pk_bf16_f32 v233, v178, v179
v_cvt_pk_bf16_f32 v234, v180, v181
v_cvt_pk_bf16_f32 v235, v182, v183
v_cvt_pk_bf16_f32 v236, v184, v185
v_cvt_pk_bf16_f32 v237, v186, v187
v_cvt_pk_bf16_f32 v238, v188, v189
v_cvt_pk_bf16_f32 v239, v190, v191
ds_write_b64 v45, v[232:233] offset:2304
ds_write_b64 v45, v[234:235] offset:2336
ds_write_b64 v45, v[236:237] offset:2368
ds_write_b64 v45, v[238:239] offset:2400
dq v[248:251],v46,2304
dq v[252:255],v46,3456
s_mov_b32 s3, 0
s_waitcnt lgkmcnt(6)
buffer_store_dwordx4 v[240:243], v38, s[60:63], s3 offen sc1
s_mov_b32 s3, 16384
s_waitcnt lgkmcnt(6)
buffer_store_dwordx4 v[244:247], v38, s[60:63], s3 offen sc1
s_mov_b32 s3, 32768
s_waitcnt lgkmcnt(1)
buffer_store_dwordx4 v[248:251], v38, s[60:63], s3 offen sc1
s_mov_b32 s3, 49152
s_waitcnt lgkmcnt(0)
buffer_store_dwordx4 v[252:255], v38, s[60:63], s3 offen sc1
L_end:
s_endpgm
L_tagQ_slow:
s_mov_b32 s3, 0
L_tagQ:
buffer_load_dword v5, v4, s[96:99], 0 offen sc1
s_waitcnt vmcnt(0)
v_cmp_eq_u32 vcc, 0, v5
s_add_u32 s3, s3, 1
s_cbranch_vccz L_tagQ_ok
s_sleep 1
s_cmp_lt_u32 s3, 262144
s_cbranch_scc1 L_tagQ
L_tagQ_ok:
s_branch L_tagQ_back
L_eQ_slow:
s_mov_b32 s3, 0
L_eQ:
buffer_load_dword v42, v41, s[28:31], 0 offen sc1
s_waitcnt vmcnt(0)
v_sub_u32 v42, v42, v5
v_subrev_u32 v42, 1, v42
v_cmp_lt_u32 vcc, 2, v42
s_add_u32 s3, s3, 1
s_cbranch_vccz L_eQ_ok
s_sleep 1
s_cmp_lt_u32 s3, 262144
s_cbranch_scc1 L_eQ
L_eQ_ok:
s_branch L_eQ_back
L_lateQ:
v_sub_u32 v39, v39, v5
v_subrev_u32 v39, 1, v39
v_cmp_lt_u32 vcc, 2, v39
s_nop 0
s_cbranch_vccz L_aQ_ok
s_mov_b32 s3, 0
L_aQ:
buffer_load_dword v39, v27, s[28:31], 0 offen sc1
s_waitcnt vmcnt(0)
v_sub_u32 v39, v39, v5
v_subrev_u32 v39, 1, v39
v_cmp_lt_u32 vcc, 2, v39
s_add_u32 s3, s3, 1
s_cbranch_vccz L_aQ_ok
s_sleep 1
s_cmp_lt_u32 s3, 262144
s_cbranch_scc1 L_aQ
L_aQ_ok:
v_readlane_b32 s69, v24, 0
s_nop 2
s_add_u32 m0, s65, 0
s_nop 0
s_nop 0
buffer_load_dwordx4 v29, s[28:31], s69 offen offset:0 sc1 lds
buffer_load_dwordx4 v29, s[28:31], s69 offen offset:1024 sc1 lds
buffer_load_dwordx4 v29, s[28:31], s69 offen offset:2048 sc1 lds
buffer_load_dwordx4 v29, s[28:31], s69 offen offset:3072 sc1 lds
v_readlane_b32 s69, v24, 1
s_nop 2
s_add_u32 m0, s65, 16384
s_nop 0
buffer_load_dwordx4 v29, s[28:31], s69 offen offset:0 sc1 lds
buffer_load_dwordx4 v29, s[28:31], s69 offen offset:1024 sc1 lds
buffer_load_dwordx4 v29, s[28:31], s69 offen offset:2048 sc1 lds
buffer_load_dwordx4 v29, s[28:31], s69 offen offset:3072 sc1 lds
s_waitcnt vmcnt(4)
s_branch L_lateQ_ret
L_kvflag:
L_stub28:
s_cbranch_execz L_iwret
s_lshl_b32 s82, s27, 8
s_lshl_b32 s83, s24, 5
s_add_u32 s82, s82, s83
s_lshl_b32 s83, s21, 4
s_add_u32 s82, s82, s83
s_add_u32 s82, s82, 23650304
v_add_u32 v6, 1, v5
s_mov_b64 exec, 1
buffer_store_dword v6, v4, s[28:31], s82 offen sc1
s_mov_b64 exec, -1
s_branch L_kvflag_ret
L_kvload:
s_lshl_b32 s82, s27, 8
s_add_u32 s82, s82, 23650304
v_lshrrev_b32 v41, 2, v2
v_lshl_add_u32 v41, v41, 4, s82
buffer_load_dword v46, v41, s[28:31], 0 offen sc1
s_branch L_kvload_ret
L_kvfetch:
s_mul_i32 s10, s27, 6144
s_add_u32 s10, s10, 23068672
s_add_u32 s11, s10, 4096
v_and_b32 v7, 48, v2
v_sub_u32 v46, v46, v5
v_subrev_u32 v46, 1, v46
v_cmp_lt_u32 vcc, 2, v46
s_nop 0
s_cbranch_vccz L_k_ok
s_mov_b32 s3, 0
L_k:
buffer_load_dword v46, v41, s[28:31], 0 offen sc1
s_waitcnt vmcnt(0)
v_sub_u32 v46, v46, v5
v_subrev_u32 v46, 1, v46
v_cmp_lt_u32 vcc, 2, v46
s_add_u32 s3, s3, 1
s_cbranch_vccz L_k_ok
s_sleep 1
s_cmp_lt_u32 s3, 262144
s_cbranch_scc1 L_k
L_k_ok:
buffer_load_dwordx4 v[128:131], v3, s[28:31], s10 offen offset:0 sc1
buffer_load_dwordx4 v[132:135], v3, s[28:31], s10 offen offset:1024 sc1
buffer_load_dwordx4 v[136:139], v3, s[28:31], s10 offen offset:2048 sc1
buffer_load_dwordx4 v[140:143], v3, s[28:31], s10 offen offset:3072 sc1
buffer_load_dwordx4 v[144:147], v7, s[28:31], s11 offen offset:0 sc1
buffer_load_dwordx4 v[148:151], v7, s[28:31], s11 offen offset:64 sc1
s_branch L_kvfetch_ret
L_ocomp:
L_stub29:
s_cbranch_execz L_iwret
s_lshl_b32 s10, s27, 13
s_add_u32 s10, s10, s78
s_sub_u32 s10, s10, 262144
s_add_u32 s11, s10, 4096
v_cvt_pk_bf16_f32 v8, v128, v129
v_cvt_pk_bf16_f32 v9, v130, v131
v_cvt_pk_bf16_f32 v10, v136, v137
v_cvt_pk_bf16_f32 v11, v138, v139
v_cvt_pk_bf16_f32 v12, v132, v133
v_cvt_pk_bf16_f32 v13, v134, v135
v_cvt_pk_bf16_f32 v14, v140, v141
v_cvt_pk_bf16_f32 v15, v142, v143
v_cvt_pk_bf16_f32 v16, v144, v145
v_cvt_pk_bf16_f32 v17, v146, v147
v_cvt_pk_bf16_f32 v18, v148, v149
v_cvt_pk_bf16_f32 v19, v150, v151
s_nop 1
v_mfma_f32_16x16x32_bf16 v[192:195], v[16:19], v[80:83], 0
v_mfma_f32_16x16x32_bf16 v[196:199], v[16:19], v[84:87], 0
v_mfma_f32_16x16x32_bf16 v[200:203], v[16:19], v[88:91], 0
v_mfma_f32_16x16x32_bf16 v[204:207], v[16:19], v[92:95], 0
v_mfma_f32_16x16x32_bf16 v[240:243], v[16:19], v[96:99], 0
v_mfma_f32_16x16x32_bf16 v[244:247], v[16:19], v[100:103], 0
v_mfma_f32_16x16x32_bf16 v[248:251], v[16:19], v[104:107], 0
v_mfma_f32_16x16x32_bf16 v[252:255], v[16:19], v[108:111], 0
v_mfma_f32_16x16x32_bf16 v[112:115], v[8:11], v[80:83], 0
v_add_f32 v192, v40, v192
v_mfma_f32_16x16x32_bf16 v[116:119], v[12:15], v[80:83], 0
v_rcp_f32 v192, v192
v_mfma_f32_16x16x32_bf16 v[120:123], v[8:11], v[84:87], 0
v_add_f32 v196, v40, v196
v_mfma_f32_16x16x32_bf16 v[124:127], v[12:15], v[84:87], 0
v_rcp_f32 v196, v196
v_mfma_f32_16x16x32_bf16 v[128:131], v[8:11], v[88:91], 0
v_add_f32 v200, v40, v200
v_mfma_f32_16x16x32_bf16 v[132:135], v[12:15], v[88:91], 0
v_rcp_f32 v200, v200
v_mfma_f32_16x16x32_bf16 v[136:139], v[8:11], v[92:95], 0
v_add_f32 v204, v40, v204
v_mfma_f32_16x16x32_bf16 v[140:143], v[12:15], v[92:95], 0
v_rcp_f32 v204, v204
v_mfma_f32_16x16x32_bf16 v[144:147], v[8:11], v[96:99], 0
v_add_f32 v240, v40, v240
v_mfma_f32_16x16x32_bf16 v[148:151], v[12:15], v[96:99], 0
v_rcp_f32 v240, v240
v_mfma_f32_16x16x32_bf16 v[152:155], v[8:11], v[100:103], 0
v_add_f32 v244, v40, v244
v_mfma_f32_16x16x32_bf16 v[156:159], v[12:15], v[100:103], 0
v_rcp_f32_e64 v244, v244
v_pk_mul_f32 v[112:113], v[112:113], v[192:193] op_sel_hi:[1,0]
v_pk_mul_f32 v[114:115], v[114:115], v[192:193] op_sel_hi:[1,0]
v_pk_mul_f32 v[116:117], v[116:117], v[192:193] op_sel_hi:[1,0]
v_pk_mul_f32 v[118:119], v[118:119], v[192:193] op_sel_hi:[1,0]
v_cvt_pk_bf16_f32 v192, v112, v113
v_cvt_pk_bf16_f32 v193, v114, v115
v_cvt_pk_bf16_f32 v194, v116, v117
v_cvt_pk_bf16_f32 v195, v118, v119
buffer_store_dwordx4 v[192:195], v3, s[28:31], s10 offen offset:0 sc1
v_pk_mul_f32 v[120:121], v[120:121], v[196:197] op_sel_hi:[1,0]
v_pk_mul_f32 v[122:123], v[122:123], v[196:197] op_sel_hi:[1,0]
v_pk_mul_f32 v[124:125], v[124:125], v[196:197] op_sel_hi:[1,0]
v_pk_mul_f32 v[126:127], v[126:127], v[196:197] op_sel_hi:[1,0]
v_cvt_pk_bf16_f32 v196, v120, v121
v_cvt_pk_bf16_f32 v197, v122, v123
v_cvt_pk_bf16_f32 v198, v124, v125
v_cvt_pk_bf16_f32 v199, v126, v127
buffer_store_dwordx4 v[196:199], v3, s[28:31], s10 offen offset:1024 sc1
v_mfma_f32_16x16x32_bf16 v[112:115], v[8:11], v[104:107], 0
v_add_f32 v248, v40, v248
v_mfma_f32_16x16x32_bf16 v[116:119], v[12:15], v[104:107], 0
v_rcp_f32 v248, v248
v_mfma_f32_16x16x32_bf16 v[120:123], v[8:11], v[108:111], 0
v_add_f32 v252, v40, v252
v_mfma_f32_16x16x32_bf16 v[124:127], v[12:15], v[108:111], 0
v_rcp_f32 v252, v252
v_pk_mul_f32 v[128:129], v[128:129], v[200:201] op_sel_hi:[1,0]
v_pk_mul_f32 v[130:131], v[130:131], v[200:201] op_sel_hi:[1,0]
v_pk_mul_f32 v[132:133], v[132:133], v[200:201] op_sel_hi:[1,0]
v_pk_mul_f32 v[134:135], v[134:135], v[200:201] op_sel_hi:[1,0]
v_cvt_pk_bf16_f32 v200, v128, v129
v_cvt_pk_bf16_f32 v201, v130, v131
v_cvt_pk_bf16_f32 v202, v132, v133
v_cvt_pk_bf16_f32 v203, v134, v135
buffer_store_dwordx4 v[200:203], v3, s[28:31], s10 offen offset:2048 sc1
v_pk_mul_f32 v[136:137], v[136:137], v[204:205] op_sel_hi:[1,0]
v_pk_mul_f32 v[138:139], v[138:139], v[204:205] op_sel_hi:[1,0]
v_pk_mul_f32 v[140:141], v[140:141], v[204:205] op_sel_hi:[1,0]
v_pk_mul_f32 v[142:143], v[142:143], v[204:205] op_sel_hi:[1,0]
v_cvt_pk_bf16_f32 v204, v136, v137
v_cvt_pk_bf16_f32 v205, v138, v139
v_cvt_pk_bf16_f32 v206, v140, v141
v_cvt_pk_bf16_f32 v207, v142, v143
buffer_store_dwordx4 v[204:207], v3, s[28:31], s10 offen offset:3072 sc1
v_pk_mul_f32 v[144:145], v[144:145], v[240:241] op_sel_hi:[1,0]
v_pk_mul_f32 v[146:147], v[146:147], v[240:241] op_sel_hi:[1,0]
v_pk_mul_f32 v[148:149], v[148:149], v[240:241] op_sel_hi:[1,0]
v_pk_mul_f32 v[150:151], v[150:151], v[240:241] op_sel_hi:[1,0]
v_cvt_pk_bf16_f32 v240, v144, v145
v_cvt_pk_bf16_f32 v241, v146, v147
v_cvt_pk_bf16_f32 v242, v148, v149
v_cvt_pk_bf16_f32 v243, v150, v151
buffer_store_dwordx4 v[240:243], v3, s[28:31], s11 offen offset:0 sc1
v_pk_mul_f32 v[152:153], v[152:153], v[244:245] op_sel_hi:[1,0]
v_pk_mul_f32 v[154:155], v[154:155], v[244:245] op_sel_hi:[1,0]
v_pk_mul_f32 v[156:157], v[156:157], v[244:245] op_sel_hi:[1,0]
v_pk_mul_f32 v[158:159], v[158:159], v[244:245] op_sel_hi:[1,0]
v_cvt_pk_bf16_f32 v244, v152, v153
v_cvt_pk_bf16_f32 v245, v154, v155
v_cvt_pk_bf16_f32 v246, v156, v157
v_cvt_pk_bf16_f32 v247, v158, v159
buffer_store_dwordx4 v[244:247], v3, s[28:31], s11 offen offset:1024 sc1
v_pk_mul_f32 v[112:113], v[112:113], v[248:249] op_sel_hi:[1,0]
v_pk_mul_f32 v[114:115], v[114:115], v[248:249] op_sel_hi:[1,0]
v_pk_mul_f32 v[116:117], v[116:117], v[248:249] op_sel_hi:[1,0]
v_pk_mul_f32 v[118:119], v[118:119], v[248:249] op_sel_hi:[1,0]
v_cvt_pk_bf16_f32 v248, v112, v113
v_cvt_pk_bf16_f32 v249, v114, v115
v_cvt_pk_bf16_f32 v250, v116, v117
v_cvt_pk_bf16_f32 v251, v118, v119
buffer_store_dwordx4 v[248:251], v3, s[28:31], s11 offen offset:2048 sc1
v_pk_mul_f32 v[120:121], v[120:121], v[252:253] op_sel_hi:[1,0]
v_pk_mul_f32 v[122:123], v[122:123], v[252:253] op_sel_hi:[1,0]
v_pk_mul_f32 v[124:125], v[124:125], v[252:253] op_sel_hi:[1,0]
v_pk_mul_f32 v[126:127], v[126:127], v[252:253] op_sel_hi:[1,0]
v_cvt_pk_bf16_f32 v252, v120, v121
v_cvt_pk_bf16_f32 v253, v122, v123
v_cvt_pk_bf16_f32 v254, v124, v125
v_cvt_pk_bf16_f32 v255, v126, v127
buffer_store_dwordx4 v[252:255], v3, s[28:31], s11 offen offset:3072 sc1
s_branch L_ocomp_ret
L_b_slow:
s_mov_b32 s3, 0
L_b:
buffer_load_dword v39, v28, s[28:31], 0 offen sc1
s_waitcnt vmcnt(0)
v_sub_u32 v39, v39, v5
v_subrev_u32 v39, 2, v39
v_cmp_lt_u32 vcc, 1, v39
s_add_u32 s3, s3, 1
s_cbranch_vccz L_b_ok
s_sleep 1
s_cmp_lt_u32 s3, 262144
s_cbranch_scc1 L_b
L_b_ok:
s_branch L_b_back
L_oflag:
v_add_u32 v6, 3, v5
s_mov_b64 exec, 1
buffer_store_dword v6, v4, s[28:31], s79 offen sc1
s_mov_b64 exec, -1
s_branch L_oflag_ret
L_s_slow:
s_mov_b32 s3, 0
L_s:
buffer_load_dword v39, v28, s[28:31], 0 offen sc1
s_waitcnt vmcnt(0)
v_sub_u32 v39, v39, v5
v_subrev_u32 v39, 3, v39
v_cmp_lt_u32 vcc, 0, v39
s_add_u32 s3, s3, 1
s_cbranch_vccz L_s_ok
s_sleep 1
s_cmp_lt_u32 s3, 262144
s_cbranch_scc1 L_s
L_s_ok:
s_branch L_s_back
L_p_slow:
s_mov_b32 s3, 0
L_p:
buffer_load_dword v39, v4, s[28:31], s13 offen sc1
s_waitcnt vmcnt(0)
v_sub_u32 v39, v39, v5
v_subrev_u32 v39, 1, v39
v_cmp_lt_u32 vcc, 2, v39
s_add_u32 s3, s3, 1
s_cbranch_vccz L_p_ok
s_sleep 1
s_cmp_lt_u32 s3, 262144
s_cbranch_scc1 L_p
L_p_ok:
s_branch L_p_back
L_pcref:
s_endpgm
.section .rodata,"a"
.p2align 6
.amdhsa_kernel recurrent_scan__linear_attn_block__geglu_ffn__prompt_kernel
  .amdhsa_next_free_vgpr 512
  .amdhsa_next_free_sgpr 102
  .amdhsa_accum_offset 256
  .amdhsa_group_segment_fixed_size 0
  .amdhsa_kernarg_size 80
  .amdhsa_user_sgpr_count 2
  .amdhsa_user_sgpr_kernarg_segment_ptr 1
  .amdhsa_system_sgpr_workgroup_id_x 1
  .amdhsa_float_denorm_mode_32 3
.end_amdhsa_kernel
```
